```python
import torch

def _softmax(x, axis=-1):
    return torch.softmax(x, dim=axis)
def _gelu(x):
    return torch.nn.functional.gelu(x, approximate="tanh")
def _silu(x):
    return torch.nn.functional.silu(x)
def _sigmoid(x):
    return torch.sigmoid(x)
def _layernorm(x, axis=-1, eps=1e-5):
    m = x.mean(dim=axis, keepdim=True)
    v = x.var(dim=axis, keepdim=True, unbiased=False)
    return (x - m) / torch.sqrt(v + eps)
def _scatter_add(tgt, idx, src, axis=0):
    return tgt.clone().index_add_(axis, idx, src)
def _segment_sum(src, seg, n):
    out = torch.zeros((n,) + src.shape[1:], dtype=src.dtype)
    return out.index_add_(0, seg, src)
def _pad(x, pw):
    flat = tuple(v for pair in reversed(pw) for v in pair)
    return torch.nn.functional.pad(x, flat)

kernel_name = 'recurrent_scan__sliding_block_cached__glu_gated_bilinear__prompt'

def setup_inputs():

    _w = (lambda a: (lambda t: t.to(torch.bfloat16) if t.is_floating_point() else t)(torch.as_tensor(a)))
    def _A_setup():
        B, Sq, D = 1, 2048, 640
        Hq, Hkv, Sk, Dh = 32, 32, 2048, 192
        assert Hq % Hkv == 0, (Hq, Hkv)
        return {
            "x": _w((lambda *s: torch.randn(*s, dtype=torch.bfloat16) * 0.05)(B, Sq, D)),
            "k_cache": _w((lambda *s: torch.randn(*s, dtype=torch.bfloat16) * 1.6)(B, Hkv, Sk, Dh)),
            "v_cache": _w((lambda *s: torch.randn(*s, dtype=torch.bfloat16) * 1.6)(B, Hkv, Sk, Dh)),
            "wq": _w((lambda *s: torch.randn(*s, dtype=torch.bfloat16) * 1.6)(D, Hq * Dh) * (D ** -0.5)),
            "wo": _w((lambda *s: torch.randn(*s, dtype=torch.bfloat16) * 1.6)(Hq * Dh, D) * ((Hq * Dh) ** -0.5)),
        }
    _A_in = _A_setup()

    def _B_setup():
        B, S, D, F = 1, 2048, 640, 1536
        return {
            "x": _w((lambda *s: torch.randn(*s, dtype=torch.bfloat16) * 0.05)(B, S, D)),
            "w_gate": _w((lambda *s: torch.randn(*s, dtype=torch.bfloat16) * 0.2)(D, F) * (D ** -0.5)),
            "w_up": _w((lambda *s: torch.randn(*s, dtype=torch.bfloat16) * 0.2)(D, F) * (D ** -0.5)),
            "w_down": _w((lambda *s: torch.randn(*s, dtype=torch.bfloat16) * 0.2)(F, D) * (F ** -0.5)),
        }
    _B_in = _B_setup()

    return {
        "A_x": _A_in["x"],
        "A_k_cache": _A_in["k_cache"],
        "A_v_cache": _A_in["v_cache"],
        "A_wq": _A_in["wq"],
        "A_wo": _A_in["wo"],
        "B_x": _B_in["x"],
        "B_w_gate": _B_in["w_gate"],
        "B_w_up": _B_in["w_up"],
        "B_w_down": _B_in["w_down"],
    }

def reference(A_x, A_k_cache, A_v_cache, A_wq, A_wo, B_x, B_w_gate, B_w_up, B_w_down):
    def _A_ref(x, k_cache, v_cache, wq, wo):
        B, Sq, D = x.shape
        Hq, Dh = 32, 192
        Hkv, Sk = k_cache.shape[1], k_cache.shape[2]
        W = min(4096, max(256, Sk // 4))
        rep = Hq // Hkv
        q = (lambda x, *d: x.permute(*d))((x @ wq).reshape(B, Sq, Hq, Dh), 0, 2, 1, 3)
        k = (lambda x, n, axis: torch.repeat_interleave(x, n, dim=axis))(k_cache[:, :, Sk - W:, :], rep, axis=1)
        v = (lambda x, n, axis: torch.repeat_interleave(x, n, dim=axis))(v_cache[:, :, Sk - W:, :], rep, axis=1)
        scores = torch.einsum("bhqd,bhkd->bhqk", q, k) * (Dh ** -0.5)
        p = _softmax(scores, axis=-1)
        o = torch.einsum("bhqk,bhkd->bhqd", p, v)
        return (lambda x, *d: x.permute(*d))(o, 0, 2, 1, 3).reshape(B, Sq, Hq * Dh) @ wo

    def _B_ref(x, w_gate, w_up, w_down):
        g = torch.einsum("bsd,df->bsf", x, w_gate)
        u = torch.einsum("bsd,df->bsf", x, w_up)
        h = g * u
        return torch.einsum("bsf,fd->bsd", h, w_down)

    x = A_x
    xn = _layernorm(x, axis=-1)
    s = _A_ref(xn, A_k_cache, A_v_cache, A_wq, A_wo)
    g = _silu(_B_ref(xn, B_w_gate, B_w_up, B_w_down))
    return x + s * g
```

```asm
; @launch grid=(256,1,1) block=(256,1,1) lds=163840
.amdgcn_target "amdgcn-amd-amdhsa--gfx950"
.text
.globl recurrent_scan__sliding_block_cached__glu_gated_bilinear__prompt_kernel
.p2align 8
.type recurrent_scan__sliding_block_cached__glu_gated_bilinear__prompt_kernel,@function
recurrent_scan__sliding_block_cached__glu_gated_bilinear__prompt_kernel:
    s_cmp_ge_u32 s2, 256
    s_cbranch_scc1 END
    s_load_dwordx16 s[64:79], s[0:1], 0
    s_load_dwordx8 s[80:87], s[0:1], 64
    s_and_b32 s40, s2, 31
    s_lshr_b32 s41, s2, 5
    s_and_b32 s55, s2, 7
    s_lshl_b32 s55, s55, 2
    s_bfe_u32 s60, s2, 0x20003
    s_add_u32 s55, s55, s60
    s_bitcmp1_b32 s2, 7
    s_cbranch_scc1 ROLEB
    s_mov_b32 s95, s2
    s_mul_i32 s60, s2, 20480
    v_lshrrev_b32 v52, 4, v0
    v_mul_u32_u24 v53, 1280, v52
    v_and_b32 v54, 15, v0
    v_lshl_add_u32 v53, v54, 3, v53
    s_mov_b32 s26, 2621440
    s_mov_b32 s27, 0x20000
    s_waitcnt lgkmcnt(0)
    s_mov_b32 s24, s64
    s_and_b32 s25, s65, 0xffff
    buffer_load_dwordx2 v[64:65], v53, s[24:27], s60 offen offset:0
    buffer_load_dwordx2 v[66:67], v53, s[24:27], s60 offen offset:128
    buffer_load_dwordx2 v[68:69], v53, s[24:27], s60 offen offset:256
    buffer_load_dwordx2 v[70:71], v53, s[24:27], s60 offen offset:384
    buffer_load_dwordx2 v[72:73], v53, s[24:27], s60 offen offset:512
    buffer_load_dwordx2 v[74:75], v53, s[24:27], s60 offen offset:640
    buffer_load_dwordx2 v[76:77], v53, s[24:27], s60 offen offset:768
    buffer_load_dwordx2 v[78:79], v53, s[24:27], s60 offen offset:896
    buffer_load_dwordx2 v[80:81], v53, s[24:27], s60 offen offset:1024
    buffer_load_dwordx2 v[82:83], v53, s[24:27], s60 offen offset:1152
    s_mov_b32 s16, s86
    s_and_b32 s17, s87, 0xffff
    s_mov_b32 s18, 88080384
    s_mov_b32 s19, 0x20000
    v_mov_b32 v59, 0
    s_mov_b32 s58, 62390272
    buffer_load_dword v61, v59, s[16:19], s58 offen offset:28 sc1
    v_lshrrev_b32 v57, 3, v54
    v_lshlrev_b32 v57, 10, v57
    v_and_b32 v58, 3, v54
    v_lshl_add_u32 v57, v58, 8, v57
    v_bfe_u32 v58, v54, 2, 1
    v_lshl_add_u32 v57, v58, 3, v57
    v_lshl_add_u32 v57, v52, 4, v57
    v_add_u32 v129, 73728, v57
    v_lshrrev_b32 v55, 6, v0
    v_and_b32 v56, 63, v0
    v_readfirstlane_b32 s3, v55
    v_lshlrev_b32 v1, 4, v56
    s_lshr_b32 s60, s95, 2
    s_mul_i32 s60, s60, 81920
    s_and_b32 s61, s95, 3
    s_lshl_b32 s61, s61, 10
    s_add_u32 s60, s60, s61
    s_mul_i32 s61, s3, 20480
    s_add_u32 s95, s60, s61
    s_mul_i32 s60, s3, 5120
    s_add_u32 s60, s60, 73728
    v_add_u32 v131, s60, v1
    buffer_load_dword v127, v59, s[16:19], s95 offen sc1
    s_lshl_b32 s60, s2, 7
    s_lshl_b32 s61, s3, 2
    s_add_u32 s61, s61, s60
    s_add_u32 s61, s61, 62390272
    v_mov_b32 v9, 0xffffff00
    v_writelane_b32 v9, s61, 0
    buffer_load_dword v126, v59, s[16:19], s61 offen sc1
    s_waitcnt vmcnt(3)
LNLOOP:
    v_mov_b32 v106, 0x3f803f80
    v_dot2_f32_bf16 v100, v64, v106, 0
    v_dot2_f32_bf16 v102, v64, v64, 0
    v_dot2_f32_bf16 v101, v65, v106, 0
    v_dot2_f32_bf16 v103, v65, v65, 0
    v_dot2_f32_bf16 v100, v66, v106, v100
    v_dot2_f32_bf16 v102, v66, v66, v102
    v_dot2_f32_bf16 v101, v67, v106, v101
    v_dot2_f32_bf16 v103, v67, v67, v103
    v_dot2_f32_bf16 v100, v68, v106, v100
    v_dot2_f32_bf16 v102, v68, v68, v102
    v_dot2_f32_bf16 v101, v69, v106, v101
    v_dot2_f32_bf16 v103, v69, v69, v103
    v_dot2_f32_bf16 v100, v70, v106, v100
    v_dot2_f32_bf16 v102, v70, v70, v102
    v_dot2_f32_bf16 v101, v71, v106, v101
    v_dot2_f32_bf16 v103, v71, v71, v103
    v_dot2_f32_bf16 v100, v72, v106, v100
    v_dot2_f32_bf16 v102, v72, v72, v102
    v_dot2_f32_bf16 v101, v73, v106, v101
    v_dot2_f32_bf16 v103, v73, v73, v103
    v_dot2_f32_bf16 v100, v74, v106, v100
    v_dot2_f32_bf16 v102, v74, v74, v102
    v_dot2_f32_bf16 v101, v75, v106, v101
    v_dot2_f32_bf16 v103, v75, v75, v103
    v_dot2_f32_bf16 v100, v76, v106, v100
    v_dot2_f32_bf16 v102, v76, v76, v102
    v_dot2_f32_bf16 v101, v77, v106, v101
    v_dot2_f32_bf16 v103, v77, v77, v103
    v_dot2_f32_bf16 v100, v78, v106, v100
    v_dot2_f32_bf16 v102, v78, v78, v102
    v_dot2_f32_bf16 v101, v79, v106, v101
    v_dot2_f32_bf16 v103, v79, v79, v103
    v_dot2_f32_bf16 v100, v80, v106, v100
    v_dot2_f32_bf16 v102, v80, v80, v102
    v_dot2_f32_bf16 v101, v81, v106, v101
    v_dot2_f32_bf16 v103, v81, v81, v103
    v_dot2_f32_bf16 v100, v82, v106, v100
    v_dot2_f32_bf16 v102, v82, v82, v102
    v_dot2_f32_bf16 v101, v83, v106, v101
    v_dot2_f32_bf16 v103, v83, v83, v103
    v_lshlrev_b32 v140, 16, v64
    v_and_b32 v141, 0xffff0000, v64
    v_lshlrev_b32 v142, 16, v65
    v_and_b32 v143, 0xffff0000, v65
    v_add_f32 v100, v100, v101
    v_lshlrev_b32 v144, 16, v66
    v_add_f32 v102, v102, v103
    v_and_b32 v145, 0xffff0000, v66
    v_add_f32_dpp v100, v100, v100 row_ror:8 row_mask:0xf bank_mask:0xf
    v_lshlrev_b32 v146, 16, v67
    v_add_f32_dpp v102, v102, v102 row_ror:8 row_mask:0xf bank_mask:0xf
    v_and_b32 v147, 0xffff0000, v67
    v_add_f32_dpp v100, v100, v100 row_ror:4 row_mask:0xf bank_mask:0xf
    v_lshlrev_b32 v148, 16, v68
    v_add_f32_dpp v102, v102, v102 row_ror:4 row_mask:0xf bank_mask:0xf
    v_and_b32 v149, 0xffff0000, v68
    v_add_f32_dpp v100, v100, v100 row_ror:2 row_mask:0xf bank_mask:0xf
    v_lshlrev_b32 v150, 16, v69
    v_add_f32_dpp v102, v102, v102 row_ror:2 row_mask:0xf bank_mask:0xf
    v_and_b32 v151, 0xffff0000, v69
    v_add_f32_dpp v100, v100, v100 row_ror:1 row_mask:0xf bank_mask:0xf
    v_lshlrev_b32 v152, 16, v70
    v_add_f32_dpp v102, v102, v102 row_ror:1 row_mask:0xf bank_mask:0xf
    v_and_b32 v153, 0xffff0000, v70
    v_mul_f32 v100, 0xbacccccd, v100
    v_lshlrev_b32 v154, 16, v71
    v_mul_f32 v102, 0x3acccccd, v102
    v_and_b32 v155, 0xffff0000, v71
    v_fma_f32 v102, -v100, v100, v102
    v_lshlrev_b32 v156, 16, v72
    v_max_f32 v102, 0, v102
    v_and_b32 v157, 0xffff0000, v72
    v_cvt_pk_bf16_f32 v104, v100, v102
    v_lshlrev_b32 v158, 16, v73
    v_lshlrev_b32 v100, 16, v104
    v_and_b32 v159, 0xffff0000, v73
    v_and_b32 v102, 0xffff0000, v104
    v_lshlrev_b32 v160, 16, v74
    v_add_f32 v102, 0x3727c5ac, v102
    v_and_b32 v161, 0xffff0000, v74
    v_cvt_pk_bf16_f32 v102, v102, v102
    v_lshlrev_b32 v162, 16, v75
    v_lshlrev_b32 v102, 16, v102
    v_and_b32 v163, 0xffff0000, v75
    v_sqrt_f32 v102, v102
    v_lshlrev_b32 v164, 16, v76
    v_cvt_pk_bf16_f32 v102, v102, v102
    v_and_b32 v165, 0xffff0000, v76
    v_lshlrev_b32 v102, 16, v102
    v_lshlrev_b32 v166, 16, v77
    v_rcp_f32 v102, v102
    v_and_b32 v167, 0xffff0000, v77
    v_mul_f32 v102, 0x3dd53b95, v102
    v_lshlrev_b32 v168, 16, v78
    v_mul_f32 v100, v100, v102
    v_and_b32 v169, 0xffff0000, v78
    v_lshlrev_b32 v170, 16, v79
    v_and_b32 v171, 0xffff0000, v79
    v_lshlrev_b32 v172, 16, v80
    v_and_b32 v173, 0xffff0000, v80
    v_lshlrev_b32 v174, 16, v81
    v_and_b32 v175, 0xffff0000, v81
    v_lshlrev_b32 v176, 16, v82
    v_and_b32 v177, 0xffff0000, v82
    v_lshlrev_b32 v178, 16, v83
    v_and_b32 v179, 0xffff0000, v83
    v_fma_f32 v140, v140, v102, v100
    v_fma_f32 v141, v141, v102, v100
    v_fma_f32 v142, v142, v102, v100
    v_fma_f32 v143, v143, v102, v100
    v_cvt_pk_bf16_f32 v190, v140, v141
    v_cvt_pk_bf16_f32 v191, v142, v143
    ds_write_b64 v129, v[190:191] offset:0
    v_fma_f32 v144, v144, v102, v100
    v_fma_f32 v145, v145, v102, v100
    v_fma_f32 v146, v146, v102, v100
    v_fma_f32 v147, v147, v102, v100
    v_cvt_pk_bf16_f32 v192, v144, v145
    v_cvt_pk_bf16_f32 v193, v146, v147
    ds_write_b64 v129, v[192:193] offset:2048
    v_fma_f32 v148, v148, v102, v100
    v_fma_f32 v149, v149, v102, v100
    v_fma_f32 v150, v150, v102, v100
    v_fma_f32 v151, v151, v102, v100
    v_cvt_pk_bf16_f32 v194, v148, v149
    v_cvt_pk_bf16_f32 v195, v150, v151
    ds_write_b64 v129, v[194:195] offset:4096
    v_fma_f32 v152, v152, v102, v100
    v_fma_f32 v153, v153, v102, v100
    v_fma_f32 v154, v154, v102, v100
    v_fma_f32 v155, v155, v102, v100
    v_cvt_pk_bf16_f32 v196, v152, v153
    v_cvt_pk_bf16_f32 v197, v154, v155
    ds_write_b64 v129, v[196:197] offset:6144
    v_fma_f32 v156, v156, v102, v100
    v_fma_f32 v157, v157, v102, v100
    v_fma_f32 v158, v158, v102, v100
    v_fma_f32 v159, v159, v102, v100
    v_cvt_pk_bf16_f32 v198, v156, v157
    v_cvt_pk_bf16_f32 v199, v158, v159
    ds_write_b64 v129, v[198:199] offset:8192
    v_fma_f32 v160, v160, v102, v100
    v_fma_f32 v161, v161, v102, v100
    v_fma_f32 v162, v162, v102, v100
    v_fma_f32 v163, v163, v102, v100
    v_cvt_pk_bf16_f32 v200, v160, v161
    v_cvt_pk_bf16_f32 v201, v162, v163
    ds_write_b64 v129, v[200:201] offset:10240
    v_fma_f32 v164, v164, v102, v100
    v_fma_f32 v165, v165, v102, v100
    v_fma_f32 v166, v166, v102, v100
    v_fma_f32 v167, v167, v102, v100
    v_cvt_pk_bf16_f32 v202, v164, v165
    v_cvt_pk_bf16_f32 v203, v166, v167
    ds_write_b64 v129, v[202:203] offset:12288
    v_fma_f32 v168, v168, v102, v100
    v_fma_f32 v169, v169, v102, v100
    v_fma_f32 v170, v170, v102, v100
    v_fma_f32 v171, v171, v102, v100
    v_cvt_pk_bf16_f32 v204, v168, v169
    v_cvt_pk_bf16_f32 v205, v170, v171
    ds_write_b64 v129, v[204:205] offset:14336
    v_fma_f32 v172, v172, v102, v100
    v_fma_f32 v173, v173, v102, v100
    v_fma_f32 v174, v174, v102, v100
    v_fma_f32 v175, v175, v102, v100
    v_cvt_pk_bf16_f32 v206, v172, v173
    v_cvt_pk_bf16_f32 v207, v174, v175
    ds_write_b64 v129, v[206:207] offset:16384
    v_fma_f32 v176, v176, v102, v100
    v_fma_f32 v177, v177, v102, v100
    v_fma_f32 v178, v178, v102, v100
    v_fma_f32 v179, v179, v102, v100
    v_cvt_pk_bf16_f32 v208, v176, v177
    v_cvt_pk_bf16_f32 v209, v178, v179
    ds_write_b64 v129, v[208:209] offset:18432
    s_waitcnt lgkmcnt(0)
    s_barrier
    ds_read_b128 v[140:143], v131 offset:0
    ds_read_b128 v[144:147], v131 offset:1024
    ds_read_b128 v[148:151], v131 offset:2048
    ds_read_b128 v[152:155], v131 offset:3072
    ds_read_b128 v[156:159], v131 offset:4096
    s_waitcnt lgkmcnt(4)
    buffer_store_dwordx4 v[140:143], v1, s[16:19], s95 offen sc1
    s_add_u32 s95, s95, 4096
    s_waitcnt lgkmcnt(3)
    buffer_store_dwordx4 v[144:147], v1, s[16:19], s95 offen sc1
    s_add_u32 s95, s95, 4096
    s_waitcnt lgkmcnt(2)
    buffer_store_dwordx4 v[148:151], v1, s[16:19], s95 offen sc1
    s_add_u32 s95, s95, 4096
    s_waitcnt lgkmcnt(1)
    buffer_store_dwordx4 v[152:155], v1, s[16:19], s95 offen sc1
    s_add_u32 s95, s95, 4096
    s_waitcnt lgkmcnt(0)
    buffer_store_dwordx4 v[156:159], v1, s[16:19], s95 offen sc1
    s_add_u32 s95, s95, 4096
    s_branch COMMON
ROLEB:
    s_mov_b32 s60, 1431655766
    v_mul_hi_u32 v55, v0, s60
    v_mul_u32_u24 v56, 3, v55
    v_sub_u32 v56, v0, v56
    v_lshrrev_b32 v57, 4, v55
    v_and_b32 v55, 15, v55
    v_lshl_add_u32 v55, v57, 6, v55
    v_mul_u32_u24 v55, 12288, v55
    v_lshl_add_u32 v52, v56, 7, v55
    v_cmp_gt_u32 vcc, 240, v0
    v_mov_b32 v57, 0x40000000
    s_and_b32 s61, s41, 3
    v_cndmask_b32 v52, v57, v52, vcc
    s_mul_i32 s62, s61, 196608
    s_mul_i32 s60, s40, 384
    s_add_u32 s62, s62, s60
    v_lshrrev_b32 v55, 1, v0
    v_lshrrev_b32 v57, 4, v55
    v_and_b32 v55, 15, v55
    v_lshl_add_u32 v55, v57, 6, v55
    v_mul_u32_u24 v55, 3072, v55
    v_and_b32 v56, 1, v0
    v_mul_u32_u24 v56, 92, v56
    v_add_u32 v53, v55, v56
    v_mov_b32 v57, 0x40000000
    v_cmp_gt_u32 vcc, 160, v0
    s_mul_i32 s63, s61, 49152
    s_nop 0
    v_cndmask_b32 v53, v57, v53, vcc
    s_mul_i32 s60, s55, 96
    s_add_u32 s63, s63, s60
    s_waitcnt lgkmcnt(0)
    s_mov_b32 s20, s70
    s_and_b32 s21, s71, 0xffff
    s_mov_b32 s22, 7864320
    s_mov_b32 s23, 0x20000
    s_mov_b32 s8, s76
    s_and_b32 s9, s77, 0xffff
    s_mov_b32 s10, 1966080
    s_mov_b32 s11, 0x20000
    s_mov_b32 s12, s78
    s_and_b32 s13, s79, 0xffff
    s_mov_b32 s14, 1966080
    s_mov_b32 s15, 0x20000
    buffer_load_dword v64, v52, s[20:23], s62 offen
    buffer_load_dword v65, v53, s[8:11], s63 offen
    buffer_load_dword v66, v53, s[12:15], s63 offen
    s_mov_b32 s16, s86
    s_and_b32 s17, s87, 0xffff
    s_mov_b32 s18, 88080384
    s_mov_b32 s19, 0x20000
    v_mov_b32 v59, 0
    s_mov_b32 s58, 62390272
    buffer_load_dword v61, v59, s[16:19], s58 offen offset:28 sc1
    s_getpc_b64 s[88:89]
PCREF:
    s_sub_u32 s32, s88, PCREF-recurrent_scan__sliding_block_cached__glu_gated_bilinear__prompt_kernel
    s_subb_u32 s33, s89, 0
    s_and_b32 s33, s33, 0xffff
    s_mov_b32 s34, CODE_END-recurrent_scan__sliding_block_cached__glu_gated_bilinear__prompt_kernel
    s_mov_b32 s35, 0x20000
    s_bfe_u32 s59, s2, 0x40003
    s_lshl_b32 s59, s59, 12
    s_add_u32 s59, s59, 3328
    v_lshrrev_b32 v60, 3, v0
    v_lshlrev_b32 v60, 7, v60
    buffer_load_dword v126, v60, s[32:35], s59 offen
    v_lshrrev_b32 v55, 6, v0
    s_nop 0
    v_readfirstlane_b32 s3, v55
    v_mov_b32 v9, 0xffffff00
COMMON:
    s_getpc_b64 s[88:89]
PCREF2:
    s_sub_u32 s32, s88, PCREF2-recurrent_scan__sliding_block_cached__glu_gated_bilinear__prompt_kernel
    s_subb_u32 s33, s89, 0
    s_and_b32 s33, s33, 0xffff
    s_mov_b32 s34, CODE_END-recurrent_scan__sliding_block_cached__glu_gated_bilinear__prompt_kernel
    s_mov_b32 s35, 0x20000
    s_bfe_u32 s59, s2, 0x40003
    s_lshl_b32 s59, s59, 12
    s_add_u32 s59, s59, 16384
    v_and_b32 v0, 63, v0
    v_lshlrev_b32 v1, 4, v0
    v_lshlrev_b32 v42, 7, v0
    s_mul_i32 s57, s40, 384
    s_mul_i32 s53, s55, 96
    s_mul_i32 s42, s3, 6144
    s_lshl_b32 s60, s3, 10
    s_add_u32 s59, s59, s60
    s_mov_b32 s60, 178956971
    s_waitcnt lgkmcnt(1)
    s_mov_b32 s20, s70
    s_and_b32 s21, s71, 0xffff
    s_mov_b32 s22, 7864320
    s_mov_b32 s23, 0x20000
    v_add_u32 v52, 0, v0
    v_mul_hi_u32 v53, v52, s60
    v_and_b32 v54, 6, v53
    v_mul_u32_u24 v55, 24, v53
    v_sub_u32 v55, v52, v55
    v_xor_b32 v55, v54, v55
    v_mul_u32_u24 v56, 12288, v53
    v_lshl_add_u32 v55, v55, 4, v56
    v_subrev_u32 v2, 0, v55
    v_add_u32 v52, 64, v0
    v_mul_hi_u32 v53, v52, s60
    v_and_b32 v54, 6, v53
    v_mul_u32_u24 v55, 24, v53
    v_sub_u32 v55, v52, v55
    v_xor_b32 v55, v54, v55
    v_mul_u32_u24 v56, 12288, v53
    v_lshl_add_u32 v55, v55, 4, v56
    v_subrev_u32 v3, 1024, v55
    v_add_u32 v52, 128, v0
    v_mul_hi_u32 v53, v52, s60
    v_and_b32 v54, 6, v53
    v_mul_u32_u24 v55, 24, v53
    v_sub_u32 v55, v52, v55
    v_xor_b32 v55, v54, v55
    v_mul_u32_u24 v56, 12288, v53
    v_lshl_add_u32 v55, v55, 4, v56
    v_subrev_u32 v4, 2048, v55
    v_add_u32 v52, 192, v0
    v_mul_hi_u32 v53, v52, s60
    v_and_b32 v54, 6, v53
    v_mul_u32_u24 v55, 24, v53
    v_sub_u32 v55, v52, v55
    v_xor_b32 v55, v54, v55
    v_mul_u32_u24 v56, 12288, v53
    v_lshl_add_u32 v55, v55, 4, v56
    v_subrev_u32 v5, 3072, v55
    v_add_u32 v52, 256, v0
    v_mul_hi_u32 v53, v52, s60
    v_and_b32 v54, 6, v53
    v_mul_u32_u24 v55, 24, v53
    v_sub_u32 v55, v52, v55
    v_xor_b32 v55, v54, v55
    v_mul_u32_u24 v56, 12288, v53
    v_lshl_add_u32 v55, v55, 4, v56
    v_subrev_u32 v6, 0, v55
    v_add_u32 v52, 320, v0
    v_mul_hi_u32 v53, v52, s60
    v_and_b32 v54, 6, v53
    v_mul_u32_u24 v55, 24, v53
    v_sub_u32 v55, v52, v55
    v_xor_b32 v55, v54, v55
    v_mul_u32_u24 v56, 12288, v53
    v_lshl_add_u32 v55, v55, 4, v56
    v_subrev_u32 v7, 1024, v55
    s_mul_i32 s60, s3, 196608
    s_add_u32 s57, s57, s60
    s_cmp_lt_u32 s3, 2
    s_cselect_b32 s12, s76, s78
    s_cselect_b32 s13, s77, s79
    s_and_b32 s13, s13, 0xffff
    s_mov_b32 s14, 1966080
    s_mov_b32 s15, 0x20000
    s_and_b32 s60, s3, 1
    s_mul_i32 s60, s60, 98304
    s_add_u32 s53, s53, s60
    s_mul_i32 s97, s3, 3072
    s_mov_b32 s60, 715827883
    v_add_u32 v52, 0, v0
    v_mul_hi_u32 v53, v52, s60
    v_mul_u32_u24 v55, 6, v53
    v_sub_u32 v55, v52, v55
    v_mul_u32_u24 v56, 3072, v53
    v_lshl_add_u32 v55, v55, 4, v56
    v_subrev_u32 v44, 0, v55
    v_add_u32 v52, 64, v0
    v_mul_hi_u32 v53, v52, s60
    v_mul_u32_u24 v55, 6, v53
    v_sub_u32 v55, v52, v55
    v_mul_u32_u24 v56, 3072, v53
    v_lshl_add_u32 v55, v55, 4, v56
    v_subrev_u32 v45, 1024, v55
    v_add_u32 v52, 128, v0
    v_mul_hi_u32 v53, v52, s60
    v_mul_u32_u24 v55, 6, v53
    v_sub_u32 v55, v52, v55
    v_mul_u32_u24 v56, 3072, v53
    v_lshl_add_u32 v55, v55, 4, v56
    v_subrev_u32 v46, 2048, v55
    s_bitcmp1_b32 s2, 7
    s_cbranch_scc1 NOPUB
    s_waitcnt vmcnt(0)
    v_add_u32 v128, 0x9e3779b1, v61
    buffer_store_dword v128, v9, s[16:19], 0 offen offset:80 sc1
NOPUB:
    s_add_u32 m0, s42, 0
    s_nop 0
    buffer_load_dwordx4 v2, s[20:23], s57 offen offset:0 lds
    buffer_load_dwordx4 v3, s[20:23], s57 offen offset:1024 lds
    buffer_load_dwordx4 v4, s[20:23], s57 offen offset:2048 lds
    buffer_load_dwordx4 v5, s[20:23], s57 offen offset:3072 lds
    s_add_u32 m0, m0, 4096
    s_nop 0
    buffer_load_dwordx4 v6, s[20:23], s57 offen offset:0 lds
    buffer_load_dwordx4 v7, s[20:23], s57 offen offset:1024 lds
    s_add_u32 s57, s57, 786432
    s_add_u32 m0, s97, 98304
    s_nop 0
    buffer_load_dwordx4 v44, s[12:15], s53 offen offset:0 lds
    buffer_load_dwordx4 v45, s[12:15], s53 offen offset:1024 lds
    buffer_load_dwordx4 v46, s[12:15], s53 offen offset:2048 lds
    s_add_u32 s53, s53, 196608
    s_mov_b64 exec, 0
    s_cmp_eq_u32 s3, 0
    s_cbranch_scc1 WS14
    s_cmp_eq_u32 s3, 1
    s_cbranch_scc1 WS13
    s_cmp_eq_u32 s3, 2
    s_cbranch_scc1 WS12
    s_branch WS11
.p2align 12
MAINC:
    s_mov_b64 exec, -1
    v_lshrrev_b32 v52, 4, v0
    v_bfe_u32 v53, v0, 2, 2
    v_lshl_add_u32 v54, v52, 2, v53
    v_and_b32 v55, 3, v0
    v_mul_u32_u24 v56, 384, v54
    v_lshl_add_u32 v56, v55, 3, v56
    v_bfe_u32 v57, v54, 1, 2
    v_xor_b32 v58, 0, v57
    v_lshl_add_u32 v22, v58, 5, v56
    v_mov_b32 v26, v22
    v_xor_b32 v58, 1, v57
    v_lshl_add_u32 v23, v58, 5, v56
    v_mov_b32 v27, v23
    v_xor_b32 v58, 2, v57
    v_lshl_add_u32 v24, v58, 5, v56
    v_mov_b32 v28, v24
    v_xor_b32 v58, 3, v57
    v_lshl_add_u32 v25, v58, 5, v56
    v_mov_b32 v29, v25
    v_mul_u32_u24 v56, 96, v54
    v_lshl_add_u32 v56, v55, 3, v56
    s_and_b32 s60, s55, 1
    s_lshl_b32 s61, s60, 5
    s_add_u32 s61, s61, 98304
    v_add_u32 v47, s61, v56
    v_add_u32 v48, 32, v47
    s_xor_b32 s60, s60, 1
    s_lshl_b32 s60, s60, 6
    s_add_u32 s60, s60, 98304
    v_add_u32 v49, s60, v56
    s_getreg_b32 s54, hwreg(HW_REG_XCC_ID, 0, 4)
    s_lshl_b32 s60, s41, 2
    s_add_u32 s60, s60, s3
    s_mul_i32 s49, s60, 81920
    s_lshl_b32 s60, s2, 7
    s_add_u32 s60, s60, 62390272
    s_lshl_b32 s61, s3, 2
    s_add_u32 s61, s61, s60
    s_cmp_eq_u32 s3, 0
    s_cselect_b32 s60, s60, 0xffffff00
    v_mov_b32 v43, 0xffffff00
    v_mov_b32 v9, 0xffffff00
    v_writelane_b32 v43, s60, 0
    v_writelane_b32 v9, s61, 0
    v_lshlrev_b32 v62, 7, v55
    v_lshl_add_u32 v62, v53, 2, v62
    s_lshl_b32 s58, s41, 2
    s_add_u32 s58, s58, s3
    s_lshl_b32 s58, s58, 9
    s_add_u32 s58, s58, 62390272
    buffer_load_dword v38, v62, s[16:19], s58 offen offset:80 sc1
    s_waitcnt vmcnt(0)
    v_add_u32 v61, 0x9e3779b1, v61
    s_mov_b32 s101, 0x80000
ISPX:
    s_waitcnt vmcnt(0)
    v_cmp_ne_u32 vcc, v38, v61
    s_cbranch_vccz ISDX
    buffer_load_dword v38, v62, s[16:19], s58 offen offset:80 sc1
    s_sub_u32 s101, s101, 1
    s_cmp_lg_u32 s101, 0
    s_cbranch_scc1 ISPX
    s_waitcnt vmcnt(0)
ISDX:
BACKX:
    s_add_u32 s96, s49, 0
    buffer_load_dwordx4 a[96:99], v1, s[16:19], s96 offen offset:0 sc1
    buffer_load_dwordx4 a[100:103], v1, s[16:19], s96 offen offset:1024 sc1
    buffer_load_dwordx4 a[104:107], v1, s[16:19], s96 offen offset:2048 sc1
    buffer_load_dwordx4 a[108:111], v1, s[16:19], s96 offen offset:3072 sc1
    s_add_u32 s96, s49, 4096
    buffer_load_dwordx4 a[112:115], v1, s[16:19], s96 offen offset:0 sc1
    buffer_load_dwordx4 a[116:119], v1, s[16:19], s96 offen offset:1024 sc1
    buffer_load_dwordx4 a[120:123], v1, s[16:19], s96 offen offset:2048 sc1
    buffer_load_dwordx4 a[124:127], v1, s[16:19], s96 offen offset:3072 sc1
    s_barrier
    ds_read_b64_tr_b16 a[192:193], v47 offset:0
    ds_read_b64_tr_b16 a[194:195], v47 offset:1536
    ds_read_b64_tr_b16 a[196:197], v47 offset:3072
    ds_read_b64_tr_b16 a[198:199], v47 offset:4608
    ds_read_b64_tr_b16 a[200:201], v48 offset:0
    ds_read_b64_tr_b16 a[202:203], v48 offset:1536
    ds_read_b64_tr_b16 a[204:205], v48 offset:3072
    ds_read_b64_tr_b16 a[206:207], v48 offset:4608
    ds_read_b64_tr_b16 a[208:209], v49 offset:0
    ds_read_b64_tr_b16 a[210:211], v49 offset:1536
    ds_read_b64_tr_b16 a[212:213], v49 offset:3072
    ds_read_b64_tr_b16 a[214:215], v49 offset:4608
    s_add_u32 m0, s42, 24576
    s_nop 0
    buffer_load_dwordx4 v2, s[20:23], s57 offen offset:0 lds
    s_waitcnt vmcnt(8) lgkmcnt(10)
    v_mfma_f32_16x16x32_bf16 a[0:3], a[192:195], a[96:99], 0
    s_waitcnt vmcnt(4) lgkmcnt(8)
    ds_read_b64_tr_b16 a[216:217], v47 offset:6144
    v_mfma_f32_16x16x32_bf16 a[0:3], a[196:199], a[112:115], a[0:3]
    s_waitcnt vmcnt(3)
    ds_read_b64_tr_b16 a[218:219], v47 offset:7680
    v_mfma_f32_16x16x32_bf16 a[4:7], a[196:199], a[116:119], 0
    ds_read_b64_tr_b16 a[220:221], v47 offset:9216
    v_mfma_f32_16x16x32_bf16 a[4:7], a[192:195], a[100:103], a[4:7]
    buffer_load_dwordx4 v3, s[20:23], s57 offen offset:1024 lds
    v_mfma_f32_16x16x32_bf16 a[8:11], a[192:195], a[104:107], 0
    s_waitcnt vmcnt(3)
    ds_read_b64_tr_b16 a[222:223], v47 offset:10752
    v_lshlrev_b32 v58, 6, v54
    v_mfma_f32_16x16x32_bf16 a[8:11], a[196:199], a[120:123], a[8:11]
    s_waitcnt vmcnt(2)
    ds_read_b64_tr_b16 a[224:225], v48 offset:6144
    v_lshl_add_u32 v58, v55, 3, v58
    v_mfma_f32_16x16x32_bf16 a[12:15], a[196:199], a[124:127], 0
    s_lshl_b32 s52, s3, 12
    ds_read_b64_tr_b16 a[226:227], v48 offset:7680
    v_mfma_f32_16x16x32_bf16 a[12:15], a[192:195], a[108:111], a[12:15]
    s_waitcnt lgkmcnt(12)
    buffer_load_dwordx4 v4, s[20:23], s57 offen offset:2048 lds
    v_mfma_f32_16x16x32_bf16 a[28:31], a[200:203], a[108:111], 0
    s_waitcnt lgkmcnt(6)
    ds_read_b64_tr_b16 a[228:229], v48 offset:9216
    s_add_u32 s52, s52, 147456
    v_mfma_f32_16x16x32_bf16 a[28:31], a[204:207], a[124:127], a[28:31]
    ds_read_b64_tr_b16 a[230:231], v48 offset:10752
    v_add_u32 v41, s52, v58
    v_mfma_f32_16x16x32_bf16 a[24:27], a[204:207], a[120:123], 0
    ds_read_b64_tr_b16 a[232:233], v49 offset:6144
    v_and_b32 v56, 15, v0
    v_mfma_f32_16x16x32_bf16 a[24:27], a[200:203], a[104:107], a[24:27]
    ds_read_b64_tr_b16 a[234:235], v49 offset:7680
    v_and_b32 v57, 2, v56
    v_mfma_f32_16x16x32_bf16 a[20:23], a[200:203], a[100:103], 0
    buffer_load_dwordx4 v5, s[20:23], s57 offen offset:3072 lds
    v_mfma_f32_16x16x32_bf16 a[20:23], a[204:207], a[116:119], a[20:23]
    s_add_u32 m0, m0, 4096
    ds_read_b64_tr_b16 a[236:237], v49 offset:9216
    v_bfe_u32 v58, v56, 2, 1
    v_mfma_f32_16x16x32_bf16 a[16:19], a[204:207], a[112:115], 0
    ds_read_b64_tr_b16 a[238:239], v49 offset:10752
    v_or_b32 v57, v57, v58
    v_mfma_f32_16x16x32_bf16 a[16:19], a[200:203], a[96:99], a[16:19]
    ds_read_b64_tr_b16 a[240:241], v26 offset:0
    v_bfe_u32 v58, v56, 3, 1
    v_mfma_f32_16x16x32_bf16 a[32:35], a[208:211], a[96:99], 0
    buffer_load_dwordx4 v6, s[20:23], s57 offen offset:0 lds
    v_mfma_f32_16x16x32_bf16 a[32:35], a[212:215], a[112:115], a[32:35]
    ds_read_b64_tr_b16 a[242:243], v26 offset:6144
    v_lshl_or_b32 v57, v58, 2, v57
    v_mfma_f32_16x16x32_bf16 a[36:39], a[212:215], a[116:119], 0
    ds_read_b64_tr_b16 a[244:245], v26 offset:12288
    v_and_b32 v58, 1, v52
    v_mfma_f32_16x16x32_bf16 a[36:39], a[208:211], a[100:103], a[36:39]
    ds_read_b64_tr_b16 a[246:247], v26 offset:18432
    v_lshrrev_b32 v59, 1, v52
    v_mfma_f32_16x16x32_bf16 a[40:43], a[208:211], a[104:107], 0
    ds_read_b64_tr_b16 a[248:249], v27 offset:0
    v_lshl_or_b32 v58, v58, 1, v59
    v_mfma_f32_16x16x32_bf16 a[40:43], a[212:215], a[120:123], a[40:43]
    buffer_load_dwordx4 v7, s[20:23], s57 offen offset:1024 lds
    v_mfma_f32_16x16x32_bf16 a[44:47], a[212:215], a[124:127], 0
    s_add_u32 s57, s57, 786432
    ds_read_b64_tr_b16 a[250:251], v27 offset:6144
    s_add_u32 m0, s97, 110592
    v_mfma_f32_16x16x32_bf16 a[44:47], a[208:211], a[108:111], a[44:47]
    s_waitcnt lgkmcnt(6)
    ds_read_b64_tr_b16 a[252:253], v27 offset:12288
    v_xor_b32 v57, v57, v58
    v_mfma_f32_16x16x32_bf16 a[60:63], a[216:219], a[108:111], 0
    ds_read_b64_tr_b16 a[254:255], v27 offset:18432
    v_mul_u32_u24 v56, 384, v56
    v_mfma_f32_16x16x32_bf16 a[60:63], a[220:223], a[124:127], a[60:63]
    buffer_load_dwordx4 v44, s[12:15], s53 offen offset:0 lds
    v_mfma_f32_16x16x32_bf16 a[56:59], a[220:223], a[120:123], 0
    v_lshl_add_u32 v30, v57, 4, v56
    v_xor_b32 v57, 4, v57
    v_mfma_f32_16x16x32_bf16 a[56:59], a[216:219], a[104:107], a[56:59]
    v_lshl_add_u32 v31, v57, 4, v56
    v_lshrrev_b32 v56, 2, v0
    v_mfma_f32_16x16x32_bf16 a[52:55], a[216:219], a[100:103], 0
    ds_read_b64_tr_b16 a[192:193], v28 offset:0
    v_mul_u32_u24 v56, 1280, v56
    v_mfma_f32_16x16x32_bf16 a[52:55], a[220:223], a[116:119], a[52:55]
    ds_read_b64_tr_b16 a[194:195], v28 offset:6144
    v_lshl_add_u32 v39, v55, 4, v56
    v_mfma_f32_16x16x32_bf16 a[48:51], a[220:223], a[112:115], 0
    ds_read_b64_tr_b16 a[196:197], v28 offset:12288
    v_add_u32 v40, 19456, v39
    v_mfma_f32_16x16x32_bf16 a[48:51], a[216:219], a[96:99], a[48:51]
    ds_read_b64_tr_b16 a[198:199], v28 offset:18432
    v_lshlrev_b32 v8, 3, v0
    v_mfma_f32_16x16x32_bf16 a[64:67], a[224:227], a[96:99], 0
    v_min_u32 v50, 1920, v42
    s_mul_i32 s60, s40, 786432
    v_mfma_f32_16x16x32_bf16 a[64:67], a[228:231], a[112:115], a[64:67]
    s_add_u32 s60, s60, 589824
    s_mov_b32 s89, 178956971
    v_add_u32 v56, 0, v0
    v_mfma_f32_16x16x32_bf16 a[68:71], a[228:231], a[116:119], 0
    buffer_load_dwordx4 v45, s[12:15], s53 offen offset:1024 lds
    v_mfma_f32_16x16x32_bf16 a[68:71], a[224:227], a[100:103], a[68:71]
    v_mul_hi_u32 v56, v56, s89
    v_and_b32 v57, 6, v56
    v_mfma_f32_16x16x32_bf16 a[72:75], a[224:227], a[104:107], 0
    ds_read_b64_tr_b16 a[200:201], v29 offset:0
    v_xor_b32 v57, v57, v0
    v_mfma_f32_16x16x32_bf16 a[72:75], a[228:231], a[120:123], a[72:75]
    ds_read_b64_tr_b16 a[202:203], v29 offset:6144
    v_lshlrev_b32 v16, 4, v57
    v_mfma_f32_16x16x32_bf16 a[76:79], a[228:231], a[124:127], 0
    ds_read_b64_tr_b16 a[204:205], v29 offset:12288
    v_and_b32 v57, 2, v56
    v_mfma_f32_16x16x32_bf16 a[76:79], a[224:227], a[108:111], a[76:79]
    ds_read_b64_tr_b16 a[206:207], v29 offset:18432
    v_bfe_u32 v58, v56, 2, 1
    v_mfma_f32_16x16x32_bf16 a[92:95], a[232:235], a[108:111], 0
    v_or_b32 v57, v57, v58
    v_bfe_u32 v58, v56, 3, 1
    v_mfma_f32_16x16x32_bf16 a[92:95], a[236:239], a[124:127], a[92:95]
    v_lshl_or_b32 v57, v58, 2, v57
    v_mfma_f32_16x16x32_bf16 a[88:91], a[236:239], a[120:123], 0
    v_xor_b32 v57, v57, v0
    v_mfma_f32_16x16x32_bf16 a[88:91], a[232:235], a[104:107], a[88:91]
    buffer_load_dwordx4 v46, s[12:15], s53 offen offset:2048 lds
    v_mfma_f32_16x16x32_bf16 a[84:87], a[232:235], a[100:103], 0
    s_add_u32 s53, s53, 196608
    ds_read_b64_tr_b16 a[208:209], v26 offset:128
    s_add_u32 s96, s49, 8192
    v_mfma_f32_16x16x32_bf16 a[84:87], a[236:239], a[116:119], a[84:87]
    ds_read_b64_tr_b16 a[210:211], v26 offset:6272
    v_lshlrev_b32 v10, 4, v57
    v_mfma_f32_16x16x32_bf16 a[80:83], a[236:239], a[112:115], 0
    ds_read_b64_tr_b16 a[212:213], v26 offset:12416
    v_add_u32 v56, 64, v0
    v_mfma_f32_16x16x32_bf16 a[80:83], a[232:235], a[96:99], a[80:83]
    s_waitcnt lgkmcnt(4)
    ds_read_b64_tr_b16 a[214:215], v26 offset:18560
    v_mul_hi_u32 v56, v56, s89
    v_mfma_f32_16x16x32_bf16 v[64:67], a[240:243], a[96:99], 0
    v_and_b32 v57, 6, v56
    v_xor_b32 v57, v57, v0
    v_mfma_f32_16x16x32_bf16 v[64:67], a[244:247], a[112:115], v[64:67]
    v_lshlrev_b32 v17, 4, v57
    v_and_b32 v57, 2, v56
    v_mfma_f32_16x16x32_bf16 v[72:75], a[244:247], a[116:119], 0
    v_bfe_u32 v58, v56, 2, 1
    v_mfma_f32_16x16x32_bf16 v[72:75], a[240:243], a[100:103], v[72:75]
    v_or_b32 v57, v57, v58
    v_mfma_f32_16x16x32_bf16 v[80:83], a[240:243], a[104:107], 0
    buffer_load_dwordx4 a[128:131], v1, s[16:19], s96 offen offset:0 sc1
    v_mfma_f32_16x16x32_bf16 v[80:83], a[244:247], a[120:123], v[80:83]
    ds_read_b64_tr_b16 a[216:217], v27 offset:128
    v_bfe_u32 v58, v56, 3, 1
    v_mfma_f32_16x16x32_bf16 v[88:91], a[244:247], a[124:127], 0
    ds_read_b64_tr_b16 a[218:219], v27 offset:6272
    v_lshl_or_b32 v57, v58, 2, v57
    v_mfma_f32_16x16x32_bf16 v[88:91], a[240:243], a[108:111], v[88:91]
    ds_read_b64_tr_b16 a[220:221], v27 offset:12416
    v_xor_b32 v57, v57, v0
    v_mfma_f32_16x16x32_bf16 v[92:95], a[248:251], a[108:111], 0
    ds_read_b64_tr_b16 a[222:223], v27 offset:18560
    v_lshlrev_b32 v11, 4, v57
    v_mfma_f32_16x16x32_bf16 v[92:95], a[252:255], a[124:127], v[92:95]
    buffer_load_dwordx4 a[132:135], v1, s[16:19], s96 offen offset:1024 sc1
    v_mfma_f32_16x16x32_bf16 v[84:87], a[252:255], a[120:123], 0
    v_add_u32 v56, 128, v0
    v_mul_hi_u32 v56, v56, s89
    v_mfma_f32_16x16x32_bf16 v[84:87], a[248:251], a[104:107], v[84:87]
    v_and_b32 v57, 6, v56
    v_xor_b32 v57, v57, v0
    v_mfma_f32_16x16x32_bf16 v[76:79], a[248:251], a[100:103], 0
    ds_read_b64_tr_b16 a[224:225], v28 offset:128
    v_lshlrev_b32 v18, 4, v57
    v_mfma_f32_16x16x32_bf16 v[76:79], a[252:255], a[116:119], v[76:79]
    buffer_load_dwordx4 a[136:139], v1, s[16:19], s96 offen offset:2048 sc1
    v_mfma_f32_16x16x32_bf16 v[68:71], a[252:255], a[112:115], 0
    ds_read_b64_tr_b16 a[226:227], v28 offset:6272
    v_and_b32 v57, 2, v56
    v_mfma_f32_16x16x32_bf16 v[68:71], a[248:251], a[96:99], v[68:71]
    ds_read_b64_tr_b16 a[228:229], v28 offset:12416
    v_bfe_u32 v58, v56, 2, 1
    v_mfma_f32_16x16x32_bf16 v[96:99], a[192:195], a[96:99], 0
    ds_read_b64_tr_b16 a[230:231], v28 offset:18560
    v_or_b32 v57, v57, v58
    v_mfma_f32_16x16x32_bf16 v[96:99], a[196:199], a[112:115], v[96:99]
    v_bfe_u32 v58, v56, 3, 1
    v_lshl_or_b32 v57, v58, 2, v57
    v_mfma_f32_16x16x32_bf16 v[104:107], a[196:199], a[116:119], 0
    buffer_load_dwordx4 a[140:143], v1, s[16:19], s96 offen offset:3072 sc1
    v_mfma_f32_16x16x32_bf16 v[104:107], a[192:195], a[100:103], v[104:107]
    s_add_u32 s96, s49, 12288
    v_xor_b32 v57, v57, v0
    v_lshlrev_b32 v12, 4, v57
    v_mfma_f32_16x16x32_bf16 v[112:115], a[192:195], a[104:107], 0
    ds_read_b64_tr_b16 a[232:233], v29 offset:128
    v_add_u32 v56, 192, v0
    v_mfma_f32_16x16x32_bf16 v[112:115], a[196:199], a[120:123], v[112:115]
    ds_read_b64_tr_b16 a[234:235], v29 offset:6272
    v_mul_hi_u32 v56, v56, s89
    v_mfma_f32_16x16x32_bf16 v[120:123], a[196:199], a[124:127], 0
    buffer_load_dwordx4 a[144:147], v1, s[16:19], s96 offen offset:0 sc1
    v_mfma_f32_16x16x32_bf16 v[120:123], a[192:195], a[108:111], v[120:123]
    ds_read_b64_tr_b16 a[236:237], v29 offset:12416
    v_and_b32 v57, 6, v56
    v_mfma_f32_16x16x32_bf16 v[124:127], a[200:203], a[108:111], 0
    s_waitcnt lgkmcnt(4)
    ds_read_b64_tr_b16 a[238:239], v29 offset:18560
    v_xor_b32 v57, v57, v0
    v_mfma_f32_16x16x32_bf16 v[124:127], a[204:207], a[124:127], v[124:127]
    v_lshlrev_b32 v19, 4, v57
    v_and_b32 v57, 2, v56
    v_mfma_f32_16x16x32_bf16 v[116:119], a[204:207], a[120:123], 0
    v_bfe_u32 v58, v56, 2, 1
    v_mfma_f32_16x16x32_bf16 v[116:119], a[200:203], a[104:107], v[116:119]
    buffer_load_dwordx4 a[148:151], v1, s[16:19], s96 offen offset:1024 sc1
    v_mfma_f32_16x16x32_bf16 v[108:111], a[200:203], a[100:103], 0
    ds_read_b64_tr_b16 a[240:241], v26 offset:256
    v_or_b32 v57, v57, v58
    v_mfma_f32_16x16x32_bf16 v[108:111], a[204:207], a[116:119], v[108:111]
    ds_read_b64_tr_b16 a[242:243], v26 offset:6400
    v_bfe_u32 v58, v56, 3, 1
    v_mfma_f32_16x16x32_bf16 v[100:103], a[204:207], a[112:115], 0
    ds_read_b64_tr_b16 a[244:245], v26 offset:12544
    v_lshl_or_b32 v57, v58, 2, v57
    v_mfma_f32_16x16x32_bf16 v[100:103], a[200:203], a[96:99], v[100:103]
    buffer_load_dwordx4 a[152:155], v1, s[16:19], s96 offen offset:2048 sc1
    v_mfma_f32_16x16x32_bf16 v[128:131], a[208:211], a[96:99], 0
    ds_read_b64_tr_b16 a[246:247], v26 offset:18688
    v_xor_b32 v57, v57, v0
    v_mfma_f32_16x16x32_bf16 v[128:131], a[212:215], a[112:115], v[128:131]
    v_lshlrev_b32 v13, 4, v57
    v_add_u32 v56, 256, v0
    v_mfma_f32_16x16x32_bf16 v[136:139], a[212:215], a[116:119], 0
    v_mul_hi_u32 v56, v56, s89
    v_and_b32 v57, 6, v56
    v_mfma_f32_16x16x32_bf16 v[136:139], a[208:211], a[100:103], v[136:139]
    v_xor_b32 v57, v57, v0
    v_mfma_f32_16x16x32_bf16 v[144:147], a[208:211], a[104:107], 0
    buffer_load_dwordx4 a[156:159], v1, s[16:19], s96 offen offset:3072 sc1
    v_mfma_f32_16x16x32_bf16 v[144:147], a[212:215], a[120:123], v[144:147]
    s_add_u32 m0, s42, 49152
    ds_read_b64_tr_b16 a[248:249], v27 offset:256
    v_lshlrev_b32 v20, 4, v57
    v_mfma_f32_16x16x32_bf16 v[152:155], a[212:215], a[124:127], 0
    ds_read_b64_tr_b16 a[250:251], v27 offset:6400
    v_and_b32 v57, 2, v56
    v_mfma_f32_16x16x32_bf16 v[152:155], a[208:211], a[108:111], v[152:155]
    ds_read_b64_tr_b16 a[252:253], v27 offset:12544
    v_bfe_u32 v58, v56, 2, 1
    v_mfma_f32_16x16x32_bf16 v[156:159], a[216:219], a[108:111], 0
    buffer_load_dwordx4 v2, s[20:23], s57 offen offset:0 lds
    v_mfma_f32_16x16x32_bf16 v[156:159], a[220:223], a[124:127], v[156:159]
    ds_read_b64_tr_b16 a[254:255], v27 offset:18688
    v_or_b32 v57, v57, v58
    v_mfma_f32_16x16x32_bf16 v[148:151], a[220:223], a[120:123], 0
    v_bfe_u32 v58, v56, 3, 1
    v_lshl_or_b32 v57, v58, 2, v57
    v_mfma_f32_16x16x32_bf16 v[148:151], a[216:219], a[104:107], v[148:151]
    v_xor_b32 v57, v57, v0
    v_lshlrev_b32 v14, 4, v57
    v_mfma_f32_16x16x32_bf16 v[140:143], a[216:219], a[100:103], 0
    ds_read_b64_tr_b16 a[192:193], v28 offset:256
    v_add_u32 v20, 4096, v20
    v_mfma_f32_16x16x32_bf16 v[140:143], a[220:223], a[116:119], v[140:143]
    buffer_load_dwordx4 v3, s[20:23], s57 offen offset:1024 lds
    v_mfma_f32_16x16x32_bf16 v[132:135], a[220:223], a[112:115], 0
    ds_read_b64_tr_b16 a[194:195], v28 offset:6400
    v_add_u32 v14, 4096, v14
    v_mfma_f32_16x16x32_bf16 v[132:135], a[216:219], a[96:99], v[132:135]
    ds_read_b64_tr_b16 a[196:197], v28 offset:12544
    v_add_u32 v56, 320, v0
    v_mfma_f32_16x16x32_bf16 v[160:163], a[224:227], a[96:99], 0
    s_waitcnt lgkmcnt(4)
    ds_read_b64_tr_b16 a[198:199], v28 offset:18688
    v_mul_hi_u32 v56, v56, s89
    v_mfma_f32_16x16x32_bf16 v[160:163], a[228:231], a[112:115], v[160:163]
    buffer_load_dwordx4 v4, s[20:23], s57 offen offset:2048 lds
    v_mfma_f32_16x16x32_bf16 v[168:171], a[228:231], a[116:119], 0
    v_and_b32 v57, 6, v56
    v_xor_b32 v57, v57, v0
    v_mfma_f32_16x16x32_bf16 v[168:171], a[224:227], a[100:103], v[168:171]
    v_lshlrev_b32 v21, 4, v57
    v_and_b32 v57, 2, v56
    v_mfma_f32_16x16x32_bf16 v[176:179], a[224:227], a[104:107], 0
    ds_read_b64_tr_b16 a[200:201], v29 offset:256
    v_bfe_u32 v58, v56, 2, 1
    v_mfma_f32_16x16x32_bf16 v[176:179], a[228:231], a[120:123], v[176:179]
    ds_read_b64_tr_b16 a[202:203], v29 offset:6400
    v_or_b32 v57, v57, v58
    v_mfma_f32_16x16x32_bf16 v[184:187], a[228:231], a[124:127], 0
    buffer_load_dwordx4 v5, s[20:23], s57 offen offset:3072 lds
    v_mfma_f32_16x16x32_bf16 v[184:187], a[224:227], a[108:111], v[184:187]
    s_add_u32 m0, m0, 4096
    ds_read_b64_tr_b16 a[204:205], v29 offset:12544
    v_bfe_u32 v58, v56, 3, 1
    v_mfma_f32_16x16x32_bf16 v[188:191], a[232:235], a[108:111], 0
    ds_read_b64_tr_b16 a[206:207], v29 offset:18688
    v_lshl_or_b32 v57, v58, 2, v57
    v_mfma_f32_16x16x32_bf16 v[188:191], a[236:239], a[124:127], v[188:191]
    v_xor_b32 v57, v57, v0
    v_lshlrev_b32 v15, 4, v57
    v_mfma_f32_16x16x32_bf16 v[180:183], a[236:239], a[120:123], 0
    buffer_load_dwordx4 v6, s[20:23], s57 offen offset:0 lds
    v_mfma_f32_16x16x32_bf16 v[180:183], a[232:235], a[104:107], v[180:183]
    v_add_u32 v21, 4096, v21
    v_add_u32 v15, 4096, v15
    v_mfma_f32_16x16x32_bf16 v[172:175], a[232:235], a[100:103], 0
    s_add_u32 s66, s66, s60
    s_addc_u32 s67, s67, 0
    v_mfma_f32_16x16x32_bf16 v[172:175], a[236:239], a[116:119], v[172:175]
    s_add_u32 s68, s68, s60
    s_addc_u32 s69, s69, 0
    v_mfma_f32_16x16x32_bf16 v[164:167], a[236:239], a[112:115], 0
    s_mov_b32 s8, s66
    v_mfma_f32_16x16x32_bf16 v[164:167], a[232:235], a[96:99], v[164:167]
    s_and_b32 s9, s67, 0xffff
    buffer_load_dwordx4 v7, s[20:23], s57 offen offset:1024 lds
    v_mfma_f32_16x16x32_bf16 v[192:195], a[240:243], a[96:99], 0
    s_mov_b32 s10, 196608
    s_add_u32 s57, s57, 786432
    s_add_u32 m0, s97, 122880
    v_mfma_f32_16x16x32_bf16 v[192:195], a[244:247], a[112:115], v[192:195]
    s_mov_b32 s11, 0x20000
    v_mfma_f32_16x16x32_bf16 v[200:203], a[244:247], a[116:119], 0
    s_mov_b32 s43, s42
    v_add_u32 v26, 24576, v22
    v_add_u32 v27, 24576, v23
    v_mfma_f32_16x16x32_bf16 v[200:203], a[240:243], a[100:103], v[200:203]
    s_mov_b32 s44, s42
    buffer_load_dwordx4 v44, s[12:15], s53 offen offset:0 lds
    v_mfma_f32_16x16x32_bf16 v[208:211], a[240:243], a[104:107], 0
    v_add_u32 v28, 24576, v24
    v_add_u32 v29, 24576, v25
    v_mfma_f32_16x16x32_bf16 v[208:211], a[244:247], a[120:123], v[208:211]
    v_mfma_f32_16x16x32_bf16 v[216:219], a[244:247], a[124:127], 0
    v_mfma_f32_16x16x32_bf16 v[216:219], a[240:243], a[108:111], v[216:219]
    v_mfma_f32_16x16x32_bf16 v[220:223], a[248:251], a[108:111], 0
    s_waitcnt lgkmcnt(0)
    v_mfma_f32_16x16x32_bf16 v[220:223], a[252:255], a[124:127], v[220:223]
    v_mfma_f32_16x16x32_bf16 v[212:215], a[252:255], a[120:123], 0
    v_mfma_f32_16x16x32_bf16 v[212:215], a[248:251], a[104:107], v[212:215]
    v_mfma_f32_16x16x32_bf16 v[204:207], a[248:251], a[100:103], 0
    buffer_load_dwordx4 v45, s[12:15], s53 offen offset:1024 lds
    v_mfma_f32_16x16x32_bf16 v[204:207], a[252:255], a[116:119], v[204:207]
    v_mfma_f32_16x16x32_bf16 v[196:199], a[252:255], a[112:115], 0
    s_waitcnt vmcnt(16)
    s_waitcnt lgkmcnt(0)
    s_barrier
    v_mfma_f32_16x16x32_bf16 v[196:199], a[248:251], a[96:99], v[196:199]
    ds_read_b64_tr_b16 a[208:209], v47 offset:12288
    v_mfma_f32_16x16x32_bf16 v[224:227], a[192:195], a[96:99], 0
    ds_read_b64_tr_b16 a[210:211], v47 offset:13824
    v_mfma_f32_16x16x32_bf16 v[224:227], a[196:199], a[112:115], v[224:227]
    ds_read_b64_tr_b16 a[212:213], v47 offset:15360
    v_mfma_f32_16x16x32_bf16 v[232:235], a[196:199], a[116:119], 0
    ds_read_b64_tr_b16 a[214:215], v47 offset:16896
    v_mfma_f32_16x16x32_bf16 v[232:235], a[192:195], a[100:103], v[232:235]
    ds_read_b64_tr_b16 a[216:217], v48 offset:12288
    v_mfma_f32_16x16x32_bf16 v[240:243], a[192:195], a[104:107], 0
    ds_read_b64_tr_b16 a[218:219], v48 offset:13824
    v_mfma_f32_16x16x32_bf16 v[240:243], a[196:199], a[120:123], v[240:243]
    buffer_load_dwordx4 v46, s[12:15], s53 offen offset:2048 lds
    v_mfma_f32_16x16x32_bf16 v[248:251], a[196:199], a[124:127], 0
    s_add_u32 s53, s53, 196608
    ds_read_b64_tr_b16 a[220:221], v48 offset:15360
    s_add_u32 s96, s49, 16384
    v_mfma_f32_16x16x32_bf16 v[248:251], a[192:195], a[108:111], v[248:251]
    ds_read_b64_tr_b16 a[222:223], v48 offset:16896
    v_mfma_f32_16x16x32_bf16 v[252:255], a[200:203], a[108:111], 0
    ds_read_b64_tr_b16 a[224:225], v49 offset:12288
    v_mfma_f32_16x16x32_bf16 v[252:255], a[204:207], a[124:127], v[252:255]
    ds_read_b64_tr_b16 a[226:227], v49 offset:13824
    v_mfma_f32_16x16x32_bf16 v[244:247], a[204:207], a[120:123], 0
    ds_read_b64_tr_b16 a[228:229], v49 offset:15360
    v_mfma_f32_16x16x32_bf16 v[244:247], a[200:203], a[104:107], v[244:247]
    ds_read_b64_tr_b16 a[230:231], v49 offset:16896
    v_mfma_f32_16x16x32_bf16 v[236:239], a[200:203], a[100:103], 0
    ds_read_b64_tr_b16 a[232:233], v47 offset:18432
    v_mfma_f32_16x16x32_bf16 v[236:239], a[204:207], a[116:119], v[236:239]
    ds_read_b64_tr_b16 a[234:235], v47 offset:19968
    v_mfma_f32_16x16x32_bf16 v[228:231], a[204:207], a[112:115], 0
    buffer_load_dwordx4 a[160:163], v1, s[16:19], s96 offen offset:0 sc1
    v_mfma_f32_16x16x32_bf16 v[228:231], a[200:203], a[96:99], v[228:231]
    s_waitcnt vmcnt(17) lgkmcnt(7)
    ds_read_b64_tr_b16 a[236:237], v47 offset:21504
    v_mfma_f32_16x16x32_bf16 a[0:3], a[208:211], a[128:131], a[0:3]
    s_waitcnt vmcnt(13)
    ds_read_b64_tr_b16 a[238:239], v47 offset:23040
    v_mfma_f32_16x16x32_bf16 a[0:3], a[212:215], a[144:147], a[0:3]
    s_waitcnt vmcnt(12)
    ds_read_b64_tr_b16 a[240:241], v48 offset:18432
    v_mfma_f32_16x16x32_bf16 a[4:7], a[212:215], a[148:151], a[4:7]
    ds_read_b64_tr_b16 a[242:243], v48 offset:19968
    v_mfma_f32_16x16x32_bf16 a[4:7], a[208:211], a[132:135], a[4:7]
    buffer_load_dwordx4 a[164:167], v1, s[16:19], s96 offen offset:1024 sc1
    v_mfma_f32_16x16x32_bf16 a[8:11], a[208:211], a[136:139], a[8:11]
    s_waitcnt vmcnt(12)
    ds_read_b64_tr_b16 a[244:245], v48 offset:21504
    v_mfma_f32_16x16x32_bf16 a[8:11], a[212:215], a[152:155], a[8:11]
    s_waitcnt vmcnt(11)
    ds_read_b64_tr_b16 a[246:247], v48 offset:23040
    v_mfma_f32_16x16x32_bf16 a[12:15], a[212:215], a[156:159], a[12:15]
    ds_read_b64_tr_b16 a[248:249], v49 offset:18432
    v_mfma_f32_16x16x32_bf16 a[12:15], a[208:211], a[140:143], a[12:15]
    buffer_load_dwordx4 a[168:171], v1, s[16:19], s96 offen offset:2048 sc1
    v_mfma_f32_16x16x32_bf16 a[28:31], a[216:219], a[140:143], a[28:31]
    s_waitcnt lgkmcnt(6)
    ds_read_b64_tr_b16 a[250:251], v49 offset:19968
    v_mfma_f32_16x16x32_bf16 a[28:31], a[220:223], a[156:159], a[28:31]
    ds_read_b64_tr_b16 a[252:253], v49 offset:21504
    v_mfma_f32_16x16x32_bf16 a[24:27], a[220:223], a[152:155], a[24:27]
    ds_read_b64_tr_b16 a[254:255], v49 offset:23040
    v_mfma_f32_16x16x32_bf16 a[24:27], a[216:219], a[136:139], a[24:27]
    v_mfma_f32_16x16x32_bf16 a[20:23], a[216:219], a[132:135], a[20:23]
    buffer_load_dwordx4 a[172:175], v1, s[16:19], s96 offen offset:3072 sc1
    v_mfma_f32_16x16x32_bf16 a[20:23], a[220:223], a[148:151], a[20:23]
    s_add_u32 s96, s49, 20480
    ds_read_b64_tr_b16 a[192:193], v26 offset:0
    v_mfma_f32_16x16x32_bf16 a[16:19], a[220:223], a[144:147], a[16:19]
    ds_read_b64_tr_b16 a[194:195], v26 offset:6144
    v_mfma_f32_16x16x32_bf16 a[16:19], a[216:219], a[128:131], a[16:19]
    ds_read_b64_tr_b16 a[196:197], v26 offset:12288
    v_mfma_f32_16x16x32_bf16 a[32:35], a[224:227], a[128:131], a[32:35]
    buffer_load_dwordx4 a[176:179], v1, s[16:19], s96 offen offset:0 sc1
    v_mfma_f32_16x16x32_bf16 a[32:35], a[228:231], a[144:147], a[32:35]
    ds_read_b64_tr_b16 a[198:199], v26 offset:18432
    v_mfma_f32_16x16x32_bf16 a[36:39], a[228:231], a[148:151], a[36:39]
    v_mfma_f32_16x16x32_bf16 a[36:39], a[224:227], a[132:135], a[36:39]
    v_mfma_f32_16x16x32_bf16 a[40:43], a[224:227], a[136:139], a[40:43]
    ds_read_b64_tr_b16 a[200:201], v27 offset:0
    v_mfma_f32_16x16x32_bf16 a[40:43], a[228:231], a[152:155], a[40:43]
    buffer_load_dwordx4 a[180:183], v1, s[16:19], s96 offen offset:1024 sc1
    v_mfma_f32_16x16x32_bf16 a[44:47], a[228:231], a[156:159], a[44:47]
    ds_read_b64_tr_b16 a[202:203], v27 offset:6144
    v_mfma_f32_16x16x32_bf16 a[44:47], a[224:227], a[140:143], a[44:47]
    ds_read_b64_tr_b16 a[204:205], v27 offset:12288
    v_mfma_f32_16x16x32_bf16 a[60:63], a[232:235], a[140:143], a[60:63]
    s_waitcnt lgkmcnt(4)
    ds_read_b64_tr_b16 a[206:207], v27 offset:18432
    v_mfma_f32_16x16x32_bf16 a[60:63], a[236:239], a[156:159], a[60:63]
    buffer_load_dwordx4 a[184:187], v1, s[16:19], s96 offen offset:2048 sc1
    v_mfma_f32_16x16x32_bf16 a[56:59], a[236:239], a[152:155], a[56:59]
    v_mfma_f32_16x16x32_bf16 a[56:59], a[232:235], a[136:139], a[56:59]
    v_mfma_f32_16x16x32_bf16 a[52:55], a[232:235], a[132:135], a[52:55]
    ds_read_b64_tr_b16 a[208:209], v28 offset:0
    v_mfma_f32_16x16x32_bf16 a[52:55], a[236:239], a[148:151], a[52:55]
    ds_read_b64_tr_b16 a[210:211], v28 offset:6144
    v_mfma_f32_16x16x32_bf16 a[48:51], a[236:239], a[144:147], a[48:51]
    buffer_load_dwordx4 a[188:191], v1, s[16:19], s96 offen offset:3072 sc1
    v_mfma_f32_16x16x32_bf16 a[48:51], a[232:235], a[128:131], a[48:51]
    s_add_u32 m0, s42, 73728
    ds_read_b64_tr_b16 a[212:213], v28 offset:12288
    v_mfma_f32_16x16x32_bf16 a[64:67], a[240:243], a[128:131], a[64:67]
    ds_read_b64_tr_b16 a[214:215], v28 offset:18432
    v_mfma_f32_16x16x32_bf16 a[64:67], a[244:247], a[144:147], a[64:67]
    v_mfma_f32_16x16x32_bf16 a[68:71], a[244:247], a[148:151], a[68:71]
    buffer_load_dwordx4 v2, s[20:23], s57 offen offset:0 lds
    v_mfma_f32_16x16x32_bf16 a[68:71], a[240:243], a[132:135], a[68:71]
    v_mfma_f32_16x16x32_bf16 a[72:75], a[240:243], a[136:139], a[72:75]
    ds_read_b64_tr_b16 a[216:217], v29 offset:0
    v_mfma_f32_16x16x32_bf16 a[72:75], a[244:247], a[152:155], a[72:75]
    ds_read_b64_tr_b16 a[218:219], v29 offset:6144
    v_mfma_f32_16x16x32_bf16 a[76:79], a[244:247], a[156:159], a[76:79]
    ds_read_b64_tr_b16 a[220:221], v29 offset:12288
    v_mfma_f32_16x16x32_bf16 a[76:79], a[240:243], a[140:143], a[76:79]
    buffer_load_dwordx4 v3, s[20:23], s57 offen offset:1024 lds
    v_mfma_f32_16x16x32_bf16 a[92:95], a[248:251], a[140:143], a[92:95]
    ds_read_b64_tr_b16 a[222:223], v29 offset:18432
    v_mfma_f32_16x16x32_bf16 a[92:95], a[252:255], a[156:159], a[92:95]
    v_mfma_f32_16x16x32_bf16 a[88:91], a[252:255], a[152:155], a[88:91]
    v_mfma_f32_16x16x32_bf16 a[88:91], a[248:251], a[136:139], a[88:91]
    buffer_load_dwordx4 v4, s[20:23], s57 offen offset:2048 lds
    v_mfma_f32_16x16x32_bf16 a[84:87], a[248:251], a[132:135], a[84:87]
    ds_read_b64_tr_b16 a[224:225], v26 offset:128
    v_mfma_f32_16x16x32_bf16 a[84:87], a[252:255], a[148:151], a[84:87]
    ds_read_b64_tr_b16 a[226:227], v26 offset:6272
    v_mfma_f32_16x16x32_bf16 a[80:83], a[252:255], a[144:147], a[80:83]
    ds_read_b64_tr_b16 a[228:229], v26 offset:12416
    v_mfma_f32_16x16x32_bf16 a[80:83], a[248:251], a[128:131], a[80:83]
    ds_read_b64_tr_b16 a[230:231], v26 offset:18560
    v_mfma_f32_16x16x32_bf16 v[64:67], a[192:195], a[128:131], v[64:67]
WS0:
    s_cbranch_execz MAINC
    s_waitcnt lgkmcnt(5)
    buffer_load_dwordx4 v5, s[20:23], s57 offen offset:3072 lds
    v_mfma_f32_16x16x32_bf16 v[64:67], a[196:199], a[144:147], v[64:67]
    s_add_u32 m0, m0, 4096
    v_mfma_f32_16x16x32_bf16 v[72:75], a[196:199], a[148:151], v[72:75]
    v_mfma_f32_16x16x32_bf16 v[72:75], a[192:195], a[132:135], v[72:75]
    v_mfma_f32_16x16x32_bf16 v[80:83], a[192:195], a[136:139], v[80:83]
    buffer_load_dwordx4 v6, s[20:23], s57 offen offset:0 lds
    v_mfma_f32_16x16x32_bf16 v[80:83], a[196:199], a[152:155], v[80:83]
    ds_read_b64_tr_b16 a[232:233], v27 offset:128
    v_mfma_f32_16x16x32_bf16 v[88:91], a[196:199], a[156:159], v[88:91]
    ds_read_b64_tr_b16 a[234:235], v27 offset:6272
    v_mfma_f32_16x16x32_bf16 v[88:91], a[192:195], a[140:143], v[88:91]
    ds_read_b64_tr_b16 a[236:237], v27 offset:12416
    v_mfma_f32_16x16x32_bf16 v[92:95], a[200:203], a[140:143], v[92:95]
    s_and_b32 s84, s40, 7
    ds_read_b64_tr_b16 a[238:239], v27 offset:18560
    v_mfma_f32_16x16x32_bf16 v[92:95], a[204:207], a[156:159], v[92:95]
    s_lshr_b32 s85, s40, 3
    buffer_load_dwordx4 v7, s[20:23], s57 offen offset:1024 lds
    v_mfma_f32_16x16x32_bf16 v[84:87], a[204:207], a[152:155], v[84:87]
    s_mul_i32 s85, s85, 10
    s_add_u32 s57, s57, 786432
    s_add_u32 m0, s97, 135168
    v_mfma_f32_16x16x32_bf16 v[84:87], a[200:203], a[136:139], v[84:87]
    s_lshl_b32 s39, s41, 2
    v_mfma_f32_16x16x32_bf16 v[76:79], a[200:203], a[132:135], v[76:79]
    s_add_u32 s39, s39, s3
    ds_read_b64_tr_b16 a[240:241], v28 offset:128
    v_mfma_f32_16x16x32_bf16 v[76:79], a[204:207], a[148:151], v[76:79]
    s_lshl_b32 s39, s39, 2
    buffer_load_dwordx4 v44, s[12:15], s53 offen offset:0 lds
    v_mfma_f32_16x16x32_bf16 v[68:71], a[204:207], a[144:147], v[68:71]
    s_mul_i32 s70, s3, 24576
    ds_read_b64_tr_b16 a[242:243], v28 offset:6272
    v_mfma_f32_16x16x32_bf16 v[68:71], a[200:203], a[128:131], v[68:71]
    s_add_u32 s70, s70, 4194304
    ds_read_b64_tr_b16 a[244:245], v28 offset:12416
    v_mfma_f32_16x16x32_bf16 v[96:99], a[208:211], a[128:131], v[96:99]
    s_mul_i32 s71, s39, 49152
    ds_read_b64_tr_b16 a[246:247], v28 offset:18560
    v_mfma_f32_16x16x32_bf16 v[96:99], a[212:215], a[144:147], v[96:99]
    s_add_u32 s71, s71, 29360128
    v_mfma_f32_16x16x32_bf16 v[104:107], a[212:215], a[148:151], v[104:107]
    s_mul_i32 s95, s55, 3
    v_mfma_f32_16x16x32_bf16 v[104:107], a[208:211], a[132:135], v[104:107]
    s_add_u32 s95, s95, 1
    v_mfma_f32_16x16x32_bf16 v[112:115], a[208:211], a[136:139], v[112:115]
    s_lshr_b32 s95, s95, 1
    ds_read_b64_tr_b16 a[248:249], v29 offset:128
    v_mfma_f32_16x16x32_bf16 v[112:115], a[212:215], a[152:155], v[112:115]
    s_lshl_b32 s95, s95, 10
    ds_read_b64_tr_b16 a[250:251], v29 offset:6272
    v_mfma_f32_16x16x32_bf16 v[120:123], a[212:215], a[156:159], v[120:123]
    s_add_u32 s71, s71, s95
    buffer_load_dwordx4 v45, s[12:15], s53 offen offset:1024 lds
    v_mfma_f32_16x16x32_bf16 v[120:123], a[208:211], a[140:143], v[120:123]
    s_and_b32 s94, s55, 1
    ds_read_b64_tr_b16 a[252:253], v29 offset:12416
    v_mfma_f32_16x16x32_bf16 v[124:127], a[216:219], a[140:143], v[124:127]
    s_waitcnt lgkmcnt(4)
    ds_read_b64_tr_b16 a[254:255], v29 offset:18560
    s_mul_i32 s95, s94, 2040
    v_mfma_f32_16x16x32_bf16 v[124:127], a[220:223], a[156:159], v[124:127]
    s_and_b32 s94, s40, 1
    v_mfma_f32_16x16x32_bf16 v[116:119], a[220:223], a[152:155], v[116:119]
    s_add_u32 s74, s71, 1024
    v_mfma_f32_16x16x32_bf16 v[116:119], a[216:219], a[136:139], v[116:119]
    s_sub_u32 s74, s74, s95
    v_mfma_f32_16x16x32_bf16 v[108:111], a[216:219], a[132:135], v[108:111]
    s_lshr_b32 s5, s84, 1
    ds_read_b64_tr_b16 a[192:193], v26 offset:256
    v_mfma_f32_16x16x32_bf16 v[108:111], a[220:223], a[148:151], v[108:111]
    s_add_u32 s39, s39, s5
    ds_read_b64_tr_b16 a[194:195], v26 offset:6400
    v_mfma_f32_16x16x32_bf16 v[100:103], a[220:223], a[144:147], v[100:103]
    s_lshl_b32 s76, s41, 4
    ds_read_b64_tr_b16 a[196:197], v26 offset:12544
    v_mfma_f32_16x16x32_bf16 v[100:103], a[216:219], a[128:131], v[100:103]
    s_add_u32 s76, s76, s5
    buffer_load_dwordx4 v46, s[12:15], s53 offen offset:2048 lds
    v_mfma_f32_16x16x32_bf16 v[128:131], a[224:227], a[128:131], v[128:131]
    s_mul_i32 s76, s76, 49152
    ds_read_b64_tr_b16 a[198:199], v26 offset:18688
    s_add_u32 s53, s53, 196608
    v_mfma_f32_16x16x32_bf16 v[128:131], a[228:231], a[144:147], v[128:131]
    s_mul_i32 s95, s3, 12288
    v_add_u32 v38, s54, v61
    v_mfma_f32_16x16x32_bf16 v[136:139], a[228:231], a[148:151], v[136:139]
    s_add_u32 s76, s76, s95
    v_mfma_f32_16x16x32_bf16 v[136:139], a[224:227], a[132:135], v[136:139]
    s_add_u32 s76, s76, 29360128
    v_mfma_f32_16x16x32_bf16 v[144:147], a[224:227], a[136:139], v[144:147]
    s_lshr_b32 s75, s3, 1
    ds_read_b64_tr_b16 a[200:201], v27 offset:256
    v_mfma_f32_16x16x32_bf16 v[144:147], a[228:231], a[152:155], v[144:147]
    s_mul_i32 s75, s75, 40
    ds_read_b64_tr_b16 a[202:203], v27 offset:6400
    v_mfma_f32_16x16x32_bf16 v[152:155], a[228:231], a[156:159], v[152:155]
    s_and_b32 s95, s3, 1
    ds_read_b64_tr_b16 a[204:205], v27 offset:12544
    v_mfma_f32_16x16x32_bf16 v[152:155], a[224:227], a[140:143], v[152:155]
    s_xor_b32 s95, s95, s94
    ds_read_b64_tr_b16 a[206:207], v27 offset:18688
    v_mfma_f32_16x16x32_bf16 v[156:159], a[232:235], a[140:143], v[156:159]
    s_mul_i32 s95, s95, 5
    buffer_store_dword v38, v43, s[16:19], 0 offen offset:12 sc1
    v_mfma_f32_16x16x32_bf16 v[156:159], a[236:239], a[156:159], v[156:159]
    s_add_u32 s75, s75, s95
    s_add_u32 s96, s49, 24576
    v_mfma_f32_16x16x32_bf16 v[148:151], a[236:239], a[152:155], v[148:151]
    s_add_u32 s75, s75, s85
    v_mfma_f32_16x16x32_bf16 v[148:151], a[232:235], a[136:139], v[148:151]
    s_lshl_b32 s75, s75, 10
    v_mfma_f32_16x16x32_bf16 v[140:143], a[232:235], a[132:135], v[140:143]
    s_add_u32 s75, s75, 52428800
    ds_read_b64_tr_b16 a[208:209], v28 offset:256
    v_mfma_f32_16x16x32_bf16 v[140:143], a[236:239], a[148:151], v[140:143]
    s_add_u32 s95, s3, 0
    buffer_load_dwordx4 a[96:99], v1, s[16:19], s96 offen offset:0 sc1
    v_mfma_f32_16x16x32_bf16 v[132:135], a[236:239], a[144:147], v[132:135]
    ds_read_b64_tr_b16 a[210:211], v28 offset:6400
    v_mfma_f32_16x16x32_bf16 v[132:135], a[232:235], a[128:131], v[132:135]
    ds_read_b64_tr_b16 a[212:213], v28 offset:12544
    v_mfma_f32_16x16x32_bf16 v[160:163], a[240:243], a[128:131], v[160:163]
    s_waitcnt lgkmcnt(3)
    ds_read_b64_tr_b16 a[214:215], v28 offset:18688
    v_mfma_f32_16x16x32_bf16 v[160:163], a[244:247], a[144:147], v[160:163]
    buffer_load_dwordx4 a[100:103], v1, s[16:19], s96 offen offset:1024 sc1
    v_mfma_f32_16x16x32_bf16 v[168:171], a[244:247], a[148:151], v[168:171]
    s_cmp_ge_u32 s95, 6
    s_cselect_b32 s89, 6, 0
    s_cselect_b32 s36, 0, 1
    v_mfma_f32_16x16x32_bf16 v[168:171], a[240:243], a[132:135], v[168:171]
    s_sub_u32 s95, s95, s89
    s_xor_b32 s36, s36, s94
    s_mul_i32 s36, s36, 5
    v_mfma_f32_16x16x32_bf16 v[176:179], a[240:243], a[136:139], v[176:179]
    s_add_u32 s36, s36, s85
    ds_read_b64_tr_b16 a[216:217], v29 offset:256
    s_lshr_b32 s89, s95, 1
    v_mfma_f32_16x16x32_bf16 v[176:179], a[244:247], a[152:155], v[176:179]
    s_add_u32 s89, s89, 1
    ds_read_b64_tr_b16 a[218:219], v29 offset:6400
    s_lshl_b32 s89, s89, 3
    v_mfma_f32_16x16x32_bf16 v[184:187], a[244:247], a[156:159], v[184:187]
    s_xor_b32 s89, s89, s40
    buffer_load_dwordx4 a[104:107], v1, s[16:19], s96 offen offset:2048 sc1
    v_mfma_f32_16x16x32_bf16 v[184:187], a[240:243], a[140:143], v[184:187]
    s_mul_i32 s89, s89, 6
    ds_read_b64_tr_b16 a[220:221], v29 offset:12544
    v_mfma_f32_16x16x32_bf16 v[188:191], a[248:251], a[140:143], v[188:191]
    s_and_b32 s95, s95, 1
    ds_read_b64_tr_b16 a[222:223], v29 offset:18688
    v_mfma_f32_16x16x32_bf16 v[188:191], a[252:255], a[156:159], v[188:191]
    s_add_u32 s89, s89, s95
    v_mfma_f32_16x16x32_bf16 v[180:183], a[252:255], a[152:155], v[180:183]
    s_add_u32 s89, s89, 4
    buffer_load_dwordx4 a[108:111], v1, s[16:19], s96 offen offset:3072 sc1
    v_mfma_f32_16x16x32_bf16 v[180:183], a[248:251], a[136:139], v[180:183]
    s_mul_i32 s89, s89, 40
    s_add_u32 s96, s49, 28672
    v_mfma_f32_16x16x32_bf16 v[172:175], a[248:251], a[132:135], v[172:175]
    s_add_u32 s36, s36, s89
    v_mfma_f32_16x16x32_bf16 v[172:175], a[252:255], a[148:151], v[172:175]
    s_lshl_b32 s36, s36, 10
    v_mfma_f32_16x16x32_bf16 v[164:167], a[252:255], a[144:147], v[164:167]
    s_add_u32 s36, s36, 52428800
    v_mfma_f32_16x16x32_bf16 v[164:167], a[248:251], a[128:131], v[164:167]
    s_add_u32 s95, s3, 4
    buffer_load_dwordx4 a[112:115], v1, s[16:19], s96 offen offset:0 sc1
    v_mfma_f32_16x16x32_bf16 v[192:195], a[192:195], a[128:131], v[192:195]
    s_cmp_ge_u32 s95, 6
    s_cselect_b32 s89, 6, 0
    s_cselect_b32 s37, 0, 1
    v_mfma_f32_16x16x32_bf16 v[192:195], a[196:199], a[144:147], v[192:195]
    s_sub_u32 s95, s95, s89
    v_mfma_f32_16x16x32_bf16 v[200:203], a[196:199], a[148:151], v[200:203]
    s_xor_b32 s37, s37, s94
    v_add_u32 v26, 49152, v22
    v_add_u32 v27, 49152, v23
    v_mfma_f32_16x16x32_bf16 v[200:203], a[192:195], a[132:135], v[200:203]
    s_mul_i32 s37, s37, 5
    buffer_load_dwordx4 a[116:119], v1, s[16:19], s96 offen offset:1024 sc1
    v_mfma_f32_16x16x32_bf16 v[208:211], a[192:195], a[136:139], v[208:211]
    s_add_u32 s37, s37, s85
    v_add_u32 v28, 49152, v24
    v_add_u32 v29, 49152, v25
    v_mfma_f32_16x16x32_bf16 v[208:211], a[196:199], a[152:155], v[208:211]
    s_lshr_b32 s89, s95, 1
    v_mfma_f32_16x16x32_bf16 v[216:219], a[196:199], a[156:159], v[216:219]
    s_add_u32 s89, s89, 1
    v_mfma_f32_16x16x32_bf16 v[216:219], a[192:195], a[140:143], v[216:219]
    s_lshl_b32 s89, s89, 3
    v_mfma_f32_16x16x32_bf16 v[220:223], a[200:203], a[140:143], v[220:223]
    s_xor_b32 s89, s89, s40
    buffer_load_dwordx4 a[120:123], v1, s[16:19], s96 offen offset:2048 sc1
    v_mfma_f32_16x16x32_bf16 v[220:223], a[204:207], a[156:159], v[220:223]
    s_mul_i32 s89, s89, 6
    v_mfma_f32_16x16x32_bf16 v[212:215], a[204:207], a[152:155], v[212:215]
    s_and_b32 s95, s95, 1
    v_mfma_f32_16x16x32_bf16 v[212:215], a[200:203], a[136:139], v[212:215]
    s_add_u32 s89, s89, s95
    v_mfma_f32_16x16x32_bf16 v[204:207], a[200:203], a[132:135], v[204:207]
    s_add_u32 s89, s89, 4
    buffer_load_dwordx4 a[124:127], v1, s[16:19], s96 offen offset:3072 sc1
    v_mfma_f32_16x16x32_bf16 v[204:207], a[204:207], a[148:151], v[204:207]
    s_mul_i32 s89, s89, 40
    s_add_u32 m0, s42, 0
    v_mfma_f32_16x16x32_bf16 v[196:199], a[204:207], a[144:147], v[196:199]
    s_add_u32 s37, s37, s89
    s_waitcnt vmcnt(26)
    s_waitcnt lgkmcnt(0)
    s_barrier
    v_mfma_f32_16x16x32_bf16 v[196:199], a[200:203], a[128:131], v[196:199]
    s_lshl_b32 s37, s37, 10
    ds_read_b64_tr_b16 a[224:225], v47 offset:24576
    v_mfma_f32_16x16x32_bf16 v[224:227], a[208:211], a[128:131], v[224:227]
    s_add_u32 s37, s37, 52428800
    ds_read_b64_tr_b16 a[226:227], v47 offset:26112
    v_mfma_f32_16x16x32_bf16 v[224:227], a[212:215], a[144:147], v[224:227]
    s_add_u32 s95, s3, 8
    buffer_load_dwordx4 v2, s[20:23], s57 offen offset:0 lds
    v_mfma_f32_16x16x32_bf16 v[232:235], a[212:215], a[148:151], v[232:235]
    ds_read_b64_tr_b16 a[228:229], v47 offset:27648
    v_mfma_f32_16x16x32_bf16 v[232:235], a[208:211], a[132:135], v[232:235]
    ds_read_b64_tr_b16 a[230:231], v47 offset:29184
    v_mfma_f32_16x16x32_bf16 v[240:243], a[208:211], a[136:139], v[240:243]
    ds_read_b64_tr_b16 a[232:233], v48 offset:24576
    v_mfma_f32_16x16x32_bf16 v[240:243], a[212:215], a[152:155], v[240:243]
    buffer_load_dwordx4 v3, s[20:23], s57 offen offset:1024 lds
    v_mfma_f32_16x16x32_bf16 v[248:251], a[212:215], a[156:159], v[248:251]
    ds_read_b64_tr_b16 a[234:235], v48 offset:26112
    v_mfma_f32_16x16x32_bf16 v[248:251], a[208:211], a[140:143], v[248:251]
    ds_read_b64_tr_b16 a[236:237], v48 offset:27648
    v_mfma_f32_16x16x32_bf16 v[252:255], a[216:219], a[140:143], v[252:255]
    ds_read_b64_tr_b16 a[238:239], v48 offset:29184
    v_mfma_f32_16x16x32_bf16 v[252:255], a[220:223], a[156:159], v[252:255]
    ds_read_b64_tr_b16 a[240:241], v49 offset:24576
    v_mfma_f32_16x16x32_bf16 v[244:247], a[220:223], a[152:155], v[244:247]
    buffer_load_dwordx4 v4, s[20:23], s57 offen offset:2048 lds
    v_mfma_f32_16x16x32_bf16 v[244:247], a[216:219], a[136:139], v[244:247]
    ds_read_b64_tr_b16 a[242:243], v49 offset:26112
    v_mfma_f32_16x16x32_bf16 v[236:239], a[216:219], a[132:135], v[236:239]
    ds_read_b64_tr_b16 a[244:245], v49 offset:27648
    v_mfma_f32_16x16x32_bf16 v[236:239], a[220:223], a[148:151], v[236:239]
    ds_read_b64_tr_b16 a[246:247], v49 offset:29184
    v_mfma_f32_16x16x32_bf16 v[228:231], a[220:223], a[144:147], v[228:231]
    buffer_load_dwordx4 v5, s[20:23], s57 offen offset:3072 lds
    v_mfma_f32_16x16x32_bf16 v[228:231], a[216:219], a[128:131], v[228:231]
    s_waitcnt vmcnt(29) lgkmcnt(6)
    ds_read_b64_tr_b16 a[248:249], v47 offset:30720
    s_add_u32 m0, m0, 4096
    v_mfma_f32_16x16x32_bf16 a[0:3], a[224:227], a[160:163], a[0:3]
    s_waitcnt vmcnt(25)
    ds_read_b64_tr_b16 a[250:251], v47 offset:32256
    v_mfma_f32_16x16x32_bf16 a[0:3], a[228:231], a[176:179], a[0:3]
    s_waitcnt vmcnt(24)
    ds_read_b64_tr_b16 a[252:253], v47 offset:33792
    v_mfma_f32_16x16x32_bf16 a[4:7], a[228:231], a[180:183], a[4:7]
    ds_read_b64_tr_b16 a[254:255], v47 offset:35328
    v_mfma_f32_16x16x32_bf16 a[4:7], a[224:227], a[164:167], a[4:7]
    buffer_load_dwordx4 v6, s[20:23], s57 offen offset:0 lds
    v_mfma_f32_16x16x32_bf16 a[8:11], a[224:227], a[168:171], a[8:11]
    s_waitcnt vmcnt(24)
    ds_read_b64_tr_b16 a[192:193], v48 offset:30720
    v_mfma_f32_16x16x32_bf16 a[8:11], a[228:231], a[184:187], a[8:11]
    s_waitcnt vmcnt(23)
    ds_read_b64_tr_b16 a[194:195], v48 offset:32256
    v_mfma_f32_16x16x32_bf16 a[12:15], a[228:231], a[188:191], a[12:15]
    ds_read_b64_tr_b16 a[196:197], v48 offset:33792
    v_mfma_f32_16x16x32_bf16 a[12:15], a[224:227], a[172:175], a[12:15]
    buffer_load_dwordx4 v7, s[20:23], s57 offen offset:1024 lds
    v_mfma_f32_16x16x32_bf16 a[28:31], a[232:235], a[172:175], a[28:31]
    s_waitcnt lgkmcnt(6)
    ds_read_b64_tr_b16 a[198:199], v48 offset:35328
    s_add_u32 s57, s57, 786432
    v_mfma_f32_16x16x32_bf16 a[28:31], a[236:239], a[188:191], a[28:31]
    s_add_u32 m0, s97, 98304
    ds_read_b64_tr_b16 a[200:201], v49 offset:30720
    v_mfma_f32_16x16x32_bf16 a[24:27], a[236:239], a[184:187], a[24:27]
    ds_read_b64_tr_b16 a[202:203], v49 offset:32256
    v_mfma_f32_16x16x32_bf16 a[24:27], a[232:235], a[168:171], a[24:27]
    ds_read_b64_tr_b16 a[204:205], v49 offset:33792
    v_mfma_f32_16x16x32_bf16 a[20:23], a[232:235], a[164:167], a[20:23]
    buffer_load_dwordx4 v44, s[12:15], s53 offen offset:0 lds
    v_mfma_f32_16x16x32_bf16 a[20:23], a[236:239], a[180:183], a[20:23]
    ds_read_b64_tr_b16 a[206:207], v49 offset:35328
    v_mfma_f32_16x16x32_bf16 a[16:19], a[236:239], a[176:179], a[16:19]
    ds_read_b64_tr_b16 a[208:209], v26 offset:0
    v_mfma_f32_16x16x32_bf16 a[16:19], a[232:235], a[160:163], a[16:19]
    ds_read_b64_tr_b16 a[210:211], v26 offset:6144
    v_mfma_f32_16x16x32_bf16 a[32:35], a[240:243], a[160:163], a[32:35]
    ds_read_b64_tr_b16 a[212:213], v26 offset:12288
    v_mfma_f32_16x16x32_bf16 a[32:35], a[244:247], a[176:179], a[32:35]
    ds_read_b64_tr_b16 a[214:215], v26 offset:18432
    v_mfma_f32_16x16x32_bf16 a[36:39], a[244:247], a[180:183], a[36:39]
    s_cmp_ge_u32 s95, 6
    s_cselect_b32 s89, 6, 0
    s_cselect_b32 s38, 0, 1
    v_mfma_f32_16x16x32_bf16 a[36:39], a[240:243], a[164:167], a[36:39]
    s_sub_u32 s95, s95, s89
    s_xor_b32 s38, s38, s94
    s_mul_i32 s38, s38, 5
    v_mfma_f32_16x16x32_bf16 a[40:43], a[240:243], a[168:171], a[40:43]
    s_add_u32 s38, s38, s85
    ds_read_b64_tr_b16 a[216:217], v27 offset:0
    s_lshr_b32 s89, s95, 1
    v_mfma_f32_16x16x32_bf16 a[40:43], a[244:247], a[184:187], a[40:43]
    s_add_u32 s89, s89, 1
    buffer_load_dwordx4 v45, s[12:15], s53 offen offset:1024 lds
    v_mfma_f32_16x16x32_bf16 a[44:47], a[244:247], a[188:191], a[44:47]
    s_lshl_b32 s89, s89, 3
    ds_read_b64_tr_b16 a[218:219], v27 offset:6144
    s_xor_b32 s89, s89, s40
    v_mfma_f32_16x16x32_bf16 a[44:47], a[240:243], a[172:175], a[44:47]
    s_waitcnt lgkmcnt(5)
    ds_read_b64_tr_b16 a[220:221], v27 offset:12288
    s_mul_i32 s89, s89, 6
    v_mfma_f32_16x16x32_bf16 a[60:63], a[248:251], a[172:175], a[60:63]
    s_and_b32 s95, s95, 1
    ds_read_b64_tr_b16 a[222:223], v27 offset:18432
    s_add_u32 s89, s89, s95
    v_mfma_f32_16x16x32_bf16 a[60:63], a[252:255], a[188:191], a[60:63]
    s_add_u32 s89, s89, 4
    s_mul_i32 s89, s89, 40
    s_add_u32 s38, s38, s89
    v_mfma_f32_16x16x32_bf16 a[56:59], a[252:255], a[184:187], a[56:59]
    s_lshl_b32 s38, s38, 10
    s_add_u32 s38, s38, 52428800
    s_mul_i32 s95, s94, 5
    v_mfma_f32_16x16x32_bf16 a[56:59], a[248:251], a[168:171], a[56:59]
    s_add_u32 s85, s85, s95
    s_add_u32 s77, s3, 16
    s_mul_i32 s77, s77, 480
    v_mfma_f32_16x16x32_bf16 a[52:55], a[248:251], a[164:167], a[52:55]
    s_add_u32 s77, s77, s85
    ds_read_b64_tr_b16 a[224:225], v28 offset:0
    s_lshl_b32 s77, s77, 10
    v_mfma_f32_16x16x32_bf16 a[52:55], a[252:255], a[180:183], a[52:55]
    s_add_u32 s77, s77, 52428800
    ds_read_b64_tr_b16 a[226:227], v28 offset:6144
    s_lshl_b32 s85, s85, 5
    v_mfma_f32_16x16x32_bf16 a[48:51], a[252:255], a[176:179], a[48:51]
    s_mul_i32 s39, s39, 20480
    buffer_load_dwordx4 v46, s[12:15], s53 offen offset:2048 lds
    v_mfma_f32_16x16x32_bf16 a[48:51], a[248:251], a[160:163], a[48:51]
    s_add_u32 s4, s39, s85
    ds_read_b64_tr_b16 a[228:229], v28 offset:12288
    s_and_b32 s95, s2, 0xf9
    v_mfma_f32_16x16x32_bf16 a[64:67], a[192:195], a[160:163], a[64:67]
    s_xor_b32 s95, s95, 1
    ds_read_b64_tr_b16 a[230:231], v28 offset:18432
    s_lshl_b32 s95, s95, 3
    v_mfma_f32_16x16x32_bf16 a[64:67], a[196:199], a[176:179], a[64:67]
    s_add_u32 s95, s95, s84
    s_lshl_b32 s95, s95, 2
    s_add_u32 s95, s95, s3
    v_mfma_f32_16x16x32_bf16 a[68:71], a[196:199], a[180:183], a[68:71]
    s_mul_i32 s95, s95, 2560
    s_add_u32 s78, s95, 67108864
    s_lshl_b32 s95, s2, 5
    v_mfma_f32_16x16x32_bf16 a[68:71], a[192:195], a[164:167], a[68:71]
    s_add_u32 s95, s95, s3
    s_mul_i32 s95, s95, 2560
    s_add_u32 s79, s95, 67108864
    v_mfma_f32_16x16x32_bf16 a[72:75], a[192:195], a[168:171], a[72:75]
    s_lshl_b32 s95, s84, 5
    ds_read_b64_tr_b16 a[232:233], v29 offset:0
    s_lshr_b32 s39, s2, 3
    v_mfma_f32_16x16x32_bf16 a[72:75], a[196:199], a[184:187], a[72:75]
    s_add_u32 s39, s39, s95
    ds_read_b64_tr_b16 a[234:235], v29 offset:6144
    s_add_u32 s53, s53, 196608
    v_mfma_f32_16x16x32_bf16 a[76:79], a[196:199], a[188:191], a[76:79]
    s_add_u32 s96, s49, 32768
    ds_read_b64_tr_b16 a[236:237], v29 offset:12288
    v_mfma_f32_16x16x32_bf16 a[76:79], a[192:195], a[172:175], a[76:79]
    buffer_load_dwordx4 a[128:131], v1, s[16:19], s96 offen offset:0 sc1
    v_mfma_f32_16x16x32_bf16 a[92:95], a[200:203], a[172:175], a[92:95]
    ds_read_b64_tr_b16 a[238:239], v29 offset:18432
    v_mfma_f32_16x16x32_bf16 a[92:95], a[204:207], a[188:191], a[92:95]
    v_mfma_f32_16x16x32_bf16 a[88:91], a[204:207], a[184:187], a[88:91]
    v_mfma_f32_16x16x32_bf16 a[88:91], a[200:203], a[168:171], a[88:91]
    buffer_load_dwordx4 a[132:135], v1, s[16:19], s96 offen offset:1024 sc1
    v_mfma_f32_16x16x32_bf16 a[84:87], a[200:203], a[164:167], a[84:87]
    ds_read_b64_tr_b16 a[240:241], v26 offset:128
    v_mfma_f32_16x16x32_bf16 a[84:87], a[204:207], a[180:183], a[84:87]
    ds_read_b64_tr_b16 a[242:243], v26 offset:6272
    v_mfma_f32_16x16x32_bf16 a[80:83], a[204:207], a[176:179], a[80:83]
    ds_read_b64_tr_b16 a[244:245], v26 offset:12416
    v_mfma_f32_16x16x32_bf16 a[80:83], a[200:203], a[160:163], a[80:83]
    s_waitcnt lgkmcnt(4)
    ds_read_b64_tr_b16 a[246:247], v26 offset:18560
    v_mfma_f32_16x16x32_bf16 v[64:67], a[208:211], a[160:163], v[64:67]
    buffer_load_dwordx4 a[136:139], v1, s[16:19], s96 offen offset:2048 sc1
    v_mfma_f32_16x16x32_bf16 v[64:67], a[212:215], a[176:179], v[64:67]
    v_mfma_f32_16x16x32_bf16 v[72:75], a[212:215], a[180:183], v[72:75]
    v_mfma_f32_16x16x32_bf16 v[72:75], a[208:211], a[164:167], v[72:75]
    v_mfma_f32_16x16x32_bf16 v[80:83], a[208:211], a[168:171], v[80:83]
    buffer_load_dwordx4 a[140:143], v1, s[16:19], s96 offen offset:3072 sc1
    v_mfma_f32_16x16x32_bf16 v[80:83], a[212:215], a[184:187], v[80:83]
    s_add_u32 s96, s49, 36864
    ds_read_b64_tr_b16 a[248:249], v27 offset:128
    v_mfma_f32_16x16x32_bf16 v[88:91], a[212:215], a[188:191], v[88:91]
    ds_read_b64_tr_b16 a[250:251], v27 offset:6272
    v_mfma_f32_16x16x32_bf16 v[88:91], a[208:211], a[172:175], v[88:91]
    ds_read_b64_tr_b16 a[252:253], v27 offset:12416
    v_mfma_f32_16x16x32_bf16 v[92:95], a[216:219], a[172:175], v[92:95]
    ds_read_b64_tr_b16 a[254:255], v27 offset:18560
    v_mfma_f32_16x16x32_bf16 v[92:95], a[220:223], a[188:191], v[92:95]
    buffer_load_dwordx4 a[144:147], v1, s[16:19], s96 offen offset:0 sc1
    v_mfma_f32_16x16x32_bf16 v[84:87], a[220:223], a[184:187], v[84:87]
    v_mfma_f32_16x16x32_bf16 v[84:87], a[216:219], a[168:171], v[84:87]
    v_mfma_f32_16x16x32_bf16 v[76:79], a[216:219], a[164:167], v[76:79]
    ds_read_b64_tr_b16 a[192:193], v28 offset:128
    v_mfma_f32_16x16x32_bf16 v[76:79], a[220:223], a[180:183], v[76:79]
    buffer_load_dwordx4 a[148:151], v1, s[16:19], s96 offen offset:1024 sc1
    v_mfma_f32_16x16x32_bf16 v[68:71], a[220:223], a[176:179], v[68:71]
    ds_read_b64_tr_b16 a[194:195], v28 offset:6272
    v_mfma_f32_16x16x32_bf16 v[68:71], a[216:219], a[160:163], v[68:71]
    ds_read_b64_tr_b16 a[196:197], v28 offset:12416
    v_mfma_f32_16x16x32_bf16 v[96:99], a[224:227], a[160:163], v[96:99]
    ds_read_b64_tr_b16 a[198:199], v28 offset:18560
    v_mfma_f32_16x16x32_bf16 v[96:99], a[228:231], a[176:179], v[96:99]
    v_mfma_f32_16x16x32_bf16 v[104:107], a[228:231], a[180:183], v[104:107]
    buffer_load_dwordx4 a[152:155], v1, s[16:19], s96 offen offset:2048 sc1
    v_mfma_f32_16x16x32_bf16 v[104:107], a[224:227], a[164:167], v[104:107]
    v_mfma_f32_16x16x32_bf16 v[112:115], a[224:227], a[168:171], v[112:115]
    ds_read_b64_tr_b16 a[200:201], v29 offset:128
    v_mfma_f32_16x16x32_bf16 v[112:115], a[228:231], a[184:187], v[112:115]
    ds_read_b64_tr_b16 a[202:203], v29 offset:6272
    v_mfma_f32_16x16x32_bf16 v[120:123], a[228:231], a[188:191], v[120:123]
    buffer_load_dwordx4 a[156:159], v1, s[16:19], s96 offen offset:3072 sc1
    v_mfma_f32_16x16x32_bf16 v[120:123], a[224:227], a[172:175], v[120:123]
    s_add_u32 m0, s42, 24576
    ds_read_b64_tr_b16 a[204:205], v29 offset:12416
    v_mfma_f32_16x16x32_bf16 v[124:127], a[232:235], a[172:175], v[124:127]
    s_waitcnt lgkmcnt(4)
    ds_read_b64_tr_b16 a[206:207], v29 offset:18560
    v_mfma_f32_16x16x32_bf16 v[124:127], a[236:239], a[188:191], v[124:127]
    v_mfma_f32_16x16x32_bf16 v[116:119], a[236:239], a[184:187], v[116:119]
    v_mfma_f32_16x16x32_bf16 v[116:119], a[232:235], a[168:171], v[116:119]
    buffer_load_dwordx4 v2, s[20:23], s57 offen offset:0 lds
    v_mfma_f32_16x16x32_bf16 v[108:111], a[232:235], a[164:167], v[108:111]
    ds_read_b64_tr_b16 a[208:209], v26 offset:256
    v_mfma_f32_16x16x32_bf16 v[108:111], a[236:239], a[180:183], v[108:111]
    ds_read_b64_tr_b16 a[210:211], v26 offset:6400
    v_mfma_f32_16x16x32_bf16 v[100:103], a[236:239], a[176:179], v[100:103]
    ds_read_b64_tr_b16 a[212:213], v26 offset:12544
    v_mfma_f32_16x16x32_bf16 v[100:103], a[232:235], a[160:163], v[100:103]
    buffer_load_dwordx4 v3, s[20:23], s57 offen offset:1024 lds
    v_mfma_f32_16x16x32_bf16 v[128:131], a[240:243], a[160:163], v[128:131]
    ds_read_b64_tr_b16 a[214:215], v26 offset:18688
    v_mfma_f32_16x16x32_bf16 v[128:131], a[244:247], a[176:179], v[128:131]
    v_mfma_f32_16x16x32_bf16 v[136:139], a[244:247], a[180:183], v[136:139]
    v_mfma_f32_16x16x32_bf16 v[136:139], a[240:243], a[164:167], v[136:139]
    v_mfma_f32_16x16x32_bf16 v[144:147], a[240:243], a[168:171], v[144:147]
    buffer_load_dwordx4 v4, s[20:23], s57 offen offset:2048 lds
    v_mfma_f32_16x16x32_bf16 v[144:147], a[244:247], a[184:187], v[144:147]
    ds_read_b64_tr_b16 a[216:217], v27 offset:256
    v_mfma_f32_16x16x32_bf16 v[152:155], a[244:247], a[188:191], v[152:155]
    ds_read_b64_tr_b16 a[218:219], v27 offset:6400
    v_mfma_f32_16x16x32_bf16 v[152:155], a[240:243], a[172:175], v[152:155]
    ds_read_b64_tr_b16 a[220:221], v27 offset:12544
    v_mfma_f32_16x16x32_bf16 v[156:159], a[248:251], a[172:175], v[156:159]
    buffer_load_dwordx4 v5, s[20:23], s57 offen offset:3072 lds
    v_mfma_f32_16x16x32_bf16 v[156:159], a[252:255], a[188:191], v[156:159]
    s_add_u32 m0, m0, 4096
    ds_read_b64_tr_b16 a[222:223], v27 offset:18688
    v_mfma_f32_16x16x32_bf16 v[148:151], a[252:255], a[184:187], v[148:151]
    v_mfma_f32_16x16x32_bf16 v[148:151], a[248:251], a[168:171], v[148:151]
    v_mfma_f32_16x16x32_bf16 v[140:143], a[248:251], a[164:167], v[140:143]
    ds_read_b64_tr_b16 a[224:225], v28 offset:256
    v_mfma_f32_16x16x32_bf16 v[140:143], a[252:255], a[180:183], v[140:143]
    buffer_load_dwordx4 v6, s[20:23], s57 offen offset:0 lds
    v_mfma_f32_16x16x32_bf16 v[132:135], a[252:255], a[176:179], v[132:135]
    ds_read_b64_tr_b16 a[226:227], v28 offset:6400
    v_mfma_f32_16x16x32_bf16 v[132:135], a[248:251], a[160:163], v[132:135]
    ds_read_b64_tr_b16 a[228:229], v28 offset:12544
    v_mfma_f32_16x16x32_bf16 v[160:163], a[192:195], a[160:163], v[160:163]
    s_waitcnt lgkmcnt(4)
    ds_read_b64_tr_b16 a[230:231], v28 offset:18688
    v_mfma_f32_16x16x32_bf16 v[160:163], a[196:199], a[176:179], v[160:163]
    buffer_load_dwordx4 v7, s[20:23], s57 offen offset:1024 lds
    v_mfma_f32_16x16x32_bf16 v[168:171], a[196:199], a[180:183], v[168:171]
    s_add_u32 s57, s57, 786432
    s_add_u32 m0, s97, 110592
    v_mfma_f32_16x16x32_bf16 v[168:171], a[192:195], a[164:167], v[168:171]
    v_mfma_f32_16x16x32_bf16 v[176:179], a[192:195], a[168:171], v[176:179]
    ds_read_b64_tr_b16 a[232:233], v29 offset:256
    v_mfma_f32_16x16x32_bf16 v[176:179], a[196:199], a[184:187], v[176:179]
    ds_read_b64_tr_b16 a[234:235], v29 offset:6400
    v_mfma_f32_16x16x32_bf16 v[184:187], a[196:199], a[188:191], v[184:187]
    buffer_load_dwordx4 v44, s[12:15], s53 offen offset:0 lds
    v_mfma_f32_16x16x32_bf16 v[184:187], a[192:195], a[172:175], v[184:187]
    ds_read_b64_tr_b16 a[236:237], v29 offset:12544
    v_mfma_f32_16x16x32_bf16 v[188:191], a[200:203], a[172:175], v[188:191]
    ds_read_b64_tr_b16 a[238:239], v29 offset:18688
    v_mfma_f32_16x16x32_bf16 v[188:191], a[204:207], a[188:191], v[188:191]
    v_mfma_f32_16x16x32_bf16 v[180:183], a[204:207], a[184:187], v[180:183]
    v_mfma_f32_16x16x32_bf16 v[180:183], a[200:203], a[168:171], v[180:183]
    v_mfma_f32_16x16x32_bf16 v[172:175], a[200:203], a[164:167], v[172:175]
    v_mfma_f32_16x16x32_bf16 v[172:175], a[204:207], a[180:183], v[172:175]
    v_mfma_f32_16x16x32_bf16 v[164:167], a[204:207], a[176:179], v[164:167]
    v_mfma_f32_16x16x32_bf16 v[164:167], a[200:203], a[160:163], v[164:167]
    buffer_load_dwordx4 v45, s[12:15], s53 offen offset:1024 lds
    v_mfma_f32_16x16x32_bf16 v[192:195], a[208:211], a[160:163], v[192:195]
    v_mfma_f32_16x16x32_bf16 v[192:195], a[212:215], a[176:179], v[192:195]
    v_mfma_f32_16x16x32_bf16 v[200:203], a[212:215], a[180:183], v[200:203]
    v_add_u32 v26, 73728, v22
    v_add_u32 v27, 73728, v23
    v_mfma_f32_16x16x32_bf16 v[200:203], a[208:211], a[164:167], v[200:203]
    v_add_u32 v28, 73728, v24
    v_add_u32 v29, 73728, v25
    v_mfma_f32_16x16x32_bf16 v[208:211], a[208:211], a[168:171], v[208:211]
    v_mfma_f32_16x16x32_bf16 v[208:211], a[212:215], a[184:187], v[208:211]
    v_mfma_f32_16x16x32_bf16 v[216:219], a[212:215], a[188:191], v[216:219]
    v_mfma_f32_16x16x32_bf16 v[216:219], a[208:211], a[172:175], v[216:219]
    v_mfma_f32_16x16x32_bf16 v[220:223], a[216:219], a[172:175], v[220:223]
    s_waitcnt lgkmcnt(0)
    buffer_load_dwordx4 v46, s[12:15], s53 offen offset:2048 lds
    v_mfma_f32_16x16x32_bf16 v[220:223], a[220:223], a[188:191], v[220:223]
    s_add_u32 s53, s53, 196608
    v_mfma_f32_16x16x32_bf16 v[212:215], a[220:223], a[184:187], v[212:215]
    v_mfma_f32_16x16x32_bf16 v[212:215], a[216:219], a[168:171], v[212:215]
    v_mfma_f32_16x16x32_bf16 v[204:207], a[216:219], a[164:167], v[204:207]
    v_mfma_f32_16x16x32_bf16 v[204:207], a[220:223], a[180:183], v[204:207]
    v_mfma_f32_16x16x32_bf16 v[196:199], a[220:223], a[176:179], v[196:199]
    s_waitcnt vmcnt(35)
    s_waitcnt lgkmcnt(0)
    s_barrier
    v_mfma_f32_16x16x32_bf16 v[196:199], a[216:219], a[160:163], v[196:199]
    ds_read_b64_tr_b16 a[240:241], v47 offset:36864
    v_mfma_f32_16x16x32_bf16 v[224:227], a[224:227], a[160:163], v[224:227]
    ds_read_b64_tr_b16 a[242:243], v47 offset:38400
    v_mfma_f32_16x16x32_bf16 v[224:227], a[228:231], a[176:179], v[224:227]
    ds_read_b64_tr_b16 a[244:245], v47 offset:39936
    v_mfma_f32_16x16x32_bf16 v[232:235], a[228:231], a[180:183], v[232:235]
    ds_read_b64_tr_b16 a[246:247], v47 offset:41472
    v_mfma_f32_16x16x32_bf16 v[232:235], a[224:227], a[164:167], v[232:235]
    ds_read_b64_tr_b16 a[248:249], v48 offset:36864
    v_mfma_f32_16x16x32_bf16 v[240:243], a[224:227], a[168:171], v[240:243]
    ds_read_b64_tr_b16 a[250:251], v48 offset:38400
    v_mfma_f32_16x16x32_bf16 v[240:243], a[228:231], a[184:187], v[240:243]
    ds_read_b64_tr_b16 a[252:253], v48 offset:39936
    v_mfma_f32_16x16x32_bf16 v[248:251], a[228:231], a[188:191], v[248:251]
    ds_read_b64_tr_b16 a[254:255], v48 offset:41472
    v_mfma_f32_16x16x32_bf16 v[248:251], a[224:227], a[172:175], v[248:251]
    ds_read_b64_tr_b16 a[192:193], v49 offset:36864
    v_mfma_f32_16x16x32_bf16 v[252:255], a[232:235], a[172:175], v[252:255]
    ds_read_b64_tr_b16 a[194:195], v49 offset:38400
    v_mfma_f32_16x16x32_bf16 v[252:255], a[236:239], a[188:191], v[252:255]
    ds_read_b64_tr_b16 a[196:197], v49 offset:39936
    v_mfma_f32_16x16x32_bf16 v[244:247], a[236:239], a[184:187], v[244:247]
    ds_read_b64_tr_b16 a[198:199], v49 offset:41472
    v_mfma_f32_16x16x32_bf16 v[244:247], a[232:235], a[168:171], v[244:247]
    ds_read_b64_tr_b16 a[200:201], v47 offset:43008
    v_mfma_f32_16x16x32_bf16 v[236:239], a[232:235], a[164:167], v[236:239]
    ds_read_b64_tr_b16 a[202:203], v47 offset:44544
    v_mfma_f32_16x16x32_bf16 v[236:239], a[236:239], a[180:183], v[236:239]
    ds_read_b64_tr_b16 a[204:205], v47 offset:46080
    v_mfma_f32_16x16x32_bf16 v[228:231], a[236:239], a[176:179], v[228:231]
    ds_read_b64_tr_b16 a[206:207], v47 offset:47616
    v_mfma_f32_16x16x32_bf16 v[228:231], a[232:235], a[160:163], v[228:231]
    s_waitcnt vmcnt(33) lgkmcnt(8)
    ds_read_b64_tr_b16 a[208:209], v48 offset:43008
    v_mfma_f32_16x16x32_bf16 a[0:3], a[240:243], a[96:99], a[0:3]
    s_waitcnt vmcnt(29)
    ds_read_b64_tr_b16 a[210:211], v48 offset:44544
    v_mfma_f32_16x16x32_bf16 a[0:3], a[244:247], a[112:115], a[0:3]
    s_waitcnt vmcnt(28)
    ds_read_b64_tr_b16 a[212:213], v48 offset:46080
    s_add_u32 s96, s49, 40960
    v_mfma_f32_16x16x32_bf16 a[4:7], a[244:247], a[116:119], a[4:7]
WS1:
    s_cbranch_execz MAINC
    buffer_load_dwordx4 a[160:163], v1, s[16:19], s96 offen offset:0 sc1
    v_mfma_f32_16x16x32_bf16 a[4:7], a[240:243], a[100:103], a[4:7]
    ds_read_b64_tr_b16 a[214:215], v48 offset:47616
    v_mfma_f32_16x16x32_bf16 a[8:11], a[240:243], a[104:107], a[8:11]
    s_waitcnt vmcnt(28)
    ds_read_b64_tr_b16 a[216:217], v49 offset:43008
    v_mfma_f32_16x16x32_bf16 a[8:11], a[244:247], a[120:123], a[8:11]
    s_waitcnt vmcnt(27)
    ds_read_b64_tr_b16 a[218:219], v49 offset:44544
    v_mfma_f32_16x16x32_bf16 a[12:15], a[244:247], a[124:127], a[12:15]
    buffer_load_dwordx4 a[164:167], v1, s[16:19], s96 offen offset:1024 sc1
    v_mfma_f32_16x16x32_bf16 a[12:15], a[240:243], a[108:111], a[12:15]
    ds_read_b64_tr_b16 a[220:221], v49 offset:46080
    v_mfma_f32_16x16x32_bf16 a[28:31], a[248:251], a[108:111], a[28:31]
    ds_read_b64_tr_b16 a[222:223], v49 offset:47616
    v_mfma_f32_16x16x32_bf16 a[28:31], a[252:255], a[124:127], a[28:31]
    v_mfma_f32_16x16x32_bf16 a[24:27], a[252:255], a[120:123], a[24:27]
    buffer_load_dwordx4 a[168:171], v1, s[16:19], s96 offen offset:2048 sc1
    v_mfma_f32_16x16x32_bf16 a[24:27], a[248:251], a[104:107], a[24:27]
    v_mfma_f32_16x16x32_bf16 a[20:23], a[248:251], a[100:103], a[20:23]
    ds_read_b64_tr_b16 a[224:225], v26 offset:0
    v_mfma_f32_16x16x32_bf16 a[20:23], a[252:255], a[116:119], a[20:23]
    ds_read_b64_tr_b16 a[226:227], v26 offset:6144
    v_mfma_f32_16x16x32_bf16 a[16:19], a[252:255], a[112:115], a[16:19]
    ds_read_b64_tr_b16 a[228:229], v26 offset:12288
    v_mfma_f32_16x16x32_bf16 a[16:19], a[248:251], a[96:99], a[16:19]
    s_waitcnt lgkmcnt(5)
    buffer_load_dwordx4 a[172:175], v1, s[16:19], s96 offen offset:3072 sc1
    v_mfma_f32_16x16x32_bf16 a[32:35], a[192:195], a[96:99], a[32:35]
    s_add_u32 s96, s49, 45056
    ds_read_b64_tr_b16 a[230:231], v26 offset:18432
    v_mfma_f32_16x16x32_bf16 a[32:35], a[196:199], a[112:115], a[32:35]
    v_mfma_f32_16x16x32_bf16 a[36:39], a[196:199], a[116:119], a[36:39]
    v_mfma_f32_16x16x32_bf16 a[36:39], a[192:195], a[100:103], a[36:39]
    buffer_load_dwordx4 a[176:179], v1, s[16:19], s96 offen offset:0 sc1
    v_mfma_f32_16x16x32_bf16 a[40:43], a[192:195], a[104:107], a[40:43]
    ds_read_b64_tr_b16 a[232:233], v27 offset:0
    v_mfma_f32_16x16x32_bf16 a[40:43], a[196:199], a[120:123], a[40:43]
    ds_read_b64_tr_b16 a[234:235], v27 offset:6144
    v_mfma_f32_16x16x32_bf16 a[44:47], a[196:199], a[124:127], a[44:47]
    ds_read_b64_tr_b16 a[236:237], v27 offset:12288
    v_mfma_f32_16x16x32_bf16 a[44:47], a[192:195], a[108:111], a[44:47]
    ds_read_b64_tr_b16 a[238:239], v27 offset:18432
    v_mfma_f32_16x16x32_bf16 a[60:63], a[200:203], a[108:111], a[60:63]
    buffer_load_dwordx4 a[180:183], v1, s[16:19], s96 offen offset:1024 sc1
    v_mfma_f32_16x16x32_bf16 a[60:63], a[204:207], a[124:127], a[60:63]
    v_mfma_f32_16x16x32_bf16 a[56:59], a[204:207], a[120:123], a[56:59]
    v_mfma_f32_16x16x32_bf16 a[56:59], a[200:203], a[104:107], a[56:59]
    v_mfma_f32_16x16x32_bf16 a[52:55], a[200:203], a[100:103], a[52:55]
    buffer_load_dwordx4 a[184:187], v1, s[16:19], s96 offen offset:2048 sc1
    v_mfma_f32_16x16x32_bf16 a[52:55], a[204:207], a[116:119], a[52:55]
    ds_read_b64_tr_b16 a[240:241], v28 offset:0
    v_mfma_f32_16x16x32_bf16 a[48:51], a[204:207], a[112:115], a[48:51]
    ds_read_b64_tr_b16 a[242:243], v28 offset:6144
    v_mfma_f32_16x16x32_bf16 a[48:51], a[200:203], a[96:99], a[48:51]
    ds_read_b64_tr_b16 a[244:245], v28 offset:12288
    v_mfma_f32_16x16x32_bf16 a[64:67], a[208:211], a[96:99], a[64:67]
    ds_read_b64_tr_b16 a[246:247], v28 offset:18432
    v_mfma_f32_16x16x32_bf16 a[64:67], a[212:215], a[112:115], a[64:67]
    buffer_load_dwordx4 a[188:191], v1, s[16:19], s96 offen offset:3072 sc1
    v_mfma_f32_16x16x32_bf16 a[68:71], a[212:215], a[116:119], a[68:71]
    s_add_u32 m0, s42, 49152
    v_mfma_f32_16x16x32_bf16 a[68:71], a[208:211], a[100:103], a[68:71]
    v_mfma_f32_16x16x32_bf16 a[72:75], a[208:211], a[104:107], a[72:75]
    ds_read_b64_tr_b16 a[248:249], v29 offset:0
    v_mfma_f32_16x16x32_bf16 a[72:75], a[212:215], a[120:123], a[72:75]
    buffer_load_dwordx4 v2, s[20:23], s57 offen offset:0 lds
    v_mfma_f32_16x16x32_bf16 a[76:79], a[212:215], a[124:127], a[76:79]
    ds_read_b64_tr_b16 a[250:251], v29 offset:6144
    v_mfma_f32_16x16x32_bf16 a[76:79], a[208:211], a[108:111], a[76:79]
    ds_read_b64_tr_b16 a[252:253], v29 offset:12288
    v_mfma_f32_16x16x32_bf16 a[92:95], a[216:219], a[108:111], a[92:95]
    s_waitcnt lgkmcnt(4)
    ds_read_b64_tr_b16 a[254:255], v29 offset:18432
    v_mfma_f32_16x16x32_bf16 a[92:95], a[220:223], a[124:127], a[92:95]
    v_mfma_f32_16x16x32_bf16 a[88:91], a[220:223], a[120:123], a[88:91]
    buffer_load_dwordx4 v3, s[20:23], s57 offen offset:1024 lds
    v_mfma_f32_16x16x32_bf16 a[88:91], a[216:219], a[104:107], a[88:91]
    v_mfma_f32_16x16x32_bf16 a[84:87], a[216:219], a[100:103], a[84:87]
    ds_read_b64_tr_b16 a[192:193], v26 offset:128
    v_mfma_f32_16x16x32_bf16 a[84:87], a[220:223], a[116:119], a[84:87]
    ds_read_b64_tr_b16 a[194:195], v26 offset:6272
    v_mfma_f32_16x16x32_bf16 a[80:83], a[220:223], a[112:115], a[80:83]
    buffer_load_dwordx4 v4, s[20:23], s57 offen offset:2048 lds
    v_mfma_f32_16x16x32_bf16 a[80:83], a[216:219], a[96:99], a[80:83]
    ds_read_b64_tr_b16 a[196:197], v26 offset:12416
    v_mfma_f32_16x16x32_bf16 v[64:67], a[224:227], a[96:99], v[64:67]
    ds_read_b64_tr_b16 a[198:199], v26 offset:18560
    v_mfma_f32_16x16x32_bf16 v[64:67], a[228:231], a[112:115], v[64:67]
    v_mfma_f32_16x16x32_bf16 v[72:75], a[228:231], a[116:119], v[72:75]
    v_mfma_f32_16x16x32_bf16 v[72:75], a[224:227], a[100:103], v[72:75]
    buffer_load_dwordx4 v5, s[20:23], s57 offen offset:3072 lds
    v_mfma_f32_16x16x32_bf16 v[80:83], a[224:227], a[104:107], v[80:83]
    s_add_u32 m0, m0, 4096
    ds_read_b64_tr_b16 a[200:201], v27 offset:128
    v_mfma_f32_16x16x32_bf16 v[80:83], a[228:231], a[120:123], v[80:83]
    ds_read_b64_tr_b16 a[202:203], v27 offset:6272
    v_mfma_f32_16x16x32_bf16 v[88:91], a[228:231], a[124:127], v[88:91]
    ds_read_b64_tr_b16 a[204:205], v27 offset:12416
    v_mfma_f32_16x16x32_bf16 v[88:91], a[224:227], a[108:111], v[88:91]
    buffer_load_dwordx4 v6, s[20:23], s57 offen offset:0 lds
    v_mfma_f32_16x16x32_bf16 v[92:95], a[232:235], a[108:111], v[92:95]
    ds_read_b64_tr_b16 a[206:207], v27 offset:18560
    v_mfma_f32_16x16x32_bf16 v[92:95], a[236:239], a[124:127], v[92:95]
    v_mfma_f32_16x16x32_bf16 v[84:87], a[236:239], a[120:123], v[84:87]
    v_mfma_f32_16x16x32_bf16 v[84:87], a[232:235], a[104:107], v[84:87]
    v_mfma_f32_16x16x32_bf16 v[76:79], a[232:235], a[100:103], v[76:79]
    buffer_load_dwordx4 v7, s[20:23], s57 offen offset:1024 lds
    v_mfma_f32_16x16x32_bf16 v[76:79], a[236:239], a[116:119], v[76:79]
    s_add_u32 s57, s57, 786432
    ds_read_b64_tr_b16 a[208:209], v28 offset:128
    s_add_u32 m0, s97, 122880
    v_mfma_f32_16x16x32_bf16 v[68:71], a[236:239], a[112:115], v[68:71]
    ds_read_b64_tr_b16 a[210:211], v28 offset:6272
    v_mfma_f32_16x16x32_bf16 v[68:71], a[232:235], a[96:99], v[68:71]
    ds_read_b64_tr_b16 a[212:213], v28 offset:12416
    v_mfma_f32_16x16x32_bf16 v[96:99], a[240:243], a[96:99], v[96:99]
    s_waitcnt lgkmcnt(4)
    buffer_load_dwordx4 v44, s[12:15], s53 offen offset:0 lds
    v_mfma_f32_16x16x32_bf16 v[96:99], a[244:247], a[112:115], v[96:99]
    ds_read_b64_tr_b16 a[214:215], v28 offset:18560
    v_mfma_f32_16x16x32_bf16 v[104:107], a[244:247], a[116:119], v[104:107]
    v_mfma_f32_16x16x32_bf16 v[104:107], a[240:243], a[100:103], v[104:107]
    v_mfma_f32_16x16x32_bf16 v[112:115], a[240:243], a[104:107], v[112:115]
    ds_read_b64_tr_b16 a[216:217], v29 offset:128
    v_mfma_f32_16x16x32_bf16 v[112:115], a[244:247], a[120:123], v[112:115]
    ds_read_b64_tr_b16 a[218:219], v29 offset:6272
    v_mfma_f32_16x16x32_bf16 v[120:123], a[244:247], a[124:127], v[120:123]
    ds_read_b64_tr_b16 a[220:221], v29 offset:12416
    v_mfma_f32_16x16x32_bf16 v[120:123], a[240:243], a[108:111], v[120:123]
    ds_read_b64_tr_b16 a[222:223], v29 offset:18560
    v_mfma_f32_16x16x32_bf16 v[124:127], a[248:251], a[108:111], v[124:127]
    v_mfma_f32_16x16x32_bf16 v[124:127], a[252:255], a[124:127], v[124:127]
    buffer_load_dwordx4 v45, s[12:15], s53 offen offset:1024 lds
    v_mfma_f32_16x16x32_bf16 v[116:119], a[252:255], a[120:123], v[116:119]
    v_mfma_f32_16x16x32_bf16 v[116:119], a[248:251], a[104:107], v[116:119]
    v_mfma_f32_16x16x32_bf16 v[108:111], a[248:251], a[100:103], v[108:111]
    ds_read_b64_tr_b16 a[224:225], v26 offset:256
    v_mfma_f32_16x16x32_bf16 v[108:111], a[252:255], a[116:119], v[108:111]
    ds_read_b64_tr_b16 a[226:227], v26 offset:6400
    v_mfma_f32_16x16x32_bf16 v[100:103], a[252:255], a[112:115], v[100:103]
    ds_read_b64_tr_b16 a[228:229], v26 offset:12544
    v_mfma_f32_16x16x32_bf16 v[100:103], a[248:251], a[96:99], v[100:103]
    ds_read_b64_tr_b16 a[230:231], v26 offset:18688
    v_mfma_f32_16x16x32_bf16 v[128:131], a[192:195], a[96:99], v[128:131]
    v_mfma_f32_16x16x32_bf16 v[128:131], a[196:199], a[112:115], v[128:131]
    v_mfma_f32_16x16x32_bf16 v[136:139], a[196:199], a[116:119], v[136:139]
    buffer_load_dwordx4 v46, s[12:15], s53 offen offset:2048 lds
    v_mfma_f32_16x16x32_bf16 v[136:139], a[192:195], a[100:103], v[136:139]
    s_add_u32 s53, s53, 196608
    v_mfma_f32_16x16x32_bf16 v[144:147], a[192:195], a[104:107], v[144:147]
    ds_read_b64_tr_b16 a[232:233], v27 offset:256
    v_mfma_f32_16x16x32_bf16 v[144:147], a[196:199], a[120:123], v[144:147]
    ds_read_b64_tr_b16 a[234:235], v27 offset:6400
    v_mfma_f32_16x16x32_bf16 v[152:155], a[196:199], a[124:127], v[152:155]
    ds_read_b64_tr_b16 a[236:237], v27 offset:12544
    v_mfma_f32_16x16x32_bf16 v[152:155], a[192:195], a[108:111], v[152:155]
    ds_read_b64_tr_b16 a[238:239], v27 offset:18688
    v_mfma_f32_16x16x32_bf16 v[156:159], a[200:203], a[108:111], v[156:159]
    s_waitcnt lgkmcnt(4)
    v_mov_b32 v34, 0
    v_mfma_f32_16x16x32_bf16 v[156:159], a[204:207], a[124:127], v[156:159]
    v_mov_b32 v35, 0
    v_mfma_f32_16x16x32_bf16 v[148:151], a[204:207], a[120:123], v[148:151]
    v_mov_b32 v36, 0
    v_mfma_f32_16x16x32_bf16 v[148:151], a[200:203], a[104:107], v[148:151]
    v_mov_b32 v37, 0
    v_mfma_f32_16x16x32_bf16 v[140:143], a[200:203], a[100:103], v[140:143]
    s_mov_b32 s45, 98304
    ds_read_b64_tr_b16 a[240:241], v28 offset:256
    v_mfma_f32_16x16x32_bf16 v[140:143], a[204:207], a[116:119], v[140:143]
    s_mov_b32 s46, 0
    ds_read_b64_tr_b16 a[242:243], v28 offset:6400
    v_mfma_f32_16x16x32_bf16 v[132:135], a[204:207], a[112:115], v[132:135]
    s_mov_b32 s47, 49152
    ds_read_b64_tr_b16 a[244:245], v28 offset:12544
    v_mfma_f32_16x16x32_bf16 v[132:135], a[200:203], a[96:99], v[132:135]
    s_mov_b32 s48, 6
    ds_read_b64_tr_b16 a[246:247], v28 offset:18688
    v_mfma_f32_16x16x32_bf16 v[160:163], a[208:211], a[96:99], v[160:163]
    s_add_u32 s7, s42, 24576
    v_mfma_f32_16x16x32_bf16 v[160:163], a[212:215], a[112:115], v[160:163]
    v_mfma_f32_16x16x32_bf16 v[168:171], a[212:215], a[116:119], v[168:171]
    v_mfma_f32_16x16x32_bf16 v[168:171], a[208:211], a[100:103], v[168:171]
    v_mfma_f32_16x16x32_bf16 v[176:179], a[208:211], a[104:107], v[176:179]
    ds_read_b64_tr_b16 a[248:249], v29 offset:256
    v_mfma_f32_16x16x32_bf16 v[176:179], a[212:215], a[120:123], v[176:179]
    ds_read_b64_tr_b16 a[250:251], v29 offset:6400
    v_mfma_f32_16x16x32_bf16 v[184:187], a[212:215], a[124:127], v[184:187]
    ds_read_b64_tr_b16 a[252:253], v29 offset:12544
    v_mfma_f32_16x16x32_bf16 v[184:187], a[208:211], a[108:111], v[184:187]
    ds_read_b64_tr_b16 a[254:255], v29 offset:18688
    v_mfma_f32_16x16x32_bf16 v[188:191], a[216:219], a[108:111], v[188:191]
    v_mfma_f32_16x16x32_bf16 v[188:191], a[220:223], a[124:127], v[188:191]
    v_mfma_f32_16x16x32_bf16 v[180:183], a[220:223], a[120:123], v[180:183]
    v_mfma_f32_16x16x32_bf16 v[180:183], a[216:219], a[104:107], v[180:183]
    v_mfma_f32_16x16x32_bf16 v[172:175], a[216:219], a[100:103], v[172:175]
    v_mfma_f32_16x16x32_bf16 v[172:175], a[220:223], a[116:119], v[172:175]
    v_mfma_f32_16x16x32_bf16 v[164:167], a[220:223], a[112:115], v[164:167]
    v_mfma_f32_16x16x32_bf16 v[164:167], a[216:219], a[96:99], v[164:167]
    v_mfma_f32_16x16x32_bf16 v[192:195], a[224:227], a[96:99], v[192:195]
    v_mfma_f32_16x16x32_bf16 v[192:195], a[228:231], a[112:115], v[192:195]
    v_mfma_f32_16x16x32_bf16 v[200:203], a[228:231], a[116:119], v[200:203]
    v_add_u32 v26, 0, v22
    v_add_u32 v27, 0, v23
    v_mfma_f32_16x16x32_bf16 v[200:203], a[224:227], a[100:103], v[200:203]
    v_add_u32 v28, 0, v24
    v_add_u32 v29, 0, v25
    v_mfma_f32_16x16x32_bf16 v[208:211], a[224:227], a[104:107], v[208:211]
    v_mfma_f32_16x16x32_bf16 v[208:211], a[228:231], a[120:123], v[208:211]
    v_mfma_f32_16x16x32_bf16 v[216:219], a[228:231], a[124:127], v[216:219]
    v_mfma_f32_16x16x32_bf16 v[216:219], a[224:227], a[108:111], v[216:219]
    s_waitcnt lgkmcnt(0)
    v_mfma_f32_16x16x32_bf16 v[220:223], a[232:235], a[108:111], v[220:223]
    v_mfma_f32_16x16x32_bf16 v[220:223], a[236:239], a[124:127], v[220:223]
    v_mfma_f32_16x16x32_bf16 v[212:215], a[236:239], a[120:123], v[212:215]
    v_mfma_f32_16x16x32_bf16 v[212:215], a[232:235], a[104:107], v[212:215]
    v_mfma_f32_16x16x32_bf16 v[204:207], a[232:235], a[100:103], v[204:207]
    s_mul_i32 s56, s39, 98304
    s_add_u32 s56, s56, s70
    s_add_u32 s84, s56, 22528
    v_mfma_f32_16x16x32_bf16 v[204:207], a[236:239], a[116:119], v[204:207]
    s_mov_b32 s85, s56
    s_add_u32 s56, s56, 0
    v_mfma_f32_16x16x32_bf16 v[196:199], a[236:239], a[112:115], v[196:199]
    s_waitcnt vmcnt(34)
    s_waitcnt lgkmcnt(0)
    s_barrier
    v_mfma_f32_16x16x32_bf16 v[196:199], a[232:235], a[96:99], v[196:199]
    ds_read_b64_tr_b16 a[192:193], v47 offset:0
    v_mfma_f32_16x16x32_bf16 v[224:227], a[240:243], a[96:99], v[224:227]
    ds_read_b64_tr_b16 a[194:195], v47 offset:1536
    v_mfma_f32_16x16x32_bf16 v[224:227], a[244:247], a[112:115], v[224:227]
    ds_read_b64_tr_b16 a[196:197], v47 offset:3072
    v_mfma_f32_16x16x32_bf16 v[232:235], a[244:247], a[116:119], v[232:235]
    ds_read_b64_tr_b16 a[198:199], v47 offset:4608
    v_mfma_f32_16x16x32_bf16 v[232:235], a[240:243], a[100:103], v[232:235]
    ds_read_b64_tr_b16 a[200:201], v48 offset:0
    v_mfma_f32_16x16x32_bf16 v[240:243], a[240:243], a[104:107], v[240:243]
    ds_read_b64_tr_b16 a[202:203], v48 offset:1536
    v_mfma_f32_16x16x32_bf16 v[240:243], a[244:247], a[120:123], v[240:243]
    ds_read_b64_tr_b16 a[204:205], v48 offset:3072
    v_mfma_f32_16x16x32_bf16 v[248:251], a[244:247], a[124:127], v[248:251]
    ds_read_b64_tr_b16 a[206:207], v48 offset:4608
    v_mfma_f32_16x16x32_bf16 v[248:251], a[240:243], a[108:111], v[248:251]
    ds_read_b64_tr_b16 a[208:209], v49 offset:0
    v_mfma_f32_16x16x32_bf16 v[252:255], a[248:251], a[108:111], v[252:255]
    ds_read_b64_tr_b16 a[210:211], v49 offset:1536
    v_mfma_f32_16x16x32_bf16 v[252:255], a[252:255], a[124:127], v[252:255]
    ds_read_b64_tr_b16 a[212:213], v49 offset:3072
    v_mfma_f32_16x16x32_bf16 v[244:247], a[252:255], a[120:123], v[244:247]
    ds_read_b64_tr_b16 a[214:215], v49 offset:4608
    v_mfma_f32_16x16x32_bf16 v[244:247], a[248:251], a[104:107], v[244:247]
    ds_read_b64_tr_b16 a[216:217], v47 offset:6144
    v_mfma_f32_16x16x32_bf16 v[236:239], a[248:251], a[100:103], v[236:239]
    ds_read_b64_tr_b16 a[218:219], v47 offset:7680
    v_mfma_f32_16x16x32_bf16 v[236:239], a[252:255], a[116:119], v[236:239]
    ds_read_b64_tr_b16 a[220:221], v47 offset:9216
    v_mfma_f32_16x16x32_bf16 v[228:231], a[252:255], a[112:115], v[228:231]
    ds_read_b64_tr_b16 a[222:223], v47 offset:10752
    v_mfma_f32_16x16x32_bf16 v[228:231], a[248:251], a[96:99], v[228:231]
    s_waitcnt vmcnt(33) lgkmcnt(8)
    ds_read_b64_tr_b16 a[224:225], v48 offset:6144
    v_mfma_f32_16x16x32_bf16 a[0:3], a[192:195], a[128:131], a[0:3]
    s_waitcnt vmcnt(29)
    ds_read_b64_tr_b16 a[226:227], v48 offset:7680
    v_mfma_f32_16x16x32_bf16 a[0:3], a[196:199], a[144:147], a[0:3]
    s_waitcnt vmcnt(28)
    ds_read_b64_tr_b16 a[228:229], v48 offset:9216
    s_add_u32 s96, s49, 49152
    v_mfma_f32_16x16x32_bf16 a[4:7], a[196:199], a[148:151], a[4:7]
    buffer_load_dwordx4 a[96:99], v1, s[16:19], s96 offen offset:0 sc1
    v_mfma_f32_16x16x32_bf16 a[4:7], a[192:195], a[132:135], a[4:7]
    ds_read_b64_tr_b16 a[230:231], v48 offset:10752
    v_mfma_f32_16x16x32_bf16 a[8:11], a[192:195], a[136:139], a[8:11]
    s_waitcnt vmcnt(28)
    ds_read_b64_tr_b16 a[232:233], v49 offset:6144
    v_mfma_f32_16x16x32_bf16 a[8:11], a[196:199], a[152:155], a[8:11]
    s_waitcnt vmcnt(27)
    ds_read_b64_tr_b16 a[234:235], v49 offset:7680
    v_mfma_f32_16x16x32_bf16 a[12:15], a[196:199], a[156:159], a[12:15]
    buffer_load_dwordx4 a[100:103], v1, s[16:19], s96 offen offset:1024 sc1
    v_mfma_f32_16x16x32_bf16 a[12:15], a[192:195], a[140:143], a[12:15]
    ds_read_b64_tr_b16 a[236:237], v49 offset:9216
    v_mfma_f32_16x16x32_bf16 a[28:31], a[200:203], a[140:143], a[28:31]
    ds_read_b64_tr_b16 a[238:239], v49 offset:10752
    v_mfma_f32_16x16x32_bf16 a[28:31], a[204:207], a[156:159], a[28:31]
    v_mfma_f32_16x16x32_bf16 a[24:27], a[204:207], a[152:155], a[24:27]
    buffer_load_dwordx4 a[104:107], v1, s[16:19], s96 offen offset:2048 sc1
    v_mfma_f32_16x16x32_bf16 a[24:27], a[200:203], a[136:139], a[24:27]
    v_mfma_f32_16x16x32_bf16 a[20:23], a[200:203], a[132:135], a[20:23]
    ds_read_b64_tr_b16 a[240:241], v26 offset:0
    v_mfma_f32_16x16x32_bf16 a[20:23], a[204:207], a[148:151], a[20:23]
    ds_read_b64_tr_b16 a[242:243], v26 offset:6144
    v_mfma_f32_16x16x32_bf16 a[16:19], a[204:207], a[144:147], a[16:19]
    ds_read_b64_tr_b16 a[244:245], v26 offset:12288
    v_mfma_f32_16x16x32_bf16 a[16:19], a[200:203], a[128:131], a[16:19]
    s_waitcnt lgkmcnt(5)
    buffer_load_dwordx4 a[108:111], v1, s[16:19], s96 offen offset:3072 sc1
    v_mfma_f32_16x16x32_bf16 a[32:35], a[208:211], a[128:131], a[32:35]
    s_add_u32 s96, s49, 53248
    ds_read_b64_tr_b16 a[246:247], v26 offset:18432
    v_mfma_f32_16x16x32_bf16 a[32:35], a[212:215], a[144:147], a[32:35]
    v_mfma_f32_16x16x32_bf16 a[36:39], a[212:215], a[148:151], a[36:39]
    v_mfma_f32_16x16x32_bf16 a[36:39], a[208:211], a[132:135], a[36:39]
    buffer_load_dwordx4 a[112:115], v1, s[16:19], s96 offen offset:0 sc1
    v_mfma_f32_16x16x32_bf16 a[40:43], a[208:211], a[136:139], a[40:43]
    ds_read_b64_tr_b16 a[248:249], v27 offset:0
    v_mfma_f32_16x16x32_bf16 a[40:43], a[212:215], a[152:155], a[40:43]
    ds_read_b64_tr_b16 a[250:251], v27 offset:6144
    v_mfma_f32_16x16x32_bf16 a[44:47], a[212:215], a[156:159], a[44:47]
    ds_read_b64_tr_b16 a[252:253], v27 offset:12288
    v_mfma_f32_16x16x32_bf16 a[44:47], a[208:211], a[140:143], a[44:47]
    ds_read_b64_tr_b16 a[254:255], v27 offset:18432
    v_mfma_f32_16x16x32_bf16 a[60:63], a[216:219], a[140:143], a[60:63]
    buffer_load_dwordx4 a[116:119], v1, s[16:19], s96 offen offset:1024 sc1
    v_mfma_f32_16x16x32_bf16 a[60:63], a[220:223], a[156:159], a[60:63]
    v_mfma_f32_16x16x32_bf16 a[56:59], a[220:223], a[152:155], a[56:59]
    v_mfma_f32_16x16x32_bf16 a[56:59], a[216:219], a[136:139], a[56:59]
    v_mfma_f32_16x16x32_bf16 a[52:55], a[216:219], a[132:135], a[52:55]
    buffer_load_dwordx4 a[120:123], v1, s[16:19], s96 offen offset:2048 sc1
    v_mfma_f32_16x16x32_bf16 a[52:55], a[220:223], a[148:151], a[52:55]
    ds_read_b64_tr_b16 a[192:193], v28 offset:0
    v_mfma_f32_16x16x32_bf16 a[48:51], a[220:223], a[144:147], a[48:51]
    ds_read_b64_tr_b16 a[194:195], v28 offset:6144
    v_mfma_f32_16x16x32_bf16 a[48:51], a[216:219], a[128:131], a[48:51]
    ds_read_b64_tr_b16 a[196:197], v28 offset:12288
    v_mfma_f32_16x16x32_bf16 a[64:67], a[224:227], a[128:131], a[64:67]
    ds_read_b64_tr_b16 a[198:199], v28 offset:18432
    v_mfma_f32_16x16x32_bf16 a[64:67], a[228:231], a[144:147], a[64:67]
    buffer_load_dwordx4 a[124:127], v1, s[16:19], s96 offen offset:3072 sc1
    v_mfma_f32_16x16x32_bf16 a[68:71], a[228:231], a[148:151], a[68:71]
    s_add_u32 m0, s42, 73728
    v_mfma_f32_16x16x32_bf16 a[68:71], a[224:227], a[132:135], a[68:71]
    v_mfma_f32_16x16x32_bf16 a[72:75], a[224:227], a[136:139], a[72:75]
    ds_read_b64_tr_b16 a[200:201], v29 offset:0
    v_mfma_f32_16x16x32_bf16 a[72:75], a[228:231], a[152:155], a[72:75]
    buffer_load_dwordx4 v2, s[20:23], s57 offen offset:0 lds
    v_mfma_f32_16x16x32_bf16 a[76:79], a[228:231], a[156:159], a[76:79]
    ds_read_b64_tr_b16 a[202:203], v29 offset:6144
    v_mfma_f32_16x16x32_bf16 a[76:79], a[224:227], a[140:143], a[76:79]
    ds_read_b64_tr_b16 a[204:205], v29 offset:12288
    v_mfma_f32_16x16x32_bf16 a[92:95], a[232:235], a[140:143], a[92:95]
    s_waitcnt lgkmcnt(4)
    ds_read_b64_tr_b16 a[206:207], v29 offset:18432
    v_mfma_f32_16x16x32_bf16 a[92:95], a[236:239], a[156:159], a[92:95]
    v_mfma_f32_16x16x32_bf16 a[88:91], a[236:239], a[152:155], a[88:91]
    buffer_load_dwordx4 v3, s[20:23], s57 offen offset:1024 lds
    v_mfma_f32_16x16x32_bf16 a[88:91], a[232:235], a[136:139], a[88:91]
    v_mfma_f32_16x16x32_bf16 a[84:87], a[232:235], a[132:135], a[84:87]
    ds_read_b64_tr_b16 a[208:209], v26 offset:128
    v_mfma_f32_16x16x32_bf16 a[84:87], a[236:239], a[148:151], a[84:87]
    ds_read_b64_tr_b16 a[210:211], v26 offset:6272
    v_mfma_f32_16x16x32_bf16 a[80:83], a[236:239], a[144:147], a[80:83]
    buffer_load_dwordx4 v4, s[20:23], s57 offen offset:2048 lds
    v_mfma_f32_16x16x32_bf16 a[80:83], a[232:235], a[128:131], a[80:83]
    ds_read_b64_tr_b16 a[212:213], v26 offset:12416
    v_mfma_f32_16x16x32_bf16 v[64:67], a[240:243], a[128:131], v[64:67]
    ds_read_b64_tr_b16 a[214:215], v26 offset:18560
    v_mfma_f32_16x16x32_bf16 v[64:67], a[244:247], a[144:147], v[64:67]
    v_mfma_f32_16x16x32_bf16 v[72:75], a[244:247], a[148:151], v[72:75]
    v_mfma_f32_16x16x32_bf16 v[72:75], a[240:243], a[132:135], v[72:75]
    buffer_load_dwordx4 v5, s[20:23], s57 offen offset:3072 lds
    v_mfma_f32_16x16x32_bf16 v[80:83], a[240:243], a[136:139], v[80:83]
    s_add_u32 m0, m0, 4096
    ds_read_b64_tr_b16 a[216:217], v27 offset:128
    v_mfma_f32_16x16x32_bf16 v[80:83], a[244:247], a[152:155], v[80:83]
    ds_read_b64_tr_b16 a[218:219], v27 offset:6272
    v_mfma_f32_16x16x32_bf16 v[88:91], a[244:247], a[156:159], v[88:91]
    ds_read_b64_tr_b16 a[220:221], v27 offset:12416
    v_mfma_f32_16x16x32_bf16 v[88:91], a[240:243], a[140:143], v[88:91]
    buffer_load_dwordx4 v6, s[20:23], s57 offen offset:0 lds
    v_mfma_f32_16x16x32_bf16 v[92:95], a[248:251], a[140:143], v[92:95]
    ds_read_b64_tr_b16 a[222:223], v27 offset:18560
    v_mfma_f32_16x16x32_bf16 v[92:95], a[252:255], a[156:159], v[92:95]
    v_mfma_f32_16x16x32_bf16 v[84:87], a[252:255], a[152:155], v[84:87]
    v_mfma_f32_16x16x32_bf16 v[84:87], a[248:251], a[136:139], v[84:87]
    v_mfma_f32_16x16x32_bf16 v[76:79], a[248:251], a[132:135], v[76:79]
    buffer_load_dwordx4 v7, s[20:23], s57 offen offset:1024 lds
    v_mfma_f32_16x16x32_bf16 v[76:79], a[252:255], a[148:151], v[76:79]
    s_add_u32 s57, s57, 786432
    ds_read_b64_tr_b16 a[224:225], v28 offset:128
    s_add_u32 m0, s97, 135168
    v_mfma_f32_16x16x32_bf16 v[68:71], a[252:255], a[144:147], v[68:71]
    ds_read_b64_tr_b16 a[226:227], v28 offset:6272
    v_mfma_f32_16x16x32_bf16 v[68:71], a[248:251], a[128:131], v[68:71]
    ds_read_b64_tr_b16 a[228:229], v28 offset:12416
    v_mfma_f32_16x16x32_bf16 v[96:99], a[192:195], a[128:131], v[96:99]
    s_waitcnt lgkmcnt(4)
    buffer_load_dwordx4 v44, s[12:15], s53 offen offset:0 lds
    v_mfma_f32_16x16x32_bf16 v[96:99], a[196:199], a[144:147], v[96:99]
    ds_read_b64_tr_b16 a[230:231], v28 offset:18560
    v_mfma_f32_16x16x32_bf16 v[104:107], a[196:199], a[148:151], v[104:107]
    v_mfma_f32_16x16x32_bf16 v[104:107], a[192:195], a[132:135], v[104:107]
    v_mfma_f32_16x16x32_bf16 v[112:115], a[192:195], a[136:139], v[112:115]
    ds_read_b64_tr_b16 a[232:233], v29 offset:128
    v_mfma_f32_16x16x32_bf16 v[112:115], a[196:199], a[152:155], v[112:115]
    ds_read_b64_tr_b16 a[234:235], v29 offset:6272
    v_mfma_f32_16x16x32_bf16 v[120:123], a[196:199], a[156:159], v[120:123]
    ds_read_b64_tr_b16 a[236:237], v29 offset:12416
    v_mfma_f32_16x16x32_bf16 v[120:123], a[192:195], a[140:143], v[120:123]
    ds_read_b64_tr_b16 a[238:239], v29 offset:18560
    v_mfma_f32_16x16x32_bf16 v[124:127], a[200:203], a[140:143], v[124:127]
    v_mfma_f32_16x16x32_bf16 v[124:127], a[204:207], a[156:159], v[124:127]
    buffer_load_dwordx4 v45, s[12:15], s53 offen offset:1024 lds
    v_mfma_f32_16x16x32_bf16 v[116:119], a[204:207], a[152:155], v[116:119]
    v_mfma_f32_16x16x32_bf16 v[116:119], a[200:203], a[136:139], v[116:119]
    v_mfma_f32_16x16x32_bf16 v[108:111], a[200:203], a[132:135], v[108:111]
    ds_read_b64_tr_b16 a[240:241], v26 offset:256
    v_mfma_f32_16x16x32_bf16 v[108:111], a[204:207], a[148:151], v[108:111]
    ds_read_b64_tr_b16 a[242:243], v26 offset:6400
    v_mfma_f32_16x16x32_bf16 v[100:103], a[204:207], a[144:147], v[100:103]
    ds_read_b64_tr_b16 a[244:245], v26 offset:12544
    v_mfma_f32_16x16x32_bf16 v[100:103], a[200:203], a[128:131], v[100:103]
    ds_read_b64_tr_b16 a[246:247], v26 offset:18688
    v_mfma_f32_16x16x32_bf16 v[128:131], a[208:211], a[128:131], v[128:131]
    v_mfma_f32_16x16x32_bf16 v[128:131], a[212:215], a[144:147], v[128:131]
    v_mfma_f32_16x16x32_bf16 v[136:139], a[212:215], a[148:151], v[136:139]
    buffer_load_dwordx4 v46, s[12:15], s53 offen offset:2048 lds
    v_mfma_f32_16x16x32_bf16 v[136:139], a[208:211], a[132:135], v[136:139]
    s_add_u32 s53, s53, 196608
    v_mfma_f32_16x16x32_bf16 v[144:147], a[208:211], a[136:139], v[144:147]
    ds_read_b64_tr_b16 a[248:249], v27 offset:256
    v_mfma_f32_16x16x32_bf16 v[144:147], a[212:215], a[152:155], v[144:147]
    ds_read_b64_tr_b16 a[250:251], v27 offset:6400
    v_mfma_f32_16x16x32_bf16 v[152:155], a[212:215], a[156:159], v[152:155]
    ds_read_b64_tr_b16 a[252:253], v27 offset:12544
    v_mfma_f32_16x16x32_bf16 v[152:155], a[208:211], a[140:143], v[152:155]
    ds_read_b64_tr_b16 a[254:255], v27 offset:18688
    v_mfma_f32_16x16x32_bf16 v[156:159], a[216:219], a[140:143], v[156:159]
    s_waitcnt lgkmcnt(4)
    v_mfma_f32_16x16x32_bf16 v[156:159], a[220:223], a[156:159], v[156:159]
    v_mfma_f32_16x16x32_bf16 v[148:151], a[220:223], a[152:155], v[148:151]
    v_mfma_f32_16x16x32_bf16 v[148:151], a[216:219], a[136:139], v[148:151]
    v_mfma_f32_16x16x32_bf16 v[140:143], a[216:219], a[132:135], v[140:143]
    ds_read_b64_tr_b16 a[192:193], v28 offset:256
    v_mfma_f32_16x16x32_bf16 v[140:143], a[220:223], a[148:151], v[140:143]
    ds_read_b64_tr_b16 a[194:195], v28 offset:6400
    v_mfma_f32_16x16x32_bf16 v[132:135], a[220:223], a[144:147], v[132:135]
    ds_read_b64_tr_b16 a[196:197], v28 offset:12544
    v_mfma_f32_16x16x32_bf16 v[132:135], a[216:219], a[128:131], v[132:135]
    ds_read_b64_tr_b16 a[198:199], v28 offset:18688
    v_mfma_f32_16x16x32_bf16 v[160:163], a[224:227], a[128:131], v[160:163]
    v_mfma_f32_16x16x32_bf16 v[160:163], a[228:231], a[144:147], v[160:163]
    v_mfma_f32_16x16x32_bf16 v[168:171], a[228:231], a[148:151], v[168:171]
    v_mfma_f32_16x16x32_bf16 v[168:171], a[224:227], a[132:135], v[168:171]
    v_mfma_f32_16x16x32_bf16 v[176:179], a[224:227], a[136:139], v[176:179]
    ds_read_b64_tr_b16 a[200:201], v29 offset:256
    v_mfma_f32_16x16x32_bf16 v[176:179], a[228:231], a[152:155], v[176:179]
    ds_read_b64_tr_b16 a[202:203], v29 offset:6400
    v_mfma_f32_16x16x32_bf16 v[184:187], a[228:231], a[156:159], v[184:187]
    ds_read_b64_tr_b16 a[204:205], v29 offset:12544
    v_mfma_f32_16x16x32_bf16 v[184:187], a[224:227], a[140:143], v[184:187]
    ds_read_b64_tr_b16 a[206:207], v29 offset:18688
    v_mfma_f32_16x16x32_bf16 v[188:191], a[232:235], a[140:143], v[188:191]
    v_mfma_f32_16x16x32_bf16 v[188:191], a[236:239], a[156:159], v[188:191]
    v_mfma_f32_16x16x32_bf16 v[180:183], a[236:239], a[152:155], v[180:183]
    v_mfma_f32_16x16x32_bf16 v[180:183], a[232:235], a[136:139], v[180:183]
    v_mfma_f32_16x16x32_bf16 v[172:175], a[232:235], a[132:135], v[172:175]
    v_mfma_f32_16x16x32_bf16 v[172:175], a[236:239], a[148:151], v[172:175]
    v_mfma_f32_16x16x32_bf16 v[164:167], a[236:239], a[144:147], v[164:167]
    v_mfma_f32_16x16x32_bf16 v[164:167], a[232:235], a[128:131], v[164:167]
    v_mfma_f32_16x16x32_bf16 v[192:195], a[240:243], a[128:131], v[192:195]
    v_mfma_f32_16x16x32_bf16 v[192:195], a[244:247], a[144:147], v[192:195]
    v_mfma_f32_16x16x32_bf16 v[200:203], a[244:247], a[148:151], v[200:203]
    v_add_u32 v26, 24576, v22
    v_add_u32 v27, 24576, v23
    v_mfma_f32_16x16x32_bf16 v[200:203], a[240:243], a[132:135], v[200:203]
    v_add_u32 v28, 24576, v24
    v_add_u32 v29, 24576, v25
    v_mfma_f32_16x16x32_bf16 v[208:211], a[240:243], a[136:139], v[208:211]
    v_mfma_f32_16x16x32_bf16 v[208:211], a[244:247], a[152:155], v[208:211]
    v_mfma_f32_16x16x32_bf16 v[216:219], a[244:247], a[156:159], v[216:219]
    v_mfma_f32_16x16x32_bf16 v[216:219], a[240:243], a[140:143], v[216:219]
    s_waitcnt lgkmcnt(0)
    v_mfma_f32_16x16x32_bf16 v[220:223], a[248:251], a[140:143], v[220:223]
    v_mfma_f32_16x16x32_bf16 v[220:223], a[252:255], a[156:159], v[220:223]
    v_mfma_f32_16x16x32_bf16 v[212:215], a[252:255], a[152:155], v[212:215]
    v_mfma_f32_16x16x32_bf16 v[212:215], a[248:251], a[136:139], v[212:215]
    v_mfma_f32_16x16x32_bf16 v[204:207], a[248:251], a[132:135], v[204:207]
    v_mfma_f32_16x16x32_bf16 v[204:207], a[252:255], a[148:151], v[204:207]
    v_mfma_f32_16x16x32_bf16 v[196:199], a[252:255], a[144:147], v[196:199]
    s_waitcnt vmcnt(34)
    s_waitcnt lgkmcnt(0)
    s_barrier
    v_mfma_f32_16x16x32_bf16 v[196:199], a[248:251], a[128:131], v[196:199]
    ds_read_b64_tr_b16 a[208:209], v47 offset:12288
    v_mfma_f32_16x16x32_bf16 v[224:227], a[192:195], a[128:131], v[224:227]
    ds_read_b64_tr_b16 a[210:211], v47 offset:13824
    v_mfma_f32_16x16x32_bf16 v[224:227], a[196:199], a[144:147], v[224:227]
    ds_read_b64_tr_b16 a[212:213], v47 offset:15360
    v_mfma_f32_16x16x32_bf16 v[232:235], a[196:199], a[148:151], v[232:235]
    ds_read_b64_tr_b16 a[214:215], v47 offset:16896
    v_mfma_f32_16x16x32_bf16 v[232:235], a[192:195], a[132:135], v[232:235]
    ds_read_b64_tr_b16 a[216:217], v48 offset:12288
    v_mfma_f32_16x16x32_bf16 v[240:243], a[192:195], a[136:139], v[240:243]
    ds_read_b64_tr_b16 a[218:219], v48 offset:13824
    v_mfma_f32_16x16x32_bf16 v[240:243], a[196:199], a[152:155], v[240:243]
    ds_read_b64_tr_b16 a[220:221], v48 offset:15360
    v_mfma_f32_16x16x32_bf16 v[248:251], a[196:199], a[156:159], v[248:251]
    ds_read_b64_tr_b16 a[222:223], v48 offset:16896
    v_mfma_f32_16x16x32_bf16 v[248:251], a[192:195], a[140:143], v[248:251]
    ds_read_b64_tr_b16 a[224:225], v49 offset:12288
    v_mfma_f32_16x16x32_bf16 v[252:255], a[200:203], a[140:143], v[252:255]
    ds_read_b64_tr_b16 a[226:227], v49 offset:13824
    v_mfma_f32_16x16x32_bf16 v[252:255], a[204:207], a[156:159], v[252:255]
    ds_read_b64_tr_b16 a[228:229], v49 offset:15360
    v_mfma_f32_16x16x32_bf16 v[244:247], a[204:207], a[152:155], v[244:247]
    ds_read_b64_tr_b16 a[230:231], v49 offset:16896
    v_mfma_f32_16x16x32_bf16 v[244:247], a[200:203], a[136:139], v[244:247]
    ds_read_b64_tr_b16 a[232:233], v47 offset:18432
    v_mfma_f32_16x16x32_bf16 v[236:239], a[200:203], a[132:135], v[236:239]
    ds_read_b64_tr_b16 a[234:235], v47 offset:19968
    v_mfma_f32_16x16x32_bf16 v[236:239], a[204:207], a[148:151], v[236:239]
    ds_read_b64_tr_b16 a[236:237], v47 offset:21504
    v_mfma_f32_16x16x32_bf16 v[228:231], a[204:207], a[144:147], v[228:231]
    ds_read_b64_tr_b16 a[238:239], v47 offset:23040
    v_mfma_f32_16x16x32_bf16 v[228:231], a[200:203], a[128:131], v[228:231]
    s_waitcnt vmcnt(33) lgkmcnt(8)
    ds_read_b64_tr_b16 a[240:241], v48 offset:18432
    v_mfma_f32_16x16x32_bf16 a[0:3], a[208:211], a[160:163], a[0:3]
    s_waitcnt vmcnt(29)
    ds_read_b64_tr_b16 a[242:243], v48 offset:19968
    v_mfma_f32_16x16x32_bf16 a[0:3], a[212:215], a[176:179], a[0:3]
    s_waitcnt vmcnt(28)
    ds_read_b64_tr_b16 a[244:245], v48 offset:21504
    s_add_u32 s96, s49, 57344
    v_mfma_f32_16x16x32_bf16 a[4:7], a[212:215], a[180:183], a[4:7]
    buffer_load_dwordx4 a[128:131], v1, s[16:19], s96 offen offset:0 sc1
    v_mfma_f32_16x16x32_bf16 a[4:7], a[208:211], a[164:167], a[4:7]
WS2:
    s_cbranch_execz MAINC
    ds_read_b64_tr_b16 a[246:247], v48 offset:23040
    v_mfma_f32_16x16x32_bf16 a[8:11], a[208:211], a[168:171], a[8:11]
    s_waitcnt vmcnt(28)
    ds_read_b64_tr_b16 a[248:249], v49 offset:18432
    v_mfma_f32_16x16x32_bf16 a[8:11], a[212:215], a[184:187], a[8:11]
    s_waitcnt vmcnt(27)
    ds_read_b64_tr_b16 a[250:251], v49 offset:19968
    v_mfma_f32_16x16x32_bf16 a[12:15], a[212:215], a[188:191], a[12:15]
    buffer_load_dwordx4 a[132:135], v1, s[16:19], s96 offen offset:1024 sc1
    v_mfma_f32_16x16x32_bf16 a[12:15], a[208:211], a[172:175], a[12:15]
    ds_read_b64_tr_b16 a[252:253], v49 offset:21504
    v_mfma_f32_16x16x32_bf16 a[28:31], a[216:219], a[172:175], a[28:31]
    ds_read_b64_tr_b16 a[254:255], v49 offset:23040
    v_mfma_f32_16x16x32_bf16 a[28:31], a[220:223], a[188:191], a[28:31]
    v_mfma_f32_16x16x32_bf16 a[24:27], a[220:223], a[184:187], a[24:27]
    buffer_load_dwordx4 a[136:139], v1, s[16:19], s96 offen offset:2048 sc1
    v_mfma_f32_16x16x32_bf16 a[24:27], a[216:219], a[168:171], a[24:27]
    v_mfma_f32_16x16x32_bf16 a[20:23], a[216:219], a[164:167], a[20:23]
    ds_read_b64_tr_b16 a[192:193], v26 offset:0
    v_mfma_f32_16x16x32_bf16 a[20:23], a[220:223], a[180:183], a[20:23]
    ds_read_b64_tr_b16 a[194:195], v26 offset:6144
    v_mfma_f32_16x16x32_bf16 a[16:19], a[220:223], a[176:179], a[16:19]
    ds_read_b64_tr_b16 a[196:197], v26 offset:12288
    v_mfma_f32_16x16x32_bf16 a[16:19], a[216:219], a[160:163], a[16:19]
    s_waitcnt lgkmcnt(5)
    buffer_load_dwordx4 a[140:143], v1, s[16:19], s96 offen offset:3072 sc1
    v_mfma_f32_16x16x32_bf16 a[32:35], a[224:227], a[160:163], a[32:35]
    s_add_u32 s96, s49, 61440
    ds_read_b64_tr_b16 a[198:199], v26 offset:18432
    v_mfma_f32_16x16x32_bf16 a[32:35], a[228:231], a[176:179], a[32:35]
    v_mfma_f32_16x16x32_bf16 a[36:39], a[228:231], a[180:183], a[36:39]
    v_mfma_f32_16x16x32_bf16 a[36:39], a[224:227], a[164:167], a[36:39]
    buffer_load_dwordx4 a[144:147], v1, s[16:19], s96 offen offset:0 sc1
    v_mfma_f32_16x16x32_bf16 a[40:43], a[224:227], a[168:171], a[40:43]
    ds_read_b64_tr_b16 a[200:201], v27 offset:0
    v_mfma_f32_16x16x32_bf16 a[40:43], a[228:231], a[184:187], a[40:43]
    ds_read_b64_tr_b16 a[202:203], v27 offset:6144
    v_mfma_f32_16x16x32_bf16 a[44:47], a[228:231], a[188:191], a[44:47]
    ds_read_b64_tr_b16 a[204:205], v27 offset:12288
    v_mfma_f32_16x16x32_bf16 a[44:47], a[224:227], a[172:175], a[44:47]
    ds_read_b64_tr_b16 a[206:207], v27 offset:18432
    v_mfma_f32_16x16x32_bf16 a[60:63], a[232:235], a[172:175], a[60:63]
    buffer_load_dwordx4 a[148:151], v1, s[16:19], s96 offen offset:1024 sc1
    v_mfma_f32_16x16x32_bf16 a[60:63], a[236:239], a[188:191], a[60:63]
    v_mfma_f32_16x16x32_bf16 a[56:59], a[236:239], a[184:187], a[56:59]
    v_mfma_f32_16x16x32_bf16 a[56:59], a[232:235], a[168:171], a[56:59]
    v_mfma_f32_16x16x32_bf16 a[52:55], a[232:235], a[164:167], a[52:55]
    buffer_load_dwordx4 a[152:155], v1, s[16:19], s96 offen offset:2048 sc1
    v_mfma_f32_16x16x32_bf16 a[52:55], a[236:239], a[180:183], a[52:55]
    ds_read_b64_tr_b16 a[208:209], v28 offset:0
    v_mfma_f32_16x16x32_bf16 a[48:51], a[236:239], a[176:179], a[48:51]
    ds_read_b64_tr_b16 a[210:211], v28 offset:6144
    v_mfma_f32_16x16x32_bf16 a[48:51], a[232:235], a[160:163], a[48:51]
    ds_read_b64_tr_b16 a[212:213], v28 offset:12288
    v_mfma_f32_16x16x32_bf16 a[64:67], a[240:243], a[160:163], a[64:67]
    ds_read_b64_tr_b16 a[214:215], v28 offset:18432
    v_mfma_f32_16x16x32_bf16 a[64:67], a[244:247], a[176:179], a[64:67]
    buffer_load_dwordx4 a[156:159], v1, s[16:19], s96 offen offset:3072 sc1
    v_mfma_f32_16x16x32_bf16 a[68:71], a[244:247], a[180:183], a[68:71]
    s_add_u32 m0, s42, 0
    v_mfma_f32_16x16x32_bf16 a[68:71], a[240:243], a[164:167], a[68:71]
    v_mfma_f32_16x16x32_bf16 a[72:75], a[240:243], a[168:171], a[72:75]
    ds_read_b64_tr_b16 a[216:217], v29 offset:0
    v_mfma_f32_16x16x32_bf16 a[72:75], a[244:247], a[184:187], a[72:75]
    buffer_load_dwordx4 v2, s[20:23], s57 offen offset:0 lds
    v_mfma_f32_16x16x32_bf16 a[76:79], a[244:247], a[188:191], a[76:79]
    ds_read_b64_tr_b16 a[218:219], v29 offset:6144
    v_mfma_f32_16x16x32_bf16 a[76:79], a[240:243], a[172:175], a[76:79]
    ds_read_b64_tr_b16 a[220:221], v29 offset:12288
    v_mfma_f32_16x16x32_bf16 a[92:95], a[248:251], a[172:175], a[92:95]
    s_waitcnt lgkmcnt(4)
    ds_read_b64_tr_b16 a[222:223], v29 offset:18432
    v_mfma_f32_16x16x32_bf16 a[92:95], a[252:255], a[188:191], a[92:95]
    v_mfma_f32_16x16x32_bf16 a[88:91], a[252:255], a[184:187], a[88:91]
    buffer_load_dwordx4 v3, s[20:23], s57 offen offset:1024 lds
    v_mfma_f32_16x16x32_bf16 a[88:91], a[248:251], a[168:171], a[88:91]
    v_mfma_f32_16x16x32_bf16 a[84:87], a[248:251], a[164:167], a[84:87]
    ds_read_b64_tr_b16 a[224:225], v26 offset:128
    v_mfma_f32_16x16x32_bf16 a[84:87], a[252:255], a[180:183], a[84:87]
    ds_read_b64_tr_b16 a[226:227], v26 offset:6272
    v_mfma_f32_16x16x32_bf16 a[80:83], a[252:255], a[176:179], a[80:83]
    buffer_load_dwordx4 v4, s[20:23], s57 offen offset:2048 lds
    v_mfma_f32_16x16x32_bf16 a[80:83], a[248:251], a[160:163], a[80:83]
    ds_read_b64_tr_b16 a[228:229], v26 offset:12416
    v_mfma_f32_16x16x32_bf16 v[64:67], a[192:195], a[160:163], v[64:67]
    ds_read_b64_tr_b16 a[230:231], v26 offset:18560
    v_mfma_f32_16x16x32_bf16 v[64:67], a[196:199], a[176:179], v[64:67]
    v_mfma_f32_16x16x32_bf16 v[72:75], a[196:199], a[180:183], v[72:75]
    v_mfma_f32_16x16x32_bf16 v[72:75], a[192:195], a[164:167], v[72:75]
    buffer_load_dwordx4 v5, s[20:23], s57 offen offset:3072 lds
    v_mfma_f32_16x16x32_bf16 v[80:83], a[192:195], a[168:171], v[80:83]
    s_add_u32 m0, m0, 4096
    ds_read_b64_tr_b16 a[232:233], v27 offset:128
    v_mfma_f32_16x16x32_bf16 v[80:83], a[196:199], a[184:187], v[80:83]
    ds_read_b64_tr_b16 a[234:235], v27 offset:6272
    v_mfma_f32_16x16x32_bf16 v[88:91], a[196:199], a[188:191], v[88:91]
    ds_read_b64_tr_b16 a[236:237], v27 offset:12416
    v_mfma_f32_16x16x32_bf16 v[88:91], a[192:195], a[172:175], v[88:91]
    buffer_load_dwordx4 v6, s[20:23], s57 offen offset:0 lds
    v_mfma_f32_16x16x32_bf16 v[92:95], a[200:203], a[172:175], v[92:95]
    ds_read_b64_tr_b16 a[238:239], v27 offset:18560
    v_mfma_f32_16x16x32_bf16 v[92:95], a[204:207], a[188:191], v[92:95]
    v_mfma_f32_16x16x32_bf16 v[84:87], a[204:207], a[184:187], v[84:87]
    v_mfma_f32_16x16x32_bf16 v[84:87], a[200:203], a[168:171], v[84:87]
    v_mfma_f32_16x16x32_bf16 v[76:79], a[200:203], a[164:167], v[76:79]
    buffer_load_dwordx4 v7, s[20:23], s57 offen offset:1024 lds
    v_mfma_f32_16x16x32_bf16 v[76:79], a[204:207], a[180:183], v[76:79]
    s_add_u32 s57, s57, 786432
    ds_read_b64_tr_b16 a[240:241], v28 offset:128
    s_add_u32 m0, s97, 98304
    v_mfma_f32_16x16x32_bf16 v[68:71], a[204:207], a[176:179], v[68:71]
    ds_read_b64_tr_b16 a[242:243], v28 offset:6272
    v_mfma_f32_16x16x32_bf16 v[68:71], a[200:203], a[160:163], v[68:71]
    ds_read_b64_tr_b16 a[244:245], v28 offset:12416
    v_mfma_f32_16x16x32_bf16 v[96:99], a[208:211], a[160:163], v[96:99]
    s_waitcnt lgkmcnt(4)
    buffer_load_dwordx4 v44, s[12:15], s53 offen offset:0 lds
    v_mfma_f32_16x16x32_bf16 v[96:99], a[212:215], a[176:179], v[96:99]
    ds_read_b64_tr_b16 a[246:247], v28 offset:18560
    v_mfma_f32_16x16x32_bf16 v[104:107], a[212:215], a[180:183], v[104:107]
    v_mfma_f32_16x16x32_bf16 v[104:107], a[208:211], a[164:167], v[104:107]
    v_mfma_f32_16x16x32_bf16 v[112:115], a[208:211], a[168:171], v[112:115]
    ds_read_b64_tr_b16 a[248:249], v29 offset:128
    v_mfma_f32_16x16x32_bf16 v[112:115], a[212:215], a[184:187], v[112:115]
    ds_read_b64_tr_b16 a[250:251], v29 offset:6272
    v_mfma_f32_16x16x32_bf16 v[120:123], a[212:215], a[188:191], v[120:123]
    ds_read_b64_tr_b16 a[252:253], v29 offset:12416
    v_lshlrev_b32 v62, 3, v42
    v_mfma_f32_16x16x32_bf16 v[120:123], a[208:211], a[172:175], v[120:123]
    ds_read_b64_tr_b16 a[254:255], v29 offset:18560
    v_and_b32 v62, 3072, v62
    v_mfma_f32_16x16x32_bf16 v[124:127], a[216:219], a[172:175], v[124:127]
    s_and_b32 s58, s2, 0xe7
    s_lshl_b32 s58, s58, 7
    s_add_u32 s58, s58, 62390272
    v_mfma_f32_16x16x32_bf16 v[124:127], a[220:223], a[188:191], v[124:127]
    buffer_load_dword v38, v62, s[16:19], s58 offen offset:12 sc1
    v_mfma_f32_16x16x32_bf16 v[116:119], a[220:223], a[184:187], v[116:119]
    v_mfma_f32_16x16x32_bf16 v[116:119], a[216:219], a[168:171], v[116:119]
    v_mfma_f32_16x16x32_bf16 v[108:111], a[216:219], a[164:167], v[108:111]
    ds_read_b64_tr_b16 a[192:193], v26 offset:256
    v_mfma_f32_16x16x32_bf16 v[108:111], a[220:223], a[180:183], v[108:111]
    ds_read_b64_tr_b16 a[194:195], v26 offset:6400
    v_mfma_f32_16x16x32_bf16 v[100:103], a[220:223], a[176:179], v[100:103]
    buffer_load_dwordx4 v45, s[12:15], s53 offen offset:1024 lds
    v_mfma_f32_16x16x32_bf16 v[100:103], a[216:219], a[160:163], v[100:103]
    ds_read_b64_tr_b16 a[196:197], v26 offset:12544
    v_mfma_f32_16x16x32_bf16 v[128:131], a[224:227], a[160:163], v[128:131]
    ds_read_b64_tr_b16 a[198:199], v26 offset:18688
    v_mfma_f32_16x16x32_bf16 v[128:131], a[228:231], a[176:179], v[128:131]
    v_mfma_f32_16x16x32_bf16 v[136:139], a[228:231], a[180:183], v[136:139]
    v_mfma_f32_16x16x32_bf16 v[136:139], a[224:227], a[164:167], v[136:139]
    v_mfma_f32_16x16x32_bf16 v[144:147], a[224:227], a[168:171], v[144:147]
    ds_read_b64_tr_b16 a[200:201], v27 offset:256
    v_mfma_f32_16x16x32_bf16 v[144:147], a[228:231], a[184:187], v[144:147]
    ds_read_b64_tr_b16 a[202:203], v27 offset:6400
    v_mfma_f32_16x16x32_bf16 v[152:155], a[228:231], a[188:191], v[152:155]
    ds_read_b64_tr_b16 a[204:205], v27 offset:12544
    v_mfma_f32_16x16x32_bf16 v[152:155], a[224:227], a[172:175], v[152:155]
    buffer_load_dwordx4 v46, s[12:15], s53 offen offset:2048 lds
    v_mfma_f32_16x16x32_bf16 v[156:159], a[232:235], a[172:175], v[156:159]
    s_waitcnt lgkmcnt(4)
    ds_read_b64_tr_b16 a[206:207], v27 offset:18688
    s_add_u32 s53, s53, 196608
    v_mfma_f32_16x16x32_bf16 v[156:159], a[236:239], a[188:191], v[156:159]
    v_mfma_f32_16x16x32_bf16 v[148:151], a[236:239], a[184:187], v[148:151]
    v_mfma_f32_16x16x32_bf16 v[148:151], a[232:235], a[168:171], v[148:151]
    v_mfma_f32_16x16x32_bf16 v[140:143], a[232:235], a[164:167], v[140:143]
    ds_read_b64_tr_b16 a[208:209], v28 offset:256
    v_mfma_f32_16x16x32_bf16 v[140:143], a[236:239], a[180:183], v[140:143]
    ds_read_b64_tr_b16 a[210:211], v28 offset:6400
    v_mfma_f32_16x16x32_bf16 v[132:135], a[236:239], a[176:179], v[132:135]
    ds_read_b64_tr_b16 a[212:213], v28 offset:12544
    v_mfma_f32_16x16x32_bf16 v[132:135], a[232:235], a[160:163], v[132:135]
    ds_read_b64_tr_b16 a[214:215], v28 offset:18688
    v_mfma_f32_16x16x32_bf16 v[160:163], a[240:243], a[160:163], v[160:163]
    v_mfma_f32_16x16x32_bf16 v[160:163], a[244:247], a[176:179], v[160:163]
    v_mfma_f32_16x16x32_bf16 v[168:171], a[244:247], a[180:183], v[168:171]
    v_mfma_f32_16x16x32_bf16 v[168:171], a[240:243], a[164:167], v[168:171]
    v_mfma_f32_16x16x32_bf16 v[176:179], a[240:243], a[168:171], v[176:179]
    ds_read_b64_tr_b16 a[216:217], v29 offset:256
    v_mfma_f32_16x16x32_bf16 v[176:179], a[244:247], a[184:187], v[176:179]
    ds_read_b64_tr_b16 a[218:219], v29 offset:6400
    v_mfma_f32_16x16x32_bf16 v[184:187], a[244:247], a[188:191], v[184:187]
    ds_read_b64_tr_b16 a[220:221], v29 offset:12544
    v_mfma_f32_16x16x32_bf16 v[184:187], a[240:243], a[172:175], v[184:187]
    ds_read_b64_tr_b16 a[222:223], v29 offset:18688
    v_mfma_f32_16x16x32_bf16 v[188:191], a[248:251], a[172:175], v[188:191]
    v_mfma_f32_16x16x32_bf16 v[188:191], a[252:255], a[188:191], v[188:191]
    v_mfma_f32_16x16x32_bf16 v[180:183], a[252:255], a[184:187], v[180:183]
    v_mfma_f32_16x16x32_bf16 v[180:183], a[248:251], a[168:171], v[180:183]
    v_mfma_f32_16x16x32_bf16 v[172:175], a[248:251], a[164:167], v[172:175]
    v_mfma_f32_16x16x32_bf16 v[172:175], a[252:255], a[180:183], v[172:175]
    v_mfma_f32_16x16x32_bf16 v[164:167], a[252:255], a[176:179], v[164:167]
    v_mfma_f32_16x16x32_bf16 v[164:167], a[248:251], a[160:163], v[164:167]
    v_mfma_f32_16x16x32_bf16 v[192:195], a[192:195], a[160:163], v[192:195]
    s_waitcnt lgkmcnt(0)
    v_mfma_f32_16x16x32_bf16 v[192:195], a[196:199], a[176:179], v[192:195]
    v_mfma_f32_16x16x32_bf16 v[200:203], a[196:199], a[180:183], v[200:203]
    v_add_u32 v26, 49152, v22
    v_add_u32 v27, 49152, v23
    v_mfma_f32_16x16x32_bf16 v[200:203], a[192:195], a[164:167], v[200:203]
    v_add_u32 v28, 49152, v24
    v_add_u32 v29, 49152, v25
    v_mfma_f32_16x16x32_bf16 v[208:211], a[192:195], a[168:171], v[208:211]
    v_mfma_f32_16x16x32_bf16 v[208:211], a[196:199], a[184:187], v[208:211]
    v_mfma_f32_16x16x32_bf16 v[216:219], a[196:199], a[188:191], v[216:219]
    v_mfma_f32_16x16x32_bf16 v[216:219], a[192:195], a[172:175], v[216:219]
    v_mfma_f32_16x16x32_bf16 v[220:223], a[200:203], a[172:175], v[220:223]
    v_mfma_f32_16x16x32_bf16 v[220:223], a[204:207], a[188:191], v[220:223]
    v_mfma_f32_16x16x32_bf16 v[212:215], a[204:207], a[184:187], v[212:215]
    v_mfma_f32_16x16x32_bf16 v[212:215], a[200:203], a[168:171], v[212:215]
    v_mfma_f32_16x16x32_bf16 v[204:207], a[200:203], a[164:167], v[204:207]
    v_mfma_f32_16x16x32_bf16 v[204:207], a[204:207], a[180:183], v[204:207]
    v_mfma_f32_16x16x32_bf16 v[196:199], a[204:207], a[176:179], v[196:199]
    s_waitcnt vmcnt(35)
    s_waitcnt lgkmcnt(0)
    s_barrier
    v_mfma_f32_16x16x32_bf16 v[196:199], a[200:203], a[160:163], v[196:199]
    ds_read_b64_tr_b16 a[224:225], v47 offset:24576
    v_mfma_f32_16x16x32_bf16 v[224:227], a[208:211], a[160:163], v[224:227]
    ds_read_b64_tr_b16 a[226:227], v47 offset:26112
    v_mfma_f32_16x16x32_bf16 v[224:227], a[212:215], a[176:179], v[224:227]
    ds_read_b64_tr_b16 a[228:229], v47 offset:27648
    v_mfma_f32_16x16x32_bf16 v[232:235], a[212:215], a[180:183], v[232:235]
    ds_read_b64_tr_b16 a[230:231], v47 offset:29184
    v_mfma_f32_16x16x32_bf16 v[232:235], a[208:211], a[164:167], v[232:235]
    ds_read_b64_tr_b16 a[232:233], v48 offset:24576
    v_mfma_f32_16x16x32_bf16 v[240:243], a[208:211], a[168:171], v[240:243]
    ds_read_b64_tr_b16 a[234:235], v48 offset:26112
    v_mfma_f32_16x16x32_bf16 v[240:243], a[212:215], a[184:187], v[240:243]
    ds_read_b64_tr_b16 a[236:237], v48 offset:27648
    v_mfma_f32_16x16x32_bf16 v[248:251], a[212:215], a[188:191], v[248:251]
    ds_read_b64_tr_b16 a[238:239], v48 offset:29184
    v_mfma_f32_16x16x32_bf16 v[248:251], a[208:211], a[172:175], v[248:251]
    ds_read_b64_tr_b16 a[240:241], v49 offset:24576
    v_mfma_f32_16x16x32_bf16 v[252:255], a[216:219], a[172:175], v[252:255]
    ds_read_b64_tr_b16 a[242:243], v49 offset:26112
    v_mfma_f32_16x16x32_bf16 v[252:255], a[220:223], a[188:191], v[252:255]
    ds_read_b64_tr_b16 a[244:245], v49 offset:27648
    v_mfma_f32_16x16x32_bf16 v[244:247], a[220:223], a[184:187], v[244:247]
    ds_read_b64_tr_b16 a[246:247], v49 offset:29184
    v_mfma_f32_16x16x32_bf16 v[244:247], a[216:219], a[168:171], v[244:247]
    ds_read_b64_tr_b16 a[248:249], v47 offset:30720
    v_mfma_f32_16x16x32_bf16 v[236:239], a[216:219], a[164:167], v[236:239]
    ds_read_b64_tr_b16 a[250:251], v47 offset:32256
    v_mfma_f32_16x16x32_bf16 v[236:239], a[220:223], a[180:183], v[236:239]
    ds_read_b64_tr_b16 a[252:253], v47 offset:33792
    v_mfma_f32_16x16x32_bf16 v[228:231], a[220:223], a[176:179], v[228:231]
    ds_read_b64_tr_b16 a[254:255], v47 offset:35328
    v_mfma_f32_16x16x32_bf16 v[228:231], a[216:219], a[160:163], v[228:231]
    s_waitcnt vmcnt(34) lgkmcnt(8)
    ds_read_b64_tr_b16 a[192:193], v48 offset:30720
    v_mfma_f32_16x16x32_bf16 a[0:3], a[224:227], a[96:99], a[0:3]
    s_waitcnt vmcnt(30)
    ds_read_b64_tr_b16 a[194:195], v48 offset:32256
    v_mfma_f32_16x16x32_bf16 a[0:3], a[228:231], a[112:115], a[0:3]
    s_waitcnt vmcnt(29)
    ds_read_b64_tr_b16 a[196:197], v48 offset:33792
    s_add_u32 s96, s49, 65536
    v_mfma_f32_16x16x32_bf16 a[4:7], a[228:231], a[116:119], a[4:7]
    buffer_load_dwordx4 a[160:163], v1, s[16:19], s96 offen offset:0 sc1
    v_mfma_f32_16x16x32_bf16 a[4:7], a[224:227], a[100:103], a[4:7]
    ds_read_b64_tr_b16 a[198:199], v48 offset:35328
    v_mfma_f32_16x16x32_bf16 a[8:11], a[224:227], a[104:107], a[8:11]
    s_waitcnt vmcnt(29)
    ds_read_b64_tr_b16 a[200:201], v49 offset:30720
    v_mfma_f32_16x16x32_bf16 a[8:11], a[228:231], a[120:123], a[8:11]
    s_waitcnt vmcnt(28)
    ds_read_b64_tr_b16 a[202:203], v49 offset:32256
    v_mfma_f32_16x16x32_bf16 a[12:15], a[228:231], a[124:127], a[12:15]
    buffer_load_dwordx4 a[164:167], v1, s[16:19], s96 offen offset:1024 sc1
    v_mfma_f32_16x16x32_bf16 a[12:15], a[224:227], a[108:111], a[12:15]
    ds_read_b64_tr_b16 a[204:205], v49 offset:33792
    v_mfma_f32_16x16x32_bf16 a[28:31], a[232:235], a[108:111], a[28:31]
    ds_read_b64_tr_b16 a[206:207], v49 offset:35328
    v_mfma_f32_16x16x32_bf16 a[28:31], a[236:239], a[124:127], a[28:31]
    v_mfma_f32_16x16x32_bf16 a[24:27], a[236:239], a[120:123], a[24:27]
    buffer_load_dwordx4 a[168:171], v1, s[16:19], s96 offen offset:2048 sc1
    v_mfma_f32_16x16x32_bf16 a[24:27], a[232:235], a[104:107], a[24:27]
    v_mfma_f32_16x16x32_bf16 a[20:23], a[232:235], a[100:103], a[20:23]
    ds_read_b64_tr_b16 a[208:209], v26 offset:0
    v_mfma_f32_16x16x32_bf16 a[20:23], a[236:239], a[116:119], a[20:23]
    ds_read_b64_tr_b16 a[210:211], v26 offset:6144
    v_mfma_f32_16x16x32_bf16 a[16:19], a[236:239], a[112:115], a[16:19]
    ds_read_b64_tr_b16 a[212:213], v26 offset:12288
    v_mfma_f32_16x16x32_bf16 a[16:19], a[232:235], a[96:99], a[16:19]
    s_waitcnt lgkmcnt(5)
    buffer_load_dwordx4 a[172:175], v1, s[16:19], s96 offen offset:3072 sc1
    v_mfma_f32_16x16x32_bf16 a[32:35], a[240:243], a[96:99], a[32:35]
    s_add_u32 s96, s49, 69632
    ds_read_b64_tr_b16 a[214:215], v26 offset:18432
    v_mfma_f32_16x16x32_bf16 a[32:35], a[244:247], a[112:115], a[32:35]
    v_mfma_f32_16x16x32_bf16 a[36:39], a[244:247], a[116:119], a[36:39]
    v_mfma_f32_16x16x32_bf16 a[36:39], a[240:243], a[100:103], a[36:39]
    buffer_load_dwordx4 a[176:179], v1, s[16:19], s96 offen offset:0 sc1
    v_mfma_f32_16x16x32_bf16 a[40:43], a[240:243], a[104:107], a[40:43]
    ds_read_b64_tr_b16 a[216:217], v27 offset:0
    v_mfma_f32_16x16x32_bf16 a[40:43], a[244:247], a[120:123], a[40:43]
    ds_read_b64_tr_b16 a[218:219], v27 offset:6144
    v_mfma_f32_16x16x32_bf16 a[44:47], a[244:247], a[124:127], a[44:47]
    ds_read_b64_tr_b16 a[220:221], v27 offset:12288
    v_mfma_f32_16x16x32_bf16 a[44:47], a[240:243], a[108:111], a[44:47]
    ds_read_b64_tr_b16 a[222:223], v27 offset:18432
    v_mfma_f32_16x16x32_bf16 a[60:63], a[248:251], a[108:111], a[60:63]
    buffer_load_dwordx4 a[180:183], v1, s[16:19], s96 offen offset:1024 sc1
    v_mfma_f32_16x16x32_bf16 a[60:63], a[252:255], a[124:127], a[60:63]
    v_mfma_f32_16x16x32_bf16 a[56:59], a[252:255], a[120:123], a[56:59]
    v_mfma_f32_16x16x32_bf16 a[56:59], a[248:251], a[104:107], a[56:59]
    v_mfma_f32_16x16x32_bf16 a[52:55], a[248:251], a[100:103], a[52:55]
    buffer_load_dwordx4 a[184:187], v1, s[16:19], s96 offen offset:2048 sc1
    v_mfma_f32_16x16x32_bf16 a[52:55], a[252:255], a[116:119], a[52:55]
    ds_read_b64_tr_b16 a[224:225], v28 offset:0
    v_mfma_f32_16x16x32_bf16 a[48:51], a[252:255], a[112:115], a[48:51]
    ds_read_b64_tr_b16 a[226:227], v28 offset:6144
    v_mfma_f32_16x16x32_bf16 a[48:51], a[248:251], a[96:99], a[48:51]
    ds_read_b64_tr_b16 a[228:229], v28 offset:12288
    v_mfma_f32_16x16x32_bf16 a[64:67], a[192:195], a[96:99], a[64:67]
    ds_read_b64_tr_b16 a[230:231], v28 offset:18432
    v_mfma_f32_16x16x32_bf16 a[64:67], a[196:199], a[112:115], a[64:67]
    buffer_load_dwordx4 a[188:191], v1, s[16:19], s96 offen offset:3072 sc1
    v_mfma_f32_16x16x32_bf16 a[68:71], a[196:199], a[116:119], a[68:71]
    s_add_u32 m0, s42, 24576
    v_mfma_f32_16x16x32_bf16 a[68:71], a[192:195], a[100:103], a[68:71]
    v_mfma_f32_16x16x32_bf16 a[72:75], a[192:195], a[104:107], a[72:75]
    ds_read_b64_tr_b16 a[232:233], v29 offset:0
    v_mfma_f32_16x16x32_bf16 a[72:75], a[196:199], a[120:123], a[72:75]
    buffer_load_dwordx4 v2, s[20:23], s57 offen offset:0 lds
    v_mfma_f32_16x16x32_bf16 a[76:79], a[196:199], a[124:127], a[76:79]
    ds_read_b64_tr_b16 a[234:235], v29 offset:6144
    v_mfma_f32_16x16x32_bf16 a[76:79], a[192:195], a[108:111], a[76:79]
    ds_read_b64_tr_b16 a[236:237], v29 offset:12288
    v_mfma_f32_16x16x32_bf16 a[92:95], a[200:203], a[108:111], a[92:95]
    s_waitcnt lgkmcnt(4)
    ds_read_b64_tr_b16 a[238:239], v29 offset:18432
    v_mfma_f32_16x16x32_bf16 a[92:95], a[204:207], a[124:127], a[92:95]
    v_mfma_f32_16x16x32_bf16 a[88:91], a[204:207], a[120:123], a[88:91]
    buffer_load_dwordx4 v3, s[20:23], s57 offen offset:1024 lds
    v_mfma_f32_16x16x32_bf16 a[88:91], a[200:203], a[104:107], a[88:91]
    v_mfma_f32_16x16x32_bf16 a[84:87], a[200:203], a[100:103], a[84:87]
    ds_read_b64_tr_b16 a[240:241], v26 offset:128
    v_mfma_f32_16x16x32_bf16 a[84:87], a[204:207], a[116:119], a[84:87]
    ds_read_b64_tr_b16 a[242:243], v26 offset:6272
    v_mfma_f32_16x16x32_bf16 a[80:83], a[204:207], a[112:115], a[80:83]
    buffer_load_dwordx4 v4, s[20:23], s57 offen offset:2048 lds
    v_mfma_f32_16x16x32_bf16 a[80:83], a[200:203], a[96:99], a[80:83]
    ds_read_b64_tr_b16 a[244:245], v26 offset:12416
    v_mfma_f32_16x16x32_bf16 v[64:67], a[208:211], a[96:99], v[64:67]
    ds_read_b64_tr_b16 a[246:247], v26 offset:18560
    v_mfma_f32_16x16x32_bf16 v[64:67], a[212:215], a[112:115], v[64:67]
    v_mfma_f32_16x16x32_bf16 v[72:75], a[212:215], a[116:119], v[72:75]
    v_mfma_f32_16x16x32_bf16 v[72:75], a[208:211], a[100:103], v[72:75]
    buffer_load_dwordx4 v5, s[20:23], s57 offen offset:3072 lds
    v_mfma_f32_16x16x32_bf16 v[80:83], a[208:211], a[104:107], v[80:83]
    s_add_u32 m0, m0, 4096
    ds_read_b64_tr_b16 a[248:249], v27 offset:128
    v_mfma_f32_16x16x32_bf16 v[80:83], a[212:215], a[120:123], v[80:83]
    ds_read_b64_tr_b16 a[250:251], v27 offset:6272
    v_mfma_f32_16x16x32_bf16 v[88:91], a[212:215], a[124:127], v[88:91]
    ds_read_b64_tr_b16 a[252:253], v27 offset:12416
    v_mfma_f32_16x16x32_bf16 v[88:91], a[208:211], a[108:111], v[88:91]
    buffer_load_dwordx4 v6, s[20:23], s57 offen offset:0 lds
    v_mfma_f32_16x16x32_bf16 v[92:95], a[216:219], a[108:111], v[92:95]
    ds_read_b64_tr_b16 a[254:255], v27 offset:18560
    v_mfma_f32_16x16x32_bf16 v[92:95], a[220:223], a[124:127], v[92:95]
    v_mfma_f32_16x16x32_bf16 v[84:87], a[220:223], a[120:123], v[84:87]
    v_mfma_f32_16x16x32_bf16 v[84:87], a[216:219], a[104:107], v[84:87]
    v_mfma_f32_16x16x32_bf16 v[76:79], a[216:219], a[100:103], v[76:79]
    buffer_load_dwordx4 v7, s[20:23], s57 offen offset:1024 lds
    v_mfma_f32_16x16x32_bf16 v[76:79], a[220:223], a[116:119], v[76:79]
    s_add_u32 s57, s57, 786432
    ds_read_b64_tr_b16 a[192:193], v28 offset:128
    s_add_u32 m0, s97, 110592
    v_mfma_f32_16x16x32_bf16 v[68:71], a[220:223], a[112:115], v[68:71]
    ds_read_b64_tr_b16 a[194:195], v28 offset:6272
    v_mfma_f32_16x16x32_bf16 v[68:71], a[216:219], a[96:99], v[68:71]
    ds_read_b64_tr_b16 a[196:197], v28 offset:12416
    v_mfma_f32_16x16x32_bf16 v[96:99], a[224:227], a[96:99], v[96:99]
    s_waitcnt lgkmcnt(4)
    buffer_load_dwordx4 v44, s[12:15], s53 offen offset:0 lds
    v_mfma_f32_16x16x32_bf16 v[96:99], a[228:231], a[112:115], v[96:99]
    ds_read_b64_tr_b16 a[198:199], v28 offset:18560
    v_mfma_f32_16x16x32_bf16 v[104:107], a[228:231], a[116:119], v[104:107]
    v_mfma_f32_16x16x32_bf16 v[104:107], a[224:227], a[100:103], v[104:107]
    v_mfma_f32_16x16x32_bf16 v[112:115], a[224:227], a[104:107], v[112:115]
    ds_read_b64_tr_b16 a[200:201], v29 offset:128
    v_mfma_f32_16x16x32_bf16 v[112:115], a[228:231], a[120:123], v[112:115]
    ds_read_b64_tr_b16 a[202:203], v29 offset:6272
    v_mfma_f32_16x16x32_bf16 v[120:123], a[228:231], a[124:127], v[120:123]
    ds_read_b64_tr_b16 a[204:205], v29 offset:12416
    v_mfma_f32_16x16x32_bf16 v[120:123], a[224:227], a[108:111], v[120:123]
    ds_read_b64_tr_b16 a[206:207], v29 offset:18560
    v_mfma_f32_16x16x32_bf16 v[124:127], a[232:235], a[108:111], v[124:127]
    v_mfma_f32_16x16x32_bf16 v[124:127], a[236:239], a[124:127], v[124:127]
    buffer_load_dwordx4 v45, s[12:15], s53 offen offset:1024 lds
    v_mfma_f32_16x16x32_bf16 v[116:119], a[236:239], a[120:123], v[116:119]
    v_mfma_f32_16x16x32_bf16 v[116:119], a[232:235], a[104:107], v[116:119]
    v_mfma_f32_16x16x32_bf16 v[108:111], a[232:235], a[100:103], v[108:111]
    ds_read_b64_tr_b16 a[208:209], v26 offset:256
    v_mfma_f32_16x16x32_bf16 v[108:111], a[236:239], a[116:119], v[108:111]
    ds_read_b64_tr_b16 a[210:211], v26 offset:6400
    v_mfma_f32_16x16x32_bf16 v[100:103], a[236:239], a[112:115], v[100:103]
    ds_read_b64_tr_b16 a[212:213], v26 offset:12544
    v_mfma_f32_16x16x32_bf16 v[100:103], a[232:235], a[96:99], v[100:103]
    ds_read_b64_tr_b16 a[214:215], v26 offset:18688
    v_mfma_f32_16x16x32_bf16 v[128:131], a[240:243], a[96:99], v[128:131]
    v_mfma_f32_16x16x32_bf16 v[128:131], a[244:247], a[112:115], v[128:131]
    v_mfma_f32_16x16x32_bf16 v[136:139], a[244:247], a[116:119], v[136:139]
    buffer_load_dwordx4 v46, s[12:15], s53 offen offset:2048 lds
    v_mfma_f32_16x16x32_bf16 v[136:139], a[240:243], a[100:103], v[136:139]
    s_add_u32 s53, s53, 196608
    v_mfma_f32_16x16x32_bf16 v[144:147], a[240:243], a[104:107], v[144:147]
    ds_read_b64_tr_b16 a[216:217], v27 offset:256
    v_mfma_f32_16x16x32_bf16 v[144:147], a[244:247], a[120:123], v[144:147]
    ds_read_b64_tr_b16 a[218:219], v27 offset:6400
    v_mfma_f32_16x16x32_bf16 v[152:155], a[244:247], a[124:127], v[152:155]
    ds_read_b64_tr_b16 a[220:221], v27 offset:12544
    v_mfma_f32_16x16x32_bf16 v[152:155], a[240:243], a[108:111], v[152:155]
    ds_read_b64_tr_b16 a[222:223], v27 offset:18688
    v_mfma_f32_16x16x32_bf16 v[156:159], a[248:251], a[108:111], v[156:159]
    s_waitcnt lgkmcnt(4)
    v_mfma_f32_16x16x32_bf16 v[156:159], a[252:255], a[124:127], v[156:159]
    v_mfma_f32_16x16x32_bf16 v[148:151], a[252:255], a[120:123], v[148:151]
    v_mfma_f32_16x16x32_bf16 v[148:151], a[248:251], a[104:107], v[148:151]
    v_mfma_f32_16x16x32_bf16 v[140:143], a[248:251], a[100:103], v[140:143]
    ds_read_b64_tr_b16 a[224:225], v28 offset:256
    v_mfma_f32_16x16x32_bf16 v[140:143], a[252:255], a[116:119], v[140:143]
    ds_read_b64_tr_b16 a[226:227], v28 offset:6400
    v_mfma_f32_16x16x32_bf16 v[132:135], a[252:255], a[112:115], v[132:135]
    ds_read_b64_tr_b16 a[228:229], v28 offset:12544
    v_mfma_f32_16x16x32_bf16 v[132:135], a[248:251], a[96:99], v[132:135]
    ds_read_b64_tr_b16 a[230:231], v28 offset:18688
    v_mfma_f32_16x16x32_bf16 v[160:163], a[192:195], a[96:99], v[160:163]
    v_mfma_f32_16x16x32_bf16 v[160:163], a[196:199], a[112:115], v[160:163]
    v_mfma_f32_16x16x32_bf16 v[168:171], a[196:199], a[116:119], v[168:171]
    v_mfma_f32_16x16x32_bf16 v[168:171], a[192:195], a[100:103], v[168:171]
    v_mfma_f32_16x16x32_bf16 v[176:179], a[192:195], a[104:107], v[176:179]
    ds_read_b64_tr_b16 a[232:233], v29 offset:256
    v_mfma_f32_16x16x32_bf16 v[176:179], a[196:199], a[120:123], v[176:179]
    ds_read_b64_tr_b16 a[234:235], v29 offset:6400
    v_mfma_f32_16x16x32_bf16 v[184:187], a[196:199], a[124:127], v[184:187]
    ds_read_b64_tr_b16 a[236:237], v29 offset:12544
    v_mfma_f32_16x16x32_bf16 v[184:187], a[192:195], a[108:111], v[184:187]
    ds_read_b64_tr_b16 a[238:239], v29 offset:18688
    v_mfma_f32_16x16x32_bf16 v[188:191], a[200:203], a[108:111], v[188:191]
    v_mfma_f32_16x16x32_bf16 v[188:191], a[204:207], a[124:127], v[188:191]
    v_mfma_f32_16x16x32_bf16 v[180:183], a[204:207], a[120:123], v[180:183]
    v_mfma_f32_16x16x32_bf16 v[180:183], a[200:203], a[104:107], v[180:183]
    v_mfma_f32_16x16x32_bf16 v[172:175], a[200:203], a[100:103], v[172:175]
    v_mfma_f32_16x16x32_bf16 v[172:175], a[204:207], a[116:119], v[172:175]
    v_mfma_f32_16x16x32_bf16 v[164:167], a[204:207], a[112:115], v[164:167]
    v_mfma_f32_16x16x32_bf16 v[164:167], a[200:203], a[96:99], v[164:167]
    v_mfma_f32_16x16x32_bf16 v[192:195], a[208:211], a[96:99], v[192:195]
    v_mfma_f32_16x16x32_bf16 v[192:195], a[212:215], a[112:115], v[192:195]
    v_mfma_f32_16x16x32_bf16 v[200:203], a[212:215], a[116:119], v[200:203]
    v_add_u32 v26, 73728, v22
    v_add_u32 v27, 73728, v23
    v_mfma_f32_16x16x32_bf16 v[200:203], a[208:211], a[100:103], v[200:203]
    v_add_u32 v28, 73728, v24
    v_add_u32 v29, 73728, v25
    v_mfma_f32_16x16x32_bf16 v[208:211], a[208:211], a[104:107], v[208:211]
    v_mfma_f32_16x16x32_bf16 v[208:211], a[212:215], a[120:123], v[208:211]
    v_mfma_f32_16x16x32_bf16 v[216:219], a[212:215], a[124:127], v[216:219]
    v_mfma_f32_16x16x32_bf16 v[216:219], a[208:211], a[108:111], v[216:219]
    s_waitcnt lgkmcnt(0)
    v_mfma_f32_16x16x32_bf16 v[220:223], a[216:219], a[108:111], v[220:223]
    v_mfma_f32_16x16x32_bf16 v[220:223], a[220:223], a[124:127], v[220:223]
    v_mfma_f32_16x16x32_bf16 v[212:215], a[220:223], a[120:123], v[212:215]
    v_mfma_f32_16x16x32_bf16 v[212:215], a[216:219], a[104:107], v[212:215]
    v_mfma_f32_16x16x32_bf16 v[204:207], a[216:219], a[100:103], v[204:207]
    v_mfma_f32_16x16x32_bf16 v[204:207], a[220:223], a[116:119], v[204:207]
    v_mfma_f32_16x16x32_bf16 v[196:199], a[220:223], a[112:115], v[196:199]
    s_waitcnt vmcnt(17)
    s_waitcnt lgkmcnt(0)
    s_barrier
    v_mfma_f32_16x16x32_bf16 v[196:199], a[216:219], a[96:99], v[196:199]
    ds_read_b64_tr_b16 a[240:241], v47 offset:36864
    v_mfma_f32_16x16x32_bf16 v[224:227], a[224:227], a[96:99], v[224:227]
    ds_read_b64_tr_b16 a[242:243], v47 offset:38400
    v_mfma_f32_16x16x32_bf16 v[224:227], a[228:231], a[112:115], v[224:227]
    ds_read_b64_tr_b16 a[244:245], v47 offset:39936
    v_mfma_f32_16x16x32_bf16 v[232:235], a[228:231], a[116:119], v[232:235]
    ds_read_b64_tr_b16 a[246:247], v47 offset:41472
    v_mfma_f32_16x16x32_bf16 v[232:235], a[224:227], a[100:103], v[232:235]
    ds_read_b64_tr_b16 a[248:249], v47 offset:0
    v_mfma_f32_16x16x32_bf16 v[240:243], a[224:227], a[104:107], v[240:243]
    ds_read_b64_tr_b16 a[250:251], v47 offset:1536
    v_mfma_f32_16x16x32_bf16 v[240:243], a[228:231], a[120:123], v[240:243]
    ds_read_b64_tr_b16 a[252:253], v47 offset:3072
    v_mfma_f32_16x16x32_bf16 v[248:251], a[228:231], a[124:127], v[248:251]
    ds_read_b64_tr_b16 a[254:255], v47 offset:4608
    v_mfma_f32_16x16x32_bf16 v[248:251], a[224:227], a[108:111], v[248:251]
    ds_read_b64_tr_b16 a[192:193], v48 offset:36864
    v_mfma_f32_16x16x32_bf16 v[252:255], a[232:235], a[108:111], v[252:255]
    ds_read_b64_tr_b16 a[194:195], v48 offset:38400
    v_mfma_f32_16x16x32_bf16 v[252:255], a[236:239], a[124:127], v[252:255]
    ds_read_b64_tr_b16 a[196:197], v48 offset:39936
    v_mfma_f32_16x16x32_bf16 v[244:247], a[236:239], a[120:123], v[244:247]
    ds_read_b64_tr_b16 a[198:199], v48 offset:41472
    v_mfma_f32_16x16x32_bf16 v[244:247], a[232:235], a[104:107], v[244:247]
    ds_read_b64_tr_b16 a[200:201], v48 offset:0
    v_mfma_f32_16x16x32_bf16 v[236:239], a[232:235], a[100:103], v[236:239]
    ds_read_b64_tr_b16 a[202:203], v48 offset:1536
    v_mfma_f32_16x16x32_bf16 v[236:239], a[236:239], a[116:119], v[236:239]
    ds_read_b64_tr_b16 a[204:205], v48 offset:3072
    v_mfma_f32_16x16x32_bf16 v[228:231], a[236:239], a[112:115], v[228:231]
    ds_read_b64_tr_b16 a[206:207], v48 offset:4608
    v_mfma_f32_16x16x32_bf16 v[228:231], a[232:235], a[96:99], v[228:231]
    s_waitcnt lgkmcnt(8)
    ds_read_b64_tr_b16 a[208:209], v49 offset:36864
    v_mfma_f32_16x16x32_bf16 a[0:3], a[240:243], a[128:131], a[0:3]
    ds_read_b64_tr_b16 a[210:211], v49 offset:38400
    v_mfma_f32_16x16x32_bf16 a[0:3], a[244:247], a[144:147], a[0:3]
    s_waitcnt vmcnt(16)
    s_add_u32 s96, s49, 73728
    ds_read_b64_tr_b16 a[212:213], v49 offset:39936
    v_mfma_f32_16x16x32_bf16 a[0:3], a[248:251], a[160:163], a[0:3]
    s_waitcnt vmcnt(12)
    buffer_load_dwordx4 a[96:99], v1, s[16:19], s96 offen offset:0 sc1
    v_mfma_f32_16x16x32_bf16 a[0:3], a[252:255], a[176:179], a[0:3]
    s_waitcnt vmcnt(12)
    ds_read_b64_tr_b16 a[214:215], v49 offset:41472
    v_mfma_f32_16x16x32_bf16 a[4:7], a[252:255], a[180:183], a[4:7]
    ds_read_b64_tr_b16 a[216:217], v49 offset:0
    v_mfma_f32_16x16x32_bf16 a[4:7], a[248:251], a[164:167], a[4:7]
    ds_read_b64_tr_b16 a[218:219], v49 offset:1536
    v_mfma_f32_16x16x32_bf16 a[4:7], a[244:247], a[148:151], a[4:7]
WS3:
    s_cbranch_execz MAINC
    buffer_load_dwordx4 a[100:103], v1, s[16:19], s96 offen offset:1024 sc1
    v_mfma_f32_16x16x32_bf16 a[4:7], a[240:243], a[132:135], a[4:7]
    ds_read_b64_tr_b16 a[220:221], v49 offset:3072
    v_mfma_f32_16x16x32_bf16 a[8:11], a[240:243], a[136:139], a[8:11]
    ds_read_b64_tr_b16 a[222:223], v49 offset:4608
    v_mfma_f32_16x16x32_bf16 a[8:11], a[244:247], a[152:155], a[8:11]
    v_mfma_f32_16x16x32_bf16 a[8:11], a[248:251], a[168:171], a[8:11]
    s_waitcnt vmcnt(12)
    buffer_load_dwordx4 a[104:107], v1, s[16:19], s96 offen offset:2048 sc1
    v_mfma_f32_16x16x32_bf16 a[8:11], a[252:255], a[184:187], a[8:11]
    s_waitcnt vmcnt(12)
    v_mfma_f32_16x16x32_bf16 a[12:15], a[252:255], a[188:191], a[12:15]
    ds_read_b64_tr_b16 a[224:225], v47 offset:43008
    v_mfma_f32_16x16x32_bf16 a[12:15], a[248:251], a[172:175], a[12:15]
    ds_read_b64_tr_b16 a[226:227], v47 offset:44544
    v_mfma_f32_16x16x32_bf16 a[12:15], a[244:247], a[156:159], a[12:15]
    ds_read_b64_tr_b16 a[228:229], v47 offset:46080
    v_mfma_f32_16x16x32_bf16 a[12:15], a[240:243], a[140:143], a[12:15]
    s_waitcnt lgkmcnt(5)
    buffer_load_dwordx4 a[108:111], v1, s[16:19], s96 offen offset:3072 sc1
    v_mfma_f32_16x16x32_bf16 a[28:31], a[192:195], a[140:143], a[28:31]
    s_add_u32 s96, s49, 77824
    ds_read_b64_tr_b16 a[230:231], v47 offset:47616
    v_mfma_f32_16x16x32_bf16 a[28:31], a[196:199], a[156:159], a[28:31]
    ds_read_b64_tr_b16 a[232:233], v47 offset:6144
    v_mfma_f32_16x16x32_bf16 a[28:31], a[200:203], a[172:175], a[28:31]
    ds_read_b64_tr_b16 a[234:235], v47 offset:7680
    v_mfma_f32_16x16x32_bf16 a[28:31], a[204:207], a[188:191], a[28:31]
    buffer_load_dwordx4 a[112:115], v1, s[16:19], s96 offen offset:0 sc1
    v_mfma_f32_16x16x32_bf16 a[24:27], a[204:207], a[184:187], a[24:27]
    ds_read_b64_tr_b16 a[236:237], v47 offset:9216
    v_add_u32 v52, s54, v61
    v_mfma_f32_16x16x32_bf16 a[24:27], a[200:203], a[168:171], a[24:27]
    ds_read_b64_tr_b16 a[238:239], v47 offset:10752
    v_mfma_f32_16x16x32_bf16 a[24:27], a[196:199], a[152:155], a[24:27]
    v_cmp_ne_u32 vcc, v38, v52
    s_cmp_lg_u64 vcc, 0
    s_cselect_b32 s54, 1, 0
    v_mfma_f32_16x16x32_bf16 a[24:27], a[192:195], a[136:139], a[24:27]
    v_mfma_f32_16x16x32_bf16 a[20:23], a[192:195], a[132:135], a[20:23]
    buffer_load_dwordx4 a[116:119], v1, s[16:19], s96 offen offset:1024 sc1
    v_mfma_f32_16x16x32_bf16 a[20:23], a[196:199], a[148:151], a[20:23]
    v_mfma_f32_16x16x32_bf16 a[20:23], a[200:203], a[164:167], a[20:23]
    v_mfma_f32_16x16x32_bf16 a[20:23], a[204:207], a[180:183], a[20:23]
    v_mfma_f32_16x16x32_bf16 a[16:19], a[204:207], a[176:179], a[16:19]
    buffer_load_dwordx4 a[120:123], v1, s[16:19], s96 offen offset:2048 sc1
    v_mfma_f32_16x16x32_bf16 a[16:19], a[200:203], a[160:163], a[16:19]
    ds_read_b64_tr_b16 a[240:241], v48 offset:43008
    v_mfma_f32_16x16x32_bf16 a[16:19], a[196:199], a[144:147], a[16:19]
    ds_read_b64_tr_b16 a[242:243], v48 offset:44544
    v_lshlrev_b32 v62, 5, v42
    v_mfma_f32_16x16x32_bf16 a[16:19], a[192:195], a[128:131], a[16:19]
    ds_read_b64_tr_b16 a[244:245], v48 offset:46080
    v_and_b32 v62, 28672, v62
    v_mfma_f32_16x16x32_bf16 a[32:35], a[208:211], a[128:131], a[32:35]
    s_mov_b32 s58, s40
    ds_read_b64_tr_b16 a[246:247], v48 offset:47616
    s_lshl_b32 s58, s58, 7
    v_mfma_f32_16x16x32_bf16 a[32:35], a[212:215], a[144:147], a[32:35]
    s_add_u32 s58, s58, 62390272
    buffer_load_dwordx4 a[124:127], v1, s[16:19], s96 offen offset:3072 sc1
    v_mfma_f32_16x16x32_bf16 a[32:35], a[216:219], a[160:163], a[32:35]
    s_waitcnt lgkmcnt(4)
    ds_read_b64_tr_b16 a[248:249], v48 offset:6144
    v_mfma_f32_16x16x32_bf16 a[32:35], a[220:223], a[176:179], a[32:35]
    ds_read_b64_tr_b16 a[250:251], v48 offset:7680
    v_mfma_f32_16x16x32_bf16 a[36:39], a[220:223], a[180:183], a[36:39]
    s_add_u32 m0, s42, 49152
    ds_read_b64_tr_b16 a[252:253], v48 offset:9216
    v_mfma_f32_16x16x32_bf16 a[36:39], a[216:219], a[164:167], a[36:39]
    buffer_load_dwordx4 v10, s[8:11], s43 offen offset:0 nt lds
    v_mfma_f32_16x16x32_bf16 a[36:39], a[212:215], a[148:151], a[36:39]
    ds_read_b64_tr_b16 a[254:255], v48 offset:10752
    v_mfma_f32_16x16x32_bf16 a[36:39], a[208:211], a[132:135], a[36:39]
    v_mfma_f32_16x16x32_bf16 a[40:43], a[208:211], a[136:139], a[40:43]
    v_mfma_f32_16x16x32_bf16 a[40:43], a[212:215], a[152:155], a[40:43]
    v_mfma_f32_16x16x32_bf16 a[40:43], a[216:219], a[168:171], a[40:43]
    v_mfma_f32_16x16x32_bf16 a[40:43], a[220:223], a[184:187], a[40:43]
    v_mfma_f32_16x16x32_bf16 a[44:47], a[220:223], a[188:191], a[44:47]
    ds_read_b64_tr_b16 a[192:193], v49 offset:43008
    v_mfma_f32_16x16x32_bf16 a[44:47], a[216:219], a[172:175], a[44:47]
    ds_read_b64_tr_b16 a[194:195], v49 offset:44544
    v_mfma_f32_16x16x32_bf16 a[44:47], a[212:215], a[156:159], a[44:47]
    buffer_load_dwordx4 v11, s[8:11], s43 offen offset:1024 nt lds
    v_mfma_f32_16x16x32_bf16 a[44:47], a[208:211], a[140:143], a[44:47]
    ds_read_b64_tr_b16 a[196:197], v49 offset:46080
    v_mfma_f32_16x16x32_bf16 a[60:63], a[224:227], a[140:143], a[60:63]
    ds_read_b64_tr_b16 a[198:199], v49 offset:47616
    v_mfma_f32_16x16x32_bf16 a[60:63], a[228:231], a[156:159], a[60:63]
    ds_read_b64_tr_b16 a[200:201], v49 offset:6144
    v_mfma_f32_16x16x32_bf16 a[60:63], a[232:235], a[172:175], a[60:63]
    ds_read_b64_tr_b16 a[202:203], v49 offset:7680
    v_mfma_f32_16x16x32_bf16 a[60:63], a[236:239], a[188:191], a[60:63]
    ds_read_b64_tr_b16 a[204:205], v49 offset:9216
    v_mfma_f32_16x16x32_bf16 a[56:59], a[236:239], a[184:187], a[56:59]
    ds_read_b64_tr_b16 a[206:207], v49 offset:10752
    v_mfma_f32_16x16x32_bf16 a[56:59], a[232:235], a[168:171], a[56:59]
    v_mfma_f32_16x16x32_bf16 a[56:59], a[228:231], a[152:155], a[56:59]
    v_mfma_f32_16x16x32_bf16 a[56:59], a[224:227], a[136:139], a[56:59]
    v_mfma_f32_16x16x32_bf16 a[52:55], a[224:227], a[132:135], a[52:55]
    buffer_load_dwordx4 v12, s[8:11], s43 offen offset:2048 nt lds
    v_mfma_f32_16x16x32_bf16 a[52:55], a[228:231], a[148:151], a[52:55]
    v_mfma_f32_16x16x32_bf16 a[52:55], a[232:235], a[164:167], a[52:55]
    v_mfma_f32_16x16x32_bf16 a[52:55], a[236:239], a[180:183], a[52:55]
    v_mfma_f32_16x16x32_bf16 a[48:51], a[236:239], a[176:179], a[48:51]
    v_mfma_f32_16x16x32_bf16 a[48:51], a[232:235], a[160:163], a[48:51]
    v_mfma_f32_16x16x32_bf16 a[48:51], a[228:231], a[144:147], a[48:51]
    v_mfma_f32_16x16x32_bf16 a[48:51], a[224:227], a[128:131], a[48:51]
    s_waitcnt lgkmcnt(0)
    v_mfma_f32_16x16x32_bf16 a[64:67], a[240:243], a[128:131], a[64:67]
    v_mfma_f32_16x16x32_bf16 a[64:67], a[244:247], a[144:147], a[64:67]
    v_mfma_f32_16x16x32_bf16 a[64:67], a[248:251], a[160:163], a[64:67]
    buffer_load_dwordx4 v13, s[8:11], s43 offen offset:3072 nt lds
    v_mfma_f32_16x16x32_bf16 a[64:67], a[252:255], a[176:179], a[64:67]
    v_mfma_f32_16x16x32_bf16 a[68:71], a[252:255], a[180:183], a[68:71]
    v_mfma_f32_16x16x32_bf16 a[68:71], a[248:251], a[164:167], a[68:71]
    v_mfma_f32_16x16x32_bf16 a[68:71], a[244:247], a[148:151], a[68:71]
    v_mfma_f32_16x16x32_bf16 a[68:71], a[240:243], a[132:135], a[68:71]
    v_mfma_f32_16x16x32_bf16 a[72:75], a[240:243], a[136:139], a[72:75]
    v_mfma_f32_16x16x32_bf16 a[72:75], a[244:247], a[152:155], a[72:75]
    v_mfma_f32_16x16x32_bf16 a[72:75], a[248:251], a[168:171], a[72:75]
    s_add_u32 m0, m0, 4096
    v_mfma_f32_16x16x32_bf16 a[72:75], a[252:255], a[184:187], a[72:75]
    v_mfma_f32_16x16x32_bf16 a[76:79], a[252:255], a[188:191], a[76:79]
    buffer_load_dwordx4 v14, s[8:11], s43 offen offset:0 nt lds
    v_mfma_f32_16x16x32_bf16 a[76:79], a[248:251], a[172:175], a[76:79]
    v_mfma_f32_16x16x32_bf16 a[76:79], a[244:247], a[156:159], a[76:79]
    s_waitcnt vmcnt(13)
    s_waitcnt lgkmcnt(0)
    s_barrier
    v_mfma_f32_16x16x32_bf16 a[76:79], a[240:243], a[140:143], a[76:79]
    ds_read_b64_tr_b16 a[208:209], v47 offset:12288
    v_mfma_f32_16x16x32_bf16 a[92:95], a[192:195], a[140:143], a[92:95]
    ds_read_b64_tr_b16 a[210:211], v47 offset:13824
    v_mfma_f32_16x16x32_bf16 a[92:95], a[196:199], a[156:159], a[92:95]
    ds_read_b64_tr_b16 a[212:213], v47 offset:15360
    v_mfma_f32_16x16x32_bf16 a[92:95], a[200:203], a[172:175], a[92:95]
    ds_read_b64_tr_b16 a[214:215], v47 offset:16896
    v_mfma_f32_16x16x32_bf16 a[92:95], a[204:207], a[188:191], a[92:95]
    ds_read_b64_tr_b16 a[216:217], v48 offset:12288
    v_mfma_f32_16x16x32_bf16 a[88:91], a[204:207], a[184:187], a[88:91]
    ds_read_b64_tr_b16 a[218:219], v48 offset:13824
    v_mfma_f32_16x16x32_bf16 a[88:91], a[200:203], a[168:171], a[88:91]
    ds_read_b64_tr_b16 a[220:221], v48 offset:15360
    v_mfma_f32_16x16x32_bf16 a[88:91], a[196:199], a[152:155], a[88:91]
    buffer_load_dwordx4 v15, s[8:11], s43 offen offset:1024 nt lds
    v_mfma_f32_16x16x32_bf16 a[88:91], a[192:195], a[136:139], a[88:91]
    ds_read_b64_tr_b16 a[222:223], v48 offset:16896
    v_mfma_f32_16x16x32_bf16 a[84:87], a[192:195], a[132:135], a[84:87]
    ds_read_b64_tr_b16 a[224:225], v49 offset:12288
    v_mfma_f32_16x16x32_bf16 a[84:87], a[196:199], a[148:151], a[84:87]
    ds_read_b64_tr_b16 a[226:227], v49 offset:13824
    v_mfma_f32_16x16x32_bf16 a[84:87], a[200:203], a[164:167], a[84:87]
    ds_read_b64_tr_b16 a[228:229], v49 offset:15360
    v_mfma_f32_16x16x32_bf16 a[84:87], a[204:207], a[180:183], a[84:87]
    ds_read_b64_tr_b16 a[230:231], v49 offset:16896
    v_mfma_f32_16x16x32_bf16 a[80:83], a[204:207], a[176:179], a[80:83]
    ds_read_b64_tr_b16 a[232:233], v47 offset:18432
    v_mfma_f32_16x16x32_bf16 a[80:83], a[200:203], a[160:163], a[80:83]
    ds_read_b64_tr_b16 a[234:235], v47 offset:19968
    v_mfma_f32_16x16x32_bf16 a[80:83], a[196:199], a[144:147], a[80:83]
    s_add_u32 s43, s43, 24576
    ds_read_b64_tr_b16 a[236:237], v47 offset:21504
    s_mov_b32 s12, s68
    v_mfma_f32_16x16x32_bf16 a[80:83], a[192:195], a[128:131], a[80:83]
    s_waitcnt vmcnt(13) lgkmcnt(8)
    ds_read_b64_tr_b16 a[238:239], v47 offset:23040
    s_and_b32 s13, s69, 0xffff
    v_mfma_f32_16x16x32_bf16 a[0:3], a[208:211], a[96:99], a[0:3]
    s_waitcnt vmcnt(9)
    ds_read_b64_tr_b16 a[240:241], v48 offset:18432
    s_mov_b32 s14, 196608
    v_mfma_f32_16x16x32_bf16 a[0:3], a[212:215], a[112:115], a[0:3]
    s_waitcnt vmcnt(8)
    ds_read_b64_tr_b16 a[242:243], v48 offset:19968
    s_mov_b32 s15, 0x20000
    v_mfma_f32_16x16x32_bf16 a[4:7], a[212:215], a[116:119], a[4:7]
    s_mov_b32 s24, s72
    ds_read_b64_tr_b16 a[244:245], v48 offset:21504
    s_and_b32 s25, s73, 0xffff
    v_mfma_f32_16x16x32_bf16 a[4:7], a[208:211], a[100:103], a[4:7]
    s_mov_b32 s26, 7864320
    ds_read_b64_tr_b16 a[246:247], v48 offset:23040
    s_mov_b32 s27, 0x20000
    v_mfma_f32_16x16x32_bf16 a[8:11], a[208:211], a[104:107], a[8:11]
    s_waitcnt vmcnt(7)
    ds_read_b64_tr_b16 a[248:249], v49 offset:18432
    s_mov_b32 s28, s86
    v_mfma_f32_16x16x32_bf16 a[8:11], a[212:215], a[120:123], a[8:11]
    s_waitcnt vmcnt(6)
    ds_read_b64_tr_b16 a[250:251], v49 offset:19968
    s_and_b32 s29, s87, 0xffff
    v_mfma_f32_16x16x32_bf16 a[12:15], a[212:215], a[124:127], a[12:15]
    s_mov_b32 s30, 62259200
    ds_read_b64_tr_b16 a[252:253], v49 offset:21504
    s_mov_b32 s31, 0x20000
    v_mfma_f32_16x16x32_bf16 a[12:15], a[208:211], a[108:111], a[12:15]
    s_lshl_b32 s90, s41, 2
    ds_read_b64_tr_b16 a[254:255], v49 offset:23040
    s_add_u32 s90, s90, s3
    v_mfma_f32_16x16x32_bf16 a[28:31], a[216:219], a[108:111], a[28:31]
    s_waitcnt lgkmcnt(8)
    s_mul_hi_u32 s91, s90, 858993460
    s_mul_i32 s92, s91, 5
    v_mfma_f32_16x16x32_bf16 a[28:31], a[220:223], a[124:127], a[28:31]
    s_sub_u32 s92, s90, s92
    s_and_b32 s93, s40, 7
    s_mul_i32 s93, s93, 6
    v_mfma_f32_16x16x32_bf16 a[24:27], a[220:223], a[120:123], a[24:27]
    s_add_u32 s91, s91, s93
    s_lshr_b32 s93, s40, 3
    s_mul_i32 s93, s93, 5
    v_mfma_f32_16x16x32_bf16 a[24:27], a[216:219], a[104:107], a[24:27]
    s_add_u32 s92, s92, s93
    s_mul_i32 s50, s91, 40960
    s_lshl_b32 s93, s92, 6
    v_mfma_f32_16x16x32_bf16 a[20:23], a[216:219], a[100:103], a[20:23]
    s_add_u32 s50, s50, s93
    ds_read_b64_tr_b16 a[192:193], v26 offset:0
    s_mul_i32 s51, s91, 40960
    v_mfma_f32_16x16x32_bf16 a[20:23], a[220:223], a[116:119], a[20:23]
    s_lshl_b32 s93, s92, 11
    ds_read_b64_tr_b16 a[194:195], v26 offset:6144
    s_add_u32 s51, s51, s93
    v_mfma_f32_16x16x32_bf16 a[16:19], a[220:223], a[112:115], a[16:19]
    s_add_u32 s51, s51, 52428800
    ds_read_b64_tr_b16 a[196:197], v26 offset:12288
    v_mfma_f32_16x16x32_bf16 a[16:19], a[216:219], a[96:99], a[16:19]
    ds_read_b64_tr_b16 a[198:199], v26 offset:18432
    v_mfma_f32_16x16x32_bf16 a[32:35], a[224:227], a[96:99], a[32:35]
    s_cmp_ge_u32 s90, 30
    s_cselect_b32 s30, 0, s30
    s_cselect_b32 s26, 0, s26
    v_mfma_f32_16x16x32_bf16 a[32:35], a[228:231], a[112:115], a[32:35]
    s_and_b32 s90, s81, 0xffff
    s_min_u32 s91, s26, 1966080
    s_mov_b32 s92, s50
    v_mfma_f32_16x16x32_bf16 a[36:39], a[228:231], a[116:119], a[36:39]
    s_mov_b32 m0, s52
    s_nop 0
    buffer_load_dwordx4 v39, s[24:27], s50 offen nt lds
    v_mfma_f32_16x16x32_bf16 a[36:39], a[224:227], a[100:103], a[36:39]
    v_mfma_f32_16x16x32_bf16 a[40:43], a[224:227], a[104:107], a[40:43]
    ds_read_b64_tr_b16 a[200:201], v27 offset:0
    v_mfma_f32_16x16x32_bf16 a[40:43], a[228:231], a[120:123], a[40:43]
    ds_read_b64_tr_b16 a[202:203], v27 offset:6144
    v_mfma_f32_16x16x32_bf16 a[44:47], a[228:231], a[124:127], a[44:47]
    buffer_load_dwordx4 v40, s[24:27], s50 offen offset:1024 nt lds
    v_mfma_f32_16x16x32_bf16 a[44:47], a[224:227], a[108:111], a[44:47]
    s_xor_b32 s52, s52, 2048
    ds_read_b64_tr_b16 a[204:205], v27 offset:12288
    s_add_u32 s50, s50, 1966080
    v_mfma_f32_16x16x32_bf16 a[60:63], a[232:235], a[108:111], a[60:63]
    s_mov_b32 m0, s52
    ds_read_b64_tr_b16 a[206:207], v27 offset:18432
    v_mfma_f32_16x16x32_bf16 a[60:63], a[236:239], a[124:127], a[60:63]
    v_mfma_f32_16x16x32_bf16 a[56:59], a[236:239], a[120:123], a[56:59]
    buffer_load_dwordx4 v39, s[24:27], s50 offen nt lds
    v_mfma_f32_16x16x32_bf16 a[56:59], a[232:235], a[104:107], a[56:59]
    v_mfma_f32_16x16x32_bf16 a[52:55], a[232:235], a[100:103], a[52:55]
    ds_read_b64_tr_b16 a[208:209], v28 offset:0
    v_mfma_f32_16x16x32_bf16 a[52:55], a[236:239], a[116:119], a[52:55]
    ds_read_b64_tr_b16 a[210:211], v28 offset:6144
    v_mfma_f32_16x16x32_bf16 a[48:51], a[236:239], a[112:115], a[48:51]
    ds_read_b64_tr_b16 a[212:213], v28 offset:12288
    v_mfma_f32_16x16x32_bf16 a[48:51], a[232:235], a[96:99], a[48:51]
    s_waitcnt lgkmcnt(5)
    buffer_load_dwordx4 v40, s[24:27], s50 offen offset:1024 nt lds
    v_mfma_f32_16x16x32_bf16 a[64:67], a[240:243], a[96:99], a[64:67]
    ds_read_b64_tr_b16 a[214:215], v28 offset:18432
    v_mfma_f32_16x16x32_bf16 a[64:67], a[244:247], a[112:115], a[64:67]
    v_mfma_f32_16x16x32_bf16 a[68:71], a[244:247], a[116:119], a[68:71]
    v_mfma_f32_16x16x32_bf16 a[68:71], a[240:243], a[100:103], a[68:71]
    v_mfma_f32_16x16x32_bf16 a[72:75], a[240:243], a[104:107], a[72:75]
    ds_read_b64_tr_b16 a[216:217], v29 offset:0
    v_mfma_f32_16x16x32_bf16 a[72:75], a[244:247], a[120:123], a[72:75]
    ds_read_b64_tr_b16 a[218:219], v29 offset:6144
    v_mfma_f32_16x16x32_bf16 a[76:79], a[244:247], a[124:127], a[76:79]
    s_xor_b32 s52, s52, 2048
    ds_read_b64_tr_b16 a[220:221], v29 offset:12288
    s_add_u32 s50, s50, 1966080
    v_mfma_f32_16x16x32_bf16 a[76:79], a[240:243], a[108:111], a[76:79]
    ds_read_b64_tr_b16 a[222:223], v29 offset:18432
    v_mfma_f32_16x16x32_bf16 a[92:95], a[248:251], a[108:111], a[92:95]
    v_mfma_f32_16x16x32_bf16 a[92:95], a[252:255], a[124:127], a[92:95]
    v_mfma_f32_16x16x32_bf16 a[88:91], a[252:255], a[120:123], a[88:91]
    v_mfma_f32_16x16x32_bf16 a[88:91], a[248:251], a[104:107], a[88:91]
    v_mfma_f32_16x16x32_bf16 a[84:87], a[248:251], a[100:103], a[84:87]
    ds_read_b64_tr_b16 a[224:225], v26 offset:128
    v_mfma_f32_16x16x32_bf16 a[84:87], a[252:255], a[116:119], a[84:87]
    ds_read_b64_tr_b16 a[226:227], v26 offset:6272
    v_mfma_f32_16x16x32_bf16 a[80:83], a[252:255], a[112:115], a[80:83]
    ds_read_b64_tr_b16 a[228:229], v26 offset:12416
    v_mfma_f32_16x16x32_bf16 a[80:83], a[248:251], a[96:99], a[80:83]
    ds_read_b64_tr_b16 a[230:231], v26 offset:18560
    v_mfma_f32_16x16x32_bf16 v[64:67], a[192:195], a[128:131], v[64:67]
    v_mfma_f32_16x16x32_bf16 v[64:67], a[196:199], a[144:147], v[64:67]
    v_mfma_f32_16x16x32_bf16 v[72:75], a[196:199], a[148:151], v[72:75]
    v_mfma_f32_16x16x32_bf16 v[72:75], a[192:195], a[132:135], v[72:75]
    v_mfma_f32_16x16x32_bf16 v[80:83], a[192:195], a[136:139], v[80:83]
    ds_read_b64_tr_b16 a[232:233], v27 offset:128
    v_mfma_f32_16x16x32_bf16 v[80:83], a[196:199], a[152:155], v[80:83]
    s_add_u32 s97, s71, 0
    ds_read_b64_tr_b16 a[234:235], v27 offset:6272
    v_accvgpr_read_b32 v44, a0
    v_mfma_f32_16x16x32_bf16 v[88:91], a[196:199], a[156:159], v[88:91]
    ds_read_b64_tr_b16 a[236:237], v27 offset:12416
    v_accvgpr_read_b32 v45, a1
    v_mfma_f32_16x16x32_bf16 v[88:91], a[192:195], a[140:143], v[88:91]
    ds_read_b64_tr_b16 a[238:239], v27 offset:18560
    v_accvgpr_read_b32 v46, a2
    v_mfma_f32_16x16x32_bf16 v[92:95], a[200:203], a[140:143], v[92:95]
    s_waitcnt lgkmcnt(4)
    v_accvgpr_read_b32 v47, a3
    v_accvgpr_read_b32 v48, a48
    v_mfma_f32_16x16x32_bf16 v[92:95], a[204:207], a[156:159], v[92:95]
    v_accvgpr_read_b32 v49, a49
    v_mul_f32 v44, v44, v48
    v_mfma_f32_16x16x32_bf16 v[84:87], a[204:207], a[152:155], v[84:87]
    v_mul_f32 v45, v45, v49
    v_accvgpr_read_b32 v48, a50
    v_mfma_f32_16x16x32_bf16 v[84:87], a[200:203], a[136:139], v[84:87]
    v_accvgpr_read_b32 v49, a51
    v_mul_f32 v46, v46, v48
    v_mfma_f32_16x16x32_bf16 v[76:79], a[200:203], a[132:135], v[76:79]
    ds_read_b64_tr_b16 a[240:241], v28 offset:128
    v_mul_f32 v47, v47, v49
    v_mfma_f32_16x16x32_bf16 v[76:79], a[204:207], a[148:151], v[76:79]
    ds_read_b64_tr_b16 a[242:243], v28 offset:6272
    v_cvt_pk_bf16_f32 v2, v44, v45
    v_mfma_f32_16x16x32_bf16 v[68:71], a[204:207], a[144:147], v[68:71]
    ds_read_b64_tr_b16 a[244:245], v28 offset:12416
    v_cvt_pk_bf16_f32 v3, v46, v47
    v_mfma_f32_16x16x32_bf16 v[68:71], a[200:203], a[128:131], v[68:71]
    ds_read_b64_tr_b16 a[246:247], v28 offset:18560
    v_accvgpr_read_b32 v44, a16
    v_mfma_f32_16x16x32_bf16 v[96:99], a[208:211], a[128:131], v[96:99]
    v_accvgpr_read_b32 v45, a17
    v_accvgpr_read_b32 v46, a18
    v_mfma_f32_16x16x32_bf16 v[96:99], a[212:215], a[144:147], v[96:99]
    v_accvgpr_read_b32 v47, a19
    v_accvgpr_read_b32 v48, a64
    v_mfma_f32_16x16x32_bf16 v[104:107], a[212:215], a[148:151], v[104:107]
    v_accvgpr_read_b32 v49, a65
    v_mul_f32 v44, v44, v48
    v_mfma_f32_16x16x32_bf16 v[104:107], a[208:211], a[132:135], v[104:107]
    v_mul_f32 v45, v45, v49
    v_accvgpr_read_b32 v48, a66
    v_mfma_f32_16x16x32_bf16 v[112:115], a[208:211], a[136:139], v[112:115]
    ds_read_b64_tr_b16 a[248:249], v29 offset:128
    v_accvgpr_read_b32 v49, a67
    v_mfma_f32_16x16x32_bf16 v[112:115], a[212:215], a[152:155], v[112:115]
    ds_read_b64_tr_b16 a[250:251], v29 offset:6272
    v_mul_f32 v46, v46, v48
    v_mfma_f32_16x16x32_bf16 v[120:123], a[212:215], a[156:159], v[120:123]
    ds_read_b64_tr_b16 a[252:253], v29 offset:12416
    v_mul_f32 v47, v47, v49
    v_mfma_f32_16x16x32_bf16 v[120:123], a[208:211], a[140:143], v[120:123]
    ds_read_b64_tr_b16 a[254:255], v29 offset:18560
    v_cvt_pk_bf16_f32 v4, v44, v45
    v_mfma_f32_16x16x32_bf16 v[124:127], a[216:219], a[140:143], v[124:127]
    v_cvt_pk_bf16_f32 v5, v46, v47
    v_accvgpr_read_b32 v44, a32
    v_mfma_f32_16x16x32_bf16 v[124:127], a[220:223], a[156:159], v[124:127]
    v_accvgpr_read_b32 v45, a33
    v_accvgpr_read_b32 v46, a34
    v_mfma_f32_16x16x32_bf16 v[116:119], a[220:223], a[152:155], v[116:119]
    v_accvgpr_read_b32 v47, a35
    v_accvgpr_read_b32 v48, a80
    v_mfma_f32_16x16x32_bf16 v[116:119], a[216:219], a[136:139], v[116:119]
    v_accvgpr_read_b32 v49, a81
    v_mul_f32 v44, v44, v48
    v_mfma_f32_16x16x32_bf16 v[108:111], a[216:219], a[132:135], v[108:111]
    ds_read_b64_tr_b16 a[192:193], v26 offset:256
    v_mul_f32 v45, v45, v49
    v_mfma_f32_16x16x32_bf16 v[108:111], a[220:223], a[148:151], v[108:111]
    ds_read_b64_tr_b16 a[194:195], v26 offset:6400
    v_accvgpr_read_b32 v48, a82
    v_mfma_f32_16x16x32_bf16 v[100:103], a[220:223], a[144:147], v[100:103]
    ds_read_b64_tr_b16 a[196:197], v26 offset:12544
    v_accvgpr_read_b32 v49, a83
    v_mfma_f32_16x16x32_bf16 v[100:103], a[216:219], a[128:131], v[100:103]
    ds_read_b64_tr_b16 a[198:199], v26 offset:18688
    v_mul_f32 v46, v46, v48
    v_mfma_f32_16x16x32_bf16 v[128:131], a[224:227], a[128:131], v[128:131]
    v_mul_f32 v47, v47, v49
    v_cvt_pk_bf16_f32 v6, v44, v45
    v_mfma_f32_16x16x32_bf16 v[128:131], a[228:231], a[144:147], v[128:131]
    v_cvt_pk_bf16_f32 v7, v46, v47
    v_accvgpr_read_b32 v44, a4
    v_mfma_f32_16x16x32_bf16 v[136:139], a[228:231], a[148:151], v[136:139]
    buffer_store_dwordx4 v[2:5], v1, s[16:19], s97 offen sc1
    v_mfma_f32_16x16x32_bf16 v[136:139], a[224:227], a[132:135], v[136:139]
    s_add_u32 s97, s74, 0
    v_accvgpr_read_b32 v45, a5
    v_accvgpr_read_b32 v46, a6
    v_mfma_f32_16x16x32_bf16 v[144:147], a[224:227], a[136:139], v[144:147]
    ds_read_b64_tr_b16 a[200:201], v27 offset:256
    v_accvgpr_read_b32 v47, a7
    v_mfma_f32_16x16x32_bf16 v[144:147], a[228:231], a[152:155], v[144:147]
    ds_read_b64_tr_b16 a[202:203], v27 offset:6400
    v_accvgpr_read_b32 v48, a52
    v_mfma_f32_16x16x32_bf16 v[152:155], a[228:231], a[156:159], v[152:155]
    buffer_store_dwordx2 v[6:7], v1, s[16:19], s97 offen sc1
    v_mfma_f32_16x16x32_bf16 v[152:155], a[224:227], a[140:143], v[152:155]
    s_waitcnt lgkmcnt(3)
    ds_read_b64_tr_b16 a[204:205], v27 offset:12544
    v_accvgpr_read_b32 v49, a53
    v_mfma_f32_16x16x32_bf16 v[156:159], a[232:235], a[140:143], v[156:159]
    s_add_u32 s97, s71, 49152
    ds_read_b64_tr_b16 a[206:207], v27 offset:18688
    v_mul_f32 v44, v44, v48
    v_mfma_f32_16x16x32_bf16 v[156:159], a[236:239], a[156:159], v[156:159]
    v_mul_f32 v45, v45, v49
    v_accvgpr_read_b32 v48, a54
    v_mfma_f32_16x16x32_bf16 v[148:151], a[236:239], a[152:155], v[148:151]
    v_accvgpr_read_b32 v49, a55
    v_mul_f32 v46, v46, v48
    v_mfma_f32_16x16x32_bf16 v[148:151], a[232:235], a[136:139], v[148:151]
    v_mul_f32 v47, v47, v49
    v_cvt_pk_bf16_f32 v2, v44, v45
    v_mfma_f32_16x16x32_bf16 v[140:143], a[232:235], a[132:135], v[140:143]
    ds_read_b64_tr_b16 a[208:209], v28 offset:256
    v_cvt_pk_bf16_f32 v3, v46, v47
    v_mfma_f32_16x16x32_bf16 v[140:143], a[236:239], a[148:151], v[140:143]
    ds_read_b64_tr_b16 a[210:211], v28 offset:6400
    v_accvgpr_read_b32 v44, a20
    v_mfma_f32_16x16x32_bf16 v[132:135], a[236:239], a[144:147], v[132:135]
    ds_read_b64_tr_b16 a[212:213], v28 offset:12544
    v_accvgpr_read_b32 v45, a21
    v_mfma_f32_16x16x32_bf16 v[132:135], a[232:235], a[128:131], v[132:135]
    ds_read_b64_tr_b16 a[214:215], v28 offset:18688
    v_accvgpr_read_b32 v46, a22
    v_mfma_f32_16x16x32_bf16 v[160:163], a[240:243], a[128:131], v[160:163]
    v_accvgpr_read_b32 v47, a23
    v_accvgpr_read_b32 v48, a68
    v_mfma_f32_16x16x32_bf16 v[160:163], a[244:247], a[144:147], v[160:163]
    v_accvgpr_read_b32 v49, a69
    v_mul_f32 v44, v44, v48
    v_mfma_f32_16x16x32_bf16 v[168:171], a[244:247], a[148:151], v[168:171]
    v_mul_f32 v45, v45, v49
    v_accvgpr_read_b32 v48, a70
    v_mfma_f32_16x16x32_bf16 v[168:171], a[240:243], a[132:135], v[168:171]
    v_accvgpr_read_b32 v49, a71
    v_mul_f32 v46, v46, v48
    v_mfma_f32_16x16x32_bf16 v[176:179], a[240:243], a[136:139], v[176:179]
    ds_read_b64_tr_b16 a[216:217], v29 offset:256
    v_mul_f32 v47, v47, v49
    v_mfma_f32_16x16x32_bf16 v[176:179], a[244:247], a[152:155], v[176:179]
    ds_read_b64_tr_b16 a[218:219], v29 offset:6400
    v_cvt_pk_bf16_f32 v4, v44, v45
    v_mfma_f32_16x16x32_bf16 v[184:187], a[244:247], a[156:159], v[184:187]
    ds_read_b64_tr_b16 a[220:221], v29 offset:12544
    v_cvt_pk_bf16_f32 v5, v46, v47
    v_mfma_f32_16x16x32_bf16 v[184:187], a[240:243], a[140:143], v[184:187]
    ds_read_b64_tr_b16 a[222:223], v29 offset:18688
    v_accvgpr_read_b32 v44, a36
    v_mfma_f32_16x16x32_bf16 v[188:191], a[248:251], a[140:143], v[188:191]
    v_accvgpr_read_b32 v45, a37
    v_accvgpr_read_b32 v46, a38
    v_mfma_f32_16x16x32_bf16 v[188:191], a[252:255], a[156:159], v[188:191]
    v_accvgpr_read_b32 v47, a39
    v_accvgpr_read_b32 v48, a84
    v_mfma_f32_16x16x32_bf16 v[180:183], a[252:255], a[152:155], v[180:183]
    v_accvgpr_read_b32 v49, a85
    v_mul_f32 v44, v44, v48
    v_mfma_f32_16x16x32_bf16 v[180:183], a[248:251], a[136:139], v[180:183]
    v_mul_f32 v45, v45, v49
    v_accvgpr_read_b32 v48, a86
    v_mfma_f32_16x16x32_bf16 v[172:175], a[248:251], a[132:135], v[172:175]
    v_accvgpr_read_b32 v49, a87
    v_mul_f32 v46, v46, v48
    v_mfma_f32_16x16x32_bf16 v[172:175], a[252:255], a[148:151], v[172:175]
    v_mul_f32 v47, v47, v49
    v_cvt_pk_bf16_f32 v6, v44, v45
    v_mfma_f32_16x16x32_bf16 v[164:167], a[252:255], a[144:147], v[164:167]
    v_cvt_pk_bf16_f32 v7, v46, v47
    v_accvgpr_read_b32 v44, a8
    v_mfma_f32_16x16x32_bf16 v[164:167], a[248:251], a[128:131], v[164:167]
    buffer_store_dwordx4 v[2:5], v1, s[16:19], s97 offen sc1
    v_mfma_f32_16x16x32_bf16 v[192:195], a[192:195], a[128:131], v[192:195]
    s_waitcnt lgkmcnt(0)
    s_add_u32 s97, s74, 49152
    v_accvgpr_read_b32 v45, a9
    v_mfma_f32_16x16x32_bf16 v[192:195], a[196:199], a[144:147], v[192:195]
    v_accvgpr_read_b32 v46, a10
    v_accvgpr_read_b32 v47, a11
    v_mfma_f32_16x16x32_bf16 v[200:203], a[196:199], a[148:151], v[200:203]
    v_add_u32 v26, 0, v22
    v_add_u32 v27, 0, v23
    v_mfma_f32_16x16x32_bf16 v[200:203], a[192:195], a[132:135], v[200:203]
    buffer_store_dwordx2 v[6:7], v1, s[16:19], s97 offen sc1
    v_mfma_f32_16x16x32_bf16 v[208:211], a[192:195], a[136:139], v[208:211]
    s_add_u32 s97, s71, 98304
    v_add_u32 v28, 0, v24
    v_add_u32 v29, 0, v25
    v_mfma_f32_16x16x32_bf16 v[208:211], a[196:199], a[152:155], v[208:211]
    v_accvgpr_read_b32 v48, a56
    v_accvgpr_read_b32 v49, a57
    v_mfma_f32_16x16x32_bf16 v[216:219], a[196:199], a[156:159], v[216:219]
    v_mul_f32 v44, v44, v48
    v_mul_f32 v45, v45, v49
    v_mfma_f32_16x16x32_bf16 v[216:219], a[192:195], a[140:143], v[216:219]
    v_accvgpr_read_b32 v48, a58
    v_accvgpr_read_b32 v49, a59
    v_mfma_f32_16x16x32_bf16 v[220:223], a[200:203], a[140:143], v[220:223]
    v_mul_f32 v46, v46, v48
    v_mul_f32 v47, v47, v49
    v_mfma_f32_16x16x32_bf16 v[220:223], a[204:207], a[156:159], v[220:223]
    v_cvt_pk_bf16_f32 v2, v44, v45
    v_cvt_pk_bf16_f32 v3, v46, v47
    v_mfma_f32_16x16x32_bf16 v[212:215], a[204:207], a[152:155], v[212:215]
    v_accvgpr_read_b32 v44, a24
    v_accvgpr_read_b32 v45, a25
    v_mfma_f32_16x16x32_bf16 v[212:215], a[200:203], a[136:139], v[212:215]
    v_accvgpr_read_b32 v46, a26
    v_accvgpr_read_b32 v47, a27
    v_mfma_f32_16x16x32_bf16 v[204:207], a[200:203], a[132:135], v[204:207]
    v_accvgpr_read_b32 v48, a72
    v_accvgpr_read_b32 v49, a73
    v_mfma_f32_16x16x32_bf16 v[204:207], a[204:207], a[148:151], v[204:207]
    v_mul_f32 v44, v44, v48
    v_mul_f32 v45, v45, v49
    v_mfma_f32_16x16x32_bf16 v[196:199], a[204:207], a[144:147], v[196:199]
    s_waitcnt lgkmcnt(0)
    s_barrier
    v_mfma_f32_16x16x32_bf16 v[196:199], a[200:203], a[128:131], v[196:199]
    s_add_u32 m0, s42, 73728
    s_nop 0
    buffer_load_dwordx4 v16, s[12:15], s44 offen offset:0 nt lds
    v_mfma_f32_16x16x32_bf16 v[224:227], a[208:211], a[128:131], v[224:227]
    ds_read_b64_tr_b16 a[224:225], v26 offset:0
    v_accvgpr_read_b32 v48, a74
    v_mfma_f32_16x16x32_bf16 v[224:227], a[212:215], a[144:147], v[224:227]
    ds_read_b64_tr_b16 a[226:227], v26 offset:6144
    v_accvgpr_read_b32 v49, a75
    v_mfma_f32_16x16x32_bf16 v[232:235], a[212:215], a[148:151], v[232:235]
    ds_read_b64_tr_b16 a[228:229], v26 offset:12288
    v_mul_f32 v46, v46, v48
    v_mfma_f32_16x16x32_bf16 v[232:235], a[208:211], a[132:135], v[232:235]
    ds_read_b64_tr_b16 a[230:231], v26 offset:18432
    v_mul_f32 v47, v47, v49
    v_mfma_f32_16x16x32_bf16 v[240:243], a[208:211], a[136:139], v[240:243]
    ds_read_b64_tr_b16 a[232:233], v26 offset:24576
    v_cvt_pk_bf16_f32 v4, v44, v45
    v_mfma_f32_16x16x32_bf16 v[240:243], a[212:215], a[152:155], v[240:243]
    ds_read_b64_tr_b16 a[234:235], v26 offset:30720
    v_cvt_pk_bf16_f32 v5, v46, v47
    v_mfma_f32_16x16x32_bf16 v[248:251], a[212:215], a[156:159], v[248:251]
    ds_read_b64_tr_b16 a[236:237], v26 offset:36864
    v_accvgpr_read_b32 v44, a40
    v_mfma_f32_16x16x32_bf16 v[248:251], a[208:211], a[140:143], v[248:251]
    ds_read_b64_tr_b16 a[238:239], v26 offset:43008
    v_accvgpr_read_b32 v45, a41
    v_mfma_f32_16x16x32_bf16 v[252:255], a[216:219], a[140:143], v[252:255]
WS4:
    s_cbranch_execz WS0
    ds_read_b64_tr_b16 a[240:241], v27 offset:0
    v_accvgpr_read_b32 v46, a42
    v_mfma_f32_16x16x32_bf16 v[252:255], a[220:223], a[156:159], v[252:255]
    buffer_load_dwordx4 v17, s[12:15], s44 offen offset:1024 nt lds
    v_mfma_f32_16x16x32_bf16 v[244:247], a[220:223], a[152:155], v[244:247]
    ds_read_b64_tr_b16 a[242:243], v27 offset:6144
    v_accvgpr_read_b32 v47, a43
    v_mfma_f32_16x16x32_bf16 v[244:247], a[216:219], a[136:139], v[244:247]
    ds_read_b64_tr_b16 a[244:245], v27 offset:12288
    v_accvgpr_read_b32 v48, a88
    v_mfma_f32_16x16x32_bf16 v[236:239], a[216:219], a[132:135], v[236:239]
    ds_read_b64_tr_b16 a[246:247], v27 offset:18432
    v_accvgpr_read_b32 v49, a89
    v_mfma_f32_16x16x32_bf16 v[236:239], a[220:223], a[148:151], v[236:239]
    ds_read_b64_tr_b16 a[248:249], v27 offset:24576
    v_mul_f32 v44, v44, v48
    v_mfma_f32_16x16x32_bf16 v[228:231], a[220:223], a[144:147], v[228:231]
    ds_read_b64_tr_b16 a[250:251], v27 offset:30720
    v_mul_f32 v45, v45, v49
    v_mfma_f32_16x16x32_bf16 v[228:231], a[216:219], a[128:131], v[228:231]
    s_waitcnt lgkmcnt(7)
    ds_read_b64_tr_b16 a[252:253], v27 offset:36864
    v_accvgpr_read_b32 v48, a90
    v_mfma_f32_16x16x32_bf16 v[64:67], a[224:227], a[160:163], v[64:67]
    ds_read_b64_tr_b16 a[254:255], v27 offset:43008
    v_accvgpr_read_b32 v49, a91
    v_mfma_f32_16x16x32_bf16 v[64:67], a[228:231], a[176:179], v[64:67]
    ds_read_b64_tr_b16 a[192:193], v28 offset:0
    v_mul_f32 v46, v46, v48
    v_mfma_f32_16x16x32_bf16 v[64:67], a[232:235], a[96:99], v[64:67]
    s_waitcnt lgkmcnt(8)
    ds_read_b64_tr_b16 a[194:195], v28 offset:6144
    v_mul_f32 v47, v47, v49
    v_mfma_f32_16x16x32_bf16 v[64:67], a[236:239], a[112:115], v[64:67]
    buffer_load_dwordx4 v18, s[12:15], s44 offen offset:2048 nt lds
    v_mfma_f32_16x16x32_bf16 v[72:75], a[236:239], a[116:119], v[72:75]
    ds_read_b64_tr_b16 a[196:197], v28 offset:12288
    v_cvt_pk_bf16_f32 v6, v44, v45
    v_mfma_f32_16x16x32_bf16 v[72:75], a[232:235], a[100:103], v[72:75]
    ds_read_b64_tr_b16 a[198:199], v28 offset:18432
    v_cvt_pk_bf16_f32 v7, v46, v47
    v_mfma_f32_16x16x32_bf16 v[72:75], a[228:231], a[180:183], v[72:75]
    ds_read_b64_tr_b16 a[200:201], v28 offset:24576
    v_accvgpr_read_b32 v44, a12
    v_mfma_f32_16x16x32_bf16 v[72:75], a[224:227], a[164:167], v[72:75]
    buffer_store_dwordx4 v[2:5], v1, s[16:19], s97 offen sc1
    v_mfma_f32_16x16x32_bf16 v[80:83], a[224:227], a[168:171], v[80:83]
    s_add_u32 s97, s74, 98304
    ds_read_b64_tr_b16 a[202:203], v28 offset:30720
    v_accvgpr_read_b32 v45, a13
    v_mfma_f32_16x16x32_bf16 v[80:83], a[228:231], a[184:187], v[80:83]
    ds_read_b64_tr_b16 a[204:205], v28 offset:36864
    v_accvgpr_read_b32 v46, a14
    v_mfma_f32_16x16x32_bf16 v[80:83], a[232:235], a[104:107], v[80:83]
    ds_read_b64_tr_b16 a[206:207], v28 offset:43008
    v_accvgpr_read_b32 v47, a15
    v_mfma_f32_16x16x32_bf16 v[80:83], a[236:239], a[120:123], v[80:83]
    buffer_store_dwordx2 v[6:7], v1, s[16:19], s97 offen sc1
    v_mfma_f32_16x16x32_bf16 v[88:91], a[236:239], a[124:127], v[88:91]
    s_add_u32 s97, s71, 147456
    ds_read_b64_tr_b16 a[208:209], v29 offset:0
    v_accvgpr_read_b32 v48, a60
    v_mfma_f32_16x16x32_bf16 v[88:91], a[232:235], a[108:111], v[88:91]
    ds_read_b64_tr_b16 a[210:211], v29 offset:6144
    v_accvgpr_read_b32 v49, a61
    v_mfma_f32_16x16x32_bf16 v[88:91], a[228:231], a[188:191], v[88:91]
    ds_read_b64_tr_b16 a[212:213], v29 offset:12288
    v_mul_f32 v44, v44, v48
    v_mfma_f32_16x16x32_bf16 v[88:91], a[224:227], a[172:175], v[88:91]
    s_waitcnt lgkmcnt(6)
    ds_read_b64_tr_b16 a[214:215], v29 offset:18432
    v_mul_f32 v45, v45, v49
    v_mfma_f32_16x16x32_bf16 v[68:71], a[240:243], a[160:163], v[68:71]
    buffer_load_dwordx4 v19, s[12:15], s44 offen offset:3072 nt lds
    v_mfma_f32_16x16x32_bf16 v[68:71], a[244:247], a[176:179], v[68:71]
    ds_read_b64_tr_b16 a[216:217], v29 offset:24576
    v_accvgpr_read_b32 v48, a62
    v_mfma_f32_16x16x32_bf16 v[68:71], a[248:251], a[96:99], v[68:71]
    ds_read_b64_tr_b16 a[218:219], v29 offset:30720
    v_accvgpr_read_b32 v49, a63
    v_mfma_f32_16x16x32_bf16 v[68:71], a[252:255], a[112:115], v[68:71]
    ds_read_b64_tr_b16 a[220:221], v29 offset:36864
    v_mul_f32 v46, v46, v48
    v_mfma_f32_16x16x32_bf16 v[76:79], a[252:255], a[116:119], v[76:79]
    ds_read_b64_tr_b16 a[222:223], v29 offset:43008
    v_mul_f32 v47, v47, v49
    v_mfma_f32_16x16x32_bf16 v[76:79], a[248:251], a[100:103], v[76:79]
    s_add_u32 m0, m0, 4096
    v_cvt_pk_bf16_f32 v2, v44, v45
    v_cvt_pk_bf16_f32 v3, v46, v47
    v_mfma_f32_16x16x32_bf16 v[76:79], a[244:247], a[180:183], v[76:79]
    v_accvgpr_read_b32 v44, a28
    v_accvgpr_read_b32 v45, a29
    v_mfma_f32_16x16x32_bf16 v[76:79], a[240:243], a[164:167], v[76:79]
    buffer_load_dwordx4 v20, s[12:15], s44 offen offset:0 nt lds
    v_mfma_f32_16x16x32_bf16 v[84:87], a[240:243], a[168:171], v[84:87]
    v_accvgpr_read_b32 v46, a30
    v_accvgpr_read_b32 v47, a31
    v_mfma_f32_16x16x32_bf16 v[84:87], a[244:247], a[184:187], v[84:87]
    v_accvgpr_read_b32 v48, a76
    v_accvgpr_read_b32 v49, a77
    v_mfma_f32_16x16x32_bf16 v[84:87], a[248:251], a[104:107], v[84:87]
    v_mul_f32 v44, v44, v48
    v_mul_f32 v45, v45, v49
    v_mfma_f32_16x16x32_bf16 v[84:87], a[252:255], a[120:123], v[84:87]
    v_accvgpr_read_b32 v48, a78
    v_accvgpr_read_b32 v49, a79
    v_mfma_f32_16x16x32_bf16 v[92:95], a[252:255], a[124:127], v[92:95]
    ds_read_b64_tr_b16 a[224:225], v26 offset:128
    v_mul_f32 v46, v46, v48
    v_mfma_f32_16x16x32_bf16 v[92:95], a[248:251], a[108:111], v[92:95]
    ds_read_b64_tr_b16 a[226:227], v26 offset:6272
    v_mul_f32 v47, v47, v49
    v_mfma_f32_16x16x32_bf16 v[92:95], a[244:247], a[188:191], v[92:95]
    ds_read_b64_tr_b16 a[228:229], v26 offset:12416
    v_cvt_pk_bf16_f32 v4, v44, v45
    v_mfma_f32_16x16x32_bf16 v[92:95], a[240:243], a[172:175], v[92:95]
    ds_read_b64_tr_b16 a[230:231], v26 offset:18560
    v_cvt_pk_bf16_f32 v5, v46, v47
    v_mfma_f32_16x16x32_bf16 v[96:99], a[192:195], a[160:163], v[96:99]
    ds_read_b64_tr_b16 a[232:233], v26 offset:24704
    v_accvgpr_read_b32 v44, a44
    v_mfma_f32_16x16x32_bf16 v[96:99], a[196:199], a[176:179], v[96:99]
    s_waitcnt lgkmcnt(5)
    buffer_load_dwordx4 v21, s[12:15], s44 offen offset:1024 nt lds
    v_mfma_f32_16x16x32_bf16 v[96:99], a[200:203], a[96:99], v[96:99]
    ds_read_b64_tr_b16 a[234:235], v26 offset:30848
    v_accvgpr_read_b32 v45, a45
    v_mfma_f32_16x16x32_bf16 v[96:99], a[204:207], a[112:115], v[96:99]
    ds_read_b64_tr_b16 a[236:237], v26 offset:36992
    v_accvgpr_read_b32 v46, a46
    v_mfma_f32_16x16x32_bf16 v[104:107], a[204:207], a[116:119], v[104:107]
    ds_read_b64_tr_b16 a[238:239], v26 offset:43136
    v_accvgpr_read_b32 v47, a47
    v_mfma_f32_16x16x32_bf16 v[104:107], a[200:203], a[100:103], v[104:107]
    v_accvgpr_read_b32 v48, a92
    v_cvt_pk_bf16_f32 v64, v64, v65
    v_mfma_f32_16x16x32_bf16 v[104:107], a[196:199], a[180:183], v[104:107]
    v_accvgpr_read_b32 v49, a93
    v_cvt_pk_bf16_f32 v65, v66, v67
    v_mfma_f32_16x16x32_bf16 v[104:107], a[192:195], a[164:167], v[104:107]
    v_mul_f32 v44, v44, v48
    v_cvt_pk_bf16_f32 v66, v68, v69
    v_mfma_f32_16x16x32_bf16 v[112:115], a[192:195], a[168:171], v[112:115]
    v_mul_f32 v45, v45, v49
    v_cvt_pk_bf16_f32 v67, v70, v71
    v_mfma_f32_16x16x32_bf16 v[112:115], a[196:199], a[184:187], v[112:115]
    s_add_u32 s44, s44, 24576
    v_accvgpr_read_b32 v48, a94
    v_accvgpr_read_b32 v49, a95
    v_mfma_f32_16x16x32_bf16 v[112:115], a[200:203], a[104:107], v[112:115]
    s_add_u32 m0, s42, 98304
    v_mul_f32 v46, v46, v48
    v_mul_f32 v47, v47, v49
    v_mfma_f32_16x16x32_bf16 v[112:115], a[204:207], a[120:123], v[112:115]
    buffer_load_dwordx4 v10, s[8:11], s43 offen offset:0 nt lds
    v_mfma_f32_16x16x32_bf16 v[120:123], a[204:207], a[124:127], v[120:123]
    ds_read_b64_tr_b16 a[240:241], v27 offset:128
    v_cvt_pk_bf16_f32 v6, v44, v45
    v_mfma_f32_16x16x32_bf16 v[120:123], a[200:203], a[108:111], v[120:123]
    ds_read_b64_tr_b16 a[242:243], v27 offset:6272
    v_cvt_pk_bf16_f32 v68, v72, v73
    v_mfma_f32_16x16x32_bf16 v[120:123], a[196:199], a[188:191], v[120:123]
    ds_read_b64_tr_b16 a[244:245], v27 offset:12416
    v_cvt_pk_bf16_f32 v7, v46, v47
    v_mfma_f32_16x16x32_bf16 v[120:123], a[192:195], a[172:175], v[120:123]
    buffer_store_dwordx4 v[2:5], v1, s[16:19], s97 offen sc1
    v_mfma_f32_16x16x32_bf16 v[100:103], a[208:211], a[160:163], v[100:103]
    s_add_u32 s97, s74, 147456
    ds_read_b64_tr_b16 a[246:247], v27 offset:18560
    v_cvt_pk_bf16_f32 v69, v74, v75
    v_mfma_f32_16x16x32_bf16 v[100:103], a[212:215], a[176:179], v[100:103]
    ds_read_b64_tr_b16 a[248:249], v27 offset:24704
    v_cvt_pk_bf16_f32 v70, v76, v77
    v_mfma_f32_16x16x32_bf16 v[100:103], a[216:219], a[96:99], v[100:103]
    ds_read_b64_tr_b16 a[250:251], v27 offset:30848
    v_cvt_pk_bf16_f32 v71, v78, v79
    v_mfma_f32_16x16x32_bf16 v[100:103], a[220:223], a[112:115], v[100:103]
    buffer_store_dwordx2 v[6:7], v1, s[16:19], s97 offen sc1
    v_mfma_f32_16x16x32_bf16 v[108:111], a[220:223], a[116:119], v[108:111]
    v_permlane16_swap_b32 v64, v66
    v_mfma_f32_16x16x32_bf16 v[108:111], a[216:219], a[100:103], v[108:111]
    v_permlane16_swap_b32 v65, v67
    v_mfma_f32_16x16x32_bf16 v[108:111], a[212:215], a[180:183], v[108:111]
    ds_read_b64_tr_b16 a[252:253], v27 offset:36992
    v_cvt_pk_bf16_f32 v72, v80, v81
    v_mfma_f32_16x16x32_bf16 v[108:111], a[208:211], a[164:167], v[108:111]
    ds_read_b64_tr_b16 a[254:255], v27 offset:43136
    v_cvt_pk_bf16_f32 v73, v82, v83
    v_mfma_f32_16x16x32_bf16 v[116:119], a[208:211], a[168:171], v[116:119]
    buffer_load_dwordx4 v11, s[8:11], s43 offen offset:1024 nt lds
    v_mfma_f32_16x16x32_bf16 v[116:119], a[212:215], a[184:187], v[116:119]
    v_cvt_pk_bf16_f32 v74, v84, v85
    v_cvt_pk_bf16_f32 v75, v86, v87
    v_mfma_f32_16x16x32_bf16 v[116:119], a[216:219], a[104:107], v[116:119]
    v_permlane16_swap_b32 v68, v70
    v_mfma_f32_16x16x32_bf16 v[116:119], a[220:223], a[120:123], v[116:119]
    v_permlane16_swap_b32 v69, v71
    v_mfma_f32_16x16x32_bf16 v[124:127], a[220:223], a[124:127], v[124:127]
    ds_read_b64_tr_b16 a[192:193], v28 offset:128
    v_cvt_pk_bf16_f32 v76, v88, v89
    v_mfma_f32_16x16x32_bf16 v[124:127], a[216:219], a[108:111], v[124:127]
    ds_read_b64_tr_b16 a[194:195], v28 offset:6272
    v_cvt_pk_bf16_f32 v77, v90, v91
    v_mfma_f32_16x16x32_bf16 v[124:127], a[212:215], a[188:191], v[124:127]
    ds_read_b64_tr_b16 a[196:197], v28 offset:12416
    v_cvt_pk_bf16_f32 v78, v92, v93
    v_mfma_f32_16x16x32_bf16 v[124:127], a[208:211], a[172:175], v[124:127]
    s_waitcnt lgkmcnt(4)
    buffer_load_dwordx4 v12, s[8:11], s43 offen offset:2048 nt lds
    v_mfma_f32_16x16x32_bf16 v[128:131], a[224:227], a[160:163], v[128:131]
    ds_read_b64_tr_b16 a[198:199], v28 offset:18560
    v_cvt_pk_bf16_f32 v79, v94, v95
    v_mfma_f32_16x16x32_bf16 v[128:131], a[228:231], a[176:179], v[128:131]
    ds_read_b64_tr_b16 a[200:201], v28 offset:24704
    v_add_u32 v49, 1, v61
    v_mfma_f32_16x16x32_bf16 v[128:131], a[232:235], a[96:99], v[128:131]
    v_permlane16_swap_b32 v72, v74
    v_mfma_f32_16x16x32_bf16 v[128:131], a[236:239], a[112:115], v[128:131]
    v_permlane16_swap_b32 v73, v75
    v_mfma_f32_16x16x32_bf16 v[136:139], a[236:239], a[116:119], v[136:139]
    ds_read_b64_tr_b16 a[202:203], v28 offset:30848
    v_cvt_pk_bf16_f32 v80, v96, v97
    v_mfma_f32_16x16x32_bf16 v[136:139], a[232:235], a[100:103], v[136:139]
    ds_read_b64_tr_b16 a[204:205], v28 offset:36992
    v_cvt_pk_bf16_f32 v81, v98, v99
    v_mfma_f32_16x16x32_bf16 v[136:139], a[228:231], a[180:183], v[136:139]
    ds_read_b64_tr_b16 a[206:207], v28 offset:43136
    v_cvt_pk_bf16_f32 v82, v100, v101
    v_mfma_f32_16x16x32_bf16 v[136:139], a[224:227], a[164:167], v[136:139]
    v_cvt_pk_bf16_f32 v83, v102, v103
    v_mfma_f32_16x16x32_bf16 v[144:147], a[224:227], a[168:171], v[144:147]
    v_permlane16_swap_b32 v76, v78
    v_mfma_f32_16x16x32_bf16 v[144:147], a[228:231], a[184:187], v[144:147]
    buffer_load_dwordx4 v13, s[8:11], s43 offen offset:3072 nt lds
    v_mfma_f32_16x16x32_bf16 v[144:147], a[232:235], a[104:107], v[144:147]
    v_permlane16_swap_b32 v77, v79
    v_mfma_f32_16x16x32_bf16 v[144:147], a[236:239], a[120:123], v[144:147]
    v_cvt_pk_bf16_f32 v84, v104, v105
    v_cvt_pk_bf16_f32 v85, v106, v107
    v_mfma_f32_16x16x32_bf16 v[152:155], a[236:239], a[124:127], v[152:155]
    ds_read_b64_tr_b16 a[208:209], v29 offset:128
    v_cvt_pk_bf16_f32 v86, v108, v109
    v_mfma_f32_16x16x32_bf16 v[152:155], a[232:235], a[108:111], v[152:155]
    ds_read_b64_tr_b16 a[210:211], v29 offset:6272
    v_cvt_pk_bf16_f32 v87, v110, v111
    v_mfma_f32_16x16x32_bf16 v[152:155], a[228:231], a[188:191], v[152:155]
    v_permlane16_swap_b32 v80, v82
    v_mfma_f32_16x16x32_bf16 v[152:155], a[224:227], a[172:175], v[152:155]
    v_permlane16_swap_b32 v81, v83
    v_mfma_f32_16x16x32_bf16 v[132:135], a[240:243], a[160:163], v[132:135]
    ds_read_b64_tr_b16 a[212:213], v29 offset:12416
    v_cvt_pk_bf16_f32 v88, v112, v113
    v_mfma_f32_16x16x32_bf16 v[132:135], a[244:247], a[176:179], v[132:135]
    s_add_u32 m0, m0, 4096
    ds_read_b64_tr_b16 a[214:215], v29 offset:18560
    v_cvt_pk_bf16_f32 v89, v114, v115
    v_mfma_f32_16x16x32_bf16 v[132:135], a[248:251], a[96:99], v[132:135]
    s_waitcnt lgkmcnt(4)
    ds_read_b64_tr_b16 a[216:217], v29 offset:24704
    v_cvt_pk_bf16_f32 v90, v116, v117
    v_mfma_f32_16x16x32_bf16 v[132:135], a[252:255], a[112:115], v[132:135]
    buffer_load_dwordx4 v14, s[8:11], s43 offen offset:0 nt lds
    v_mfma_f32_16x16x32_bf16 v[140:143], a[252:255], a[116:119], v[140:143]
    ds_read_b64_tr_b16 a[218:219], v29 offset:30848
    v_cvt_pk_bf16_f32 v91, v118, v119
    v_mfma_f32_16x16x32_bf16 v[140:143], a[248:251], a[100:103], v[140:143]
    v_permlane16_swap_b32 v84, v86
    v_mfma_f32_16x16x32_bf16 v[140:143], a[244:247], a[180:183], v[140:143]
    v_permlane16_swap_b32 v85, v87
    v_mfma_f32_16x16x32_bf16 v[140:143], a[240:243], a[164:167], v[140:143]
    ds_read_b64_tr_b16 a[220:221], v29 offset:36992
    v_cvt_pk_bf16_f32 v92, v120, v121
    v_mfma_f32_16x16x32_bf16 v[148:151], a[240:243], a[168:171], v[148:151]
    ds_read_b64_tr_b16 a[222:223], v29 offset:43136
    v_cvt_pk_bf16_f32 v93, v122, v123
    v_mfma_f32_16x16x32_bf16 v[148:151], a[244:247], a[184:187], v[148:151]
    v_cvt_pk_bf16_f32 v94, v124, v125
    v_cvt_pk_bf16_f32 v95, v126, v127
    v_mfma_f32_16x16x32_bf16 v[148:151], a[248:251], a[104:107], v[148:151]
    v_permlane16_swap_b32 v88, v90
    v_mfma_f32_16x16x32_bf16 v[148:151], a[252:255], a[120:123], v[148:151]
    v_permlane16_swap_b32 v89, v91
    v_mfma_f32_16x16x32_bf16 v[156:159], a[252:255], a[124:127], v[156:159]
    ds_read_b64_tr_b16 a[224:225], v26 offset:256
    v_cvt_pk_bf16_f32 v96, v128, v129
    v_mfma_f32_16x16x32_bf16 v[156:159], a[248:251], a[108:111], v[156:159]
    buffer_load_dwordx4 v15, s[8:11], s43 offen offset:1024 nt lds
    v_mfma_f32_16x16x32_bf16 v[156:159], a[244:247], a[188:191], v[156:159]
    ds_read_b64_tr_b16 a[226:227], v26 offset:6400
    v_cvt_pk_bf16_f32 v97, v130, v131
    v_mfma_f32_16x16x32_bf16 v[156:159], a[240:243], a[172:175], v[156:159]
    ds_read_b64_tr_b16 a[228:229], v26 offset:12544
    v_cvt_pk_bf16_f32 v98, v132, v133
    v_mfma_f32_16x16x32_bf16 v[160:163], a[192:195], a[160:163], v[160:163]
    ds_read_b64_tr_b16 a[230:231], v26 offset:18688
    v_cvt_pk_bf16_f32 v99, v134, v135
    v_mfma_f32_16x16x32_bf16 v[160:163], a[196:199], a[176:179], v[160:163]
    v_permlane16_swap_b32 v92, v94
    v_mfma_f32_16x16x32_bf16 v[160:163], a[200:203], a[96:99], v[160:163]
    ds_read_b64_tr_b16 a[232:233], v26 offset:24832
    v_mfma_f32_16x16x32_bf16 v[160:163], a[204:207], a[112:115], v[160:163]
    v_permlane16_swap_b32 v93, v95
    v_mfma_f32_16x16x32_bf16 v[168:171], a[204:207], a[116:119], v[168:171]
    ds_read_b64_tr_b16 a[234:235], v26 offset:30976
    v_cvt_pk_bf16_f32 v100, v136, v137
    v_mfma_f32_16x16x32_bf16 v[168:171], a[200:203], a[100:103], v[168:171]
    s_add_u32 s43, s43, 24576
    ds_read_b64_tr_b16 a[236:237], v26 offset:37120
    v_cvt_pk_bf16_f32 v101, v138, v139
    v_mfma_f32_16x16x32_bf16 v[168:171], a[196:199], a[180:183], v[168:171]
    s_add_u32 m0, s42, 122880
    ds_read_b64_tr_b16 a[238:239], v26 offset:43264
    v_cvt_pk_bf16_f32 v102, v140, v141
    v_mfma_f32_16x16x32_bf16 v[168:171], a[192:195], a[164:167], v[168:171]
    buffer_load_dwordx4 v16, s[12:15], s44 offen offset:0 nt lds
    v_mfma_f32_16x16x32_bf16 v[176:179], a[192:195], a[168:171], v[176:179]
    v_cvt_pk_bf16_f32 v103, v142, v143
    v_mfma_f32_16x16x32_bf16 v[176:179], a[196:199], a[184:187], v[176:179]
    v_permlane16_swap_b32 v96, v98
    v_mfma_f32_16x16x32_bf16 v[176:179], a[200:203], a[104:107], v[176:179]
    v_permlane16_swap_b32 v97, v99
    v_mfma_f32_16x16x32_bf16 v[176:179], a[204:207], a[120:123], v[176:179]
    v_cvt_pk_bf16_f32 v104, v144, v145
    v_cvt_pk_bf16_f32 v105, v146, v147
    v_mfma_f32_16x16x32_bf16 v[184:187], a[204:207], a[124:127], v[184:187]
    ds_read_b64_tr_b16 a[240:241], v27 offset:256
    v_cvt_pk_bf16_f32 v106, v148, v149
    v_mfma_f32_16x16x32_bf16 v[184:187], a[200:203], a[108:111], v[184:187]
    ds_read_b64_tr_b16 a[242:243], v27 offset:6400
    v_cvt_pk_bf16_f32 v107, v150, v151
    v_mfma_f32_16x16x32_bf16 v[184:187], a[196:199], a[188:191], v[184:187]
    v_permlane16_swap_b32 v100, v102
    v_mfma_f32_16x16x32_bf16 v[184:187], a[192:195], a[172:175], v[184:187]
    s_waitcnt lgkmcnt(2)
    v_permlane16_swap_b32 v101, v103
    v_mfma_f32_16x16x32_bf16 v[164:167], a[208:211], a[160:163], v[164:167]
    ds_read_b64_tr_b16 a[244:245], v27 offset:12544
    v_cvt_pk_bf16_f32 v108, v152, v153
    v_mfma_f32_16x16x32_bf16 v[164:167], a[212:215], a[176:179], v[164:167]
    buffer_load_dwordx4 v17, s[12:15], s44 offen offset:1024 nt lds
    v_mfma_f32_16x16x32_bf16 v[164:167], a[216:219], a[96:99], v[164:167]
    ds_read_b64_tr_b16 a[246:247], v27 offset:18688
    v_cvt_pk_bf16_f32 v109, v154, v155
    v_mfma_f32_16x16x32_bf16 v[164:167], a[220:223], a[112:115], v[164:167]
    ds_read_b64_tr_b16 a[248:249], v27 offset:24832
    v_cvt_pk_bf16_f32 v110, v156, v157
    v_mfma_f32_16x16x32_bf16 v[172:175], a[220:223], a[116:119], v[172:175]
    ds_read_b64_tr_b16 a[250:251], v27 offset:30976
    v_cvt_pk_bf16_f32 v111, v158, v159
    v_mfma_f32_16x16x32_bf16 v[172:175], a[216:219], a[100:103], v[172:175]
    ds_read_b64_tr_b16 a[252:253], v27 offset:37120
    v_mfma_f32_16x16x32_bf16 v[172:175], a[212:215], a[180:183], v[172:175]
    ds_read_b64_tr_b16 a[254:255], v27 offset:43264
    v_mfma_f32_16x16x32_bf16 v[172:175], a[208:211], a[164:167], v[172:175]
    v_permlane16_swap_b32 v104, v106
    v_mfma_f32_16x16x32_bf16 v[180:183], a[208:211], a[168:171], v[180:183]
    v_permlane16_swap_b32 v105, v107
    v_mfma_f32_16x16x32_bf16 v[180:183], a[212:215], a[184:187], v[180:183]
    v_cvt_pk_bf16_f32 v112, v160, v161
    v_cvt_pk_bf16_f32 v113, v162, v163
    v_mfma_f32_16x16x32_bf16 v[180:183], a[216:219], a[104:107], v[180:183]
    v_cvt_pk_bf16_f32 v114, v164, v165
    v_cvt_pk_bf16_f32 v115, v166, v167
    v_mfma_f32_16x16x32_bf16 v[180:183], a[220:223], a[120:123], v[180:183]
    buffer_load_dwordx4 v18, s[12:15], s44 offen offset:2048 nt lds
    v_mfma_f32_16x16x32_bf16 v[188:191], a[220:223], a[124:127], v[188:191]
    v_permlane16_swap_b32 v108, v110
    v_mfma_f32_16x16x32_bf16 v[188:191], a[216:219], a[108:111], v[188:191]
    v_permlane16_swap_b32 v109, v111
    v_mfma_f32_16x16x32_bf16 v[188:191], a[212:215], a[188:191], v[188:191]
    ds_read_b64_tr_b16 a[192:193], v28 offset:256
    v_cvt_pk_bf16_f32 v116, v168, v169
    v_mfma_f32_16x16x32_bf16 v[188:191], a[208:211], a[172:175], v[188:191]
    ds_read_b64_tr_b16 a[194:195], v28 offset:6400
    v_cvt_pk_bf16_f32 v117, v170, v171
    v_mfma_f32_16x16x32_bf16 v[192:195], a[224:227], a[160:163], v[192:195]
    ds_read_b64_tr_b16 a[196:197], v28 offset:12544
    v_cvt_pk_bf16_f32 v118, v172, v173
    v_mfma_f32_16x16x32_bf16 v[192:195], a[228:231], a[176:179], v[192:195]
    ds_read_b64_tr_b16 a[198:199], v28 offset:18688
    v_cvt_pk_bf16_f32 v119, v174, v175
    v_mfma_f32_16x16x32_bf16 v[192:195], a[232:235], a[96:99], v[192:195]
    v_permlane16_swap_b32 v112, v114
    v_mfma_f32_16x16x32_bf16 v[192:195], a[236:239], a[112:115], v[192:195]
    v_permlane16_swap_b32 v113, v115
    v_mfma_f32_16x16x32_bf16 v[200:203], a[236:239], a[116:119], v[200:203]
    ds_read_b64_tr_b16 a[200:201], v28 offset:24832
    v_cvt_pk_bf16_f32 v120, v176, v177
    v_mfma_f32_16x16x32_bf16 v[200:203], a[232:235], a[100:103], v[200:203]
    buffer_load_dwordx4 v19, s[12:15], s44 offen offset:3072 nt lds
    v_mfma_f32_16x16x32_bf16 v[200:203], a[228:231], a[180:183], v[200:203]
    ds_read_b64_tr_b16 a[202:203], v28 offset:30976
    v_cvt_pk_bf16_f32 v121, v178, v179
    v_mfma_f32_16x16x32_bf16 v[200:203], a[224:227], a[164:167], v[200:203]
    ds_read_b64_tr_b16 a[204:205], v28 offset:37120
    v_cvt_pk_bf16_f32 v122, v180, v181
    v_mfma_f32_16x16x32_bf16 v[208:211], a[224:227], a[168:171], v[208:211]
    ds_read_b64_tr_b16 a[206:207], v28 offset:43264
    v_cvt_pk_bf16_f32 v123, v182, v183
    v_mfma_f32_16x16x32_bf16 v[208:211], a[228:231], a[184:187], v[208:211]
    v_permlane16_swap_b32 v116, v118
    v_mfma_f32_16x16x32_bf16 v[208:211], a[232:235], a[104:107], v[208:211]
    v_permlane16_swap_b32 v117, v119
    v_mfma_f32_16x16x32_bf16 v[208:211], a[236:239], a[120:123], v[208:211]
    v_cvt_pk_bf16_f32 v124, v184, v185
    v_cvt_pk_bf16_f32 v125, v186, v187
    v_mfma_f32_16x16x32_bf16 v[216:219], a[236:239], a[124:127], v[216:219]
    ds_read_b64_tr_b16 a[208:209], v29 offset:256
    v_cvt_pk_bf16_f32 v126, v188, v189
    v_mfma_f32_16x16x32_bf16 v[216:219], a[232:235], a[108:111], v[216:219]
    s_add_u32 m0, m0, 4096
    ds_read_b64_tr_b16 a[210:211], v29 offset:6400
    v_cvt_pk_bf16_f32 v127, v190, v191
    v_mfma_f32_16x16x32_bf16 v[216:219], a[228:231], a[188:191], v[216:219]
    v_permlane16_swap_b32 v120, v122
    v_mfma_f32_16x16x32_bf16 v[216:219], a[224:227], a[172:175], v[216:219]
    s_waitcnt lgkmcnt(4)
    buffer_load_dwordx4 v20, s[12:15], s44 offen offset:0 nt lds
    v_mfma_f32_16x16x32_bf16 v[196:199], a[240:243], a[160:163], v[196:199]
    v_permlane16_swap_b32 v121, v123
    v_mfma_f32_16x16x32_bf16 v[196:199], a[244:247], a[176:179], v[196:199]
    ds_read_b64_tr_b16 a[212:213], v29 offset:12544
    v_mfma_f32_16x16x32_bf16 v[196:199], a[248:251], a[96:99], v[196:199]
    ds_read_b64_tr_b16 a[214:215], v29 offset:18688
    v_mfma_f32_16x16x32_bf16 v[196:199], a[252:255], a[112:115], v[196:199]
    ds_read_b64_tr_b16 a[216:217], v29 offset:24832
    v_mfma_f32_16x16x32_bf16 v[204:207], a[252:255], a[116:119], v[204:207]
    ds_read_b64_tr_b16 a[218:219], v29 offset:30976
    v_mfma_f32_16x16x32_bf16 v[204:207], a[248:251], a[100:103], v[204:207]
    ds_read_b64_tr_b16 a[220:221], v29 offset:37120
    v_mfma_f32_16x16x32_bf16 v[204:207], a[244:247], a[180:183], v[204:207]
    ds_read_b64_tr_b16 a[222:223], v29 offset:43264
    v_mfma_f32_16x16x32_bf16 v[204:207], a[240:243], a[164:167], v[204:207]
    v_cvt_pk_bf16_f32 v128, v192, v193
    v_cvt_pk_bf16_f32 v129, v194, v195
    v_mfma_f32_16x16x32_bf16 v[212:215], a[240:243], a[168:171], v[212:215]
    v_cvt_pk_bf16_f32 v130, v196, v197
    v_cvt_pk_bf16_f32 v131, v198, v199
    v_mfma_f32_16x16x32_bf16 v[212:215], a[244:247], a[184:187], v[212:215]
    buffer_load_dwordx4 v21, s[12:15], s44 offen offset:1024 nt lds
    v_mfma_f32_16x16x32_bf16 v[212:215], a[248:251], a[104:107], v[212:215]
    v_permlane16_swap_b32 v124, v126
    v_mfma_f32_16x16x32_bf16 v[212:215], a[252:255], a[120:123], v[212:215]
    v_permlane16_swap_b32 v125, v127
    v_mfma_f32_16x16x32_bf16 v[220:223], a[252:255], a[124:127], v[220:223]
    v_cvt_pk_bf16_f32 v132, v200, v201
    v_cvt_pk_bf16_f32 v133, v202, v203
    v_mfma_f32_16x16x32_bf16 v[220:223], a[248:251], a[108:111], v[220:223]
    v_cvt_pk_bf16_f32 v134, v204, v205
    v_cvt_pk_bf16_f32 v135, v206, v207
    v_mfma_f32_16x16x32_bf16 v[220:223], a[244:247], a[188:191], v[220:223]
    v_permlane16_swap_b32 v128, v130
    v_mfma_f32_16x16x32_bf16 v[220:223], a[240:243], a[172:175], v[220:223]
    v_permlane16_swap_b32 v129, v131
    v_mfma_f32_16x16x32_bf16 v[224:227], a[192:195], a[160:163], v[224:227]
    v_cvt_pk_bf16_f32 v136, v208, v209
    v_cvt_pk_bf16_f32 v137, v210, v211
    v_mfma_f32_16x16x32_bf16 v[224:227], a[196:199], a[176:179], v[224:227]
    s_add_u32 s44, s44, 24576
    v_cvt_pk_bf16_f32 v138, v212, v213
    v_cvt_pk_bf16_f32 v139, v214, v215
    v_mfma_f32_16x16x32_bf16 v[224:227], a[200:203], a[96:99], v[224:227]
    s_waitcnt lgkmcnt(0)
    v_add_u32 v32, 49152, v30
    v_add_u32 v33, 49152, v31
    v_mfma_f32_16x16x32_bf16 v[224:227], a[204:207], a[112:115], v[224:227]
    v_add_u32 v26, 73728, v22
    v_add_u32 v27, 73728, v23
    v_mfma_f32_16x16x32_bf16 v[232:235], a[204:207], a[116:119], v[232:235]
    v_add_u32 v28, 73728, v24
    v_add_u32 v29, 73728, v25
    v_mfma_f32_16x16x32_bf16 v[232:235], a[200:203], a[100:103], v[232:235]
    v_permlane16_swap_b32 v132, v134
    v_mfma_f32_16x16x32_bf16 v[232:235], a[196:199], a[180:183], v[232:235]
    v_permlane16_swap_b32 v133, v135
    v_mfma_f32_16x16x32_bf16 v[232:235], a[192:195], a[164:167], v[232:235]
    v_cvt_pk_bf16_f32 v140, v216, v217
    v_cvt_pk_bf16_f32 v141, v218, v219
    v_mfma_f32_16x16x32_bf16 v[240:243], a[192:195], a[168:171], v[240:243]
    v_cvt_pk_bf16_f32 v142, v220, v221
    v_cvt_pk_bf16_f32 v143, v222, v223
    v_mfma_f32_16x16x32_bf16 v[240:243], a[196:199], a[184:187], v[240:243]
    v_permlane16_swap_b32 v136, v138
    v_mfma_f32_16x16x32_bf16 v[240:243], a[200:203], a[104:107], v[240:243]
    v_permlane16_swap_b32 v137, v139
    v_mfma_f32_16x16x32_bf16 v[240:243], a[204:207], a[120:123], v[240:243]
    v_mfma_f32_16x16x32_bf16 v[248:251], a[204:207], a[124:127], v[248:251]
    v_mfma_f32_16x16x32_bf16 v[248:251], a[200:203], a[108:111], v[248:251]
    v_mfma_f32_16x16x32_bf16 v[248:251], a[196:199], a[188:191], v[248:251]
    s_waitcnt vmcnt(30)
    s_waitcnt lgkmcnt(0)
    s_barrier
    v_mfma_f32_16x16x32_bf16 v[248:251], a[192:195], a[172:175], v[248:251]
    s_add_u32 m0, s42, 0
    s_nop 0
    buffer_load_dwordx4 v10, s[8:11], s43 offen offset:0 nt lds
    v_mfma_f32_16x16x32_bf16 v[228:231], a[208:211], a[160:163], v[228:231]
    ds_read_b128 a[224:227], v32 offset:0
    v_mfma_f32_16x16x32_bf16 v[228:231], a[212:215], a[176:179], v[228:231]
    ds_read_b128 a[228:231], v33 offset:0
    v_mfma_f32_16x16x32_bf16 v[228:231], a[216:219], a[96:99], v[228:231]
    ds_read_b128 a[232:235], v32 offset:128
    v_mfma_f32_16x16x32_bf16 v[228:231], a[220:223], a[112:115], v[228:231]
    ds_read_b128 a[236:239], v33 offset:128
    v_mfma_f32_16x16x32_bf16 v[236:239], a[220:223], a[116:119], v[236:239]
    ds_read_b128 a[240:243], v32 offset:256
    v_mfma_f32_16x16x32_bf16 v[236:239], a[216:219], a[100:103], v[236:239]
    ds_read_b128 a[244:247], v33 offset:256
    v_mfma_f32_16x16x32_bf16 v[236:239], a[212:215], a[180:183], v[236:239]
    ds_read_b128 a[248:251], v32 offset:6144
    v_mfma_f32_16x16x32_bf16 v[236:239], a[208:211], a[164:167], v[236:239]
    ds_read_b128 a[252:255], v33 offset:6144
    v_cvt_pk_bf16_f32 v144, v224, v225
    v_mfma_f32_16x16x32_bf16 v[244:247], a[208:211], a[168:171], v[244:247]
    ds_read_b128 a[192:195], v32 offset:6272
    v_cvt_pk_bf16_f32 v145, v226, v227
    v_mfma_f32_16x16x32_bf16 v[244:247], a[212:215], a[184:187], v[244:247]
    ds_read_b128 a[196:199], v33 offset:6272
    v_cvt_pk_bf16_f32 v146, v228, v229
    v_mfma_f32_16x16x32_bf16 v[244:247], a[216:219], a[104:107], v[244:247]
    ds_read_b128 a[200:203], v32 offset:6400
    v_cvt_pk_bf16_f32 v147, v230, v231
    v_mfma_f32_16x16x32_bf16 v[244:247], a[220:223], a[120:123], v[244:247]
    v_permlane16_swap_b32 v140, v142
    v_mfma_f32_16x16x32_bf16 v[252:255], a[220:223], a[124:127], v[252:255]
    v_permlane16_swap_b32 v141, v143
    v_mfma_f32_16x16x32_bf16 v[252:255], a[216:219], a[108:111], v[252:255]
    ds_read_b128 a[204:207], v33 offset:6400
    v_cvt_pk_bf16_f32 v148, v232, v233
    v_mfma_f32_16x16x32_bf16 v[252:255], a[212:215], a[188:191], v[252:255]
    v_cvt_pk_bf16_f32 v149, v234, v235
    v_cvt_pk_bf16_f32 v150, v236, v237
    v_mfma_f32_16x16x32_bf16 v[252:255], a[208:211], a[172:175], v[252:255]
    s_waitcnt lgkmcnt(5)
    v_cvt_pk_bf16_f32 v151, v238, v239
    v_mfma_f32_16x16x32_bf16 v[160:163], a[224:227], v[64:67], 0
    v_permlane16_swap_b32 v144, v146
    v_mfma_f32_16x16x32_bf16 v[160:163], a[228:231], v[80:83], v[160:163]
    v_permlane16_swap_b32 v145, v147
    v_mfma_f32_16x16x32_bf16 v[160:163], a[232:235], v[96:99], v[160:163]
    v_cvt_pk_bf16_f32 v152, v240, v241
    v_cvt_pk_bf16_f32 v153, v242, v243
    v_mfma_f32_16x16x32_bf16 v[160:163], a[236:239], v[112:115], v[160:163]
    v_cvt_pk_bf16_f32 v154, v244, v245
    v_cvt_pk_bf16_f32 v155, v246, v247
    v_mfma_f32_16x16x32_bf16 v[160:163], a[240:243], v[128:131], v[160:163]
    v_permlane16_swap_b32 v148, v150
    v_mfma_f32_16x16x32_bf16 v[160:163], a[244:247], v[144:147], v[160:163]
WS5:
    s_cbranch_execz WS1
    v_permlane16_swap_b32 v149, v151
    v_mfma_f32_16x16x32_bf16 v[164:167], a[224:227], v[68:71], 0
    v_cvt_pk_bf16_f32 v156, v248, v249
    v_cvt_pk_bf16_f32 v157, v250, v251
    v_mfma_f32_16x16x32_bf16 v[164:167], a[228:231], v[84:87], v[164:167]
    v_cvt_pk_bf16_f32 v158, v252, v253
    v_cvt_pk_bf16_f32 v159, v254, v255
    v_mfma_f32_16x16x32_bf16 v[164:167], a[232:235], v[100:103], v[164:167]
    v_permlane16_swap_b32 v152, v154
    v_mfma_f32_16x16x32_bf16 v[164:167], a[236:239], v[116:119], v[164:167]
    v_permlane16_swap_b32 v153, v155
    v_mfma_f32_16x16x32_bf16 v[164:167], a[240:243], v[132:135], v[164:167]
    v_permlane16_swap_b32 v156, v158
    v_mfma_f32_16x16x32_bf16 v[164:167], a[244:247], v[148:151], v[164:167]
    v_permlane16_swap_b32 v157, v159
    v_mfma_f32_16x16x32_bf16 v[168:171], a[224:227], v[72:75], 0
    ds_read_b128 a[208:211], v32 offset:12288
    v_max3_f32 v56, v160, v161, v162
    v_mfma_f32_16x16x32_bf16 v[168:171], a[228:231], v[88:91], v[168:171]
    ds_read_b128 a[212:215], v33 offset:12288
    v_max_f32 v56, v56, v163
    v_mfma_f32_16x16x32_bf16 v[168:171], a[232:235], v[104:107], v[168:171]
    ds_read_b128 a[216:219], v32 offset:12416
    v_mov_b32 v57, v56
    v_mfma_f32_16x16x32_bf16 v[168:171], a[236:239], v[120:123], v[168:171]
    s_nop 0
    v_permlane32_swap_b32 v56, v57
    v_mfma_f32_16x16x32_bf16 v[168:171], a[240:243], v[136:139], v[168:171]
    ds_read_b128 a[220:223], v33 offset:12416
    v_max_f32 v56, v56, v57
    v_mfma_f32_16x16x32_bf16 v[168:171], a[244:247], v[152:155], v[168:171]
    v_mov_b32 v57, v56
    v_mfma_f32_16x16x32_bf16 v[172:175], a[224:227], v[76:79], 0
    s_nop 0
    v_permlane16_swap_b32 v56, v57
    v_mfma_f32_16x16x32_bf16 v[172:175], a[228:231], v[92:95], v[172:175]
    ds_read_b128 a[224:227], v32 offset:12544
    v_max_f32 v56, v56, v57
    v_mfma_f32_16x16x32_bf16 v[172:175], a[232:235], v[108:111], v[172:175]
    ds_read_b128 a[228:231], v33 offset:12544
    v_sub_f32 v224, 0, v56
    v_mfma_f32_16x16x32_bf16 v[172:175], a[236:239], v[124:127], v[172:175]
    v_sub_f32 v225, 0, v56
    v_sub_f32 v226, 0, v56
    v_mfma_f32_16x16x32_bf16 v[172:175], a[240:243], v[140:143], v[172:175]
    v_sub_f32 v227, 0, v56
    v_sub_f32 v160, v160, v56
    v_mfma_f32_16x16x32_bf16 v[172:175], a[244:247], v[156:159], v[172:175]
    v_sub_f32 v161, v161, v56
    v_sub_f32 v162, v162, v56
    v_mfma_f32_16x16x32_bf16 v[176:179], a[248:251], v[64:67], v[224:227]
    s_waitcnt lgkmcnt(3)
    v_sub_f32 v163, v163, v56
    v_max3_f32 v58, v164, v165, v166
    v_mfma_f32_16x16x32_bf16 v[176:179], a[252:255], v[80:83], v[176:179]
    v_max_f32 v58, v58, v167
    v_mov_b32 v59, v58
    v_mfma_f32_16x16x32_bf16 v[176:179], a[192:195], v[96:99], v[176:179]
    s_nop 0
    v_permlane32_swap_b32 v58, v59
    v_mfma_f32_16x16x32_bf16 v[176:179], a[196:199], v[112:115], v[176:179]
    v_max_f32 v58, v58, v59
    v_mov_b32 v59, v58
    v_mfma_f32_16x16x32_bf16 v[176:179], a[200:203], v[128:131], v[176:179]
    s_nop 0
    v_permlane16_swap_b32 v58, v59
    v_max_f32 v58, v58, v59
    v_sub_f32 v228, 0, v58
    v_sub_f32 v229, 0, v58
    v_sub_f32 v230, 0, v58
    v_sub_f32 v231, 0, v58
    v_mfma_f32_16x16x32_bf16 v[176:179], a[204:207], v[144:147], v[176:179]
    v_sub_f32 v164, v164, v58
    v_sub_f32 v165, v165, v58
    v_mfma_f32_16x16x32_bf16 v[180:183], a[248:251], v[68:71], v[228:231]
    v_sub_f32 v166, v166, v58
    v_sub_f32 v167, v167, v58
    v_mfma_f32_16x16x32_bf16 v[180:183], a[252:255], v[84:87], v[180:183]
    v_max3_f32 v56, v168, v169, v170
    v_max_f32 v56, v56, v171
    v_mfma_f32_16x16x32_bf16 v[180:183], a[192:195], v[100:103], v[180:183]
    v_mov_b32 v57, v56
    v_mfma_f32_16x16x32_bf16 v[180:183], a[196:199], v[116:119], v[180:183]
    s_nop 0
    v_permlane32_swap_b32 v56, v57
    v_mfma_f32_16x16x32_bf16 v[180:183], a[200:203], v[132:135], v[180:183]
    v_max_f32 v56, v56, v57
    v_mov_b32 v57, v56
    s_nop 0
    s_nop 0
    v_permlane16_swap_b32 v56, v57
    v_max_f32 v56, v56, v57
    v_sub_f32 v232, 0, v56
    v_sub_f32 v233, 0, v56
    v_sub_f32 v234, 0, v56
    v_sub_f32 v235, 0, v56
    v_mfma_f32_16x16x32_bf16 v[180:183], a[204:207], v[148:151], v[180:183]
    v_sub_f32 v168, v168, v56
    v_sub_f32 v169, v169, v56
    v_mfma_f32_16x16x32_bf16 v[184:187], a[248:251], v[72:75], v[232:235]
    v_exp_f32 v160, v160
    v_mfma_f32_16x16x32_bf16 v[184:187], a[252:255], v[88:91], v[184:187]
    ds_read_b128 a[232:235], v32 offset:18432
    v_sub_f32 v170, v170, v56
    v_mfma_f32_16x16x32_bf16 v[184:187], a[192:195], v[104:107], v[184:187]
    ds_read_b128 a[236:239], v33 offset:18432
    v_sub_f32 v171, v171, v56
    v_mfma_f32_16x16x32_bf16 v[184:187], a[196:199], v[120:123], v[184:187]
    ds_read_b128 a[240:243], v32 offset:18560
    v_max3_f32 v58, v172, v173, v174
    v_mfma_f32_16x16x32_bf16 v[184:187], a[200:203], v[136:139], v[184:187]
    v_exp_f32 v161, v161
    v_max_f32 v58, v58, v175
    v_mov_b32 v59, v58
    s_nop 0
    s_nop 0
    v_permlane32_swap_b32 v58, v59
    v_max_f32 v58, v58, v59
    v_mov_b32 v59, v58
    s_nop 0
    s_nop 0
    v_permlane16_swap_b32 v58, v59
    v_max_f32 v58, v58, v59
    v_sub_f32 v236, 0, v58
    v_sub_f32 v237, 0, v58
    v_sub_f32 v238, 0, v58
    v_sub_f32 v239, 0, v58
    v_mfma_f32_16x16x32_bf16 v[184:187], a[204:207], v[152:155], v[184:187]
    v_exp_f32 v162, v162
    v_mfma_f32_16x16x32_bf16 v[188:191], a[248:251], v[76:79], v[236:239]
    v_exp_f32 v163, v163
    v_mfma_f32_16x16x32_bf16 v[188:191], a[252:255], v[92:95], v[188:191]
    v_exp_f32 v164, v164
    v_mfma_f32_16x16x32_bf16 v[188:191], a[192:195], v[108:111], v[188:191]
    v_exp_f32 v165, v165
    v_mfma_f32_16x16x32_bf16 v[188:191], a[196:199], v[124:127], v[188:191]
    buffer_load_dwordx4 v11, s[8:11], s43 offen offset:1024 nt lds
    v_mfma_f32_16x16x32_bf16 v[188:191], a[200:203], v[140:143], v[188:191]
    v_exp_f32 v166, v166
    v_sub_f32 v172, v172, v58
    v_sub_f32 v173, v173, v58
    v_sub_f32 v174, v174, v58
    v_sub_f32 v175, v175, v58
    v_mfma_f32_16x16x32_bf16 v[188:191], a[204:207], v[156:159], v[188:191]
    ds_read_b128 a[244:247], v33 offset:18560
    v_add_f32 v34, v34, v160
    v_mfma_f32_16x16x32_bf16 v[192:195], a[208:211], v[64:67], v[224:227]
    v_exp_f32 v167, v167
    v_mfma_f32_16x16x32_bf16 v[192:195], a[212:215], v[80:83], v[192:195]
    ds_read_b128 a[248:251], v32 offset:18688
    v_add_f32 v34, v34, v161
    v_mfma_f32_16x16x32_bf16 v[192:195], a[216:219], v[96:99], v[192:195]
    s_waitcnt lgkmcnt(2)
    v_exp_f32 v168, v168
    v_mfma_f32_16x16x32_bf16 v[192:195], a[220:223], v[112:115], v[192:195]
    ds_read_b128 a[252:255], v33 offset:18688
    v_add_f32 v34, v34, v162
    v_mfma_f32_16x16x32_bf16 v[192:195], a[224:227], v[128:131], v[192:195]
    v_exp_f32 v169, v169
    v_mfma_f32_16x16x32_bf16 v[192:195], a[228:231], v[144:147], v[192:195]
    s_waitcnt vmcnt(30)
    v_add_f32 v34, v34, v163
    v_add_f32 v35, v35, v164
    v_mfma_f32_16x16x32_bf16 v[196:199], a[208:211], v[68:71], v[228:231]
    v_exp_f32 v170, v170
    v_mfma_f32_16x16x32_bf16 v[196:199], a[212:215], v[84:87], v[196:199]
    buffer_load_dwordx4 v12, s[8:11], s43 offen offset:2048 nt lds
    v_mfma_f32_16x16x32_bf16 v[196:199], a[216:219], v[100:103], v[196:199]
    ds_read_b64_tr_b16 v[52:53], v41 offset:0
    v_add_f32 v35, v35, v165
    v_mfma_f32_16x16x32_bf16 v[196:199], a[220:223], v[116:119], v[196:199]
    v_exp_f32 v171, v171
    v_mfma_f32_16x16x32_bf16 v[196:199], a[224:227], v[132:135], v[196:199]
    ds_read_b64_tr_b16 v[54:55], v41 offset:1024
    v_add_f32 v35, v35, v166
    v_mfma_f32_16x16x32_bf16 v[196:199], a[228:231], v[148:151], v[196:199]
    v_exp_f32 v172, v172
    v_mfma_f32_16x16x32_bf16 v[200:203], a[208:211], v[72:75], v[232:235]
    ds_read_b64_tr_b16 v[56:57], v41 offset:32
    v_add_f32 v35, v35, v167
    v_mfma_f32_16x16x32_bf16 v[200:203], a[212:215], v[88:91], v[200:203]
    v_exp_f32 v173, v173
    v_add_u32 v32, 98304, v30
    v_add_u32 v33, 98304, v31
    v_mfma_f32_16x16x32_bf16 v[200:203], a[216:219], v[104:107], v[200:203]
    s_waitcnt vmcnt(9)
    s_waitcnt lgkmcnt(0)
    s_barrier
    v_mfma_f32_16x16x32_bf16 v[200:203], a[220:223], v[120:123], v[200:203]
    ds_read_b64_tr_b16 v[58:59], v41 offset:1056
    v_add_f32 v36, v36, v168
    v_mfma_f32_16x16x32_bf16 v[200:203], a[224:227], v[136:139], v[200:203]
    ds_read_b64_tr_b16 a[192:193], v26 offset:0
    v_add_f32 v36, v36, v169
    v_mfma_f32_16x16x32_bf16 v[200:203], a[228:231], v[152:155], v[200:203]
    v_exp_f32 v174, v174
    v_mfma_f32_16x16x32_bf16 v[204:207], a[208:211], v[76:79], v[236:239]
    ds_read_b64_tr_b16 a[194:195], v26 offset:6144
    v_add_f32 v36, v36, v170
    v_mfma_f32_16x16x32_bf16 v[204:207], a[212:215], v[92:95], v[204:207]
    v_exp_f32 v175, v175
    v_mfma_f32_16x16x32_bf16 v[204:207], a[216:219], v[108:111], v[204:207]
    ds_read_b64_tr_b16 a[196:197], v27 offset:0
    v_add_f32 v36, v36, v171
    v_mfma_f32_16x16x32_bf16 v[204:207], a[220:223], v[124:127], v[204:207]
    v_exp_f32 v176, v176
    v_mfma_f32_16x16x32_bf16 v[204:207], a[224:227], v[140:143], v[204:207]
    ds_read_b64_tr_b16 a[198:199], v27 offset:6144
    v_add_f32 v37, v37, v172
    v_mfma_f32_16x16x32_bf16 v[204:207], a[228:231], v[156:159], v[204:207]
    v_exp_f32 v177, v177
    v_mfma_f32_16x16x32_bf16 v[208:211], a[232:235], v[64:67], v[224:227]
    ds_read_b64_tr_b16 a[200:201], v28 offset:0
    v_add_f32 v37, v37, v173
    v_mfma_f32_16x16x32_bf16 v[208:211], a[236:239], v[80:83], v[208:211]
    ds_read_b64_tr_b16 a[202:203], v28 offset:6144
    v_add_f32 v37, v37, v174
    v_mfma_f32_16x16x32_bf16 v[208:211], a[240:243], v[96:99], v[208:211]
    v_exp_f32 v178, v178
    v_mfma_f32_16x16x32_bf16 v[208:211], a[244:247], v[112:115], v[208:211]
    ds_read_b64_tr_b16 a[204:205], v29 offset:0
    v_add_f32 v37, v37, v175
    v_mfma_f32_16x16x32_bf16 v[208:211], a[248:251], v[128:131], v[208:211]
    v_exp_f32 v179, v179
    v_mfma_f32_16x16x32_bf16 v[208:211], a[252:255], v[144:147], v[208:211]
    ds_read_b64_tr_b16 a[206:207], v29 offset:6144
    v_add_f32 v34, v34, v176
    v_mfma_f32_16x16x32_bf16 v[212:215], a[232:235], v[68:71], v[228:231]
    v_exp_f32 v180, v180
    v_mfma_f32_16x16x32_bf16 v[212:215], a[236:239], v[84:87], v[212:215]
    ds_read_b64_tr_b16 a[208:209], v26 offset:128
    v_add_f32 v34, v34, v177
    v_mfma_f32_16x16x32_bf16 v[212:215], a[240:243], v[100:103], v[212:215]
    v_exp_f32 v181, v181
    v_mfma_f32_16x16x32_bf16 v[212:215], a[244:247], v[116:119], v[212:215]
    ds_read_b64_tr_b16 a[210:211], v26 offset:6272
    v_add_f32 v34, v34, v178
    v_mfma_f32_16x16x32_bf16 v[212:215], a[248:251], v[132:135], v[212:215]
    ds_read_b64_tr_b16 a[212:213], v27 offset:128
    v_add_f32 v34, v34, v179
    v_mfma_f32_16x16x32_bf16 v[212:215], a[252:255], v[148:151], v[212:215]
    v_exp_f32 v182, v182
    v_mfma_f32_16x16x32_bf16 v[216:219], a[232:235], v[72:75], v[232:235]
    ds_read_b64_tr_b16 a[214:215], v27 offset:6272
    v_add_f32 v35, v35, v180
    v_mfma_f32_16x16x32_bf16 v[216:219], a[236:239], v[88:91], v[216:219]
    v_exp_f32 v183, v183
    v_mfma_f32_16x16x32_bf16 v[216:219], a[240:243], v[104:107], v[216:219]
    ds_read_b64_tr_b16 a[216:217], v28 offset:128
    v_add_f32 v35, v35, v181
    v_mfma_f32_16x16x32_bf16 v[216:219], a[244:247], v[120:123], v[216:219]
    ds_read_b64_tr_b16 a[218:219], v28 offset:6272
    v_cvt_pk_bf16_f32 v240, v160, v161
    v_mfma_f32_16x16x32_bf16 v[216:219], a[248:251], v[136:139], v[216:219]
    v_exp_f32 v184, v184
    v_mfma_f32_16x16x32_bf16 v[216:219], a[252:255], v[152:155], v[216:219]
    ds_read_b64_tr_b16 a[220:221], v29 offset:128
    v_add_f32 v35, v35, v182
    v_mfma_f32_16x16x32_bf16 v[220:223], a[232:235], v[76:79], v[236:239]
    ds_read_b64_tr_b16 a[222:223], v29 offset:6272
    v_cvt_pk_bf16_f32 v241, v162, v163
    v_mfma_f32_16x16x32_bf16 v[220:223], a[236:239], v[92:95], v[220:223]
    v_cvt_pk_bf16_f32 v244, v164, v165
    v_add_f32 v35, v35, v183
    v_mfma_f32_16x16x32_bf16 v[220:223], a[240:243], v[108:111], v[220:223]
    v_exp_f32 v185, v185
    v_mfma_f32_16x16x32_bf16 v[220:223], a[244:247], v[124:127], v[220:223]
    ds_read_b64_tr_b16 a[224:225], v26 offset:256
    v_cvt_pk_bf16_f32 v245, v166, v167
    v_exp_f32 v186, v186
    v_exp_f32 v187, v187
    v_exp_f32 v188, v188
    v_exp_f32 v189, v189
    v_exp_f32 v190, v190
    v_exp_f32 v191, v191
    v_mfma_f32_16x16x32_bf16 v[220:223], a[248:251], v[140:143], v[220:223]
    ds_read_b64_tr_b16 a[226:227], v26 offset:6400
    v_add_f32 v36, v36, v184
    v_cvt_pk_bf16_f32 v248, v168, v169
    v_cvt_pk_bf16_f32 v249, v170, v171
    v_add_f32 v36, v36, v185
    v_add_f32 v36, v36, v186
    v_add_f32 v36, v36, v187
    v_cvt_pk_bf16_f32 v252, v172, v173
    v_cvt_pk_bf16_f32 v253, v174, v175
    v_cvt_pk_bf16_f32 v242, v176, v177
    v_cvt_pk_bf16_f32 v243, v178, v179
    v_cvt_pk_bf16_f32 v246, v180, v181
    v_cvt_pk_bf16_f32 v247, v182, v183
    v_cvt_pk_bf16_f32 v250, v184, v185
    v_cvt_pk_bf16_f32 v251, v186, v187
    v_add_f32 v37, v37, v188
    v_add_f32 v37, v37, v189
    v_add_f32 v37, v37, v190
    v_add_f32 v37, v37, v191
    v_cvt_pk_bf16_f32 v254, v188, v189
    v_cvt_pk_bf16_f32 v255, v190, v191
    v_mfma_f32_16x16x32_bf16 v[220:223], a[252:255], v[156:159], v[220:223]
    s_waitcnt lgkmcnt(5)
    buffer_store_dwordx4 v[52:55], v1, s[28:31], s51 offen offset:0 sc1
    v_mfma_f32_16x16x32_bf16 a[0:3], a[192:195], v[240:243], 0
    v_exp_f32 v192, v192
    v_mfma_f32_16x16x32_bf16 a[4:7], a[192:195], v[244:247], 0
    v_exp_f32 v193, v193
    v_mfma_f32_16x16x32_bf16 a[8:11], a[192:195], v[248:251], 0
    v_exp_f32 v194, v194
    v_mfma_f32_16x16x32_bf16 a[12:15], a[192:195], v[252:255], 0
    buffer_store_dwordx4 v[56:59], v1, s[28:31], s51 offen offset:1024 sc1
    v_mfma_f32_16x16x32_bf16 a[28:31], a[196:199], v[252:255], 0
    s_add_u32 s51, s51, 1966080
    ds_read_b64_tr_b16 a[228:229], v27 offset:256
    v_xor_b32 v41, 2048, v41
    v_mfma_f32_16x16x32_bf16 a[24:27], a[196:199], v[248:251], 0
    v_exp_f32 v195, v195
    v_mfma_f32_16x16x32_bf16 a[20:23], a[196:199], v[244:247], 0
    v_exp_f32 v196, v196
    v_mfma_f32_16x16x32_bf16 a[16:19], a[196:199], v[240:243], 0
    buffer_load_dwordx4 v13, s[8:11], s43 offen offset:3072 nt lds
    v_mfma_f32_16x16x32_bf16 a[32:35], a[200:203], v[240:243], 0
    s_add_u32 m0, m0, 4096
    v_exp_f32 v197, v197
    v_mfma_f32_16x16x32_bf16 a[36:39], a[200:203], v[244:247], 0
    v_exp_f32 v198, v198
    v_mfma_f32_16x16x32_bf16 a[40:43], a[200:203], v[248:251], 0
    ds_read_b64_tr_b16 a[230:231], v27 offset:6400
    v_add_f32 v34, v34, v192
    v_mfma_f32_16x16x32_bf16 a[44:47], a[200:203], v[252:255], 0
    v_exp_f32 v199, v199
    v_mfma_f32_16x16x32_bf16 a[60:63], a[204:207], v[252:255], 0
    buffer_load_dwordx4 v14, s[8:11], s43 offen offset:0 nt lds
    v_mfma_f32_16x16x32_bf16 a[56:59], a[204:207], v[248:251], 0
    ds_read_b64_tr_b16 a[232:233], v28 offset:256
    v_add_f32 v34, v34, v193
    v_mfma_f32_16x16x32_bf16 a[52:55], a[204:207], v[244:247], 0
    v_exp_f32 v200, v200
    v_mfma_f32_16x16x32_bf16 a[48:51], a[204:207], v[240:243], 0
    ds_read_b64_tr_b16 a[234:235], v28 offset:6400
    v_add_f32 v34, v34, v194
    v_mfma_f32_16x16x32_bf16 a[64:67], a[208:211], v[240:243], 0
    buffer_load_dwordx4 v15, s[8:11], s43 offen offset:1024 nt lds
    v_mfma_f32_16x16x32_bf16 a[68:71], a[208:211], v[244:247], 0
    s_add_u32 s43, s43, 24576
    ds_read_b64_tr_b16 a[236:237], v29 offset:256
    v_add_f32 v34, v34, v195
    v_mfma_f32_16x16x32_bf16 a[72:75], a[208:211], v[248:251], 0
    s_mov_b32 m0, s52
    v_exp_f32 v201, v201
    v_mfma_f32_16x16x32_bf16 a[76:79], a[208:211], v[252:255], 0
    ds_read_b64_tr_b16 a[238:239], v29 offset:6400
    v_add_f32 v35, v35, v196
    v_mfma_f32_16x16x32_bf16 a[92:95], a[212:215], v[252:255], 0
    v_exp_f32 v202, v202
    v_mfma_f32_16x16x32_bf16 a[88:91], a[212:215], v[248:251], 0
    buffer_load_dwordx4 v39, s[24:27], s50 offen nt lds
    v_mfma_f32_16x16x32_bf16 a[84:87], a[212:215], v[244:247], 0
    ds_read_b128 a[240:243], v32 offset:0
    v_add_f32 v35, v35, v197
    v_mfma_f32_16x16x32_bf16 a[80:83], a[212:215], v[240:243], 0
    s_waitcnt lgkmcnt(4)
    v_exp_f32 v203, v203
    v_mfma_f32_16x16x32_bf16 a[96:99], a[216:219], v[240:243], 0
    ds_read_b128 a[244:247], v33 offset:0
    v_add_f32 v35, v35, v198
    v_mfma_f32_16x16x32_bf16 a[100:103], a[216:219], v[244:247], 0
    buffer_load_dwordx4 v40, s[24:27], s50 offen offset:1024 nt lds
    v_mfma_f32_16x16x32_bf16 a[104:107], a[216:219], v[248:251], 0
    s_xor_b32 s52, s52, 2048
    v_exp_f32 v204, v204
    v_mfma_f32_16x16x32_bf16 a[108:111], a[216:219], v[252:255], 0
    s_add_u32 s50, s50, 1966080
    ds_read_b128 a[248:251], v32 offset:128
    v_add_f32 v35, v35, v199
    v_mfma_f32_16x16x32_bf16 a[124:127], a[220:223], v[252:255], 0
    s_add_u32 m0, s42, 24576
    ds_read_b128 a[252:255], v33 offset:128
    v_add_f32 v36, v36, v200
    v_mfma_f32_16x16x32_bf16 a[120:123], a[220:223], v[248:251], 0
    v_exp_f32 v205, v205
    v_mfma_f32_16x16x32_bf16 a[116:119], a[220:223], v[244:247], 0
    buffer_load_dwordx4 v16, s[12:15], s44 offen offset:0 nt lds
    v_mfma_f32_16x16x32_bf16 a[112:115], a[220:223], v[240:243], 0
    ds_read_b128 a[192:195], v32 offset:256
    v_add_f32 v36, v36, v201
    v_mfma_f32_16x16x32_bf16 a[128:131], a[224:227], v[240:243], 0
    ds_read_b128 a[196:199], v33 offset:256
    v_add_f32 v36, v36, v202
    v_mfma_f32_16x16x32_bf16 a[132:135], a[224:227], v[244:247], 0
    v_exp_f32 v206, v206
    v_mfma_f32_16x16x32_bf16 a[136:139], a[224:227], v[248:251], 0
    buffer_load_dwordx4 v17, s[12:15], s44 offen offset:1024 nt lds
    v_mfma_f32_16x16x32_bf16 a[140:143], a[224:227], v[252:255], 0
    v_exp_f32 v207, v207
    v_mfma_f32_16x16x32_bf16 a[156:159], a[228:231], v[252:255], 0
    ds_read_b128 a[200:203], v32 offset:6144
    v_add_f32 v36, v36, v203
    v_mfma_f32_16x16x32_bf16 a[152:155], a[228:231], v[248:251], 0
    v_exp_f32 v208, v208
    v_mfma_f32_16x16x32_bf16 a[148:151], a[228:231], v[244:247], 0
    ds_read_b128 a[204:207], v33 offset:6144
    v_add_f32 v37, v37, v204
    v_mfma_f32_16x16x32_bf16 a[144:147], a[228:231], v[240:243], 0
    s_waitcnt lgkmcnt(4)
    buffer_load_dwordx4 v18, s[12:15], s44 offen offset:2048 nt lds
    v_mfma_f32_16x16x32_bf16 a[160:163], a[232:235], v[240:243], 0
    ds_read_b128 a[208:211], v32 offset:6272
    v_add_f32 v37, v37, v205
    v_mfma_f32_16x16x32_bf16 a[164:167], a[232:235], v[244:247], 0
    v_exp_f32 v209, v209
    v_mfma_f32_16x16x32_bf16 a[168:171], a[232:235], v[248:251], 0
    ds_read_b128 a[212:215], v33 offset:6272
    v_add_f32 v37, v37, v206
    v_mfma_f32_16x16x32_bf16 a[172:175], a[232:235], v[252:255], 0
    buffer_load_dwordx4 v19, s[12:15], s44 offen offset:3072 nt lds
    v_mfma_f32_16x16x32_bf16 a[188:191], a[236:239], v[252:255], 0
    s_add_u32 m0, m0, 4096
    v_exp_f32 v210, v210
    v_mfma_f32_16x16x32_bf16 a[184:187], a[236:239], v[248:251], 0
    ds_read_b128 a[216:219], v32 offset:6400
    v_add_f32 v37, v37, v207
    v_mfma_f32_16x16x32_bf16 a[180:183], a[236:239], v[244:247], 0
    v_exp_f32 v211, v211
    v_mfma_f32_16x16x32_bf16 a[176:179], a[236:239], v[240:243], 0
    ds_read_b128 a[220:223], v33 offset:6400
    v_add_f32 v34, v34, v208
    v_mfma_f32_16x16x32_bf16 v[160:163], a[240:243], v[64:67], v[224:227]
    buffer_load_dword v60, v50, s[16:19], s56 offen sc1
    v_mfma_f32_16x16x32_bf16 v[160:163], a[244:247], v[80:83], v[160:163]
    s_add_u32 s56, s56, 2048
    v_exp_f32 v212, v212
    v_mfma_f32_16x16x32_bf16 v[160:163], a[248:251], v[96:99], v[160:163]
    v_add_f32 v34, v34, v209
    v_add_f32 v34, v34, v210
    v_mfma_f32_16x16x32_bf16 v[160:163], a[252:255], v[112:115], v[160:163]
    s_waitcnt lgkmcnt(2)
    v_exp_f32 v213, v213
    v_mfma_f32_16x16x32_bf16 v[160:163], a[192:195], v[128:131], v[160:163]
    buffer_load_dwordx4 v20, s[12:15], s44 offen offset:0 nt lds
    v_mfma_f32_16x16x32_bf16 v[160:163], a[196:199], v[144:147], v[160:163]
    v_add_f32 v34, v34, v211
    v_add_f32 v35, v35, v212
    v_mfma_f32_16x16x32_bf16 v[164:167], a[240:243], v[68:71], v[228:231]
    v_exp_f32 v214, v214
    v_mfma_f32_16x16x32_bf16 v[164:167], a[244:247], v[84:87], v[164:167]
    v_exp_f32 v215, v215
    v_mfma_f32_16x16x32_bf16 v[164:167], a[248:251], v[100:103], v[164:167]
    v_add_f32 v35, v35, v213
    v_add_f32 v35, v35, v214
    v_mfma_f32_16x16x32_bf16 v[164:167], a[252:255], v[116:119], v[164:167]
    buffer_load_dwordx4 v21, s[12:15], s44 offen offset:1024 nt lds
    v_mfma_f32_16x16x32_bf16 v[164:167], a[192:195], v[132:135], v[164:167]
    v_exp_f32 v216, v216
    v_mfma_f32_16x16x32_bf16 v[164:167], a[196:199], v[148:151], v[164:167]
    v_add_f32 v35, v35, v215
    v_add_f32 v36, v36, v216
    v_mfma_f32_16x16x32_bf16 v[168:171], a[240:243], v[72:75], v[232:235]
    v_exp_f32 v217, v217
    v_mfma_f32_16x16x32_bf16 v[168:171], a[244:247], v[88:91], v[168:171]
    v_exp_f32 v218, v218
    v_mfma_f32_16x16x32_bf16 v[168:171], a[248:251], v[104:107], v[168:171]
    ds_read_b64_tr_b16 a[224:225], v26 offset:12288
    v_cvt_pk_bf16_f32 v240, v192, v193
    v_mfma_f32_16x16x32_bf16 v[168:171], a[252:255], v[120:123], v[168:171]
    ds_read_b64_tr_b16 a[226:227], v26 offset:18432
    v_cvt_pk_bf16_f32 v241, v194, v195
    v_mfma_f32_16x16x32_bf16 v[168:171], a[192:195], v[136:139], v[168:171]
    s_add_u32 s44, s44, 24576
    ds_read_b64_tr_b16 a[228:229], v27 offset:12288
    v_add_f32 v36, v36, v217
    v_mfma_f32_16x16x32_bf16 v[168:171], a[196:199], v[152:155], v[168:171]
    ds_read_b64_tr_b16 a[230:231], v27 offset:18432
    v_cvt_pk_bf16_f32 v244, v196, v197
    v_mfma_f32_16x16x32_bf16 v[172:175], a[240:243], v[76:79], v[236:239]
    v_exp_f32 v219, v219
    v_mfma_f32_16x16x32_bf16 v[172:175], a[244:247], v[92:95], v[172:175]
    v_cvt_pk_bf16_f32 v245, v198, v199
    v_add_f32 v36, v36, v218
    v_mfma_f32_16x16x32_bf16 v[172:175], a[248:251], v[108:111], v[172:175]
    ds_read_b64_tr_b16 a[232:233], v28 offset:12288
    v_cvt_pk_bf16_f32 v248, v200, v201
    v_mfma_f32_16x16x32_bf16 v[172:175], a[252:255], v[124:127], v[172:175]
    ds_read_b64_tr_b16 a[234:235], v28 offset:18432
    v_cvt_pk_bf16_f32 v249, v202, v203
    v_mfma_f32_16x16x32_bf16 v[172:175], a[192:195], v[140:143], v[172:175]
    v_exp_f32 v220, v220
    v_mfma_f32_16x16x32_bf16 v[172:175], a[196:199], v[156:159], v[172:175]
    v_add_f32 v36, v36, v219
    v_cvt_pk_bf16_f32 v252, v204, v205
    v_mfma_f32_16x16x32_bf16 v[176:179], a[200:203], v[64:67], v[224:227]
    ds_read_b64_tr_b16 a[236:237], v29 offset:12288
    v_cvt_pk_bf16_f32 v253, v206, v207
    v_mfma_f32_16x16x32_bf16 v[176:179], a[204:207], v[80:83], v[176:179]
    ds_read_b64_tr_b16 a[238:239], v29 offset:18432
    v_cvt_pk_bf16_f32 v242, v208, v209
    v_mfma_f32_16x16x32_bf16 v[176:179], a[208:211], v[96:99], v[176:179]
    v_add_f32 v37, v37, v220
    v_cvt_pk_bf16_f32 v243, v210, v211
    v_mfma_f32_16x16x32_bf16 v[176:179], a[212:215], v[112:115], v[176:179]
    s_waitcnt lgkmcnt(4)
    v_exp_f32 v221, v221
    v_mfma_f32_16x16x32_bf16 v[176:179], a[216:219], v[128:131], v[176:179]
    ds_read_b64_tr_b16 a[240:241], v26 offset:12416
    v_cvt_pk_bf16_f32 v246, v212, v213
    v_mfma_f32_16x16x32_bf16 v[176:179], a[220:223], v[144:147], v[176:179]
    ds_read_b64_tr_b16 a[242:243], v26 offset:18560
    v_add_f32 v37, v37, v221
    v_mfma_f32_16x16x32_bf16 v[180:183], a[200:203], v[68:71], v[228:231]
    s_add_u32 m0, s42, 49152
    s_nop 0
    buffer_load_dwordx4 v10, s[8:11], s43 offen offset:0 nt lds
    v_mfma_f32_16x16x32_bf16 v[180:183], a[204:207], v[84:87], v[180:183]
    v_cvt_pk_bf16_f32 v247, v214, v215
    v_cvt_pk_bf16_f32 v250, v216, v217
    v_mfma_f32_16x16x32_bf16 v[180:183], a[208:211], v[100:103], v[180:183]
    v_exp_f32 v222, v222
    v_mfma_f32_16x16x32_bf16 v[180:183], a[212:215], v[116:119], v[180:183]
    ds_read_b64_tr_b16 a[244:245], v27 offset:12416
    v_add_f32 v37, v37, v222
    v_mfma_f32_16x16x32_bf16 v[180:183], a[216:219], v[132:135], v[180:183]
    ds_read_b64_tr_b16 a[246:247], v27 offset:18560
    v_cvt_pk_bf16_f32 v251, v218, v219
    v_mfma_f32_16x16x32_bf16 v[180:183], a[220:223], v[148:151], v[180:183]
    v_exp_f32 v223, v223
    v_mfma_f32_16x16x32_bf16 v[184:187], a[200:203], v[72:75], v[232:235]
    ds_read_b64_tr_b16 a[248:249], v28 offset:12416
    v_cvt_pk_bf16_f32 v254, v220, v221
    v_mfma_f32_16x16x32_bf16 v[184:187], a[204:207], v[88:91], v[184:187]
    ds_read_b64_tr_b16 a[250:251], v28 offset:18560
    v_add_f32 v37, v37, v223
    v_mfma_f32_16x16x32_bf16 v[184:187], a[208:211], v[104:107], v[184:187]
    v_cvt_pk_bf16_f32 v255, v222, v223
    v_mfma_f32_16x16x32_bf16 v[184:187], a[212:215], v[120:123], v[184:187]
    v_mfma_f32_16x16x32_bf16 v[184:187], a[216:219], v[136:139], v[184:187]
    buffer_load_dwordx4 v11, s[8:11], s43 offen offset:1024 nt lds
    v_mfma_f32_16x16x32_bf16 v[184:187], a[220:223], v[152:155], v[184:187]
    ds_read_b64_tr_b16 a[252:253], v29 offset:12416
    v_mfma_f32_16x16x32_bf16 v[188:191], a[200:203], v[76:79], v[236:239]
    ds_read_b64_tr_b16 a[254:255], v29 offset:18560
    v_mfma_f32_16x16x32_bf16 v[188:191], a[204:207], v[92:95], v[188:191]
    v_mfma_f32_16x16x32_bf16 v[188:191], a[208:211], v[108:111], v[188:191]
    ds_read_b64_tr_b16 a[192:193], v26 offset:12544
    v_mfma_f32_16x16x32_bf16 v[188:191], a[212:215], v[124:127], v[188:191]
    ds_read_b64_tr_b16 a[194:195], v26 offset:18688
    v_mfma_f32_16x16x32_bf16 v[188:191], a[216:219], v[140:143], v[188:191]
    v_mfma_f32_16x16x32_bf16 v[188:191], a[220:223], v[156:159], v[188:191]
    v_mfma_f32_16x16x32_bf16 a[0:3], a[224:227], v[240:243], a[0:3]
    v_exp_f32 v160, v160
    v_mfma_f32_16x16x32_bf16 a[4:7], a[224:227], v[244:247], a[4:7]
    v_exp_f32 v161, v161
    v_mfma_f32_16x16x32_bf16 a[8:11], a[224:227], v[248:251], a[8:11]
    buffer_load_dwordx4 v12, s[8:11], s43 offen offset:2048 nt lds
    v_mfma_f32_16x16x32_bf16 a[12:15], a[224:227], v[252:255], a[12:15]
    ds_read_b64_tr_b16 a[196:197], v27 offset:12544
    v_add_f32 v34, v34, v160
    v_mfma_f32_16x16x32_bf16 a[28:31], a[228:231], v[252:255], a[28:31]
    v_exp_f32 v162, v162
    v_mfma_f32_16x16x32_bf16 a[24:27], a[228:231], v[248:251], a[24:27]
    ds_read_b64_tr_b16 a[198:199], v27 offset:18688
    v_add_f32 v34, v34, v161
    v_mfma_f32_16x16x32_bf16 a[20:23], a[228:231], v[244:247], a[20:23]
    v_exp_f32 v163, v163
    v_mfma_f32_16x16x32_bf16 a[16:19], a[228:231], v[240:243], a[16:19]
    s_waitcnt lgkmcnt(2)
    ds_read_b64_tr_b16 a[200:201], v28 offset:12544
    v_add_f32 v34, v34, v162
    v_mfma_f32_16x16x32_bf16 a[32:35], a[232:235], v[240:243], a[32:35]
    v_exp_f32 v164, v164
    v_mfma_f32_16x16x32_bf16 a[36:39], a[232:235], v[244:247], a[36:39]
    ds_read_b64_tr_b16 a[202:203], v28 offset:18688
    v_add_f32 v34, v34, v163
    v_mfma_f32_16x16x32_bf16 a[40:43], a[232:235], v[248:251], a[40:43]
    v_exp_f32 v165, v165
    v_mfma_f32_16x16x32_bf16 a[44:47], a[232:235], v[252:255], a[44:47]
    ds_read_b64_tr_b16 a[204:205], v29 offset:12544
    v_add_f32 v35, v35, v164
    v_mfma_f32_16x16x32_bf16 a[60:63], a[236:239], v[252:255], a[60:63]
    buffer_load_dwordx4 v13, s[8:11], s43 offen offset:3072 nt lds
    v_mfma_f32_16x16x32_bf16 a[56:59], a[236:239], v[248:251], a[56:59]
    ds_read_b64_tr_b16 a[206:207], v29 offset:18688
    v_add_u32 v26, 122880, v22
    v_mfma_f32_16x16x32_bf16 a[52:55], a[236:239], v[244:247], a[52:55]
    v_exp_f32 v166, v166
    v_mfma_f32_16x16x32_bf16 a[48:51], a[236:239], v[240:243], a[48:51]
    v_add_u32 v27, 122880, v23
    v_add_u32 v28, 122880, v24
    v_mfma_f32_16x16x32_bf16 a[64:67], a[240:243], v[240:243], a[64:67]
    v_exp_f32 v167, v167
    v_mfma_f32_16x16x32_bf16 a[68:71], a[240:243], v[244:247], a[68:71]
    v_add_u32 v29, 122880, v25
    v_add_f32 v35, v35, v165
    v_mfma_f32_16x16x32_bf16 a[72:75], a[240:243], v[248:251], a[72:75]
    ds_read_b128 a[208:211], v32 offset:12288
    v_add_f32 v35, v35, v166
    v_mfma_f32_16x16x32_bf16 a[76:79], a[240:243], v[252:255], a[76:79]
    ds_read_b128 a[212:215], v33 offset:12288
    v_add_f32 v35, v35, v167
    v_mfma_f32_16x16x32_bf16 a[92:95], a[244:247], v[252:255], a[92:95]
    s_add_u32 m0, m0, 4096
    v_exp_f32 v168, v168
    v_mfma_f32_16x16x32_bf16 a[88:91], a[244:247], v[248:251], a[88:91]
    ds_read_b128 a[216:219], v32 offset:12416
    v_add_f32 v36, v36, v168
    v_mfma_f32_16x16x32_bf16 a[84:87], a[244:247], v[244:247], a[84:87]
    buffer_load_dwordx4 v14, s[8:11], s43 offen offset:0 nt lds
    v_mfma_f32_16x16x32_bf16 a[80:83], a[244:247], v[240:243], a[80:83]
    v_exp_f32 v169, v169
    v_mfma_f32_16x16x32_bf16 a[96:99], a[248:251], v[240:243], a[96:99]
    ds_read_b128 a[220:223], v33 offset:12416
    v_add_f32 v36, v36, v169
    v_mfma_f32_16x16x32_bf16 a[100:103], a[248:251], v[244:247], a[100:103]
    v_exp_f32 v170, v170
    v_mfma_f32_16x16x32_bf16 a[104:107], a[248:251], v[248:251], a[104:107]
    ds_read_b128 a[224:227], v32 offset:12544
    v_add_f32 v36, v36, v170
    v_mfma_f32_16x16x32_bf16 a[108:111], a[248:251], v[252:255], a[108:111]
    v_exp_f32 v171, v171
    v_mfma_f32_16x16x32_bf16 a[124:127], a[252:255], v[252:255], a[124:127]
    ds_read_b128 a[228:231], v33 offset:12544
    v_add_f32 v36, v36, v171
    v_mfma_f32_16x16x32_bf16 a[120:123], a[252:255], v[248:251], a[120:123]
    v_exp_f32 v172, v172
    v_mfma_f32_16x16x32_bf16 a[116:119], a[252:255], v[244:247], a[116:119]
    v_exp_f32 v173, v173
    v_mfma_f32_16x16x32_bf16 a[112:115], a[252:255], v[240:243], a[112:115]
    v_exp_f32 v174, v174
    v_mfma_f32_16x16x32_bf16 a[128:131], a[192:195], v[240:243], a[128:131]
    buffer_load_dwordx4 v15, s[8:11], s43 offen offset:1024 nt lds
    v_mfma_f32_16x16x32_bf16 a[132:135], a[192:195], v[244:247], a[132:135]
    v_exp_f32 v175, v175
    v_mfma_f32_16x16x32_bf16 a[136:139], a[192:195], v[248:251], a[136:139]
    v_exp_f32 v176, v176
    v_mfma_f32_16x16x32_bf16 a[140:143], a[192:195], v[252:255], a[140:143]
    s_waitcnt lgkmcnt(1)
    v_add_f32 v37, v37, v172
    v_add_f32 v37, v37, v173
    v_mfma_f32_16x16x32_bf16 a[156:159], a[196:199], v[252:255], a[156:159]
    ds_read_b128 a[232:235], v32 offset:18432
    v_add_f32 v37, v37, v174
    v_mfma_f32_16x16x32_bf16 a[152:155], a[196:199], v[248:251], a[152:155]
WS6:
    s_cbranch_execz WS2
    ds_read_b128 a[236:239], v33 offset:18432
    v_add_f32 v37, v37, v175
    v_mfma_f32_16x16x32_bf16 a[148:151], a[196:199], v[244:247], a[148:151]
    ds_read_b128 a[240:243], v32 offset:18560
    v_add_f32 v34, v34, v176
    v_mfma_f32_16x16x32_bf16 a[144:147], a[196:199], v[240:243], a[144:147]
    ds_read_b128 a[244:247], v33 offset:18560
    v_mfma_f32_16x16x32_bf16 a[160:163], a[200:203], v[240:243], a[160:163]
    s_add_u32 s43, s43, 24576
    ds_read_b128 a[248:251], v32 offset:18688
    v_mfma_f32_16x16x32_bf16 a[164:167], a[200:203], v[244:247], a[164:167]
    v_exp_f32 v177, v177
    v_mfma_f32_16x16x32_bf16 a[168:171], a[200:203], v[248:251], a[168:171]
    ds_read_b128 a[252:255], v33 offset:18688
    v_add_f32 v34, v34, v177
    v_mfma_f32_16x16x32_bf16 a[172:175], a[200:203], v[252:255], a[172:175]
    v_exp_f32 v178, v178
    v_mfma_f32_16x16x32_bf16 a[188:191], a[204:207], v[252:255], a[188:191]
    buffer_load_dword v60, v50, s[16:19], s56 offen sc1
    v_mfma_f32_16x16x32_bf16 a[184:187], a[204:207], v[248:251], a[184:187]
    s_add_u32 s56, s56, 2048
    v_exp_f32 v179, v179
    v_mfma_f32_16x16x32_bf16 a[180:183], a[204:207], v[244:247], a[180:183]
    v_exp_f32 v180, v180
    v_mfma_f32_16x16x32_bf16 a[176:179], a[204:207], v[240:243], a[176:179]
    v_exp_f32 v181, v181
    v_mfma_f32_16x16x32_bf16 v[192:195], a[208:211], v[64:67], v[224:227]
    v_add_f32 v34, v34, v178
    v_add_f32 v34, v34, v179
    v_mfma_f32_16x16x32_bf16 v[192:195], a[212:215], v[80:83], v[192:195]
    v_exp_f32 v182, v182
    v_mfma_f32_16x16x32_bf16 v[192:195], a[216:219], v[96:99], v[192:195]
    v_add_f32 v35, v35, v180
    v_add_f32 v35, v35, v181
    v_mfma_f32_16x16x32_bf16 v[192:195], a[220:223], v[112:115], v[192:195]
    v_exp_f32 v183, v183
    v_mfma_f32_16x16x32_bf16 v[192:195], a[224:227], v[128:131], v[192:195]
    s_waitcnt lgkmcnt(0)
    v_exp_f32 v184, v184
    v_mfma_f32_16x16x32_bf16 v[192:195], a[228:231], v[144:147], v[192:195]
    v_add_f32 v35, v35, v182
    v_cvt_pk_bf16_f32 v240, v160, v161
    v_mfma_f32_16x16x32_bf16 v[196:199], a[208:211], v[68:71], v[228:231]
    v_add_u32 v32, 0, v30
    v_add_u32 v33, 0, v31
    v_mfma_f32_16x16x32_bf16 v[196:199], a[212:215], v[84:87], v[196:199]
    v_exp_f32 v185, v185
    v_mfma_f32_16x16x32_bf16 v[196:199], a[216:219], v[100:103], v[196:199]
    v_add_f32 v35, v35, v183
    v_cvt_pk_bf16_f32 v241, v162, v163
    v_mfma_f32_16x16x32_bf16 v[196:199], a[220:223], v[116:119], v[196:199]
    v_cvt_pk_bf16_f32 v244, v164, v165
    v_add_f32 v36, v36, v184
    v_mfma_f32_16x16x32_bf16 v[196:199], a[224:227], v[132:135], v[196:199]
    v_exp_f32 v186, v186
    v_mfma_f32_16x16x32_bf16 v[196:199], a[228:231], v[148:151], v[196:199]
    v_cvt_pk_bf16_f32 v245, v166, v167
    v_add_f32 v36, v36, v185
    v_mfma_f32_16x16x32_bf16 v[200:203], a[208:211], v[72:75], v[232:235]
    v_cvt_pk_bf16_f32 v248, v168, v169
    v_cvt_pk_bf16_f32 v249, v170, v171
    v_mfma_f32_16x16x32_bf16 v[200:203], a[212:215], v[88:91], v[200:203]
    v_exp_f32 v187, v187
    v_mfma_f32_16x16x32_bf16 v[200:203], a[216:219], v[104:107], v[200:203]
    s_waitcnt vmcnt(16)
    s_waitcnt lgkmcnt(0)
    s_barrier
    v_mfma_f32_16x16x32_bf16 v[200:203], a[220:223], v[120:123], v[200:203]
    buffer_store_dword v49, v43, s[16:19], 0 offen offset:4 sc1
    v_mfma_f32_16x16x32_bf16 v[200:203], a[224:227], v[136:139], v[200:203]
    ds_read_b64_tr_b16 v[52:53], v41 offset:0
    v_add_f32 v36, v36, v186
    v_mfma_f32_16x16x32_bf16 v[200:203], a[228:231], v[152:155], v[200:203]
    ds_read_b64_tr_b16 v[54:55], v41 offset:1024
    v_cvt_pk_bf16_f32 v252, v172, v173
    v_mfma_f32_16x16x32_bf16 v[204:207], a[208:211], v[76:79], v[236:239]
    ds_read_b64_tr_b16 v[56:57], v41 offset:32
    v_cvt_pk_bf16_f32 v253, v174, v175
    v_mfma_f32_16x16x32_bf16 v[204:207], a[212:215], v[92:95], v[204:207]
    ds_read_b64_tr_b16 v[58:59], v41 offset:1056
    v_add_f32 v36, v36, v187
    v_mfma_f32_16x16x32_bf16 v[204:207], a[216:219], v[108:111], v[204:207]
    ds_read_b64_tr_b16 a[192:193], v26 offset:0
    v_cvt_pk_bf16_f32 v242, v176, v177
    v_mfma_f32_16x16x32_bf16 v[204:207], a[220:223], v[124:127], v[204:207]
    ds_read_b64_tr_b16 a[194:195], v26 offset:6144
    v_cvt_pk_bf16_f32 v243, v178, v179
    v_mfma_f32_16x16x32_bf16 v[204:207], a[224:227], v[140:143], v[204:207]
    ds_read_b64_tr_b16 a[196:197], v27 offset:0
    v_cvt_pk_bf16_f32 v246, v180, v181
    v_mfma_f32_16x16x32_bf16 v[204:207], a[228:231], v[156:159], v[204:207]
    ds_read_b64_tr_b16 a[198:199], v27 offset:6144
    v_cvt_pk_bf16_f32 v247, v182, v183
    v_mfma_f32_16x16x32_bf16 v[208:211], a[232:235], v[64:67], v[224:227]
    ds_read_b64_tr_b16 a[200:201], v28 offset:0
    v_cvt_pk_bf16_f32 v250, v184, v185
    v_mfma_f32_16x16x32_bf16 v[208:211], a[236:239], v[80:83], v[208:211]
    ds_read_b64_tr_b16 a[202:203], v28 offset:6144
    v_cvt_pk_bf16_f32 v251, v186, v187
    v_mfma_f32_16x16x32_bf16 v[208:211], a[240:243], v[96:99], v[208:211]
    v_exp_f32 v188, v188
    v_mfma_f32_16x16x32_bf16 v[208:211], a[244:247], v[112:115], v[208:211]
    ds_read_b64_tr_b16 a[204:205], v29 offset:0
    v_add_f32 v37, v37, v188
    v_mfma_f32_16x16x32_bf16 v[208:211], a[248:251], v[128:131], v[208:211]
    s_waitcnt lgkmcnt(7)
    buffer_store_dwordx4 v[52:55], v1, s[28:31], s51 offen offset:0 sc1
    v_mfma_f32_16x16x32_bf16 v[208:211], a[252:255], v[144:147], v[208:211]
    v_exp_f32 v189, v189
    v_mfma_f32_16x16x32_bf16 v[212:215], a[232:235], v[68:71], v[228:231]
    ds_read_b64_tr_b16 a[206:207], v29 offset:6144
    v_add_f32 v37, v37, v189
    v_mfma_f32_16x16x32_bf16 v[212:215], a[236:239], v[84:87], v[212:215]
    ds_read_b64_tr_b16 a[208:209], v26 offset:128
    v_cvt_pk_bf16_f32 v254, v188, v189
    v_mfma_f32_16x16x32_bf16 v[212:215], a[240:243], v[100:103], v[212:215]
    buffer_store_dwordx4 v[56:59], v1, s[28:31], s51 offen offset:1024 sc1
    v_mfma_f32_16x16x32_bf16 v[212:215], a[244:247], v[116:119], v[212:215]
    v_exp_f32 v190, v190
    v_mfma_f32_16x16x32_bf16 v[212:215], a[248:251], v[132:135], v[212:215]
    s_add_u32 s51, s51, 1966080
    ds_read_b64_tr_b16 a[210:211], v26 offset:6272
    v_xor_b32 v41, 2048, v41
    v_mfma_f32_16x16x32_bf16 v[212:215], a[252:255], v[148:151], v[212:215]
    s_mov_b32 m0, s52
    ds_read_b64_tr_b16 a[212:213], v27 offset:128
    v_add_f32 v37, v37, v190
    v_mfma_f32_16x16x32_bf16 v[216:219], a[232:235], v[72:75], v[232:235]
    buffer_load_dwordx4 v39, s[24:27], s50 offen nt lds
    v_mfma_f32_16x16x32_bf16 v[216:219], a[236:239], v[88:91], v[216:219]
    v_exp_f32 v191, v191
    v_mfma_f32_16x16x32_bf16 v[216:219], a[240:243], v[104:107], v[216:219]
    ds_read_b64_tr_b16 a[214:215], v27 offset:6272
    v_add_f32 v37, v37, v191
    v_mfma_f32_16x16x32_bf16 v[216:219], a[244:247], v[120:123], v[216:219]
    ds_read_b64_tr_b16 a[216:217], v28 offset:128
    v_cvt_pk_bf16_f32 v255, v190, v191
    v_mfma_f32_16x16x32_bf16 v[216:219], a[248:251], v[136:139], v[216:219]
    ds_read_b64_tr_b16 a[218:219], v28 offset:6272
    v_mfma_f32_16x16x32_bf16 v[216:219], a[252:255], v[152:155], v[216:219]
    buffer_load_dwordx4 v40, s[24:27], s50 offen offset:1024 nt lds
    v_mfma_f32_16x16x32_bf16 v[220:223], a[232:235], v[76:79], v[236:239]
    s_xor_b32 s52, s52, 2048
    ds_read_b64_tr_b16 a[220:221], v29 offset:128
    s_add_u32 s50, s50, 1966080
    v_mfma_f32_16x16x32_bf16 v[220:223], a[236:239], v[92:95], v[220:223]
    ds_read_b64_tr_b16 a[222:223], v29 offset:6272
    v_mfma_f32_16x16x32_bf16 v[220:223], a[240:243], v[108:111], v[220:223]
    v_mfma_f32_16x16x32_bf16 v[220:223], a[244:247], v[124:127], v[220:223]
    v_mfma_f32_16x16x32_bf16 v[220:223], a[248:251], v[140:143], v[220:223]
    v_mfma_f32_16x16x32_bf16 v[220:223], a[252:255], v[156:159], v[220:223]
ATT_LOOP:
    ds_read_b64_tr_b16 a[224:225], v26 offset:256
    s_waitcnt lgkmcnt(5)
    v_mfma_f32_16x16x32_bf16 a[0:3], a[192:195], v[240:243], a[0:3]
    v_exp_f32 v192, v192
    v_mfma_f32_16x16x32_bf16 a[4:7], a[192:195], v[244:247], a[4:7]
    v_exp_f32 v193, v193
    v_mfma_f32_16x16x32_bf16 a[8:11], a[192:195], v[248:251], a[8:11]
    v_exp_f32 v194, v194
    v_mfma_f32_16x16x32_bf16 a[12:15], a[192:195], v[252:255], a[12:15]
    v_exp_f32 v195, v195
    v_mfma_f32_16x16x32_bf16 a[28:31], a[196:199], v[252:255], a[28:31]
    v_exp_f32 v196, v196
    v_mfma_f32_16x16x32_bf16 a[24:27], a[196:199], v[248:251], a[24:27]
    v_exp_f32 v197, v197
    v_mfma_f32_16x16x32_bf16 a[20:23], a[196:199], v[244:247], a[20:23]
    s_add_u32 m0, s47, s7
    s_nop 0
    buffer_load_dwordx4 v16, s[12:15], s44 offen offset:0 nt lds
    v_mfma_f32_16x16x32_bf16 a[16:19], a[196:199], v[240:243], a[16:19]
    v_exp_f32 v198, v198
    v_mfma_f32_16x16x32_bf16 a[32:35], a[200:203], v[240:243], a[32:35]
    ds_read_b64_tr_b16 a[226:227], v26 offset:6400
    v_add_f32 v34, v34, v192
    v_mfma_f32_16x16x32_bf16 a[36:39], a[200:203], v[244:247], a[36:39]
    v_exp_f32 v199, v199
    v_mfma_f32_16x16x32_bf16 a[40:43], a[200:203], v[248:251], a[40:43]
    ds_read_b64_tr_b16 a[228:229], v27 offset:256
    v_add_f32 v34, v34, v193
    v_mfma_f32_16x16x32_bf16 a[44:47], a[200:203], v[252:255], a[44:47]
    ds_read_b64_tr_b16 a[230:231], v27 offset:6400
    v_add_f32 v34, v34, v194
    v_mfma_f32_16x16x32_bf16 a[60:63], a[204:207], v[252:255], a[60:63]
    v_exp_f32 v200, v200
    v_mfma_f32_16x16x32_bf16 a[56:59], a[204:207], v[248:251], a[56:59]
    ds_read_b64_tr_b16 a[232:233], v28 offset:256
    v_add_f32 v34, v34, v195
    v_mfma_f32_16x16x32_bf16 a[52:55], a[204:207], v[244:247], a[52:55]
    v_exp_f32 v201, v201
    v_mfma_f32_16x16x32_bf16 a[48:51], a[204:207], v[240:243], a[48:51]
    ds_read_b64_tr_b16 a[234:235], v28 offset:6400
    v_add_f32 v35, v35, v196
    v_mfma_f32_16x16x32_bf16 a[64:67], a[208:211], v[240:243], a[64:67]
    v_exp_f32 v202, v202
    v_mfma_f32_16x16x32_bf16 a[68:71], a[208:211], v[244:247], a[68:71]
    buffer_load_dwordx4 v17, s[12:15], s44 offen offset:1024 nt lds
    v_mfma_f32_16x16x32_bf16 a[72:75], a[208:211], v[248:251], a[72:75]
    ds_read_b64_tr_b16 a[236:237], v29 offset:256
    v_add_f32 v35, v35, v197
    v_mfma_f32_16x16x32_bf16 a[76:79], a[208:211], v[252:255], a[76:79]
    ds_read_b64_tr_b16 a[238:239], v29 offset:6400
    v_add_f32 v35, v35, v198
    v_mfma_f32_16x16x32_bf16 a[92:95], a[212:215], v[252:255], a[92:95]
    v_exp_f32 v203, v203
    v_mfma_f32_16x16x32_bf16 a[88:91], a[212:215], v[248:251], a[88:91]
    ds_read_b128 a[240:243], v32 offset:0
    v_add_f32 v35, v35, v199
    v_mfma_f32_16x16x32_bf16 a[84:87], a[212:215], v[244:247], a[84:87]
    v_exp_f32 v204, v204
    v_mfma_f32_16x16x32_bf16 a[80:83], a[212:215], v[240:243], a[80:83]
    s_waitcnt lgkmcnt(4)
    ds_read_b128 a[244:247], v33 offset:0
    v_add_f32 v36, v36, v200
    v_mfma_f32_16x16x32_bf16 a[96:99], a[216:219], v[240:243], a[96:99]
    ds_read_b128 a[248:251], v32 offset:128
    v_add_f32 v36, v36, v201
    v_mfma_f32_16x16x32_bf16 a[100:103], a[216:219], v[244:247], a[100:103]
    ds_read_b128 a[252:255], v33 offset:128
    v_add_f32 v36, v36, v202
    v_mfma_f32_16x16x32_bf16 a[104:107], a[216:219], v[248:251], a[104:107]
    v_exp_f32 v205, v205
    v_mfma_f32_16x16x32_bf16 a[108:111], a[216:219], v[252:255], a[108:111]
    ds_read_b128 a[192:195], v32 offset:256
    v_add_f32 v36, v36, v203
    v_mfma_f32_16x16x32_bf16 a[124:127], a[220:223], v[252:255], a[124:127]
    buffer_load_dwordx4 v18, s[12:15], s44 offen offset:2048 nt lds
    v_mfma_f32_16x16x32_bf16 a[120:123], a[220:223], v[248:251], a[120:123]
    ds_read_b128 a[196:199], v33 offset:256
    v_add_f32 v37, v37, v204
    v_mfma_f32_16x16x32_bf16 a[116:119], a[220:223], v[244:247], a[116:119]
    v_exp_f32 v206, v206
    v_mfma_f32_16x16x32_bf16 a[112:115], a[220:223], v[240:243], a[112:115]
    v_exp_f32 v207, v207
    v_mfma_f32_16x16x32_bf16 a[128:131], a[224:227], v[240:243], a[128:131]
    v_exp_f32 v208, v208
    v_mfma_f32_16x16x32_bf16 a[132:135], a[224:227], v[244:247], a[132:135]
    v_add_f32 v37, v37, v205
    v_add_f32 v37, v37, v206
    v_mfma_f32_16x16x32_bf16 a[136:139], a[224:227], v[248:251], a[136:139]
    v_exp_f32 v209, v209
    v_mfma_f32_16x16x32_bf16 a[140:143], a[224:227], v[252:255], a[140:143]
    v_exp_f32 v210, v210
    v_mfma_f32_16x16x32_bf16 a[156:159], a[228:231], v[252:255], a[156:159]
    ds_read_b128 a[200:203], v32 offset:6144
    v_add_f32 v37, v37, v207
    v_mfma_f32_16x16x32_bf16 a[152:155], a[228:231], v[248:251], a[152:155]
    v_exp_f32 v211, v211
    v_mfma_f32_16x16x32_bf16 a[148:151], a[228:231], v[244:247], a[148:151]
    ds_read_b128 a[204:207], v33 offset:6144
    v_add_f32 v34, v34, v208
    v_mfma_f32_16x16x32_bf16 a[144:147], a[228:231], v[240:243], a[144:147]
    s_waitcnt lgkmcnt(2)
    buffer_load_dwordx4 v19, s[12:15], s44 offen offset:3072 nt lds
    v_mfma_f32_16x16x32_bf16 a[160:163], a[232:235], v[240:243], a[160:163]
    ds_read_b128 a[208:211], v32 offset:6272
    v_add_u32 v49, 1, v49
    v_mfma_f32_16x16x32_bf16 a[164:167], a[232:235], v[244:247], a[164:167]
    v_exp_f32 v212, v212
    v_mfma_f32_16x16x32_bf16 a[168:171], a[232:235], v[248:251], a[168:171]
    ds_read_b128 a[212:215], v33 offset:6272
    v_add_f32 v34, v34, v209
    v_mfma_f32_16x16x32_bf16 a[172:175], a[232:235], v[252:255], a[172:175]
    ds_read_b128 a[216:219], v32 offset:6400
    v_add_f32 v34, v34, v210
    v_mfma_f32_16x16x32_bf16 a[188:191], a[236:239], v[252:255], a[188:191]
    buffer_load_dword v60, v50, s[16:19], s56 offen sc1
    v_mfma_f32_16x16x32_bf16 a[184:187], a[236:239], v[248:251], a[184:187]
    s_add_u32 s56, s56, 2048
    v_exp_f32 v213, v213
    v_mfma_f32_16x16x32_bf16 a[180:183], a[236:239], v[244:247], a[180:183]
    s_min_u32 s56, s56, s84
    ds_read_b128 a[220:223], v33 offset:6400
    v_add_f32 v34, v34, v211
    v_mfma_f32_16x16x32_bf16 a[176:179], a[236:239], v[240:243], a[176:179]
    v_exp_f32 v214, v214
    v_mfma_f32_16x16x32_bf16 v[160:163], a[240:243], v[64:67], v[224:227]
    s_add_u32 m0, m0, 4096
    v_add_f32 v35, v35, v212
    v_add_f32 v35, v35, v213
    v_mfma_f32_16x16x32_bf16 v[160:163], a[244:247], v[80:83], v[160:163]
    v_exp_f32 v215, v215
    v_mfma_f32_16x16x32_bf16 v[160:163], a[248:251], v[96:99], v[160:163]
    buffer_load_dwordx4 v20, s[12:15], s44 offen offset:0 nt lds
    v_mfma_f32_16x16x32_bf16 v[160:163], a[252:255], v[112:115], v[160:163]
    v_exp_f32 v216, v216
    v_mfma_f32_16x16x32_bf16 v[160:163], a[192:195], v[128:131], v[160:163]
    v_add_f32 v35, v35, v214
    v_add_f32 v35, v35, v215
    v_mfma_f32_16x16x32_bf16 v[160:163], a[196:199], v[144:147], v[160:163]
    v_exp_f32 v217, v217
    v_mfma_f32_16x16x32_bf16 v[164:167], a[240:243], v[68:71], v[228:231]
    v_add_f32 v36, v36, v216
    v_cvt_pk_bf16_f32 v240, v192, v193
    v_mfma_f32_16x16x32_bf16 v[164:167], a[244:247], v[84:87], v[164:167]
    v_exp_f32 v218, v218
    v_mfma_f32_16x16x32_bf16 v[164:167], a[248:251], v[100:103], v[164:167]
    v_cvt_pk_bf16_f32 v241, v194, v195
    v_add_f32 v36, v36, v217
    v_mfma_f32_16x16x32_bf16 v[164:167], a[252:255], v[116:119], v[164:167]
    v_cvt_pk_bf16_f32 v244, v196, v197
    v_cvt_pk_bf16_f32 v245, v198, v199
    v_mfma_f32_16x16x32_bf16 v[164:167], a[192:195], v[132:135], v[164:167]
    v_exp_f32 v219, v219
    v_mfma_f32_16x16x32_bf16 v[164:167], a[196:199], v[148:151], v[164:167]
    v_add_f32 v36, v36, v218
    v_cvt_pk_bf16_f32 v248, v200, v201
    v_mfma_f32_16x16x32_bf16 v[168:171], a[240:243], v[72:75], v[232:235]
    ds_read_b64_tr_b16 a[224:225], v26 offset:12288
    v_cvt_pk_bf16_f32 v249, v202, v203
    v_mfma_f32_16x16x32_bf16 v[168:171], a[244:247], v[88:91], v[168:171]
    buffer_load_dwordx4 v21, s[12:15], s44 offen offset:1024 nt lds
    v_mfma_f32_16x16x32_bf16 v[168:171], a[248:251], v[104:107], v[168:171]
    v_exp_f32 v220, v220
    v_mfma_f32_16x16x32_bf16 v[168:171], a[252:255], v[120:123], v[168:171]
    ds_read_b64_tr_b16 a[226:227], v26 offset:18432
    v_add_f32 v36, v36, v219
    v_mfma_f32_16x16x32_bf16 v[168:171], a[192:195], v[136:139], v[168:171]
    ds_read_b64_tr_b16 a[228:229], v27 offset:12288
    v_cvt_pk_bf16_f32 v252, v204, v205
    v_mfma_f32_16x16x32_bf16 v[168:171], a[196:199], v[152:155], v[168:171]
    ds_read_b64_tr_b16 a[230:231], v27 offset:18432
    v_cvt_pk_bf16_f32 v253, v206, v207
    v_mfma_f32_16x16x32_bf16 v[172:175], a[240:243], v[76:79], v[236:239]
    v_cvt_pk_bf16_f32 v242, v208, v209
    v_add_f32 v37, v37, v220
    v_mfma_f32_16x16x32_bf16 v[172:175], a[244:247], v[92:95], v[172:175]
    v_exp_f32 v221, v221
    v_mfma_f32_16x16x32_bf16 v[172:175], a[248:251], v[108:111], v[172:175]
    ds_read_b64_tr_b16 a[232:233], v28 offset:12288
    v_cvt_pk_bf16_f32 v243, v210, v211
    v_mfma_f32_16x16x32_bf16 v[172:175], a[252:255], v[124:127], v[172:175]
    ds_read_b64_tr_b16 a[234:235], v28 offset:18432
    v_cvt_pk_bf16_f32 v246, v212, v213
    v_mfma_f32_16x16x32_bf16 v[172:175], a[192:195], v[140:143], v[172:175]
    s_add_u32 s44, s44, 24576
    v_add_f32 v37, v37, v221
    v_cvt_pk_bf16_f32 v247, v214, v215
    v_mfma_f32_16x16x32_bf16 v[172:175], a[196:199], v[156:159], v[172:175]
    s_waitcnt lgkmcnt(5)
    v_exp_f32 v222, v222
    v_mfma_f32_16x16x32_bf16 v[176:179], a[200:203], v[64:67], v[224:227]
    ds_read_b64_tr_b16 a[236:237], v29 offset:12288
    v_cvt_pk_bf16_f32 v250, v216, v217
    v_mfma_f32_16x16x32_bf16 v[176:179], a[204:207], v[80:83], v[176:179]
    ds_read_b64_tr_b16 a[238:239], v29 offset:18432
    v_add_f32 v37, v37, v222
    v_mfma_f32_16x16x32_bf16 v[176:179], a[208:211], v[96:99], v[176:179]
    v_cvt_pk_bf16_f32 v251, v218, v219
    v_cvt_pk_bf16_f32 v254, v220, v221
    v_mfma_f32_16x16x32_bf16 v[176:179], a[212:215], v[112:115], v[176:179]
    v_exp_f32 v223, v223
    v_mfma_f32_16x16x32_bf16 v[176:179], a[216:219], v[128:131], v[176:179]
    ds_read_b64_tr_b16 a[240:241], v26 offset:12416
    v_add_f32 v37, v37, v223
    v_mfma_f32_16x16x32_bf16 v[176:179], a[220:223], v[144:147], v[176:179]
    ds_read_b64_tr_b16 a[242:243], v26 offset:18560
    v_cvt_pk_bf16_f32 v255, v222, v223
    v_mfma_f32_16x16x32_bf16 v[180:183], a[200:203], v[68:71], v[228:231]
    s_add_u32 m0, s45, s42
    s_nop 0
    buffer_load_dwordx4 v10, s[8:11], s43 offen offset:0 nt lds
    v_mfma_f32_16x16x32_bf16 v[180:183], a[204:207], v[84:87], v[180:183]
    s_cmp_eq_u32 s48, 6
    s_cselect_b32 s24, s80, s24
    s_cselect_b32 s25, s90, s25
    v_mfma_f32_16x16x32_bf16 v[180:183], a[208:211], v[100:103], v[180:183]
    ds_read_b64_tr_b16 a[244:245], v27 offset:12416
    v_mfma_f32_16x16x32_bf16 v[180:183], a[212:215], v[116:119], v[180:183]
    ds_read_b64_tr_b16 a[246:247], v27 offset:18560
    v_mfma_f32_16x16x32_bf16 v[180:183], a[216:219], v[132:135], v[180:183]
    s_cmp_eq_u32 s48, 6
    s_cselect_b32 s26, s91, s26
    s_cselect_b32 s50, s92, s50
    v_mfma_f32_16x16x32_bf16 v[180:183], a[220:223], v[148:151], v[180:183]
    v_mfma_f32_16x16x32_bf16 v[184:187], a[200:203], v[72:75], v[232:235]
    ds_read_b64_tr_b16 a[248:249], v28 offset:12416
    v_mfma_f32_16x16x32_bf16 v[184:187], a[204:207], v[88:91], v[184:187]
    ds_read_b64_tr_b16 a[250:251], v28 offset:18560
    v_mfma_f32_16x16x32_bf16 v[184:187], a[208:211], v[104:107], v[184:187]
    v_mfma_f32_16x16x32_bf16 v[184:187], a[212:215], v[120:123], v[184:187]
    v_mfma_f32_16x16x32_bf16 v[184:187], a[216:219], v[136:139], v[184:187]
    ds_read_b64_tr_b16 a[252:253], v29 offset:12416
    v_mfma_f32_16x16x32_bf16 v[184:187], a[220:223], v[152:155], v[184:187]
    buffer_load_dwordx4 v11, s[8:11], s43 offen offset:1024 nt lds
    v_mfma_f32_16x16x32_bf16 v[188:191], a[200:203], v[76:79], v[236:239]
    ds_read_b64_tr_b16 a[254:255], v29 offset:18560
    v_mfma_f32_16x16x32_bf16 v[188:191], a[204:207], v[92:95], v[188:191]
    v_mfma_f32_16x16x32_bf16 v[188:191], a[208:211], v[108:111], v[188:191]
    ds_read_b64_tr_b16 a[192:193], v26 offset:12544
    v_mfma_f32_16x16x32_bf16 v[188:191], a[212:215], v[124:127], v[188:191]
    ds_read_b64_tr_b16 a[194:195], v26 offset:18688
    v_mfma_f32_16x16x32_bf16 v[188:191], a[216:219], v[140:143], v[188:191]
    v_mfma_f32_16x16x32_bf16 v[188:191], a[220:223], v[156:159], v[188:191]
    s_waitcnt lgkmcnt(4)
    v_mfma_f32_16x16x32_bf16 a[0:3], a[224:227], v[240:243], a[0:3]
    v_exp_f32 v160, v160
    v_mfma_f32_16x16x32_bf16 a[4:7], a[224:227], v[244:247], a[4:7]
    v_exp_f32 v161, v161
    v_mfma_f32_16x16x32_bf16 a[8:11], a[224:227], v[248:251], a[8:11]
    ds_read_b64_tr_b16 a[196:197], v27 offset:12544
    v_add_f32 v34, v34, v160
    v_mfma_f32_16x16x32_bf16 a[12:15], a[224:227], v[252:255], a[12:15]
    v_exp_f32 v162, v162
    v_mfma_f32_16x16x32_bf16 a[28:31], a[228:231], v[252:255], a[28:31]
    buffer_load_dwordx4 v12, s[8:11], s43 offen offset:2048 nt lds
    v_mfma_f32_16x16x32_bf16 a[24:27], a[228:231], v[248:251], a[24:27]
    ds_read_b64_tr_b16 a[198:199], v27 offset:18688
    v_add_f32 v34, v34, v161
    v_mfma_f32_16x16x32_bf16 a[20:23], a[228:231], v[244:247], a[20:23]
    v_exp_f32 v163, v163
    v_mfma_f32_16x16x32_bf16 a[16:19], a[228:231], v[240:243], a[16:19]
    ds_read_b64_tr_b16 a[200:201], v28 offset:12544
    v_add_f32 v34, v34, v162
    v_mfma_f32_16x16x32_bf16 a[32:35], a[232:235], v[240:243], a[32:35]
    v_exp_f32 v164, v164
    v_mfma_f32_16x16x32_bf16 a[36:39], a[232:235], v[244:247], a[36:39]
    ds_read_b64_tr_b16 a[202:203], v28 offset:18688
    v_add_f32 v34, v34, v163
    v_mfma_f32_16x16x32_bf16 a[40:43], a[232:235], v[248:251], a[40:43]
    v_exp_f32 v165, v165
    v_mfma_f32_16x16x32_bf16 a[44:47], a[232:235], v[252:255], a[44:47]
    ds_read_b64_tr_b16 a[204:205], v29 offset:12544
    v_add_f32 v35, v35, v164
    v_mfma_f32_16x16x32_bf16 a[60:63], a[236:239], v[252:255], a[60:63]
    ds_read_b64_tr_b16 a[206:207], v29 offset:18688
    s_add_u32 s60, s46, 24576
    v_mfma_f32_16x16x32_bf16 a[56:59], a[236:239], v[248:251], a[56:59]
    v_exp_f32 v166, v166
    v_mfma_f32_16x16x32_bf16 a[52:55], a[236:239], v[244:247], a[52:55]
    v_add_u32 v26, s60, v22
    v_add_u32 v27, s60, v23
    v_mfma_f32_16x16x32_bf16 a[48:51], a[236:239], v[240:243], a[48:51]
    buffer_load_dwordx4 v13, s[8:11], s43 offen offset:3072 nt lds
    v_mfma_f32_16x16x32_bf16 a[64:67], a[240:243], v[240:243], a[64:67]
    v_add_u32 v28, s60, v24
    v_add_u32 v29, s60, v25
    v_mfma_f32_16x16x32_bf16 a[68:71], a[240:243], v[244:247], a[68:71]
    v_exp_f32 v167, v167
    v_mfma_f32_16x16x32_bf16 a[72:75], a[240:243], v[248:251], a[72:75]
    ds_read_b128 a[208:211], v32 offset:12288
    v_add_f32 v35, v35, v165
    v_mfma_f32_16x16x32_bf16 a[76:79], a[240:243], v[252:255], a[76:79]
    ds_read_b128 a[212:215], v33 offset:12288
    v_add_f32 v35, v35, v166
    v_mfma_f32_16x16x32_bf16 a[92:95], a[244:247], v[252:255], a[92:95]
    v_exp_f32 v168, v168
    v_mfma_f32_16x16x32_bf16 a[88:91], a[244:247], v[248:251], a[88:91]
    ds_read_b128 a[216:219], v32 offset:12416
    v_add_f32 v35, v35, v167
    v_mfma_f32_16x16x32_bf16 a[84:87], a[244:247], v[244:247], a[84:87]
    ds_read_b128 a[220:223], v33 offset:12416
    v_add_f32 v36, v36, v168
    v_mfma_f32_16x16x32_bf16 a[80:83], a[244:247], v[240:243], a[80:83]
    v_exp_f32 v169, v169
    v_mfma_f32_16x16x32_bf16 a[96:99], a[248:251], v[240:243], a[96:99]
    s_add_u32 m0, m0, 4096
    ds_read_b128 a[224:227], v32 offset:12544
    v_add_f32 v36, v36, v169
    v_mfma_f32_16x16x32_bf16 a[100:103], a[248:251], v[244:247], a[100:103]
    v_exp_f32 v170, v170
    v_mfma_f32_16x16x32_bf16 a[104:107], a[248:251], v[248:251], a[104:107]
    buffer_load_dwordx4 v14, s[8:11], s43 offen offset:0 nt lds
    v_mfma_f32_16x16x32_bf16 a[108:111], a[248:251], v[252:255], a[108:111]
    s_waitcnt lgkmcnt(4)
    ds_read_b128 a[228:231], v33 offset:12544
    v_add_f32 v36, v36, v170
    v_mfma_f32_16x16x32_bf16 a[124:127], a[252:255], v[252:255], a[124:127]
    v_exp_f32 v171, v171
    v_mfma_f32_16x16x32_bf16 a[120:123], a[252:255], v[248:251], a[120:123]
    v_exp_f32 v172, v172
    v_mfma_f32_16x16x32_bf16 a[116:119], a[252:255], v[244:247], a[116:119]
    v_exp_f32 v173, v173
    v_mfma_f32_16x16x32_bf16 a[112:115], a[252:255], v[240:243], a[112:115]
    v_exp_f32 v174, v174
    v_mfma_f32_16x16x32_bf16 a[128:131], a[192:195], v[240:243], a[128:131]
    v_exp_f32 v175, v175
    v_mfma_f32_16x16x32_bf16 a[132:135], a[192:195], v[244:247], a[132:135]
    v_add_f32 v36, v36, v171
    v_add_f32 v37, v37, v172
    v_mfma_f32_16x16x32_bf16 a[136:139], a[192:195], v[248:251], a[136:139]
    v_exp_f32 v176, v176
    v_mfma_f32_16x16x32_bf16 a[140:143], a[192:195], v[252:255], a[140:143]
    v_exp_f32 v177, v177
    v_mfma_f32_16x16x32_bf16 a[156:159], a[196:199], v[252:255], a[156:159]
    ds_read_b128 a[232:235], v32 offset:18432
    v_add_f32 v37, v37, v173
    v_mfma_f32_16x16x32_bf16 a[152:155], a[196:199], v[248:251], a[152:155]
    buffer_load_dwordx4 v15, s[8:11], s43 offen offset:1024 nt lds
    v_mfma_f32_16x16x32_bf16 a[148:151], a[196:199], v[244:247], a[148:151]
    ds_read_b128 a[236:239], v33 offset:18432
    v_add_f32 v37, v37, v174
    v_mfma_f32_16x16x32_bf16 a[144:147], a[196:199], v[240:243], a[144:147]
    ds_read_b128 a[240:243], v32 offset:18560
    v_add_f32 v37, v37, v175
    v_mfma_f32_16x16x32_bf16 a[160:163], a[200:203], v[240:243], a[160:163]
    ds_read_b128 a[244:247], v33 offset:18560
    v_add_f32 v34, v34, v176
    v_mfma_f32_16x16x32_bf16 a[164:167], a[200:203], v[244:247], a[164:167]
    ds_read_b128 a[248:251], v32 offset:18688
    v_add_f32 v34, v34, v177
    v_mfma_f32_16x16x32_bf16 a[168:171], a[200:203], v[248:251], a[168:171]
    ds_read_b128 a[252:255], v33 offset:18688
    v_mfma_f32_16x16x32_bf16 a[172:175], a[200:203], v[252:255], a[172:175]
    v_exp_f32 v178, v178
    v_mfma_f32_16x16x32_bf16 a[188:191], a[204:207], v[252:255], a[188:191]
    buffer_load_dword v60, v50, s[16:19], s56 offen sc1
    v_mfma_f32_16x16x32_bf16 a[184:187], a[204:207], v[248:251], a[184:187]
    s_add_u32 s56, s56, 2048
    v_exp_f32 v179, v179
    v_mfma_f32_16x16x32_bf16 a[180:183], a[204:207], v[244:247], a[180:183]
    s_add_u32 s43, s43, 24576
    v_exp_f32 v180, v180
    v_mfma_f32_16x16x32_bf16 a[176:179], a[204:207], v[240:243], a[176:179]
    s_min_u32 s56, s56, s84
    v_exp_f32 v181, v181
    v_mfma_f32_16x16x32_bf16 v[192:195], a[208:211], v[64:67], v[224:227]
    s_waitcnt lgkmcnt(3)
    v_add_f32 v34, v34, v178
    v_add_f32 v34, v34, v179
    v_mfma_f32_16x16x32_bf16 v[192:195], a[212:215], v[80:83], v[192:195]
    v_exp_f32 v182, v182
    v_mfma_f32_16x16x32_bf16 v[192:195], a[216:219], v[96:99], v[192:195]
    v_add_f32 v35, v35, v180
    v_add_f32 v35, v35, v181
    v_mfma_f32_16x16x32_bf16 v[192:195], a[220:223], v[112:115], v[192:195]
    v_exp_f32 v183, v183
    v_mfma_f32_16x16x32_bf16 v[192:195], a[224:227], v[128:131], v[192:195]
    v_exp_f32 v184, v184
    v_mfma_f32_16x16x32_bf16 v[192:195], a[228:231], v[144:147], v[192:195]
    v_add_f32 v35, v35, v182
    v_cvt_pk_bf16_f32 v240, v160, v161
    v_mfma_f32_16x16x32_bf16 v[196:199], a[208:211], v[68:71], v[228:231]
    v_add_u32 v32, s47, v30
    v_add_u32 v33, s47, v31
    v_mfma_f32_16x16x32_bf16 v[196:199], a[212:215], v[84:87], v[196:199]
    v_exp_f32 v185, v185
    v_mfma_f32_16x16x32_bf16 v[196:199], a[216:219], v[100:103], v[196:199]
    v_add_f32 v35, v35, v183
    v_cvt_pk_bf16_f32 v241, v162, v163
    v_mfma_f32_16x16x32_bf16 v[196:199], a[220:223], v[116:119], v[196:199]
    v_cvt_pk_bf16_f32 v244, v164, v165
    v_add_f32 v36, v36, v184
    v_mfma_f32_16x16x32_bf16 v[196:199], a[224:227], v[132:135], v[196:199]
    v_exp_f32 v186, v186
    v_mfma_f32_16x16x32_bf16 v[196:199], a[228:231], v[148:151], v[196:199]
    v_cvt_pk_bf16_f32 v245, v166, v167
    v_add_f32 v36, v36, v185
    v_mfma_f32_16x16x32_bf16 v[200:203], a[208:211], v[72:75], v[232:235]
    v_cvt_pk_bf16_f32 v248, v168, v169
    v_cvt_pk_bf16_f32 v249, v170, v171
    v_mfma_f32_16x16x32_bf16 v[200:203], a[212:215], v[88:91], v[200:203]
    v_exp_f32 v187, v187
    v_mfma_f32_16x16x32_bf16 v[200:203], a[216:219], v[104:107], v[200:203]
    s_waitcnt vmcnt(16)
    s_waitcnt lgkmcnt(0)
    s_barrier
    v_mfma_f32_16x16x32_bf16 v[200:203], a[220:223], v[120:123], v[200:203]
    s_mov_b32 s61, s45
    buffer_store_dword v49, v43, s[16:19], 0 offen offset:4 sc1
    v_mfma_f32_16x16x32_bf16 v[200:203], a[224:227], v[136:139], v[200:203]
    ds_read_b64_tr_b16 v[52:53], v41 offset:0
    v_add_f32 v36, v36, v186
    v_mfma_f32_16x16x32_bf16 v[200:203], a[228:231], v[152:155], v[200:203]
    s_mov_b32 s45, s46
    ds_read_b64_tr_b16 v[54:55], v41 offset:1024
    v_cvt_pk_bf16_f32 v252, v172, v173
    v_mfma_f32_16x16x32_bf16 v[204:207], a[208:211], v[76:79], v[236:239]
    ds_read_b64_tr_b16 v[56:57], v41 offset:32
    v_cvt_pk_bf16_f32 v253, v174, v175
    v_mfma_f32_16x16x32_bf16 v[204:207], a[212:215], v[92:95], v[204:207]
    s_mov_b32 s46, s47
    ds_read_b64_tr_b16 v[58:59], v41 offset:1056
    v_add_f32 v36, v36, v187
    v_mfma_f32_16x16x32_bf16 v[204:207], a[216:219], v[108:111], v[204:207]
    ds_read_b64_tr_b16 a[192:193], v26 offset:0
    v_cvt_pk_bf16_f32 v242, v176, v177
    v_mfma_f32_16x16x32_bf16 v[204:207], a[220:223], v[124:127], v[204:207]
    s_mov_b32 s47, s61
    ds_read_b64_tr_b16 a[194:195], v26 offset:6144
    v_cvt_pk_bf16_f32 v243, v178, v179
    v_mfma_f32_16x16x32_bf16 v[204:207], a[224:227], v[140:143], v[204:207]
    ds_read_b64_tr_b16 a[196:197], v27 offset:0
    v_cvt_pk_bf16_f32 v246, v180, v181
    v_mfma_f32_16x16x32_bf16 v[204:207], a[228:231], v[156:159], v[204:207]
    ds_read_b64_tr_b16 a[198:199], v27 offset:6144
    v_cvt_pk_bf16_f32 v247, v182, v183
    v_mfma_f32_16x16x32_bf16 v[208:211], a[232:235], v[64:67], v[224:227]
    ds_read_b64_tr_b16 a[200:201], v28 offset:0
    v_cvt_pk_bf16_f32 v250, v184, v185
    v_mfma_f32_16x16x32_bf16 v[208:211], a[236:239], v[80:83], v[208:211]
    ds_read_b64_tr_b16 a[202:203], v28 offset:6144
    v_cvt_pk_bf16_f32 v251, v186, v187
    v_mfma_f32_16x16x32_bf16 v[208:211], a[240:243], v[96:99], v[208:211]
    v_exp_f32 v188, v188
    v_mfma_f32_16x16x32_bf16 v[208:211], a[244:247], v[112:115], v[208:211]
    ds_read_b64_tr_b16 a[204:205], v29 offset:0
    v_add_f32 v37, v37, v188
    v_mfma_f32_16x16x32_bf16 v[208:211], a[248:251], v[128:131], v[208:211]
    s_waitcnt lgkmcnt(7)
    buffer_store_dwordx4 v[52:55], v1, s[28:31], s51 offen offset:0 sc1
    v_mfma_f32_16x16x32_bf16 v[208:211], a[252:255], v[144:147], v[208:211]
    v_exp_f32 v189, v189
    v_mfma_f32_16x16x32_bf16 v[212:215], a[232:235], v[68:71], v[228:231]
    ds_read_b64_tr_b16 a[206:207], v29 offset:6144
    v_add_f32 v37, v37, v189
    v_mfma_f32_16x16x32_bf16 v[212:215], a[236:239], v[84:87], v[212:215]
    ds_read_b64_tr_b16 a[208:209], v26 offset:128
    v_cvt_pk_bf16_f32 v254, v188, v189
    v_mfma_f32_16x16x32_bf16 v[212:215], a[240:243], v[100:103], v[212:215]
    buffer_store_dwordx4 v[56:59], v1, s[28:31], s51 offen offset:1024 sc1
    v_mfma_f32_16x16x32_bf16 v[212:215], a[244:247], v[116:119], v[212:215]
WS7:
    s_cbranch_execz WS3
    v_exp_f32 v190, v190
    v_mfma_f32_16x16x32_bf16 v[212:215], a[248:251], v[132:135], v[212:215]
    s_add_u32 s51, s51, 1966080
    ds_read_b64_tr_b16 a[210:211], v26 offset:6272
    v_xor_b32 v41, 2048, v41
    v_mfma_f32_16x16x32_bf16 v[212:215], a[252:255], v[148:151], v[212:215]
    s_mov_b32 m0, s52
    ds_read_b64_tr_b16 a[212:213], v27 offset:128
    v_add_f32 v37, v37, v190
    v_mfma_f32_16x16x32_bf16 v[216:219], a[232:235], v[72:75], v[232:235]
    buffer_load_dwordx4 v39, s[24:27], s50 offen nt lds
    v_mfma_f32_16x16x32_bf16 v[216:219], a[236:239], v[88:91], v[216:219]
    v_exp_f32 v191, v191
    v_mfma_f32_16x16x32_bf16 v[216:219], a[240:243], v[104:107], v[216:219]
    ds_read_b64_tr_b16 a[214:215], v27 offset:6272
    v_add_f32 v37, v37, v191
    v_mfma_f32_16x16x32_bf16 v[216:219], a[244:247], v[120:123], v[216:219]
    ds_read_b64_tr_b16 a[216:217], v28 offset:128
    v_cvt_pk_bf16_f32 v255, v190, v191
    v_mfma_f32_16x16x32_bf16 v[216:219], a[248:251], v[136:139], v[216:219]
    buffer_load_dwordx4 v40, s[24:27], s50 offen offset:1024 nt lds
    v_mfma_f32_16x16x32_bf16 v[216:219], a[252:255], v[152:155], v[216:219]
    ds_read_b64_tr_b16 a[218:219], v28 offset:6272
    v_mfma_f32_16x16x32_bf16 v[220:223], a[232:235], v[76:79], v[236:239]
    s_xor_b32 s52, s52, 2048
    ds_read_b64_tr_b16 a[220:221], v29 offset:128
    s_add_u32 s50, s50, 1966080
    v_mfma_f32_16x16x32_bf16 v[220:223], a[236:239], v[92:95], v[220:223]
    ds_read_b64_tr_b16 a[222:223], v29 offset:6272
    v_mfma_f32_16x16x32_bf16 v[220:223], a[240:243], v[108:111], v[220:223]
    v_mfma_f32_16x16x32_bf16 v[220:223], a[244:247], v[124:127], v[220:223]
    v_mfma_f32_16x16x32_bf16 v[220:223], a[248:251], v[140:143], v[220:223]
    s_sub_u32 s48, s48, 1
    s_cmp_gt_u32 s48, 2
    v_mfma_f32_16x16x32_bf16 v[220:223], a[252:255], v[156:159], v[220:223]
    s_cbranch_scc1 ATT_LOOP
ATT_DONE:
    ds_read_b64_tr_b16 a[224:225], v26 offset:256
    s_waitcnt lgkmcnt(5)
    v_mfma_f32_16x16x32_bf16 a[0:3], a[192:195], v[240:243], a[0:3]
    buffer_load_dword v38, v62, s[16:19], s58 offen offset:4 sc1
    v_mfma_f32_16x16x32_bf16 a[4:7], a[192:195], v[244:247], a[4:7]
    v_exp_f32 v192, v192
    v_mfma_f32_16x16x32_bf16 a[8:11], a[192:195], v[248:251], a[8:11]
    v_exp_f32 v193, v193
    v_mfma_f32_16x16x32_bf16 a[12:15], a[192:195], v[252:255], a[12:15]
    v_exp_f32 v194, v194
    v_mfma_f32_16x16x32_bf16 a[28:31], a[196:199], v[252:255], a[28:31]
    v_exp_f32 v195, v195
    v_mfma_f32_16x16x32_bf16 a[24:27], a[196:199], v[248:251], a[24:27]
    v_exp_f32 v196, v196
    v_mfma_f32_16x16x32_bf16 a[20:23], a[196:199], v[244:247], a[20:23]
    v_exp_f32 v197, v197
    v_mfma_f32_16x16x32_bf16 a[16:19], a[196:199], v[240:243], a[16:19]
    v_exp_f32 v198, v198
    v_mfma_f32_16x16x32_bf16 a[32:35], a[200:203], v[240:243], a[32:35]
    ds_read_b64_tr_b16 a[226:227], v26 offset:6400
    v_add_f32 v34, v34, v192
    v_mfma_f32_16x16x32_bf16 a[36:39], a[200:203], v[244:247], a[36:39]
    v_exp_f32 v199, v199
    v_mfma_f32_16x16x32_bf16 a[40:43], a[200:203], v[248:251], a[40:43]
    s_add_u32 m0, s42, 122880
    s_nop 0
    buffer_load_dwordx4 v16, s[12:15], s44 offen offset:0 nt lds
    v_mfma_f32_16x16x32_bf16 a[44:47], a[200:203], v[252:255], a[44:47]
    ds_read_b64_tr_b16 a[228:229], v27 offset:256
    v_add_f32 v34, v34, v193
    v_mfma_f32_16x16x32_bf16 a[60:63], a[204:207], v[252:255], a[60:63]
    ds_read_b64_tr_b16 a[230:231], v27 offset:6400
    v_add_f32 v34, v34, v194
    v_mfma_f32_16x16x32_bf16 a[56:59], a[204:207], v[248:251], a[56:59]
    v_exp_f32 v200, v200
    v_mfma_f32_16x16x32_bf16 a[52:55], a[204:207], v[244:247], a[52:55]
    ds_read_b64_tr_b16 a[232:233], v28 offset:256
    v_add_f32 v34, v34, v195
    v_mfma_f32_16x16x32_bf16 a[48:51], a[204:207], v[240:243], a[48:51]
    v_exp_f32 v201, v201
    v_mfma_f32_16x16x32_bf16 a[64:67], a[208:211], v[240:243], a[64:67]
    ds_read_b64_tr_b16 a[234:235], v28 offset:6400
    v_add_f32 v35, v35, v196
    v_mfma_f32_16x16x32_bf16 a[68:71], a[208:211], v[244:247], a[68:71]
    v_exp_f32 v202, v202
    v_mfma_f32_16x16x32_bf16 a[72:75], a[208:211], v[248:251], a[72:75]
    ds_read_b64_tr_b16 a[236:237], v29 offset:256
    v_add_f32 v35, v35, v197
    v_mfma_f32_16x16x32_bf16 a[76:79], a[208:211], v[252:255], a[76:79]
    ds_read_b64_tr_b16 a[238:239], v29 offset:6400
    v_add_f32 v35, v35, v198
    v_mfma_f32_16x16x32_bf16 a[92:95], a[212:215], v[252:255], a[92:95]
    s_mul_i32 s88, s39, 98304
    v_exp_f32 v203, v203
    v_mfma_f32_16x16x32_bf16 a[88:91], a[212:215], v[248:251], a[88:91]
    s_add_u32 s88, s88, s70
    buffer_load_dwordx4 v17, s[12:15], s44 offen offset:1024 nt lds
    v_mfma_f32_16x16x32_bf16 a[84:87], a[212:215], v[244:247], a[84:87]
    ds_read_b128 a[240:243], v32 offset:0
    v_add_f32 v35, v35, v199
    v_mfma_f32_16x16x32_bf16 a[80:83], a[212:215], v[240:243], a[80:83]
    s_waitcnt lgkmcnt(4)
    v_exp_f32 v204, v204
    v_mfma_f32_16x16x32_bf16 a[96:99], a[216:219], v[240:243], a[96:99]
    ds_read_b128 a[244:247], v33 offset:0
    v_add_f32 v36, v36, v200
    v_mfma_f32_16x16x32_bf16 a[100:103], a[216:219], v[244:247], a[100:103]
    ds_read_b128 a[248:251], v32 offset:128
    v_add_f32 v36, v36, v201
    v_mfma_f32_16x16x32_bf16 a[104:107], a[216:219], v[248:251], a[104:107]
    ds_read_b128 a[252:255], v33 offset:128
    v_add_f32 v36, v36, v202
    v_mfma_f32_16x16x32_bf16 a[108:111], a[216:219], v[252:255], a[108:111]
    v_exp_f32 v205, v205
    v_mfma_f32_16x16x32_bf16 a[124:127], a[220:223], v[252:255], a[124:127]
    ds_read_b128 a[192:195], v32 offset:256
    v_add_f32 v36, v36, v203
    v_mfma_f32_16x16x32_bf16 a[120:123], a[220:223], v[248:251], a[120:123]
    ds_read_b128 a[196:199], v33 offset:256
    v_add_f32 v37, v37, v204
    v_mfma_f32_16x16x32_bf16 a[116:119], a[220:223], v[244:247], a[116:119]
    buffer_load_dword v60, v50, s[16:19], s56 offen sc1
    v_mfma_f32_16x16x32_bf16 a[112:115], a[220:223], v[240:243], a[112:115]
    s_add_u32 s56, s56, 2048
    v_exp_f32 v206, v206
    v_mfma_f32_16x16x32_bf16 a[128:131], a[224:227], v[240:243], a[128:131]
    s_min_u32 s56, s56, s84
    buffer_load_dwordx4 v18, s[12:15], s44 offen offset:2048 nt lds
    v_mfma_f32_16x16x32_bf16 a[132:135], a[224:227], v[244:247], a[132:135]
    v_exp_f32 v207, v207
    v_mfma_f32_16x16x32_bf16 a[136:139], a[224:227], v[248:251], a[136:139]
    v_exp_f32 v208, v208
    v_mfma_f32_16x16x32_bf16 a[140:143], a[224:227], v[252:255], a[140:143]
    v_add_f32 v37, v37, v205
    v_add_f32 v37, v37, v206
    v_mfma_f32_16x16x32_bf16 a[156:159], a[228:231], v[252:255], a[156:159]
    v_exp_f32 v209, v209
    v_mfma_f32_16x16x32_bf16 a[152:155], a[228:231], v[248:251], a[152:155]
    v_exp_f32 v210, v210
    v_mfma_f32_16x16x32_bf16 a[148:151], a[228:231], v[244:247], a[148:151]
    ds_read_b128 a[200:203], v32 offset:6144
    v_add_f32 v37, v37, v207
    v_mfma_f32_16x16x32_bf16 a[144:147], a[228:231], v[240:243], a[144:147]
    s_waitcnt lgkmcnt(1)
    v_exp_f32 v211, v211
    v_mfma_f32_16x16x32_bf16 a[160:163], a[232:235], v[240:243], a[160:163]
    ds_read_b128 a[204:207], v33 offset:6144
    v_add_f32 v34, v34, v208
    v_mfma_f32_16x16x32_bf16 a[164:167], a[232:235], v[244:247], a[164:167]
    v_exp_f32 v212, v212
    v_mfma_f32_16x16x32_bf16 a[168:171], a[232:235], v[248:251], a[168:171]
    ds_read_b128 a[208:211], v32 offset:6272
    v_add_f32 v34, v34, v209
    v_mfma_f32_16x16x32_bf16 a[172:175], a[232:235], v[252:255], a[172:175]
    buffer_load_dwordx4 v19, s[12:15], s44 offen offset:3072 nt lds
    v_mfma_f32_16x16x32_bf16 a[188:191], a[236:239], v[252:255], a[188:191]
    ds_read_b128 a[212:215], v33 offset:6272
    v_add_f32 v34, v34, v210
    v_mfma_f32_16x16x32_bf16 a[184:187], a[236:239], v[248:251], a[184:187]
    v_exp_f32 v213, v213
    v_mfma_f32_16x16x32_bf16 a[180:183], a[236:239], v[244:247], a[180:183]
    ds_read_b128 a[216:219], v32 offset:6400
    v_add_f32 v34, v34, v211
    v_mfma_f32_16x16x32_bf16 a[176:179], a[236:239], v[240:243], a[176:179]
    ds_read_b128 a[220:223], v33 offset:6400
    v_add_f32 v35, v35, v212
    v_mfma_f32_16x16x32_bf16 v[160:163], a[240:243], v[64:67], v[224:227]
    v_exp_f32 v214, v214
    v_mfma_f32_16x16x32_bf16 v[160:163], a[244:247], v[80:83], v[160:163]
    v_exp_f32 v215, v215
    v_mfma_f32_16x16x32_bf16 v[160:163], a[248:251], v[96:99], v[160:163]
    v_add_f32 v35, v35, v213
    v_add_f32 v35, v35, v214
    v_mfma_f32_16x16x32_bf16 v[160:163], a[252:255], v[112:115], v[160:163]
    v_exp_f32 v216, v216
    v_mfma_f32_16x16x32_bf16 v[160:163], a[192:195], v[128:131], v[160:163]
    s_add_u32 m0, m0, 4096
    v_add_f32 v35, v35, v215
    v_add_f32 v36, v36, v216
    v_mfma_f32_16x16x32_bf16 v[160:163], a[196:199], v[144:147], v[160:163]
    v_exp_f32 v217, v217
    v_mfma_f32_16x16x32_bf16 v[164:167], a[240:243], v[68:71], v[228:231]
    buffer_load_dwordx4 v20, s[12:15], s44 offen offset:0 nt lds
    v_mfma_f32_16x16x32_bf16 v[164:167], a[244:247], v[84:87], v[164:167]
    v_exp_f32 v218, v218
    v_mfma_f32_16x16x32_bf16 v[164:167], a[248:251], v[100:103], v[164:167]
    v_cvt_pk_bf16_f32 v240, v192, v193
    v_cvt_pk_bf16_f32 v241, v194, v195
    v_mfma_f32_16x16x32_bf16 v[164:167], a[252:255], v[116:119], v[164:167]
    v_add_f32 v36, v36, v217
    v_cvt_pk_bf16_f32 v244, v196, v197
    v_mfma_f32_16x16x32_bf16 v[164:167], a[192:195], v[132:135], v[164:167]
    v_exp_f32 v219, v219
    v_mfma_f32_16x16x32_bf16 v[164:167], a[196:199], v[148:151], v[164:167]
    v_cvt_pk_bf16_f32 v245, v198, v199
    v_add_f32 v36, v36, v218
    v_mfma_f32_16x16x32_bf16 v[168:171], a[240:243], v[72:75], v[232:235]
    ds_read_b64_tr_b16 a[224:225], v26 offset:12288
    v_cvt_pk_bf16_f32 v248, v200, v201
    v_mfma_f32_16x16x32_bf16 v[168:171], a[244:247], v[88:91], v[168:171]
    ds_read_b64_tr_b16 a[226:227], v26 offset:18432
    v_cvt_pk_bf16_f32 v249, v202, v203
    v_mfma_f32_16x16x32_bf16 v[168:171], a[248:251], v[104:107], v[168:171]
    v_exp_f32 v220, v220
    v_mfma_f32_16x16x32_bf16 v[168:171], a[252:255], v[120:123], v[168:171]
    v_add_f32 v36, v36, v219
    v_cvt_pk_bf16_f32 v252, v204, v205
    v_mfma_f32_16x16x32_bf16 v[168:171], a[192:195], v[136:139], v[168:171]
    ds_read_b64_tr_b16 a[228:229], v27 offset:12288
    v_cvt_pk_bf16_f32 v253, v206, v207
    v_mfma_f32_16x16x32_bf16 v[168:171], a[196:199], v[152:155], v[168:171]
    buffer_load_dwordx4 v21, s[12:15], s44 offen offset:1024 nt lds
    v_mfma_f32_16x16x32_bf16 v[172:175], a[240:243], v[76:79], v[236:239]
    s_lshl_b32 s7, s3, 12
    ds_read_b64_tr_b16 a[230:231], v27 offset:18432
    v_cvt_pk_bf16_f32 v242, v208, v209
    v_mfma_f32_16x16x32_bf16 v[172:175], a[244:247], v[92:95], v[172:175]
    v_add_f32 v37, v37, v220
    v_cvt_pk_bf16_f32 v243, v210, v211
    v_mfma_f32_16x16x32_bf16 v[172:175], a[248:251], v[108:111], v[172:175]
    v_exp_f32 v221, v221
    v_mfma_f32_16x16x32_bf16 v[172:175], a[252:255], v[124:127], v[172:175]
    ds_read_b64_tr_b16 a[232:233], v28 offset:12288
    v_cvt_pk_bf16_f32 v246, v212, v213
    v_mfma_f32_16x16x32_bf16 v[172:175], a[192:195], v[140:143], v[172:175]
    s_waitcnt vmcnt(7)
    v_sub_u32 v38, v38, v61
    v_subrev_u32 v38, 4, v38
    v_cmp_lt_u32 vcc, 11, v38
    s_cbranch_vccnz SPINWO
BACKWO:
    v_mfma_f32_16x16x32_bf16 v[172:175], a[196:199], v[156:159], v[172:175]
    s_waitcnt lgkmcnt(3)
    ds_read_b64_tr_b16 a[234:235], v28 offset:18432
    v_add_f32 v37, v37, v221
    v_mfma_f32_16x16x32_bf16 v[176:179], a[200:203], v[64:67], v[224:227]
    ds_read_b64_tr_b16 a[236:237], v29 offset:12288
    v_cvt_pk_bf16_f32 v247, v214, v215
    v_mfma_f32_16x16x32_bf16 v[176:179], a[204:207], v[80:83], v[176:179]
    v_exp_f32 v222, v222
    v_mfma_f32_16x16x32_bf16 v[176:179], a[208:211], v[96:99], v[176:179]
    ds_read_b64_tr_b16 a[238:239], v29 offset:18432
    v_cvt_pk_bf16_f32 v250, v216, v217
    v_mfma_f32_16x16x32_bf16 v[176:179], a[212:215], v[112:115], v[176:179]
    v_add_f32 v37, v37, v222
    v_cvt_pk_bf16_f32 v251, v218, v219
    v_mfma_f32_16x16x32_bf16 v[176:179], a[216:219], v[128:131], v[176:179]
    v_exp_f32 v223, v223
    v_mfma_f32_16x16x32_bf16 v[176:179], a[220:223], v[144:147], v[176:179]
    ds_read_b64_tr_b16 a[240:241], v26 offset:12416
    v_cvt_pk_bf16_f32 v254, v220, v221
    v_mfma_f32_16x16x32_bf16 v[180:183], a[200:203], v[68:71], v[228:231]
    ds_read_b64_tr_b16 a[242:243], v26 offset:18560
    v_add_f32 v37, v37, v223
    v_mfma_f32_16x16x32_bf16 v[180:183], a[204:207], v[84:87], v[180:183]
    v_cvt_pk_bf16_f32 v255, v222, v223
    v_add_u32 v39, 4096, v1
    v_mfma_f32_16x16x32_bf16 v[180:183], a[208:211], v[100:103], v[180:183]
    s_xor_b32 s6, s40, 0
    ds_read_b64_tr_b16 a[244:245], v27 offset:12416
    v_and_b32 v62, 7, v0
    v_mfma_f32_16x16x32_bf16 v[180:183], a[212:215], v[116:119], v[180:183]
    s_mul_i32 s6, s6, 245760
    ds_read_b64_tr_b16 a[246:247], v27 offset:18560
    v_bfe_u32 v47, v0, 3, 1
    v_mfma_f32_16x16x32_bf16 v[180:183], a[216:219], v[132:135], v[180:183]
    s_add_u32 s6, s6, s75
    v_lshl_add_u32 v62, v62, 5, v47
    v_lshlrev_b32 v62, 7, v62
    v_mfma_f32_16x16x32_bf16 v[180:183], a[220:223], v[148:151], v[180:183]
    s_lshl_b32 s58, s3, 1
    s_and_b32 s96, s2, 24
    s_add_u32 s58, s58, s96
    v_mfma_f32_16x16x32_bf16 v[184:187], a[200:203], v[72:75], v[232:235]
    s_lshl_b32 s58, s58, 7
    ds_read_b64_tr_b16 a[248:249], v28 offset:12416
    s_add_u32 s58, s58, 62390272
    v_mfma_f32_16x16x32_bf16 v[184:187], a[204:207], v[88:91], v[184:187]
    s_add_u32 m0, s42, 0
    s_nop 0
    buffer_load_dwordx4 v1, s[16:19], s6 offen offset:0 sc1 lds
    v_mfma_f32_16x16x32_bf16 v[184:187], a[208:211], v[104:107], v[184:187]
    ds_read_b64_tr_b16 a[250:251], v28 offset:18560
    v_mfma_f32_16x16x32_bf16 v[184:187], a[212:215], v[120:123], v[184:187]
    v_mfma_f32_16x16x32_bf16 v[184:187], a[216:219], v[136:139], v[184:187]
    ds_read_b64_tr_b16 a[252:253], v29 offset:12416
    v_mfma_f32_16x16x32_bf16 v[184:187], a[220:223], v[152:155], v[184:187]
    ds_read_b64_tr_b16 a[254:255], v29 offset:18560
    v_mfma_f32_16x16x32_bf16 v[188:191], a[200:203], v[76:79], v[236:239]
    v_mfma_f32_16x16x32_bf16 v[188:191], a[204:207], v[92:95], v[188:191]
    v_mfma_f32_16x16x32_bf16 v[188:191], a[208:211], v[108:111], v[188:191]
    buffer_load_dwordx4 v1, s[16:19], s6 offen offset:1024 sc1 lds
    v_mfma_f32_16x16x32_bf16 v[188:191], a[212:215], v[124:127], v[188:191]
    ds_read_b64_tr_b16 a[192:193], v26 offset:12544
    v_mfma_f32_16x16x32_bf16 v[188:191], a[216:219], v[140:143], v[188:191]
    ds_read_b64_tr_b16 a[194:195], v26 offset:18688
    v_mfma_f32_16x16x32_bf16 v[188:191], a[220:223], v[156:159], v[188:191]
    v_mfma_f32_16x16x32_bf16 a[0:3], a[224:227], v[240:243], a[0:3]
    v_exp_f32 v160, v160
    v_mfma_f32_16x16x32_bf16 a[4:7], a[224:227], v[244:247], a[4:7]
    v_exp_f32 v161, v161
    v_mfma_f32_16x16x32_bf16 a[8:11], a[224:227], v[248:251], a[8:11]
    ds_read_b64_tr_b16 a[196:197], v27 offset:12544
    v_add_f32 v34, v34, v160
    v_mfma_f32_16x16x32_bf16 a[12:15], a[224:227], v[252:255], a[12:15]
    s_waitcnt lgkmcnt(3)
    v_exp_f32 v162, v162
    v_mfma_f32_16x16x32_bf16 a[28:31], a[228:231], v[252:255], a[28:31]
    buffer_load_dword v60, v50, s[16:19], s56 offen sc1
    v_mfma_f32_16x16x32_bf16 a[24:27], a[228:231], v[248:251], a[24:27]
    ds_read_b64_tr_b16 a[198:199], v27 offset:18688
    v_add_f32 v34, v34, v161
    v_mfma_f32_16x16x32_bf16 a[20:23], a[228:231], v[244:247], a[20:23]
    buffer_load_dwordx4 v1, s[16:19], s6 offen offset:2048 sc1 lds
    v_mfma_f32_16x16x32_bf16 a[16:19], a[228:231], v[240:243], a[16:19]
    v_exp_f32 v163, v163
    v_mfma_f32_16x16x32_bf16 a[32:35], a[232:235], v[240:243], a[32:35]
    ds_read_b64_tr_b16 a[200:201], v28 offset:12544
    v_add_f32 v34, v34, v162
    v_mfma_f32_16x16x32_bf16 a[36:39], a[232:235], v[244:247], a[36:39]
    v_exp_f32 v164, v164
    v_mfma_f32_16x16x32_bf16 a[40:43], a[232:235], v[248:251], a[40:43]
    ds_read_b64_tr_b16 a[202:203], v28 offset:18688
    v_add_f32 v34, v34, v163
    v_mfma_f32_16x16x32_bf16 a[44:47], a[232:235], v[252:255], a[44:47]
    v_exp_f32 v165, v165
    v_mfma_f32_16x16x32_bf16 a[60:63], a[236:239], v[252:255], a[60:63]
    ds_read_b64_tr_b16 a[204:205], v29 offset:12544
    v_add_f32 v35, v35, v164
    v_mfma_f32_16x16x32_bf16 a[56:59], a[236:239], v[248:251], a[56:59]
    ds_read_b64_tr_b16 a[206:207], v29 offset:18688
    v_add_u32 v26, 73728, v22
    v_mfma_f32_16x16x32_bf16 a[52:55], a[236:239], v[244:247], a[52:55]
    s_mov_b32 s20, s64
    buffer_load_dwordx4 v1, s[16:19], s6 offen offset:3072 sc1 lds
    v_mfma_f32_16x16x32_bf16 a[48:51], a[236:239], v[240:243], a[48:51]
    s_and_b32 s21, s65, 0xffff
    v_exp_f32 v166, v166
    v_mfma_f32_16x16x32_bf16 a[64:67], a[240:243], v[240:243], a[64:67]
    s_mov_b32 s22, 2621440
    v_add_u32 v27, 73728, v23
    v_add_u32 v28, 73728, v24
    v_mfma_f32_16x16x32_bf16 a[68:71], a[240:243], v[244:247], a[68:71]
    s_mov_b32 s23, 0x20000
    v_exp_f32 v167, v167
    v_mfma_f32_16x16x32_bf16 a[72:75], a[240:243], v[248:251], a[72:75]
    s_add_u32 m0, m0, 4096
    v_add_u32 v29, 73728, v25
    v_add_f32 v35, v35, v165
    v_mfma_f32_16x16x32_bf16 a[76:79], a[240:243], v[252:255], a[76:79]
    ds_read_b128 a[208:211], v32 offset:12288
    v_add_f32 v35, v35, v166
    v_mfma_f32_16x16x32_bf16 a[92:95], a[244:247], v[252:255], a[92:95]
    ds_read_b128 a[212:215], v33 offset:12288
    v_add_f32 v35, v35, v167
    v_mfma_f32_16x16x32_bf16 a[88:91], a[244:247], v[248:251], a[88:91]
    v_exp_f32 v168, v168
    v_mfma_f32_16x16x32_bf16 a[84:87], a[244:247], v[244:247], a[84:87]
    buffer_load_dwordx4 v39, s[16:19], s6 offen offset:0 sc1 lds
    v_mfma_f32_16x16x32_bf16 a[80:83], a[244:247], v[240:243], a[80:83]
    ds_read_b128 a[216:219], v32 offset:12416
    v_add_f32 v36, v36, v168
    v_mfma_f32_16x16x32_bf16 a[96:99], a[248:251], v[240:243], a[96:99]
    ds_read_b128 a[220:223], v33 offset:12416
    v_and_b32 v44, 15, v0
    v_mfma_f32_16x16x32_bf16 a[100:103], a[248:251], v[244:247], a[100:103]
    v_exp_f32 v169, v169
    v_mfma_f32_16x16x32_bf16 a[104:107], a[248:251], v[248:251], a[104:107]
    ds_read_b128 a[224:227], v32 offset:12544
    v_add_f32 v36, v36, v169
    v_mfma_f32_16x16x32_bf16 a[108:111], a[248:251], v[252:255], a[108:111]
    ds_read_b128 a[228:231], v33 offset:12544
    v_mul_u32_u24 v44, 1280, v44
    v_mfma_f32_16x16x32_bf16 a[124:127], a[252:255], v[252:255], a[124:127]
    v_exp_f32 v170, v170
    v_mfma_f32_16x16x32_bf16 a[120:123], a[252:255], v[248:251], a[120:123]
    v_exp_f32 v171, v171
    v_mfma_f32_16x16x32_bf16 a[116:119], a[252:255], v[244:247], a[116:119]
    v_exp_f32 v172, v172
    v_mfma_f32_16x16x32_bf16 a[112:115], a[252:255], v[240:243], a[112:115]
    s_waitcnt lgkmcnt(4)
    v_exp_f32 v173, v173
    v_mfma_f32_16x16x32_bf16 a[128:131], a[192:195], v[240:243], a[128:131]
    v_exp_f32 v174, v174
    v_mfma_f32_16x16x32_bf16 a[132:135], a[192:195], v[244:247], a[132:135]
    v_add_f32 v36, v36, v170
    v_add_f32 v36, v36, v171
    v_mfma_f32_16x16x32_bf16 a[136:139], a[192:195], v[248:251], a[136:139]
    buffer_load_dword v38, v62, s[16:19], s58 offen offset:4 sc1
    v_mfma_f32_16x16x32_bf16 a[140:143], a[192:195], v[252:255], a[140:143]
    v_exp_f32 v175, v175
    v_mfma_f32_16x16x32_bf16 a[156:159], a[196:199], v[252:255], a[156:159]
    ds_read_b128 a[232:235], v32 offset:18432
    v_add_f32 v37, v37, v172
    v_mfma_f32_16x16x32_bf16 a[152:155], a[196:199], v[248:251], a[152:155]
    ds_read_b128 a[236:239], v33 offset:18432
    v_add_f32 v37, v37, v173
    v_mfma_f32_16x16x32_bf16 a[148:151], a[196:199], v[244:247], a[148:151]
    ds_read_b128 a[240:243], v32 offset:18560
    v_add_f32 v37, v37, v174
    v_mfma_f32_16x16x32_bf16 a[144:147], a[196:199], v[240:243], a[144:147]
    ds_read_b128 a[244:247], v33 offset:18560
    v_add_f32 v37, v37, v175
    v_mfma_f32_16x16x32_bf16 a[160:163], a[200:203], v[240:243], a[160:163]
    ds_read_b128 a[248:251], v32 offset:18688
    v_lshrrev_b32 v45, 4, v0
    v_mfma_f32_16x16x32_bf16 a[164:167], a[200:203], v[244:247], a[164:167]
    ds_read_b128 a[252:255], v33 offset:18688
    v_lshl_add_u32 v48, v45, 3, v44
    v_mfma_f32_16x16x32_bf16 a[168:171], a[200:203], v[248:251], a[168:171]
    v_exp_f32 v176, v176
    v_mfma_f32_16x16x32_bf16 a[172:175], a[200:203], v[252:255], a[172:175]
    v_exp_f32 v177, v177
    v_mfma_f32_16x16x32_bf16 a[188:191], a[204:207], v[252:255], a[188:191]
    v_exp_f32 v178, v178
    v_mfma_f32_16x16x32_bf16 a[184:187], a[204:207], v[248:251], a[184:187]
    v_exp_f32 v179, v179
    v_mfma_f32_16x16x32_bf16 a[180:183], a[204:207], v[244:247], a[180:183]
    v_add_f32 v34, v34, v176
    v_add_f32 v34, v34, v177
    v_mfma_f32_16x16x32_bf16 a[176:179], a[204:207], v[240:243], a[176:179]
    v_exp_f32 v180, v180
    v_mfma_f32_16x16x32_bf16 v[192:195], a[208:211], v[64:67], v[224:227]
    v_exp_f32 v181, v181
    v_mfma_f32_16x16x32_bf16 v[192:195], a[212:215], v[80:83], v[192:195]
    s_waitcnt lgkmcnt(1)
    v_add_f32 v34, v34, v178
    v_add_f32 v34, v34, v179
    v_mfma_f32_16x16x32_bf16 v[192:195], a[216:219], v[96:99], v[192:195]
    v_exp_f32 v182, v182
    v_mfma_f32_16x16x32_bf16 v[192:195], a[220:223], v[112:115], v[192:195]
    v_add_f32 v35, v35, v180
    v_add_f32 v35, v35, v181
    v_mfma_f32_16x16x32_bf16 v[192:195], a[224:227], v[128:131], v[192:195]
    v_exp_f32 v183, v183
    v_mfma_f32_16x16x32_bf16 v[192:195], a[228:231], v[144:147], v[192:195]
    v_exp_f32 v184, v184
    v_mfma_f32_16x16x32_bf16 v[196:199], a[208:211], v[68:71], v[228:231]
    v_add_u32 v32, 98304, v30
    v_add_u32 v33, 98304, v31
    v_mfma_f32_16x16x32_bf16 v[196:199], a[212:215], v[84:87], v[196:199]
    v_add_f32 v35, v35, v182
    v_cvt_pk_bf16_f32 v240, v160, v161
    v_mfma_f32_16x16x32_bf16 v[196:199], a[216:219], v[100:103], v[196:199]
    v_exp_f32 v185, v185
    v_mfma_f32_16x16x32_bf16 v[196:199], a[220:223], v[116:119], v[196:199]
    v_add_f32 v35, v35, v183
    v_cvt_pk_bf16_f32 v241, v162, v163
    v_mfma_f32_16x16x32_bf16 v[196:199], a[224:227], v[132:135], v[196:199]
    v_cvt_pk_bf16_f32 v244, v164, v165
    v_add_f32 v36, v36, v184
    v_mfma_f32_16x16x32_bf16 v[196:199], a[228:231], v[148:151], v[196:199]
    v_exp_f32 v186, v186
    v_mfma_f32_16x16x32_bf16 v[200:203], a[208:211], v[72:75], v[232:235]
    v_cvt_pk_bf16_f32 v245, v166, v167
    v_add_f32 v36, v36, v185
    v_mfma_f32_16x16x32_bf16 v[200:203], a[212:215], v[88:91], v[200:203]
    v_cvt_pk_bf16_f32 v248, v168, v169
    v_cvt_pk_bf16_f32 v249, v170, v171
    v_mfma_f32_16x16x32_bf16 v[200:203], a[216:219], v[104:107], v[200:203]
    s_waitcnt lgkmcnt(0)
    s_barrier
    v_mfma_f32_16x16x32_bf16 v[200:203], a[220:223], v[120:123], v[200:203]
    s_xor_b32 s6, s40, 0
    v_exp_f32 v187, v187
    v_mfma_f32_16x16x32_bf16 v[200:203], a[224:227], v[136:139], v[200:203]
    s_mul_i32 s6, s6, 245760
    ds_read_b64_tr_b16 a[192:193], v26 offset:0
    v_add_f32 v36, v36, v186
    v_mfma_f32_16x16x32_bf16 v[200:203], a[228:231], v[152:155], v[200:203]
    s_add_u32 s6, s6, s75
    ds_read_b64_tr_b16 a[194:195], v26 offset:6144
    v_cvt_pk_bf16_f32 v252, v172, v173
    v_mfma_f32_16x16x32_bf16 v[204:207], a[208:211], v[76:79], v[236:239]
    s_add_u32 s6, s6, 81920
    ds_read_b64_tr_b16 a[196:197], v27 offset:0
    v_cvt_pk_bf16_f32 v253, v174, v175
    v_mfma_f32_16x16x32_bf16 v[204:207], a[212:215], v[92:95], v[204:207]
    s_add_u32 m0, s42, 24576
    s_nop 0
    buffer_load_dwordx4 v1, s[16:19], s6 offen offset:0 sc1 lds
    v_mfma_f32_16x16x32_bf16 v[204:207], a[216:219], v[108:111], v[204:207]
    v_exp_f32 v188, v188
    v_mfma_f32_16x16x32_bf16 v[204:207], a[220:223], v[124:127], v[204:207]
    ds_read_b64_tr_b16 a[198:199], v27 offset:6144
    v_add_f32 v36, v36, v187
    v_mfma_f32_16x16x32_bf16 v[204:207], a[224:227], v[140:143], v[204:207]
    ds_read_b64_tr_b16 a[200:201], v28 offset:0
    v_cvt_pk_bf16_f32 v242, v176, v177
    v_mfma_f32_16x16x32_bf16 v[204:207], a[228:231], v[156:159], v[204:207]
    ds_read_b64_tr_b16 a[202:203], v28 offset:6144
    v_cvt_pk_bf16_f32 v243, v178, v179
    v_mfma_f32_16x16x32_bf16 v[208:211], a[232:235], v[64:67], v[224:227]
    v_exp_f32 v189, v189
    v_mfma_f32_16x16x32_bf16 v[208:211], a[236:239], v[80:83], v[208:211]
    ds_read_b64_tr_b16 a[204:205], v29 offset:0
    v_add_f32 v37, v37, v188
    v_mfma_f32_16x16x32_bf16 v[208:211], a[240:243], v[96:99], v[208:211]
    buffer_load_dwordx4 v1, s[16:19], s6 offen offset:1024 sc1 lds
    v_mfma_f32_16x16x32_bf16 v[208:211], a[244:247], v[112:115], v[208:211]
    ds_read_b64_tr_b16 a[206:207], v29 offset:6144
    v_cvt_pk_bf16_f32 v246, v180, v181
    v_mfma_f32_16x16x32_bf16 v[208:211], a[248:251], v[128:131], v[208:211]
    ds_read_b64_tr_b16 a[208:209], v26 offset:128
    v_cvt_pk_bf16_f32 v247, v182, v183
    v_mfma_f32_16x16x32_bf16 v[208:211], a[252:255], v[144:147], v[208:211]
    ds_read_b64_tr_b16 a[210:211], v26 offset:6272
    v_add_f32 v37, v37, v189
    v_mfma_f32_16x16x32_bf16 v[212:215], a[232:235], v[68:71], v[228:231]
    v_exp_f32 v190, v190
    v_mfma_f32_16x16x32_bf16 v[212:215], a[236:239], v[84:87], v[212:215]
    v_cvt_pk_bf16_f32 v250, v184, v185
    v_cvt_pk_bf16_f32 v251, v186, v187
    v_mfma_f32_16x16x32_bf16 v[212:215], a[240:243], v[100:103], v[212:215]
    ds_read_b64_tr_b16 a[212:213], v27 offset:128
    v_add_f32 v37, v37, v190
    v_mfma_f32_16x16x32_bf16 v[212:215], a[244:247], v[116:119], v[212:215]
    v_exp_f32 v191, v191
    v_mfma_f32_16x16x32_bf16 v[212:215], a[248:251], v[132:135], v[212:215]
    buffer_load_dwordx4 v1, s[16:19], s6 offen offset:2048 sc1 lds
    v_mfma_f32_16x16x32_bf16 v[212:215], a[252:255], v[148:151], v[212:215]
    ds_read_b64_tr_b16 a[214:215], v27 offset:6272
    v_cvt_pk_bf16_f32 v254, v188, v189
    v_mfma_f32_16x16x32_bf16 v[216:219], a[232:235], v[72:75], v[232:235]
    ds_read_b64_tr_b16 a[216:217], v28 offset:128
    v_add_f32 v37, v37, v191
    v_mfma_f32_16x16x32_bf16 v[216:219], a[236:239], v[88:91], v[216:219]
    ds_read_b64_tr_b16 a[218:219], v28 offset:6272
    v_cvt_pk_bf16_f32 v255, v190, v191
    v_mfma_f32_16x16x32_bf16 v[216:219], a[240:243], v[104:107], v[216:219]
    v_mfma_f32_16x16x32_bf16 v[216:219], a[244:247], v[120:123], v[216:219]
    v_mfma_f32_16x16x32_bf16 v[216:219], a[248:251], v[136:139], v[216:219]
    ds_read_b64_tr_b16 a[220:221], v29 offset:128
    v_mfma_f32_16x16x32_bf16 v[216:219], a[252:255], v[152:155], v[216:219]
    ds_read_b64_tr_b16 a[222:223], v29 offset:6272
    v_mfma_f32_16x16x32_bf16 v[220:223], a[232:235], v[76:79], v[236:239]
    buffer_load_dwordx4 v1, s[16:19], s6 offen offset:3072 sc1 lds
    v_mfma_f32_16x16x32_bf16 v[220:223], a[236:239], v[92:95], v[220:223]
    s_add_u32 m0, m0, 4096
    v_mfma_f32_16x16x32_bf16 v[220:223], a[240:243], v[108:111], v[220:223]
    v_exp_f32 v192, v192
    v_mfma_f32_16x16x32_bf16 v[220:223], a[244:247], v[124:127], v[220:223]
    v_exp_f32 v193, v193
    v_mfma_f32_16x16x32_bf16 v[220:223], a[248:251], v[140:143], v[220:223]
    v_exp_f32 v194, v194
    v_mfma_f32_16x16x32_bf16 v[220:223], a[252:255], v[156:159], v[220:223]
    s_waitcnt lgkmcnt(2)
    v_exp_f32 v195, v195
    v_mfma_f32_16x16x32_bf16 a[0:3], a[192:195], v[240:243], a[0:3]
    v_exp_f32 v196, v196
    v_mfma_f32_16x16x32_bf16 a[4:7], a[192:195], v[244:247], a[4:7]
    v_exp_f32 v197, v197
    v_mfma_f32_16x16x32_bf16 a[8:11], a[192:195], v[248:251], a[8:11]
    buffer_load_dwordx4 v39, s[16:19], s6 offen offset:0 sc1 lds
    v_mfma_f32_16x16x32_bf16 a[12:15], a[192:195], v[252:255], a[12:15]
    v_exp_f32 v198, v198
    v_mfma_f32_16x16x32_bf16 a[28:31], a[196:199], v[252:255], a[28:31]
    s_waitcnt vmcnt(5)
    v_sub_u32 v38, v38, v61
    v_subrev_u32 v38, 5, v38
    v_cmp_lt_u32 vcc, 10, v38
    s_cbranch_vccnz SPINWD
BACKWD:
    v_mfma_f32_16x16x32_bf16 a[24:27], a[196:199], v[248:251], a[24:27]
    s_add_u32 s6, s77, 0
    ds_read_b64_tr_b16 a[224:225], v26 offset:256
    v_add_f32 v34, v34, v192
    v_mfma_f32_16x16x32_bf16 a[20:23], a[196:199], v[244:247], a[20:23]
    s_add_u32 m0, s42, 49152
    v_exp_f32 v199, v199
    v_mfma_f32_16x16x32_bf16 a[16:19], a[196:199], v[240:243], a[16:19]
    ds_read_b64_tr_b16 a[226:227], v26 offset:6400
    v_add_f32 v34, v34, v193
    v_mfma_f32_16x16x32_bf16 a[32:35], a[200:203], v[240:243], a[32:35]
    v_exp_f32 v200, v200
    v_mfma_f32_16x16x32_bf16 a[36:39], a[200:203], v[244:247], a[36:39]
    ds_read_b64_tr_b16 a[228:229], v27 offset:256
    v_add_f32 v34, v34, v194
    v_mfma_f32_16x16x32_bf16 a[40:43], a[200:203], v[248:251], a[40:43]
    buffer_load_dwordx2 v[2:3], v48, s[20:23], s4 offen offset:0
    v_mfma_f32_16x16x32_bf16 a[44:47], a[200:203], v[252:255], a[44:47]
    ds_read_b64_tr_b16 a[230:231], v27 offset:6400
    v_add_f32 v34, v34, v195
    v_mfma_f32_16x16x32_bf16 a[60:63], a[204:207], v[252:255], a[60:63]
    v_exp_f32 v201, v201
    v_mfma_f32_16x16x32_bf16 a[56:59], a[204:207], v[248:251], a[56:59]
    ds_read_b64_tr_b16 a[232:233], v28 offset:256
    v_add_f32 v35, v35, v196
    v_mfma_f32_16x16x32_bf16 a[52:55], a[204:207], v[244:247], a[52:55]
    v_exp_f32 v202, v202
    v_mfma_f32_16x16x32_bf16 a[48:51], a[204:207], v[240:243], a[48:51]
    ds_read_b64_tr_b16 a[234:235], v28 offset:6400
    v_add_f32 v35, v35, v197
    v_mfma_f32_16x16x32_bf16 a[64:67], a[208:211], v[240:243], a[64:67]
    v_exp_f32 v203, v203
    v_mfma_f32_16x16x32_bf16 a[68:71], a[208:211], v[244:247], a[68:71]
    ds_read_b64_tr_b16 a[236:237], v29 offset:256
    v_add_f32 v35, v35, v198
    v_mfma_f32_16x16x32_bf16 a[72:75], a[208:211], v[248:251], a[72:75]
    buffer_load_dwordx4 v1, s[16:19], s6 offen offset:0 sc1 lds
    v_mfma_f32_16x16x32_bf16 a[76:79], a[208:211], v[252:255], a[76:79]
    v_exp_f32 v204, v204
    v_mfma_f32_16x16x32_bf16 a[92:95], a[212:215], v[252:255], a[92:95]
    ds_read_b64_tr_b16 a[238:239], v29 offset:6400
    v_add_f32 v35, v35, v199
    v_mfma_f32_16x16x32_bf16 a[88:91], a[212:215], v[248:251], a[88:91]
    ds_read_b128 a[240:243], v32 offset:0
    v_add_f32 v36, v36, v200
    v_mfma_f32_16x16x32_bf16 a[84:87], a[212:215], v[244:247], a[84:87]
    v_exp_f32 v205, v205
    v_mfma_f32_16x16x32_bf16 a[80:83], a[212:215], v[240:243], a[80:83]
    ds_read_b128 a[244:247], v33 offset:0
    v_add_f32 v36, v36, v201
    v_mfma_f32_16x16x32_bf16 a[96:99], a[216:219], v[240:243], a[96:99]
    v_exp_f32 v206, v206
    v_mfma_f32_16x16x32_bf16 a[100:103], a[216:219], v[244:247], a[100:103]
    ds_read_b128 a[248:251], v32 offset:128
    v_add_f32 v36, v36, v202
    v_mfma_f32_16x16x32_bf16 a[104:107], a[216:219], v[248:251], a[104:107]
WS8:
    s_cbranch_execz WS4
    buffer_load_dwordx2 v[4:5], v48, s[20:23], s4 offen offset:32
    v_mfma_f32_16x16x32_bf16 a[108:111], a[216:219], v[252:255], a[108:111]
    s_waitcnt lgkmcnt(4)
    v_exp_f32 v207, v207
    v_mfma_f32_16x16x32_bf16 a[124:127], a[220:223], v[252:255], a[124:127]
    ds_read_b128 a[252:255], v33 offset:128
    v_add_f32 v36, v36, v203
    v_mfma_f32_16x16x32_bf16 a[120:123], a[220:223], v[248:251], a[120:123]
    ds_read_b128 a[192:195], v32 offset:256
    v_add_f32 v37, v37, v204
    v_mfma_f32_16x16x32_bf16 a[116:119], a[220:223], v[244:247], a[116:119]
    ds_read_b128 a[196:199], v33 offset:256
    v_add_f32 v37, v37, v205
    v_mfma_f32_16x16x32_bf16 a[112:115], a[220:223], v[240:243], a[112:115]
    v_exp_f32 v208, v208
    v_mfma_f32_16x16x32_bf16 a[128:131], a[224:227], v[240:243], a[128:131]
    v_exp_f32 v209, v209
    v_mfma_f32_16x16x32_bf16 a[132:135], a[224:227], v[244:247], a[132:135]
    v_add_f32 v37, v37, v206
    v_add_f32 v37, v37, v207
    v_mfma_f32_16x16x32_bf16 a[136:139], a[224:227], v[248:251], a[136:139]
    buffer_load_dwordx2 v[6:7], v48, s[20:23], s4 offen offset:64
    v_mfma_f32_16x16x32_bf16 a[140:143], a[224:227], v[252:255], a[140:143]
    v_exp_f32 v210, v210
    v_mfma_f32_16x16x32_bf16 a[156:159], a[228:231], v[252:255], a[156:159]
    v_exp_f32 v211, v211
    v_mfma_f32_16x16x32_bf16 a[152:155], a[228:231], v[248:251], a[152:155]
    ds_read_b128 a[200:203], v32 offset:6144
    v_add_f32 v34, v34, v208
    v_mfma_f32_16x16x32_bf16 a[148:151], a[228:231], v[244:247], a[148:151]
    v_exp_f32 v212, v212
    v_mfma_f32_16x16x32_bf16 a[144:147], a[228:231], v[240:243], a[144:147]
    ds_read_b128 a[204:207], v33 offset:6144
    v_add_f32 v34, v34, v209
    v_mfma_f32_16x16x32_bf16 a[160:163], a[232:235], v[240:243], a[160:163]
    ds_read_b128 a[208:211], v32 offset:6272
    v_add_f32 v34, v34, v210
    v_mfma_f32_16x16x32_bf16 a[164:167], a[232:235], v[244:247], a[164:167]
    v_exp_f32 v213, v213
    v_mfma_f32_16x16x32_bf16 a[168:171], a[232:235], v[248:251], a[168:171]
    buffer_load_dwordx4 v1, s[16:19], s6 offen offset:1024 sc1 lds
    v_mfma_f32_16x16x32_bf16 a[172:175], a[232:235], v[252:255], a[172:175]
    s_waitcnt lgkmcnt(3)
    ds_read_b128 a[212:215], v33 offset:6272
    v_add_f32 v34, v34, v211
    v_mfma_f32_16x16x32_bf16 a[188:191], a[236:239], v[252:255], a[188:191]
    v_exp_f32 v214, v214
    v_mfma_f32_16x16x32_bf16 a[184:187], a[236:239], v[248:251], a[184:187]
    ds_read_b128 a[216:219], v32 offset:6400
    v_add_f32 v35, v35, v212
    v_mfma_f32_16x16x32_bf16 a[180:183], a[236:239], v[244:247], a[180:183]
    v_exp_f32 v215, v215
    v_mfma_f32_16x16x32_bf16 a[176:179], a[236:239], v[240:243], a[176:179]
    ds_read_b128 a[220:223], v33 offset:6400
    v_and_b32 v62, 3968, v42
    v_mfma_f32_16x16x32_bf16 v[160:163], a[240:243], v[64:67], v[224:227]
    s_lshl_b32 s58, s41, 5
    v_add_f32 v35, v35, v213
    s_lshl_b32 s58, s58, 7
    v_mfma_f32_16x16x32_bf16 v[160:163], a[244:247], v[80:83], v[160:163]
    s_add_u32 s58, s58, 62390272
    v_exp_f32 v216, v216
    v_mfma_f32_16x16x32_bf16 v[160:163], a[248:251], v[96:99], v[160:163]
    buffer_load_dword v38, v62, s[16:19], s58 offen offset:4 sc1
    v_mfma_f32_16x16x32_bf16 v[160:163], a[252:255], v[112:115], v[160:163]
    s_lshl_b32 s89, s3, 2
    v_add_f32 v35, v35, v214
    v_add_f32 v35, v35, v215
    v_mfma_f32_16x16x32_bf16 v[160:163], a[192:195], v[128:131], v[160:163]
    s_add_u32 s56, s89, 0x8000
    buffer_load_dwordx2 v[40:41], v48, s[20:23], s4 offen offset:96
    v_mfma_f32_16x16x32_bf16 v[160:163], a[196:199], v[144:147], v[160:163]
    s_xor_b32 s44, s3, 0
    v_exp_f32 v217, v217
    v_mfma_f32_16x16x32_bf16 v[164:167], a[240:243], v[68:71], v[228:231]
    s_mul_i32 s44, s44, 196608
    v_add_f32 v36, v36, v216
    v_cvt_pk_bf16_f32 v240, v192, v193
    v_mfma_f32_16x16x32_bf16 v[164:167], a[244:247], v[84:87], v[164:167]
    s_add_u32 s44, s44, s76
    v_exp_f32 v218, v218
    v_mfma_f32_16x16x32_bf16 v[164:167], a[248:251], v[100:103], v[164:167]
    s_xor_b32 s45, s3, 1
    v_cvt_pk_bf16_f32 v241, v194, v195
    v_add_f32 v36, v36, v217
    v_mfma_f32_16x16x32_bf16 v[164:167], a[252:255], v[116:119], v[164:167]
    s_mul_i32 s45, s45, 196608
    v_cvt_pk_bf16_f32 v244, v196, v197
    v_cvt_pk_bf16_f32 v245, v198, v199
    v_mfma_f32_16x16x32_bf16 v[164:167], a[192:195], v[132:135], v[164:167]
    s_add_u32 s45, s45, s76
    v_exp_f32 v219, v219
    v_mfma_f32_16x16x32_bf16 v[164:167], a[196:199], v[148:151], v[164:167]
    s_xor_b32 s46, s3, 2
    v_cvt_pk_bf16_f32 v248, v200, v201
    v_add_f32 v36, v36, v218
    v_mfma_f32_16x16x32_bf16 v[168:171], a[240:243], v[72:75], v[232:235]
    s_mul_i32 s46, s46, 196608
    buffer_load_dwordx2 v[30:31], v48, s[20:23], s4 offen offset:128
    v_mfma_f32_16x16x32_bf16 v[168:171], a[244:247], v[88:91], v[168:171]
    s_add_u32 s46, s46, s76
    ds_read_b64_tr_b16 a[224:225], v26 offset:12288
    v_cvt_pk_bf16_f32 v249, v202, v203
    v_mfma_f32_16x16x32_bf16 v[168:171], a[248:251], v[104:107], v[168:171]
    s_xor_b32 s47, s3, 3
    v_exp_f32 v220, v220
    v_mfma_f32_16x16x32_bf16 v[168:171], a[252:255], v[120:123], v[168:171]
    s_mul_i32 s47, s47, 196608
    ds_read_b64_tr_b16 a[226:227], v26 offset:18432
    v_cvt_pk_bf16_f32 v252, v204, v205
    v_mfma_f32_16x16x32_bf16 v[168:171], a[192:195], v[136:139], v[168:171]
    s_add_u32 s47, s47, s76
    ds_read_b64_tr_b16 a[228:229], v27 offset:12288
    v_add_f32 v36, v36, v219
    v_mfma_f32_16x16x32_bf16 v[168:171], a[196:199], v[152:155], v[168:171]
    ds_read_b64_tr_b16 a[230:231], v27 offset:18432
    v_cvt_pk_bf16_f32 v253, v206, v207
    v_mfma_f32_16x16x32_bf16 v[172:175], a[240:243], v[76:79], v[236:239]
    v_cvt_pk_bf16_f32 v242, v208, v209
    v_add_f32 v37, v37, v220
    v_mfma_f32_16x16x32_bf16 v[172:175], a[244:247], v[92:95], v[172:175]
    v_exp_f32 v221, v221
    v_mfma_f32_16x16x32_bf16 v[172:175], a[248:251], v[108:111], v[172:175]
    buffer_load_dwordx4 v1, s[16:19], s6 offen offset:2048 sc1 lds
    v_mfma_f32_16x16x32_bf16 v[172:175], a[252:255], v[124:127], v[172:175]
    ds_read_b64_tr_b16 a[232:233], v28 offset:12288
    v_cvt_pk_bf16_f32 v243, v210, v211
    v_mfma_f32_16x16x32_bf16 v[172:175], a[192:195], v[140:143], v[172:175]
    ds_read_b64_tr_b16 a[234:235], v28 offset:18432
    v_cvt_pk_bf16_f32 v246, v212, v213
    v_mfma_f32_16x16x32_bf16 v[172:175], a[196:199], v[156:159], v[172:175]
    s_waitcnt lgkmcnt(5)
    v_add_f32 v37, v37, v221
    v_cvt_pk_bf16_f32 v247, v214, v215
    v_mfma_f32_16x16x32_bf16 v[176:179], a[200:203], v[64:67], v[224:227]
    v_exp_f32 v222, v222
    v_mfma_f32_16x16x32_bf16 v[176:179], a[204:207], v[80:83], v[176:179]
    ds_read_b64_tr_b16 a[236:237], v29 offset:12288
    v_cvt_pk_bf16_f32 v250, v216, v217
    v_mfma_f32_16x16x32_bf16 v[176:179], a[208:211], v[96:99], v[176:179]
    ds_read_b64_tr_b16 a[238:239], v29 offset:18432
    v_add_f32 v37, v37, v222
    v_mfma_f32_16x16x32_bf16 v[176:179], a[212:215], v[112:115], v[176:179]
    v_cvt_pk_bf16_f32 v251, v218, v219
    v_cvt_pk_bf16_f32 v254, v220, v221
    v_mfma_f32_16x16x32_bf16 v[176:179], a[216:219], v[128:131], v[176:179]
    buffer_load_dwordx4 v1, s[16:19], s6 offen offset:3072 sc1 lds
    v_mfma_f32_16x16x32_bf16 v[176:179], a[220:223], v[144:147], v[176:179]
    s_add_u32 m0, m0, 4096
    v_exp_f32 v223, v223
    v_mfma_f32_16x16x32_bf16 v[180:183], a[200:203], v[68:71], v[228:231]
    s_mov_b32 s55, 0x8000
    ds_read_b64_tr_b16 a[240:241], v26 offset:12416
    v_add_f32 v37, v37, v223
    v_mfma_f32_16x16x32_bf16 v[180:183], a[204:207], v[84:87], v[180:183]
    ds_read_b64_tr_b16 a[242:243], v26 offset:18560
    v_cvt_pk_bf16_f32 v255, v222, v223
    v_mfma_f32_16x16x32_bf16 v[180:183], a[208:211], v[100:103], v[180:183]
    v_exp_f32 v160, v160
    v_mfma_f32_16x16x32_bf16 v[180:183], a[212:215], v[116:119], v[180:183]
    v_exp_f32 v161, v161
    v_mfma_f32_16x16x32_bf16 v[180:183], a[216:219], v[132:135], v[180:183]
    v_exp_f32 v162, v162
    v_mfma_f32_16x16x32_bf16 v[180:183], a[220:223], v[148:151], v[180:183]
    ds_read_b64_tr_b16 a[244:245], v27 offset:12416
    v_add_f32 v34, v34, v160
    v_mfma_f32_16x16x32_bf16 v[184:187], a[200:203], v[72:75], v[232:235]
    buffer_load_dword v60, v9, s[16:19], s55 offen sc1
    v_mfma_f32_16x16x32_bf16 v[184:187], a[204:207], v[88:91], v[184:187]
    v_exp_f32 v163, v163
    v_mfma_f32_16x16x32_bf16 v[184:187], a[208:211], v[104:107], v[184:187]
    buffer_load_dwordx4 v39, s[16:19], s6 offen offset:0 sc1 lds
    v_mfma_f32_16x16x32_bf16 v[184:187], a[212:215], v[120:123], v[184:187]
    s_add_u32 s6, s77, 450560
    ds_read_b64_tr_b16 a[246:247], v27 offset:18560
    v_add_f32 v34, v34, v161
    v_mfma_f32_16x16x32_bf16 v[184:187], a[216:219], v[136:139], v[184:187]
    s_add_u32 m0, s7, 147456
    v_exp_f32 v164, v164
    v_mfma_f32_16x16x32_bf16 v[184:187], a[220:223], v[152:155], v[184:187]
    ds_read_b64_tr_b16 a[248:249], v28 offset:12416
    v_add_f32 v34, v34, v162
    v_mfma_f32_16x16x32_bf16 v[188:191], a[200:203], v[76:79], v[236:239]
    ds_read_b64_tr_b16 a[250:251], v28 offset:18560
    v_add_f32 v34, v34, v163
    v_mfma_f32_16x16x32_bf16 v[188:191], a[204:207], v[92:95], v[188:191]
    v_exp_f32 v165, v165
    v_mfma_f32_16x16x32_bf16 v[188:191], a[208:211], v[108:111], v[188:191]
    v_exp_f32 v166, v166
    v_mfma_f32_16x16x32_bf16 v[188:191], a[212:215], v[124:127], v[188:191]
    ds_read_b64_tr_b16 a[252:253], v29 offset:12416
    v_add_f32 v35, v35, v164
    v_mfma_f32_16x16x32_bf16 v[188:191], a[216:219], v[140:143], v[188:191]
    buffer_load_dwordx4 v1, s[16:19], s6 offen offset:0 sc1 lds
    v_mfma_f32_16x16x32_bf16 v[188:191], a[220:223], v[156:159], v[188:191]
    s_waitcnt lgkmcnt(4)
    ds_read_b64_tr_b16 a[254:255], v29 offset:18560
    v_add_f32 v35, v35, v165
    v_mfma_f32_16x16x32_bf16 a[0:3], a[224:227], v[240:243], a[0:3]
    s_add_u32 m0, s7, 147456
    v_exp_f32 v167, v167
    v_mfma_f32_16x16x32_bf16 a[4:7], a[224:227], v[244:247], a[4:7]
    ds_read_b64_tr_b16 a[192:193], v26 offset:12544
    v_add_f32 v35, v35, v166
    v_mfma_f32_16x16x32_bf16 a[8:11], a[224:227], v[248:251], a[8:11]
    v_exp_f32 v168, v168
    v_mfma_f32_16x16x32_bf16 a[12:15], a[224:227], v[252:255], a[12:15]
    ds_read_b64_tr_b16 a[194:195], v26 offset:18688
    v_add_f32 v35, v35, v167
    v_mfma_f32_16x16x32_bf16 a[28:31], a[228:231], v[252:255], a[28:31]
    v_exp_f32 v169, v169
    v_mfma_f32_16x16x32_bf16 a[24:27], a[228:231], v[248:251], a[24:27]
    ds_read_b64_tr_b16 a[196:197], v27 offset:12544
    v_add_f32 v36, v36, v168
    v_mfma_f32_16x16x32_bf16 a[20:23], a[228:231], v[244:247], a[20:23]
    buffer_load_dwordx4 v1, s[16:19], s6 offen offset:1024 sc1 lds
    v_mfma_f32_16x16x32_bf16 a[16:19], a[228:231], v[240:243], a[16:19]
    s_add_u32 m0, s7, 147456
    v_exp_f32 v170, v170
    v_mfma_f32_16x16x32_bf16 a[32:35], a[232:235], v[240:243], a[32:35]
    ds_read_b64_tr_b16 a[198:199], v27 offset:18688
    v_add_f32 v36, v36, v169
    v_mfma_f32_16x16x32_bf16 a[36:39], a[232:235], v[244:247], a[36:39]
    v_exp_f32 v171, v171
    v_mfma_f32_16x16x32_bf16 a[40:43], a[232:235], v[248:251], a[40:43]
    ds_read_b64_tr_b16 a[200:201], v28 offset:12544
    v_add_f32 v36, v36, v170
    v_mfma_f32_16x16x32_bf16 a[44:47], a[232:235], v[252:255], a[44:47]
    ds_read_b64_tr_b16 a[202:203], v28 offset:18688
    v_add_f32 v36, v36, v171
    v_mfma_f32_16x16x32_bf16 a[60:63], a[236:239], v[252:255], a[60:63]
    v_exp_f32 v172, v172
    v_mfma_f32_16x16x32_bf16 a[56:59], a[236:239], v[248:251], a[56:59]
    v_exp_f32 v173, v173
    v_mfma_f32_16x16x32_bf16 a[52:55], a[236:239], v[244:247], a[52:55]
    buffer_load_dwordx4 v1, s[16:19], s6 offen offset:2048 sc1 lds
    v_mfma_f32_16x16x32_bf16 a[48:51], a[236:239], v[240:243], a[48:51]
    s_add_u32 m0, s7, 147456
    ds_read_b64_tr_b16 a[204:205], v29 offset:12544
    v_add_f32 v37, v37, v172
    v_mfma_f32_16x16x32_bf16 a[64:67], a[240:243], v[240:243], a[64:67]
    ds_read_b64_tr_b16 a[206:207], v29 offset:18688
    v_add_u32 v26, 122880, v22
    v_mfma_f32_16x16x32_bf16 a[68:71], a[240:243], v[244:247], a[68:71]
    v_exp_f32 v174, v174
    v_mfma_f32_16x16x32_bf16 a[72:75], a[240:243], v[248:251], a[72:75]
    v_add_u32 v27, 122880, v23
    v_add_u32 v28, 122880, v24
    v_mfma_f32_16x16x32_bf16 a[76:79], a[240:243], v[252:255], a[76:79]
    s_waitcnt lgkmcnt(3)
    v_add_u32 v29, 122880, v25
    v_add_f32 v37, v37, v173
    v_mfma_f32_16x16x32_bf16 a[92:95], a[244:247], v[252:255], a[92:95]
    v_exp_f32 v175, v175
    v_mfma_f32_16x16x32_bf16 a[88:91], a[244:247], v[248:251], a[88:91]
    ds_read_b128 a[208:211], v32 offset:12288
    v_add_f32 v37, v37, v174
    v_mfma_f32_16x16x32_bf16 a[84:87], a[244:247], v[244:247], a[84:87]
    buffer_load_dwordx4 v1, s[16:19], s6 offen offset:3072 sc1 lds
    v_mfma_f32_16x16x32_bf16 a[80:83], a[244:247], v[240:243], a[80:83]
    s_add_u32 s6, s77, 409600
    ds_read_b128 a[212:215], v33 offset:12288
    v_add_f32 v37, v37, v175
    v_mfma_f32_16x16x32_bf16 a[96:99], a[248:251], v[240:243], a[96:99]
    s_add_u32 m0, s42, 5120
    v_exp_f32 v176, v176
    v_mfma_f32_16x16x32_bf16 a[100:103], a[248:251], v[244:247], a[100:103]
    ds_read_b128 a[216:219], v32 offset:12416
    v_add_f32 v34, v34, v176
    v_mfma_f32_16x16x32_bf16 a[104:107], a[248:251], v[248:251], a[104:107]
    v_exp_f32 v177, v177
    v_mfma_f32_16x16x32_bf16 a[108:111], a[248:251], v[252:255], a[108:111]
    ds_read_b128 a[220:223], v33 offset:12416
    v_add_f32 v34, v34, v177
    v_mfma_f32_16x16x32_bf16 a[124:127], a[252:255], v[252:255], a[124:127]
    s_add_u32 s62, s88, 0
    v_exp_f32 v178, v178
    v_mfma_f32_16x16x32_bf16 a[120:123], a[252:255], v[248:251], a[120:123]
    ds_read_b128 a[224:227], v32 offset:12544
    v_add_f32 v34, v34, v178
    v_mfma_f32_16x16x32_bf16 a[116:119], a[252:255], v[244:247], a[116:119]
    buffer_load_dwordx4 v1, s[16:19], s6 offen offset:0 sc1 lds
    v_mfma_f32_16x16x32_bf16 a[112:115], a[252:255], v[240:243], a[112:115]
    s_add_u32 m0, s42, 28672
    v_exp_f32 v179, v179
    v_mfma_f32_16x16x32_bf16 a[128:131], a[192:195], v[240:243], a[128:131]
    ds_read_b128 a[228:231], v33 offset:12544
    v_add_f32 v34, v34, v179
    v_mfma_f32_16x16x32_bf16 a[132:135], a[192:195], v[244:247], a[132:135]
    v_exp_f32 v180, v180
    v_mfma_f32_16x16x32_bf16 a[136:139], a[192:195], v[248:251], a[136:139]
    v_exp_f32 v181, v181
    v_mfma_f32_16x16x32_bf16 a[140:143], a[192:195], v[252:255], a[140:143]
    v_exp_f32 v182, v182
    v_mfma_f32_16x16x32_bf16 a[156:159], a[196:199], v[252:255], a[156:159]
    ds_read_b128 a[232:235], v32 offset:18432
    v_add_f32 v35, v35, v180
    v_mfma_f32_16x16x32_bf16 a[152:155], a[196:199], v[248:251], a[152:155]
    ds_read_b128 a[236:239], v33 offset:18432
    v_add_f32 v35, v35, v181
    v_mfma_f32_16x16x32_bf16 a[148:151], a[196:199], v[244:247], a[148:151]
    buffer_load_dword v60, v42, s[16:19], s62 offen sc1
    v_mfma_f32_16x16x32_bf16 a[144:147], a[196:199], v[240:243], a[144:147]
    s_waitcnt lgkmcnt(3)
    ds_read_b128 a[240:243], v32 offset:18560
    v_add_f32 v35, v35, v182
    v_mfma_f32_16x16x32_bf16 a[160:163], a[200:203], v[240:243], a[160:163]
    buffer_load_dwordx4 v1, s[16:19], s6 offen offset:1024 sc1 lds
    v_mfma_f32_16x16x32_bf16 a[164:167], a[200:203], v[244:247], a[164:167]
    s_add_u32 m0, s42, 52224
    ds_read_b128 a[244:247], v33 offset:18560
    v_mov_b32 v55, 0x53800000
    v_mfma_f32_16x16x32_bf16 a[168:171], a[200:203], v[248:251], a[168:171]
    v_exp_f32 v183, v183
    v_mfma_f32_16x16x32_bf16 a[172:175], a[200:203], v[252:255], a[172:175]
    ds_read_b128 a[248:251], v32 offset:18688
    v_add_f32 v35, v35, v183
    v_mfma_f32_16x16x32_bf16 a[188:191], a[204:207], v[252:255], a[188:191]
    s_waitcnt vmcnt(13)
    v_sub_u32 v38, v38, v61
    v_subrev_u32 v38, 1, v38
    v_cmp_lt_u32 vcc, 14, v38
    s_cbranch_vccnz SPINH
BACKH:
    v_mfma_f32_16x16x32_bf16 a[184:187], a[204:207], v[248:251], a[184:187]
    ds_read_b128 a[252:255], v33 offset:18688
    v_lshlrev_b32 v62, 3, v42
    v_mfma_f32_16x16x32_bf16 a[180:183], a[204:207], v[244:247], a[180:183]
    v_exp_f32 v184, v184
    v_mfma_f32_16x16x32_bf16 a[176:179], a[204:207], v[240:243], a[176:179]
    v_exp_f32 v185, v185
    v_mfma_f32_16x16x32_bf16 v[192:195], a[208:211], v[64:67], v[224:227]
    buffer_load_dwordx4 v1, s[16:19], s6 offen offset:2048 sc1 lds
    v_mfma_f32_16x16x32_bf16 v[192:195], a[212:215], v[80:83], v[192:195]
    v_cvt_pk_bf16_f32 v240, v160, v161
    v_cvt_pk_bf16_f32 v241, v162, v163
    v_mfma_f32_16x16x32_bf16 v[192:195], a[216:219], v[96:99], v[192:195]
    v_cvt_pk_bf16_f32 v244, v164, v165
    v_add_f32 v36, v36, v184
    v_mfma_f32_16x16x32_bf16 v[192:195], a[220:223], v[112:115], v[192:195]
    v_exp_f32 v186, v186
    v_mfma_f32_16x16x32_bf16 v[192:195], a[224:227], v[128:131], v[192:195]
    s_waitcnt lgkmcnt(1)
    v_cvt_pk_bf16_f32 v245, v166, v167
    v_add_f32 v36, v36, v185
    v_mfma_f32_16x16x32_bf16 v[192:195], a[228:231], v[144:147], v[192:195]
    v_cvt_pk_bf16_f32 v248, v168, v169
    v_cvt_pk_bf16_f32 v249, v170, v171
    v_mfma_f32_16x16x32_bf16 v[196:199], a[208:211], v[68:71], v[228:231]
    v_exp_f32 v187, v187
    v_mfma_f32_16x16x32_bf16 v[196:199], a[212:215], v[84:87], v[196:199]
    v_add_f32 v36, v36, v186
    v_cvt_pk_bf16_f32 v252, v172, v173
    v_mfma_f32_16x16x32_bf16 v[196:199], a[216:219], v[100:103], v[196:199]
    v_cvt_pk_bf16_f32 v253, v174, v175
    v_add_f32 v36, v36, v187
    v_mfma_f32_16x16x32_bf16 v[196:199], a[220:223], v[116:119], v[196:199]
    v_exp_f32 v188, v188
    v_mfma_f32_16x16x32_bf16 v[196:199], a[224:227], v[132:135], v[196:199]
    v_cvt_pk_bf16_f32 v242, v176, v177
    v_cvt_pk_bf16_f32 v243, v178, v179
    v_mfma_f32_16x16x32_bf16 v[196:199], a[228:231], v[148:151], v[196:199]
    v_exp_f32 v189, v189
    v_mfma_f32_16x16x32_bf16 v[200:203], a[208:211], v[72:75], v[232:235]
    v_exp_f32 v192, v192
    v_mfma_f32_16x16x32_bf16 v[200:203], a[212:215], v[88:91], v[200:203]
    v_exp_f32 v193, v193
    v_mfma_f32_16x16x32_bf16 v[200:203], a[216:219], v[104:107], v[200:203]
    s_waitcnt lgkmcnt(0)
    s_barrier
    v_mfma_f32_16x16x32_bf16 v[200:203], a[220:223], v[120:123], v[200:203]
    s_xor_b32 s6, s40, 0
    v_exp_f32 v194, v194
    v_mfma_f32_16x16x32_bf16 v[200:203], a[224:227], v[136:139], v[200:203]
    s_mul_i32 s6, s6, 245760
    ds_read_b64_tr_b16 a[192:193], v26 offset:0
    v_add_f32 v37, v37, v188
    v_mfma_f32_16x16x32_bf16 v[200:203], a[228:231], v[152:155], v[200:203]
    s_add_u32 s6, s6, s75
    ds_read_b64_tr_b16 a[194:195], v26 offset:6144
    v_cvt_pk_bf16_f32 v246, v180, v181
    v_mfma_f32_16x16x32_bf16 v[204:207], a[208:211], v[76:79], v[236:239]
    s_add_u32 s6, s6, 163840
    v_exp_f32 v195, v195
    v_mfma_f32_16x16x32_bf16 v[204:207], a[212:215], v[92:95], v[204:207]
    s_add_u32 m0, s42, 98304
    s_nop 0
    buffer_load_dwordx4 v1, s[16:19], s6 offen offset:0 sc1 lds
    v_mfma_f32_16x16x32_bf16 v[204:207], a[216:219], v[108:111], v[204:207]
    ds_read_b64_tr_b16 a[196:197], v27 offset:0
    v_cvt_pk_bf16_f32 v247, v182, v183
    v_mfma_f32_16x16x32_bf16 v[204:207], a[220:223], v[124:127], v[204:207]
    ds_read_b64_tr_b16 a[198:199], v27 offset:6144
    v_add_f32 v37, v37, v189
    v_mfma_f32_16x16x32_bf16 v[204:207], a[224:227], v[140:143], v[204:207]
    v_exp_f32 v190, v190
    v_mfma_f32_16x16x32_bf16 v[204:207], a[228:231], v[156:159], v[204:207]
    ds_read_b64_tr_b16 a[200:201], v28 offset:0
    v_cvt_pk_bf16_f32 v250, v184, v185
    v_mfma_f32_16x16x32_bf16 v[208:211], a[232:235], v[64:67], v[224:227]
    ds_read_b64_tr_b16 a[202:203], v28 offset:6144
    v_cvt_pk_bf16_f32 v251, v186, v187
    v_mfma_f32_16x16x32_bf16 v[208:211], a[236:239], v[80:83], v[208:211]
    ds_read_b64_tr_b16 a[204:205], v29 offset:0
    v_add_f32 v37, v37, v190
    v_mfma_f32_16x16x32_bf16 v[208:211], a[240:243], v[96:99], v[208:211]
    buffer_load_dwordx4 v1, s[16:19], s6 offen offset:1024 sc1 lds
    v_exp_f32 v191, v191
    v_mfma_f32_16x16x32_bf16 v[208:211], a[244:247], v[112:115], v[208:211]
    v_exp_f32 v196, v196
    v_add_f32 v37, v37, v191
    v_cvt_pk_bf16_f32 v254, v188, v189
    v_cvt_pk_bf16_f32 v255, v190, v191
    v_mfma_f32_16x16x32_bf16 v[208:211], a[248:251], v[128:131], v[208:211]
    v_exp_f32 v197, v197
    v_mfma_f32_16x16x32_bf16 v[208:211], a[252:255], v[144:147], v[208:211]
    v_exp_f32 v198, v198
    v_mfma_f32_16x16x32_bf16 v[212:215], a[232:235], v[68:71], v[228:231]
    ds_read_b64_tr_b16 a[206:207], v29 offset:6144
    v_add_f32 v34, v34, v192
    v_mfma_f32_16x16x32_bf16 v[212:215], a[236:239], v[84:87], v[212:215]
    v_exp_f32 v199, v199
    v_mfma_f32_16x16x32_bf16 v[212:215], a[240:243], v[100:103], v[212:215]
    ds_read_b64_tr_b16 a[208:209], v26 offset:128
    v_add_f32 v34, v34, v193
    v_mfma_f32_16x16x32_bf16 v[212:215], a[244:247], v[116:119], v[212:215]
    v_exp_f32 v200, v200
    v_mfma_f32_16x16x32_bf16 v[212:215], a[248:251], v[132:135], v[212:215]
    buffer_load_dwordx4 v1, s[16:19], s6 offen offset:2048 sc1 lds
    v_mfma_f32_16x16x32_bf16 v[212:215], a[252:255], v[148:151], v[212:215]
    ds_read_b64_tr_b16 a[210:211], v26 offset:6272
    v_add_f32 v34, v34, v194
    v_mfma_f32_16x16x32_bf16 v[216:219], a[232:235], v[72:75], v[232:235]
    v_exp_f32 v201, v201
    v_mfma_f32_16x16x32_bf16 v[216:219], a[236:239], v[88:91], v[216:219]
    ds_read_b64_tr_b16 a[212:213], v27 offset:128
    v_add_f32 v34, v34, v195
    v_mfma_f32_16x16x32_bf16 v[216:219], a[240:243], v[104:107], v[216:219]
    ds_read_b64_tr_b16 a[214:215], v27 offset:6272
    v_add_f32 v35, v35, v196
    v_mfma_f32_16x16x32_bf16 v[216:219], a[244:247], v[120:123], v[216:219]
    v_exp_f32 v202, v202
    v_mfma_f32_16x16x32_bf16 v[216:219], a[248:251], v[136:139], v[216:219]
    ds_read_b64_tr_b16 a[216:217], v28 offset:128
    v_add_f32 v35, v35, v197
    v_mfma_f32_16x16x32_bf16 v[216:219], a[252:255], v[152:155], v[216:219]
    v_exp_f32 v203, v203
    v_mfma_f32_16x16x32_bf16 v[220:223], a[232:235], v[76:79], v[236:239]
    buffer_load_dwordx4 v1, s[16:19], s6 offen offset:3072 sc1 lds
    v_mfma_f32_16x16x32_bf16 v[220:223], a[236:239], v[92:95], v[220:223]
    s_add_u32 m0, m0, 4096
    ds_read_b64_tr_b16 a[218:219], v28 offset:6272
    v_add_f32 v35, v35, v198
    v_mfma_f32_16x16x32_bf16 v[220:223], a[240:243], v[108:111], v[220:223]
    v_exp_f32 v204, v204
    v_mfma_f32_16x16x32_bf16 v[220:223], a[244:247], v[124:127], v[220:223]
    ds_read_b64_tr_b16 a[220:221], v29 offset:128
    v_add_f32 v35, v35, v199
    v_mfma_f32_16x16x32_bf16 v[220:223], a[248:251], v[140:143], v[220:223]
    v_exp_f32 v205, v205
    v_mfma_f32_16x16x32_bf16 v[220:223], a[252:255], v[156:159], v[220:223]
    s_waitcnt lgkmcnt(3)
    ds_read_b64_tr_b16 a[222:223], v29 offset:6272
    v_add_f32 v36, v36, v200
    v_mfma_f32_16x16x32_bf16 a[0:3], a[192:195], v[240:243], a[0:3]
    ds_read_b64_tr_b16 a[224:225], v26 offset:256
    v_add_f32 v36, v36, v201
    v_mfma_f32_16x16x32_bf16 a[4:7], a[192:195], v[244:247], a[4:7]
    v_exp_f32 v206, v206
    v_mfma_f32_16x16x32_bf16 a[8:11], a[192:195], v[248:251], a[8:11]
    buffer_load_dwordx4 v39, s[16:19], s6 offen offset:0 sc1 lds
    v_mfma_f32_16x16x32_bf16 a[12:15], a[192:195], v[252:255], a[12:15]
    s_add_u32 s6, s77, 40960
    ds_read_b64_tr_b16 a[226:227], v26 offset:6400
    v_add_f32 v36, v36, v202
    v_mfma_f32_16x16x32_bf16 a[28:31], a[196:199], v[252:255], a[28:31]
    s_add_u32 m0, s42, 73728
    v_exp_f32 v207, v207
    v_mfma_f32_16x16x32_bf16 a[24:27], a[196:199], v[248:251], a[24:27]
    ds_read_b64_tr_b16 a[228:229], v27 offset:256
    v_add_f32 v36, v36, v203
    v_mfma_f32_16x16x32_bf16 a[20:23], a[196:199], v[244:247], a[20:23]
    buffer_load_dwordx4 v1, s[16:19], s6 offen offset:0 sc1 lds
    v_mfma_f32_16x16x32_bf16 a[16:19], a[196:199], v[240:243], a[16:19]
    v_exp_f32 v208, v208
    v_mfma_f32_16x16x32_bf16 a[32:35], a[200:203], v[240:243], a[32:35]
    ds_read_b64_tr_b16 a[230:231], v27 offset:6400
    v_add_f32 v37, v37, v204
    v_mfma_f32_16x16x32_bf16 a[36:39], a[200:203], v[244:247], a[36:39]
    v_exp_f32 v209, v209
    v_mfma_f32_16x16x32_bf16 a[40:43], a[200:203], v[248:251], a[40:43]
    buffer_load_dwordx4 v1, s[16:19], s6 offen offset:1024 sc1 lds
    v_mfma_f32_16x16x32_bf16 a[44:47], a[200:203], v[252:255], a[44:47]
    ds_read_b64_tr_b16 a[232:233], v28 offset:256
    v_add_f32 v37, v37, v205
    v_mfma_f32_16x16x32_bf16 a[60:63], a[204:207], v[252:255], a[60:63]
    s_add_u32 s62, s88, 8192
    ds_read_b64_tr_b16 a[234:235], v28 offset:6400
    v_add_f32 v37, v37, v206
    v_mfma_f32_16x16x32_bf16 a[56:59], a[204:207], v[248:251], a[56:59]
    v_exp_f32 v210, v210
    v_mfma_f32_16x16x32_bf16 a[52:55], a[204:207], v[244:247], a[52:55]
    buffer_load_dwordx4 v1, s[16:19], s6 offen offset:2048 sc1 lds
    v_mfma_f32_16x16x32_bf16 a[48:51], a[204:207], v[240:243], a[48:51]
    ds_read_b64_tr_b16 a[236:237], v29 offset:256
    v_add_f32 v37, v37, v207
    v_mfma_f32_16x16x32_bf16 a[64:67], a[208:211], v[240:243], a[64:67]
    v_exp_f32 v211, v211
    v_mfma_f32_16x16x32_bf16 a[68:71], a[208:211], v[244:247], a[68:71]
    ds_read_b64_tr_b16 a[238:239], v29 offset:6400
    v_add_f32 v34, v34, v208
    v_mfma_f32_16x16x32_bf16 a[72:75], a[208:211], v[248:251], a[72:75]
    buffer_load_dword v60, v42, s[16:19], s62 offen sc1
    v_mfma_f32_16x16x32_bf16 a[76:79], a[208:211], v[252:255], a[76:79]
    v_exp_f32 v212, v212
    v_mfma_f32_16x16x32_bf16 a[92:95], a[212:215], v[252:255], a[92:95]
    buffer_load_dwordx4 v1, s[16:19], s6 offen offset:3072 sc1 lds
    v_mfma_f32_16x16x32_bf16 a[88:91], a[212:215], v[248:251], a[88:91]
    s_add_u32 m0, m0, 4096
    ds_read_b64_tr_b16 a[240:241], v26 offset:12288
    v_add_f32 v34, v34, v209
    v_mfma_f32_16x16x32_bf16 a[84:87], a[212:215], v[244:247], a[84:87]
    v_exp_f32 v213, v213
    v_mfma_f32_16x16x32_bf16 a[80:83], a[212:215], v[240:243], a[80:83]
    s_waitcnt lgkmcnt(3)
    ds_read_b64_tr_b16 a[242:243], v26 offset:18432
    v_add_f32 v34, v34, v210
    v_mfma_f32_16x16x32_bf16 a[96:99], a[216:219], v[240:243], a[96:99]
    buffer_load_dwordx4 v39, s[16:19], s6 offen offset:0 sc1 lds
    v_mfma_f32_16x16x32_bf16 a[100:103], a[216:219], v[244:247], a[100:103]
    s_add_u32 s6, s77, 409600
    ds_read_b64_tr_b16 a[244:245], v27 offset:12288
    v_add_f32 v34, v34, v211
    v_mfma_f32_16x16x32_bf16 a[104:107], a[216:219], v[248:251], a[104:107]
    s_add_u32 m0, s42, 75776
    v_exp_f32 v214, v214
    v_mfma_f32_16x16x32_bf16 a[108:111], a[216:219], v[252:255], a[108:111]
    ds_read_b64_tr_b16 a[246:247], v27 offset:18432
    v_add_f32 v35, v35, v212
    v_mfma_f32_16x16x32_bf16 a[124:127], a[220:223], v[252:255], a[124:127]
    buffer_load_dwordx4 v1, s[16:19], s6 offen offset:3072 sc1 lds
    v_mfma_f32_16x16x32_bf16 a[120:123], a[220:223], v[248:251], a[120:123]
    s_add_u32 m0, s42, 103424
    v_exp_f32 v215, v215
    v_mfma_f32_16x16x32_bf16 a[116:119], a[220:223], v[244:247], a[116:119]
    ds_read_b64_tr_b16 a[248:249], v28 offset:12288
    v_add_f32 v35, v35, v213
    v_mfma_f32_16x16x32_bf16 a[112:115], a[220:223], v[240:243], a[112:115]
    v_exp_f32 v216, v216
    v_mfma_f32_16x16x32_bf16 a[128:131], a[224:227], v[240:243], a[128:131]
    buffer_load_dwordx4 v39, s[16:19], s6 offen offset:0 sc1 lds
    v_mfma_f32_16x16x32_bf16 a[132:135], a[224:227], v[244:247], a[132:135]
    ds_read_b64_tr_b16 a[250:251], v28 offset:18432
    v_add_f32 v35, v35, v214
    v_mfma_f32_16x16x32_bf16 a[136:139], a[224:227], v[248:251], a[136:139]
    v_exp_f32 v217, v217
    v_mfma_f32_16x16x32_bf16 a[140:143], a[224:227], v[252:255], a[140:143]
    ds_read_b64_tr_b16 a[252:253], v29 offset:12288
    v_add_f32 v35, v35, v215
    v_mfma_f32_16x16x32_bf16 a[156:159], a[228:231], v[252:255], a[156:159]
    ds_read_b64_tr_b16 a[254:255], v29 offset:18432
    v_cvt_pk_bf16_f32 v224, v192, v193
    v_mfma_f32_16x16x32_bf16 a[152:155], a[228:231], v[248:251], a[152:155]
    ds_read_b64_tr_b16 a[192:193], v26 offset:12416
    v_add_f32 v36, v36, v216
    v_mfma_f32_16x16x32_bf16 a[148:151], a[228:231], v[244:247], a[148:151]
    ds_read_b64_tr_b16 a[194:195], v26 offset:18560
    v_cvt_pk_bf16_f32 v225, v194, v195
    v_mfma_f32_16x16x32_bf16 a[144:147], a[228:231], v[240:243], a[144:147]
    v_exp_f32 v218, v218
    v_mfma_f32_16x16x32_bf16 a[160:163], a[232:235], v[240:243], a[160:163]
    ds_read_b64_tr_b16 a[196:197], v27 offset:12416
    v_cvt_pk_bf16_f32 v228, v196, v197
    v_mfma_f32_16x16x32_bf16 a[164:167], a[232:235], v[244:247], a[164:167]
    ds_read_b64_tr_b16 a[198:199], v27 offset:18560
    v_add_f32 v36, v36, v217
    v_mfma_f32_16x16x32_bf16 a[168:171], a[232:235], v[248:251], a[168:171]
    ds_read_b64_tr_b16 a[200:201], v28 offset:12416
    v_cvt_pk_bf16_f32 v229, v198, v199
    v_mfma_f32_16x16x32_bf16 a[172:175], a[232:235], v[252:255], a[172:175]
    s_waitcnt lgkmcnt(7)
    v_exp_f32 v219, v219
    v_mfma_f32_16x16x32_bf16 a[188:191], a[236:239], v[252:255], a[188:191]
    ds_read_b64_tr_b16 a[202:203], v28 offset:18560
    v_cvt_pk_bf16_f32 v232, v200, v201
    v_mfma_f32_16x16x32_bf16 a[184:187], a[236:239], v[248:251], a[184:187]
    ds_read_b64_tr_b16 a[204:205], v29 offset:12416
    v_add_f32 v36, v36, v218
    v_exp_f32 v220, v220
    v_exp_f32 v221, v221
    v_exp_f32 v222, v222
    v_exp_f32 v223, v223
    v_mfma_f32_16x16x32_bf16 a[180:183], a[236:239], v[244:247], a[180:183]
    ds_read_b64_tr_b16 a[206:207], v29 offset:18560
    v_cvt_pk_bf16_f32 v233, v202, v203
    v_cvt_pk_bf16_f32 v236, v204, v205
    v_cvt_pk_bf16_f32 v237, v206, v207
    v_cvt_pk_bf16_f32 v226, v208, v209
    v_cvt_pk_bf16_f32 v227, v210, v211
    v_cvt_pk_bf16_f32 v230, v212, v213
    v_cvt_pk_bf16_f32 v231, v214, v215
    v_add_f32 v36, v36, v219
    v_cvt_pk_bf16_f32 v234, v216, v217
    v_cvt_pk_bf16_f32 v235, v218, v219
    v_add_f32 v37, v37, v220
    v_add_f32 v37, v37, v221
    v_add_f32 v37, v37, v222
    v_add_f32 v37, v37, v223
    v_cvt_pk_bf16_f32 v238, v220, v221
    v_cvt_pk_bf16_f32 v239, v222, v223
    v_mfma_f32_16x16x32_bf16 a[176:179], a[236:239], v[240:243], a[176:179]
WS9:
    s_cbranch_execz WS5
    v_add_f32 v53, v34, v35
    v_add_f32 v54, v36, v37
    v_add_f32 v52, v53, v54
    v_cmp_nlt_f32 vcc, v52, v55
    s_cbranch_vccnz SAFE
SAFE_BACK:
    v_mfma_f32_16x16x32_bf16 a[0:3], a[240:243], v[224:227], a[0:3]
    ds_read_b64_tr_b16 a[208:209], v26 offset:12544
    v_mov_b32 v52, v34
    v_mfma_f32_16x16x32_bf16 a[4:7], a[240:243], v[228:231], a[4:7]
    ds_read_b64_tr_b16 a[210:211], v26 offset:18688
    v_mov_b32 v53, v35
    v_mfma_f32_16x16x32_bf16 a[8:11], a[240:243], v[232:235], a[8:11]
    ds_read_b64_tr_b16 a[212:213], v27 offset:12544
    v_mov_b32 v54, v36
    v_mfma_f32_16x16x32_bf16 a[12:15], a[240:243], v[236:239], a[12:15]
    ds_read_b64_tr_b16 a[214:215], v27 offset:18688
    v_mov_b32 v55, v37
    v_mfma_f32_16x16x32_bf16 a[28:31], a[244:247], v[236:239], a[28:31]
    v_permlane32_swap_b32 v34, v52
    v_mfma_f32_16x16x32_bf16 a[24:27], a[244:247], v[232:235], a[24:27]
    v_permlane32_swap_b32 v35, v53
    v_mfma_f32_16x16x32_bf16 a[20:23], a[244:247], v[228:231], a[20:23]
    v_permlane32_swap_b32 v36, v54
    v_mfma_f32_16x16x32_bf16 a[16:19], a[244:247], v[224:227], a[16:19]
    v_permlane32_swap_b32 v37, v55
    v_mfma_f32_16x16x32_bf16 a[32:35], a[248:251], v[224:227], a[32:35]
    ds_read_b64_tr_b16 a[216:217], v28 offset:12544
    v_add_f32 v34, v34, v52
    v_mfma_f32_16x16x32_bf16 a[36:39], a[248:251], v[228:231], a[36:39]
    ds_read_b64_tr_b16 a[218:219], v28 offset:18688
    v_add_f32 v35, v35, v53
    v_mfma_f32_16x16x32_bf16 a[40:43], a[248:251], v[232:235], a[40:43]
    s_add_u32 s97, s88, 0
    ds_read_b64_tr_b16 a[220:221], v29 offset:12544
    v_add_f32 v36, v36, v54
    v_mfma_f32_16x16x32_bf16 a[44:47], a[248:251], v[236:239], a[44:47]
    s_waitcnt lgkmcnt(4)
    ds_read_b64_tr_b16 a[222:223], v29 offset:18688
    v_add_f32 v37, v37, v55
    v_mfma_f32_16x16x32_bf16 a[60:63], a[252:255], v[236:239], a[60:63]
    v_mov_b32 v52, v34
    v_mov_b32 v53, v35
    v_mfma_f32_16x16x32_bf16 a[56:59], a[252:255], v[232:235], a[56:59]
    v_mov_b32 v54, v36
    v_mov_b32 v55, v37
    v_mfma_f32_16x16x32_bf16 a[52:55], a[252:255], v[228:231], a[52:55]
    v_permlane16_swap_b32 v34, v52
    v_mfma_f32_16x16x32_bf16 a[48:51], a[252:255], v[224:227], a[48:51]
    v_permlane16_swap_b32 v35, v53
    v_mfma_f32_16x16x32_bf16 a[64:67], a[192:195], v[224:227], a[64:67]
    v_permlane16_swap_b32 v36, v54
    v_permlane16_swap_b32 v37, v55
    v_add_f32 v34, v34, v52
    v_add_f32 v35, v35, v53
    v_add_f32 v36, v36, v54
    v_add_f32 v37, v37, v55
    v_rcp_f32 v34, v34
    v_rcp_f32 v35, v35
    v_rcp_f32 v36, v36
    v_rcp_f32 v37, v37
    v_mfma_f32_16x16x32_bf16 a[68:71], a[192:195], v[228:231], a[68:71]
    v_accvgpr_read_b32 v44, a0
    v_accvgpr_read_b32 v45, a1
    v_mfma_f32_16x16x32_bf16 a[72:75], a[192:195], v[232:235], a[72:75]
    v_accvgpr_read_b32 v46, a2
    v_accvgpr_read_b32 v47, a3
    v_mfma_f32_16x16x32_bf16 a[76:79], a[192:195], v[236:239], a[76:79]
    v_accvgpr_read_b32 v48, a16
    v_accvgpr_read_b32 v49, a17
    v_mfma_f32_16x16x32_bf16 a[92:95], a[196:199], v[236:239], a[92:95]
    v_accvgpr_read_b32 v50, a18
    v_accvgpr_read_b32 v51, a19
    v_mfma_f32_16x16x32_bf16 a[88:91], a[196:199], v[232:235], a[88:91]
    v_mul_f32 v44, v44, v34
    v_mul_f32 v45, v45, v34
    v_mfma_f32_16x16x32_bf16 a[84:87], a[196:199], v[228:231], a[84:87]
    v_mul_f32 v46, v46, v34
    v_mul_f32 v47, v47, v34
    v_mfma_f32_16x16x32_bf16 a[80:83], a[196:199], v[224:227], a[80:83]
    v_mul_f32 v48, v48, v34
    v_mul_f32 v49, v49, v34
    v_mfma_f32_16x16x32_bf16 a[96:99], a[200:203], v[224:227], a[96:99]
    v_mul_f32 v50, v50, v34
    v_mul_f32 v51, v51, v34
    v_mfma_f32_16x16x32_bf16 a[100:103], a[200:203], v[228:231], a[100:103]
    v_cvt_pk_bf16_f32 v64, v44, v45
    v_cvt_pk_bf16_f32 v65, v46, v47
    v_cvt_pk_bf16_f32 v66, v48, v49
    v_mfma_f32_16x16x32_bf16 a[104:107], a[200:203], v[232:235], a[104:107]
    v_cvt_pk_bf16_f32 v67, v50, v51
    v_accvgpr_read_b32 v52, a4
    v_add_u32 v29, s42, v1
    v_accvgpr_read_b32 v53, a5
    v_accvgpr_read_b32 v54, a6
    v_mfma_f32_16x16x32_bf16 a[108:111], a[200:203], v[236:239], a[108:111]
    buffer_store_dwordx4 v[64:67], v1, s[16:19], s97 offen offset:0
    v_accvgpr_read_b32 v55, a7
    v_accvgpr_read_b32 v56, a20
    v_accvgpr_read_b32 v57, a21
    v_accvgpr_read_b32 v58, a22
    v_mfma_f32_16x16x32_bf16 a[124:127], a[204:207], v[236:239], a[124:127]
    v_accvgpr_read_b32 v59, a23
    v_mul_f32 v52, v52, v35
    v_mul_f32 v53, v53, v35
    v_mfma_f32_16x16x32_bf16 a[120:123], a[204:207], v[232:235], a[120:123]
    v_mul_f32 v54, v54, v35
    v_mul_f32 v55, v55, v35
    v_mul_f32 v56, v56, v35
    v_mfma_f32_16x16x32_bf16 a[116:119], a[204:207], v[228:231], a[116:119]
    v_mul_f32 v57, v57, v35
    v_mul_f32 v58, v58, v35
    v_mul_f32 v59, v59, v35
    v_mfma_f32_16x16x32_bf16 a[112:115], a[204:207], v[224:227], a[112:115]
    v_cvt_pk_bf16_f32 v68, v52, v53
    v_cvt_pk_bf16_f32 v69, v54, v55
    v_cvt_pk_bf16_f32 v70, v56, v57
    v_mfma_f32_16x16x32_bf16 a[128:131], a[208:211], v[224:227], a[128:131]
    v_cvt_pk_bf16_f32 v71, v58, v59
    v_accvgpr_read_b32 v44, a8
    v_accvgpr_read_b32 v45, a9
    v_accvgpr_read_b32 v46, a10
    v_mfma_f32_16x16x32_bf16 a[132:135], a[208:211], v[228:231], a[132:135]
    buffer_store_dwordx4 v[68:71], v1, s[16:19], s97 offen offset:1024
    v_accvgpr_read_b32 v47, a11
    v_accvgpr_read_b32 v48, a24
    v_accvgpr_read_b32 v49, a25
    v_accvgpr_read_b32 v50, a26
    v_add_u32 v26, 0, v1
    v_mfma_f32_16x16x32_bf16 a[136:139], a[208:211], v[232:235], a[136:139]
    s_waitcnt lgkmcnt(0)
    s_barrier
    v_accvgpr_read_b32 v51, a27
    v_mul_f32 v44, v44, v36
    v_mul_f32 v45, v45, v36
    v_mfma_f32_16x16x32_bf16 a[140:143], a[208:211], v[236:239], a[140:143]
    s_xor_b32 s6, s40, 8
    ds_read_b128 a[224:227], v26 offset:0
    v_mul_f32 v46, v46, v36
    v_mul_f32 v47, v47, v36
    v_mul_f32 v48, v48, v36
    v_mfma_f32_16x16x32_bf16 a[156:159], a[212:215], v[236:239], a[156:159]
    s_mul_i32 s6, s6, 245760
    ds_read_b128 a[228:231], v26 offset:1024
    v_mul_f32 v49, v49, v36
    v_mul_f32 v50, v50, v36
    v_mul_f32 v51, v51, v36
    v_mfma_f32_16x16x32_bf16 a[152:155], a[212:215], v[232:235], a[152:155]
    s_add_u32 s6, s6, s75
    ds_read_b128 a[232:235], v26 offset:2048
    v_cvt_pk_bf16_f32 v72, v44, v45
    v_cvt_pk_bf16_f32 v73, v46, v47
    v_cvt_pk_bf16_f32 v74, v48, v49
    v_mfma_f32_16x16x32_bf16 a[148:151], a[212:215], v[228:231], a[148:151]
    s_add_u32 m0, s42, 122880
    s_nop 0
    buffer_load_dwordx4 v1, s[16:19], s6 offen offset:0 sc1 lds
    v_cvt_pk_bf16_f32 v75, v50, v51
    v_mfma_f32_16x16x32_bf16 a[144:147], a[212:215], v[224:227], a[144:147]
    ds_read_b128 a[236:239], v26 offset:3072
    v_accvgpr_read_b32 v52, a12
    v_accvgpr_read_b32 v53, a13
    v_accvgpr_read_b32 v54, a14
    v_mfma_f32_16x16x32_bf16 a[160:163], a[216:219], v[224:227], a[160:163]
    ds_read_b128 a[240:243], v26 offset:4096
    v_accvgpr_read_b32 v55, a15
    v_accvgpr_read_b32 v56, a28
    v_accvgpr_read_b32 v57, a29
    v_accvgpr_read_b32 v58, a30
    v_mfma_f32_16x16x32_bf16 a[164:167], a[216:219], v[228:231], a[164:167]
    buffer_store_dwordx4 v[72:75], v1, s[16:19], s97 offen offset:2048
    v_accvgpr_read_b32 v59, a31
    v_mul_f32 v52, v52, v37
    v_mul_f32 v53, v53, v37
    v_mfma_f32_16x16x32_bf16 a[168:171], a[216:219], v[232:235], a[168:171]
    ds_read_b128 a[244:247], v26 offset:6144
    v_mul_f32 v54, v54, v37
    v_mul_f32 v55, v55, v37
    v_mul_f32 v56, v56, v37
    v_mfma_f32_16x16x32_bf16 a[172:175], a[216:219], v[236:239], a[172:175]
    ds_read_b128 a[248:251], v26 offset:7168
    v_mul_f32 v57, v57, v37
    v_mul_f32 v58, v58, v37
    v_mul_f32 v59, v59, v37
    v_mfma_f32_16x16x32_bf16 a[188:191], a[220:223], v[236:239], a[188:191]
    ds_read_b128 a[252:255], v26 offset:8192
    v_cvt_pk_bf16_f32 v76, v52, v53
    v_cvt_pk_bf16_f32 v77, v54, v55
    v_cvt_pk_bf16_f32 v78, v56, v57
    v_mfma_f32_16x16x32_bf16 a[184:187], a[220:223], v[232:235], a[184:187]
    ds_read_b128 a[192:195], v26 offset:9216
    v_cvt_pk_bf16_f32 v79, v58, v59
    v_mfma_f32_16x16x32_bf16 a[180:183], a[220:223], v[228:231], a[180:183]
    buffer_store_dwordx4 v[76:79], v1, s[16:19], s97 offen offset:3072
    v_mfma_f32_16x16x32_bf16 a[176:179], a[220:223], v[224:227], a[176:179]
    s_waitcnt lgkmcnt(6)
    v_accvgpr_read_b32 v44, a32
    v_accvgpr_read_b32 v45, a33
    v_mfma_f32_16x16x32_bf16 v[96:99], a[224:227], v[64:67], 0
    s_add_u32 s97, s88, 4096
    ds_read_b128 a[196:199], v26 offset:10240
    v_accvgpr_read_b32 v46, a34
    v_mfma_f32_16x16x32_bf16 v[136:139], a[224:227], v[68:71], 0
    v_accvgpr_read_b32 v47, a35
    v_accvgpr_read_b32 v48, a48
    v_mfma_f32_16x16x32_bf16 v[176:179], a[224:227], v[72:75], 0
    v_accvgpr_read_b32 v49, a49
    v_accvgpr_read_b32 v50, a50
    v_mfma_f32_16x16x32_bf16 v[216:219], a[224:227], v[76:79], 0
    buffer_load_dwordx4 v1, s[16:19], s6 offen offset:1024 sc1 lds
    v_accvgpr_read_b32 v51, a51
    v_mul_f32 v44, v44, v34
    v_mfma_f32_16x16x32_bf16 v[220:223], a[228:231], v[76:79], 0
    ds_read_b128 a[200:203], v26 offset:12288
    v_mul_f32 v45, v45, v34
    v_mul_f32 v46, v46, v34
    v_mfma_f32_16x16x32_bf16 v[180:183], a[228:231], v[72:75], 0
    v_mul_f32 v47, v47, v34
    v_mul_f32 v48, v48, v34
    v_mfma_f32_16x16x32_bf16 v[140:143], a[228:231], v[68:71], 0
    v_mul_f32 v49, v49, v34
    v_mul_f32 v50, v50, v34
    v_mfma_f32_16x16x32_bf16 v[100:103], a[228:231], v[64:67], 0
    buffer_load_dwordx4 v1, s[16:19], s6 offen offset:2048 sc1 lds
    v_mul_f32 v51, v51, v34
    v_cvt_pk_bf16_f32 v80, v44, v45
    v_mfma_f32_16x16x32_bf16 v[104:107], a[232:235], v[64:67], 0
    ds_read_b128 a[204:207], v26 offset:13312
    v_cvt_pk_bf16_f32 v81, v46, v47
    v_cvt_pk_bf16_f32 v82, v48, v49
    v_mfma_f32_16x16x32_bf16 v[144:147], a[232:235], v[68:71], 0
    v_cvt_pk_bf16_f32 v83, v50, v51
    v_accvgpr_read_b32 v52, a36
    v_accvgpr_read_b32 v53, a37
    v_mfma_f32_16x16x32_bf16 v[184:187], a[232:235], v[72:75], 0
    v_accvgpr_read_b32 v54, a38
    v_accvgpr_read_b32 v55, a39
    v_mfma_f32_16x16x32_bf16 v[224:227], a[232:235], v[76:79], 0
    s_waitcnt lgkmcnt(2)
    buffer_store_dwordx4 v[80:83], v1, s[16:19], s97 offen offset:0
    v_accvgpr_read_b32 v56, a52
    v_accvgpr_read_b32 v57, a53
    v_accvgpr_read_b32 v58, a54
    v_mfma_f32_16x16x32_bf16 v[228:231], a[236:239], v[76:79], 0
    ds_read_b128 a[208:211], v26 offset:14336
    v_accvgpr_read_b32 v59, a55
    v_mul_f32 v52, v52, v35
    v_mfma_f32_16x16x32_bf16 v[188:191], a[236:239], v[72:75], 0
    v_mul_f32 v53, v53, v35
    v_mul_f32 v54, v54, v35
    v_mfma_f32_16x16x32_bf16 v[148:151], a[236:239], v[68:71], 0
    v_mul_f32 v55, v55, v35
    v_mul_f32 v56, v56, v35
    v_mfma_f32_16x16x32_bf16 v[108:111], a[236:239], v[64:67], 0
    v_mul_f32 v57, v57, v35
    v_mul_f32 v58, v58, v35
    v_mfma_f32_16x16x32_bf16 v[112:115], a[240:243], v[64:67], 0
    buffer_load_dwordx4 v1, s[16:19], s6 offen offset:3072 sc1 lds
    v_mul_f32 v59, v59, v35
    v_cvt_pk_bf16_f32 v84, v52, v53
    v_mfma_f32_16x16x32_bf16 v[152:155], a[240:243], v[68:71], 0
    s_add_u32 m0, m0, 4096
    ds_read_b128 a[212:215], v26 offset:15360
    v_cvt_pk_bf16_f32 v85, v54, v55
    v_cvt_pk_bf16_f32 v86, v56, v57
    v_mfma_f32_16x16x32_bf16 v[192:195], a[240:243], v[72:75], 0
    v_cvt_pk_bf16_f32 v87, v58, v59
    v_accvgpr_read_b32 v44, a40
    v_accvgpr_read_b32 v45, a41
    v_mfma_f32_16x16x32_bf16 v[232:235], a[240:243], v[76:79], 0
    v_accvgpr_read_b32 v46, a42
    v_accvgpr_read_b32 v47, a43
    v_mfma_f32_16x16x32_bf16 v[236:239], a[244:247], v[76:79], 0
    buffer_store_dwordx4 v[84:87], v1, s[16:19], s97 offen offset:1024
    v_accvgpr_read_b32 v48, a56
    v_accvgpr_read_b32 v49, a57
    v_accvgpr_read_b32 v50, a58
    v_mfma_f32_16x16x32_bf16 v[196:199], a[244:247], v[72:75], 0
    ds_read_b128 a[216:219], v26 offset:16384
    v_accvgpr_read_b32 v51, a59
    v_mul_f32 v44, v44, v36
    v_mfma_f32_16x16x32_bf16 v[156:159], a[244:247], v[68:71], 0
    v_mul_f32 v45, v45, v36
    v_mul_f32 v46, v46, v36
    v_mfma_f32_16x16x32_bf16 v[116:119], a[244:247], v[64:67], 0
    v_mul_f32 v47, v47, v36
    v_mul_f32 v48, v48, v36
    v_mfma_f32_16x16x32_bf16 v[120:123], a[248:251], v[64:67], 0
    ds_read_b128 a[220:223], v26 offset:18432
    v_mul_f32 v49, v49, v36
    v_mul_f32 v50, v50, v36
    v_mfma_f32_16x16x32_bf16 v[160:163], a[248:251], v[68:71], 0
    buffer_load_dwordx4 v39, s[16:19], s6 offen offset:0 sc1 lds
    v_mul_f32 v51, v51, v36
    v_cvt_pk_bf16_f32 v88, v44, v45
    v_mfma_f32_16x16x32_bf16 v[200:203], a[248:251], v[72:75], 0
    s_add_u32 s6, s77, 450560
    v_cvt_pk_bf16_f32 v89, v46, v47
    v_cvt_pk_bf16_f32 v90, v48, v49
    v_mfma_f32_16x16x32_bf16 v[240:243], a[248:251], v[76:79], 0
    s_add_u32 m0, s42, 128000
    v_cvt_pk_bf16_f32 v91, v50, v51
    v_accvgpr_read_b32 v52, a44
    v_mfma_f32_16x16x32_bf16 v[244:247], a[252:255], v[76:79], 0
    ds_read_b128 a[224:227], v26 offset:19456
    v_accvgpr_read_b32 v53, a45
    v_mfma_f32_16x16x32_bf16 v[204:207], a[252:255], v[72:75], 0
    buffer_store_dwordx4 v[88:91], v1, s[16:19], s97 offen offset:2048
    v_accvgpr_read_b32 v54, a46
    v_accvgpr_read_b32 v55, a47
    v_mfma_f32_16x16x32_bf16 v[164:167], a[252:255], v[68:71], 0
    v_accvgpr_read_b32 v56, a60
    v_accvgpr_read_b32 v57, a61
    v_accvgpr_read_b32 v58, a62
    v_mfma_f32_16x16x32_bf16 v[124:127], a[252:255], v[64:67], 0
    v_accvgpr_read_b32 v59, a63
    v_mul_f32 v52, v52, v37
    v_mfma_f32_16x16x32_bf16 v[128:131], a[192:195], v[64:67], 0
    ds_read_b128 a[228:231], v26 offset:20480
    v_mul_f32 v53, v53, v37
    v_mul_f32 v54, v54, v37
    v_mfma_f32_16x16x32_bf16 v[168:171], a[192:195], v[68:71], 0
    v_mul_f32 v55, v55, v37
    v_mul_f32 v56, v56, v37
    v_mfma_f32_16x16x32_bf16 v[208:211], a[192:195], v[72:75], 0
    buffer_load_dwordx4 v39, s[16:19], s6 offen offset:0 sc1 lds
    v_mul_f32 v57, v57, v37
    v_mul_f32 v58, v58, v37
    v_mfma_f32_16x16x32_bf16 v[248:251], a[192:195], v[76:79], 0
    v_mul_f32 v59, v59, v37
    v_cvt_pk_bf16_f32 v92, v52, v53
    v_mfma_f32_16x16x32_bf16 v[252:255], a[196:199], v[76:79], 0
    ds_read_b128 a[232:235], v26 offset:21504
    v_cvt_pk_bf16_f32 v93, v54, v55
    v_cvt_pk_bf16_f32 v94, v56, v57
    v_mfma_f32_16x16x32_bf16 v[212:215], a[196:199], v[72:75], 0
    v_cvt_pk_bf16_f32 v95, v58, v59
    v_accvgpr_read_b32 v44, a64
    v_mfma_f32_16x16x32_bf16 v[172:175], a[196:199], v[68:71], 0
    buffer_store_dwordx4 v[92:95], v1, s[16:19], s97 offen offset:3072
    v_mfma_f32_16x16x32_bf16 v[132:135], a[196:199], v[64:67], 0
    s_waitcnt lgkmcnt(2)
    v_accvgpr_read_b32 v45, a65
    v_accvgpr_read_b32 v46, a66
    v_mfma_f32_16x16x32_bf16 v[96:99], a[200:203], v[80:83], v[96:99]
    s_add_u32 s97, s88, 8192
    ds_read_b128 a[236:239], v26 offset:22528
    v_accvgpr_read_b32 v47, a67
    v_mfma_f32_16x16x32_bf16 v[136:139], a[200:203], v[84:87], v[136:139]
    v_accvgpr_read_b32 v48, a80
    v_accvgpr_read_b32 v49, a81
    v_mfma_f32_16x16x32_bf16 v[176:179], a[200:203], v[88:91], v[176:179]
    v_accvgpr_read_b32 v50, a82
    v_accvgpr_read_b32 v51, a83
    v_mfma_f32_16x16x32_bf16 v[216:219], a[200:203], v[92:95], v[216:219]
    v_mul_f32 v44, v44, v34
    v_mul_f32 v45, v45, v34
    v_mfma_f32_16x16x32_bf16 v[220:223], a[204:207], v[92:95], v[220:223]
    v_mul_f32 v46, v46, v34
    v_mul_f32 v47, v47, v34
    v_mfma_f32_16x16x32_bf16 v[180:183], a[204:207], v[88:91], v[180:183]
    v_mul_f32 v48, v48, v34
    v_mul_f32 v49, v49, v34
    v_mfma_f32_16x16x32_bf16 v[140:143], a[204:207], v[84:87], v[140:143]
    v_mul_f32 v50, v50, v34
    v_mul_f32 v51, v51, v34
    v_mfma_f32_16x16x32_bf16 v[100:103], a[204:207], v[80:83], v[100:103]
    v_cvt_pk_bf16_f32 v10, v44, v45
    v_cvt_pk_bf16_f32 v11, v46, v47
    v_mfma_f32_16x16x32_bf16 v[104:107], a[208:211], v[80:83], v[104:107]
    v_cvt_pk_bf16_f32 v12, v48, v49
    v_cvt_pk_bf16_f32 v13, v50, v51
    v_mfma_f32_16x16x32_bf16 v[144:147], a[208:211], v[84:87], v[144:147]
    buffer_store_dwordx4 v[10:13], v1, s[16:19], s97 offen offset:0
    v_accvgpr_read_b32 v52, a68
    v_accvgpr_read_b32 v53, a69
    v_mfma_f32_16x16x32_bf16 v[184:187], a[208:211], v[88:91], v[184:187]
    v_accvgpr_read_b32 v54, a70
    v_accvgpr_read_b32 v55, a71
    v_mfma_f32_16x16x32_bf16 v[224:227], a[208:211], v[92:95], v[224:227]
    v_accvgpr_read_b32 v56, a84
    v_accvgpr_read_b32 v57, a85
    v_accvgpr_read_b32 v58, a86
    v_mfma_f32_16x16x32_bf16 v[228:231], a[212:215], v[92:95], v[228:231]
    v_accvgpr_read_b32 v59, a87
    v_mul_f32 v52, v52, v35
    v_mfma_f32_16x16x32_bf16 v[188:191], a[212:215], v[88:91], v[188:191]
    v_mul_f32 v53, v53, v35
    v_mul_f32 v54, v54, v35
    v_mfma_f32_16x16x32_bf16 v[148:151], a[212:215], v[84:87], v[148:151]
    v_mul_f32 v55, v55, v35
    v_mul_f32 v56, v56, v35
    v_mfma_f32_16x16x32_bf16 v[108:111], a[212:215], v[80:83], v[108:111]
    v_mul_f32 v57, v57, v35
    v_mul_f32 v58, v58, v35
    v_mfma_f32_16x16x32_bf16 v[112:115], a[216:219], v[80:83], v[112:115]
    v_mul_f32 v59, v59, v35
    v_cvt_pk_bf16_f32 v14, v52, v53
    v_mfma_f32_16x16x32_bf16 v[152:155], a[216:219], v[84:87], v[152:155]
    v_cvt_pk_bf16_f32 v15, v54, v55
    v_cvt_pk_bf16_f32 v16, v56, v57
    v_mfma_f32_16x16x32_bf16 v[192:195], a[216:219], v[88:91], v[192:195]
    v_cvt_pk_bf16_f32 v17, v58, v59
    v_accvgpr_read_b32 v44, a72
    v_accvgpr_read_b32 v45, a73
    v_mfma_f32_16x16x32_bf16 v[232:235], a[216:219], v[92:95], v[232:235]
    buffer_store_dwordx4 v[14:17], v1, s[16:19], s97 offen offset:1024
    v_accvgpr_read_b32 v46, a74
    v_accvgpr_read_b32 v47, a75
    v_mfma_f32_16x16x32_bf16 v[236:239], a[220:223], v[92:95], v[236:239]
    v_accvgpr_read_b32 v48, a88
    v_accvgpr_read_b32 v49, a89
    v_accvgpr_read_b32 v50, a90
    v_mfma_f32_16x16x32_bf16 v[196:199], a[220:223], v[88:91], v[196:199]
    v_accvgpr_read_b32 v51, a91
    v_add_u32 v26, 24576, v1
    v_mul_f32 v44, v44, v36
    v_mfma_f32_16x16x32_bf16 v[156:159], a[220:223], v[84:87], v[156:159]
    s_waitcnt lgkmcnt(0)
    s_barrier
    v_mul_f32 v45, v45, v36
    v_mul_f32 v46, v46, v36
    v_mfma_f32_16x16x32_bf16 v[116:119], a[220:223], v[80:83], v[116:119]
    s_xor_b32 s6, s40, 16
    ds_read_b128 a[240:243], v26 offset:0
    v_mul_f32 v47, v47, v36
    v_mul_f32 v48, v48, v36
    v_mfma_f32_16x16x32_bf16 v[120:123], a[224:227], v[80:83], v[120:123]
    s_mul_i32 s6, s6, 245760
    ds_read_b128 a[244:247], v26 offset:1024
    v_mul_f32 v49, v49, v36
    v_mul_f32 v50, v50, v36
    v_mfma_f32_16x16x32_bf16 v[160:163], a[224:227], v[84:87], v[160:163]
    s_add_u32 s6, s6, s75
    ds_read_b128 a[248:251], v26 offset:2048
    v_mul_f32 v51, v51, v36
    v_cvt_pk_bf16_f32 v18, v44, v45
    v_mfma_f32_16x16x32_bf16 v[200:203], a[224:227], v[88:91], v[200:203]
    s_add_u32 m0, s42, 0
    s_nop 0
    buffer_load_dwordx4 v1, s[16:19], s6 offen offset:0 sc1 lds
    v_cvt_pk_bf16_f32 v19, v46, v47
    v_cvt_pk_bf16_f32 v20, v48, v49
    v_mfma_f32_16x16x32_bf16 v[240:243], a[224:227], v[92:95], v[240:243]
    ds_read_b128 a[252:255], v26 offset:3072
    v_cvt_pk_bf16_f32 v21, v50, v51
    v_mfma_f32_16x16x32_bf16 v[244:247], a[228:231], v[92:95], v[244:247]
    ds_read_b128 a[192:195], v26 offset:4096
    v_accvgpr_read_b32 v52, a76
    v_accvgpr_read_b32 v53, a77
    v_mfma_f32_16x16x32_bf16 v[204:207], a[228:231], v[88:91], v[204:207]
    buffer_store_dwordx4 v[18:21], v1, s[16:19], s97 offen offset:2048
    v_accvgpr_read_b32 v54, a78
    v_accvgpr_read_b32 v55, a79
    v_mfma_f32_16x16x32_bf16 v[164:167], a[228:231], v[84:87], v[164:167]
    ds_read_b128 a[196:199], v26 offset:6144
    v_accvgpr_read_b32 v56, a92
    v_accvgpr_read_b32 v57, a93
    v_accvgpr_read_b32 v58, a94
    v_mfma_f32_16x16x32_bf16 v[124:127], a[228:231], v[80:83], v[124:127]
    ds_read_b128 a[200:203], v26 offset:7168
    v_accvgpr_read_b32 v59, a95
    v_mul_f32 v52, v52, v37
    v_mfma_f32_16x16x32_bf16 v[128:131], a[232:235], v[80:83], v[128:131]
    ds_read_b128 a[204:207], v26 offset:8192
    v_mul_f32 v53, v53, v37
    v_mul_f32 v54, v54, v37
    v_mfma_f32_16x16x32_bf16 v[168:171], a[232:235], v[84:87], v[168:171]
    v_mul_f32 v55, v55, v37
    v_mul_f32 v56, v56, v37
    v_mfma_f32_16x16x32_bf16 v[208:211], a[232:235], v[88:91], v[208:211]
    buffer_load_dwordx4 a[80:83], v1, s[16:19], s44 offen offset:0 sc1
    v_mul_f32 v57, v57, v37
    v_mul_f32 v58, v58, v37
    v_mfma_f32_16x16x32_bf16 v[248:251], a[232:235], v[92:95], v[248:251]
    v_mul_f32 v59, v59, v37
    v_cvt_pk_bf16_f32 v22, v52, v53
    v_mfma_f32_16x16x32_bf16 v[252:255], a[236:239], v[92:95], v[252:255]
    ds_read_b128 a[208:211], v26 offset:9216
    v_cvt_pk_bf16_f32 v23, v54, v55
    v_cvt_pk_bf16_f32 v24, v56, v57
    v_mfma_f32_16x16x32_bf16 v[212:215], a[236:239], v[88:91], v[212:215]
    v_cvt_pk_bf16_f32 v25, v58, v59
    v_accvgpr_read_b32 v44, a96
    v_mfma_f32_16x16x32_bf16 v[172:175], a[236:239], v[84:87], v[172:175]
    buffer_store_dwordx4 v[22:25], v1, s[16:19], s97 offen offset:3072
    v_mfma_f32_16x16x32_bf16 v[132:135], a[236:239], v[80:83], v[132:135]
    s_waitcnt lgkmcnt(3)
    v_accvgpr_read_b32 v45, a97
    v_accvgpr_read_b32 v46, a98
    v_mfma_f32_16x16x32_bf16 v[96:99], a[240:243], v[10:13], v[96:99]
    s_add_u32 s97, s88, 12288
    ds_read_b128 a[212:215], v26 offset:10240
    v_accvgpr_read_b32 v47, a99
    v_mfma_f32_16x16x32_bf16 v[136:139], a[240:243], v[14:17], v[136:139]
    v_accvgpr_read_b32 v48, a112
    v_accvgpr_read_b32 v49, a113
    v_mfma_f32_16x16x32_bf16 v[176:179], a[240:243], v[18:21], v[176:179]
    v_accvgpr_read_b32 v50, a114
    v_accvgpr_read_b32 v51, a115
    v_mfma_f32_16x16x32_bf16 v[216:219], a[240:243], v[22:25], v[216:219]
    buffer_load_dwordx4 a[84:87], v1, s[16:19], s45 offen offset:0 sc1
    v_mul_f32 v44, v44, v34
    v_mfma_f32_16x16x32_bf16 v[220:223], a[244:247], v[22:25], v[220:223]
    ds_read_b128 a[216:219], v26 offset:12288
    v_mul_f32 v45, v45, v34
    v_mul_f32 v46, v46, v34
    v_mfma_f32_16x16x32_bf16 v[180:183], a[244:247], v[18:21], v[180:183]
    v_mul_f32 v47, v47, v34
    v_mul_f32 v48, v48, v34
    v_mfma_f32_16x16x32_bf16 v[140:143], a[244:247], v[14:17], v[140:143]
    v_mul_f32 v49, v49, v34
    v_mul_f32 v50, v50, v34
    v_mfma_f32_16x16x32_bf16 v[100:103], a[244:247], v[10:13], v[100:103]
    buffer_load_dwordx4 a[88:91], v1, s[16:19], s46 offen offset:0 sc1
    v_mul_f32 v51, v51, v34
    v_cvt_pk_bf16_f32 v64, v44, v45
    v_mfma_f32_16x16x32_bf16 v[104:107], a[248:251], v[10:13], v[104:107]
    ds_read_b128 a[220:223], v26 offset:13312
    v_cvt_pk_bf16_f32 v65, v46, v47
    v_cvt_pk_bf16_f32 v66, v48, v49
    v_mfma_f32_16x16x32_bf16 v[144:147], a[248:251], v[14:17], v[144:147]
    v_cvt_pk_bf16_f32 v67, v50, v51
    v_accvgpr_read_b32 v52, a100
    v_accvgpr_read_b32 v53, a101
    v_mfma_f32_16x16x32_bf16 v[184:187], a[248:251], v[18:21], v[184:187]
    v_accvgpr_read_b32 v54, a102
    v_accvgpr_read_b32 v55, a103
    v_mfma_f32_16x16x32_bf16 v[224:227], a[248:251], v[22:25], v[224:227]
    s_waitcnt vmcnt(8)
    s_cmp_lg_u32 s54, 0
    s_cbranch_scc1 WB0
    buffer_store_dword v61, v9, s[16:19], s55 offen offset:64
WB0B:
    v_accvgpr_read_b32 v56, a116
    v_accvgpr_read_b32 v57, a117
    v_accvgpr_read_b32 v58, a118
    v_mfma_f32_16x16x32_bf16 v[228:231], a[252:255], v[22:25], v[228:231]
    ds_read_b128 a[224:227], v26 offset:14336
    v_accvgpr_read_b32 v59, a119
    v_mul_f32 v52, v52, v35
    v_mfma_f32_16x16x32_bf16 v[188:191], a[252:255], v[18:21], v[188:191]
    buffer_store_dwordx4 v[64:67], v1, s[16:19], s97 offen offset:0
    v_mul_f32 v53, v53, v35
    v_mul_f32 v54, v54, v35
    v_mfma_f32_16x16x32_bf16 v[148:151], a[252:255], v[14:17], v[148:151]
    v_mul_f32 v55, v55, v35
    v_mul_f32 v56, v56, v35
    v_mfma_f32_16x16x32_bf16 v[108:111], a[252:255], v[10:13], v[108:111]
    v_mul_f32 v57, v57, v35
    v_mul_f32 v58, v58, v35
    v_mfma_f32_16x16x32_bf16 v[112:115], a[192:195], v[10:13], v[112:115]
    ds_read_b128 a[228:231], v26 offset:15360
    v_mul_f32 v59, v59, v35
    v_cvt_pk_bf16_f32 v68, v52, v53
    v_mfma_f32_16x16x32_bf16 v[152:155], a[192:195], v[14:17], v[152:155]
    v_cvt_pk_bf16_f32 v69, v54, v55
    v_cvt_pk_bf16_f32 v70, v56, v57
    v_mfma_f32_16x16x32_bf16 v[192:195], a[192:195], v[18:21], v[192:195]
    buffer_load_dwordx4 a[92:95], v1, s[16:19], s47 offen offset:0 sc1
    v_cvt_pk_bf16_f32 v71, v58, v59
    v_accvgpr_read_b32 v44, a104
    v_accvgpr_read_b32 v45, a105
    v_mfma_f32_16x16x32_bf16 v[232:235], a[192:195], v[22:25], v[232:235]
    v_accvgpr_read_b32 v46, a106
    v_accvgpr_read_b32 v47, a107
    v_mfma_f32_16x16x32_bf16 v[236:239], a[196:199], v[22:25], v[236:239]
    ds_read_b128 a[232:235], v26 offset:16384
    v_accvgpr_read_b32 v48, a120
    v_accvgpr_read_b32 v49, a121
    v_accvgpr_read_b32 v50, a122
    v_mfma_f32_16x16x32_bf16 v[196:199], a[196:199], v[18:21], v[196:199]
    v_accvgpr_read_b32 v51, a123
    v_mul_f32 v44, v44, v36
    v_mfma_f32_16x16x32_bf16 v[156:159], a[196:199], v[14:17], v[156:159]
    buffer_store_dwordx4 v[68:71], v1, s[16:19], s97 offen offset:1024
    v_mul_f32 v45, v45, v36
    v_mul_f32 v46, v46, v36
    v_mfma_f32_16x16x32_bf16 v[116:119], a[196:199], v[10:13], v[116:119]
    s_waitcnt lgkmcnt(2)
    v_mul_f32 v47, v47, v36
    v_mul_f32 v48, v48, v36
    v_mfma_f32_16x16x32_bf16 v[120:123], a[200:203], v[10:13], v[120:123]
    ds_read_b128 a[236:239], v26 offset:18432
    v_mul_f32 v49, v49, v36
    v_mul_f32 v50, v50, v36
    v_mfma_f32_16x16x32_bf16 v[160:163], a[200:203], v[14:17], v[160:163]
    v_mul_f32 v51, v51, v36
    v_cvt_pk_bf16_f32 v72, v44, v45
    v_mfma_f32_16x16x32_bf16 v[200:203], a[200:203], v[18:21], v[200:203]
    v_cvt_pk_bf16_f32 v73, v46, v47
    v_cvt_pk_bf16_f32 v74, v48, v49
    v_mfma_f32_16x16x32_bf16 v[240:243], a[200:203], v[22:25], v[240:243]
    buffer_load_dwordx4 v1, s[16:19], s6 offen offset:1024 sc1 lds
    v_cvt_pk_bf16_f32 v75, v50, v51
    v_mfma_f32_16x16x32_bf16 v[244:247], a[204:207], v[22:25], v[244:247]
    ds_read_b128 a[240:243], v26 offset:19456
    v_accvgpr_read_b32 v52, a108
    v_accvgpr_read_b32 v53, a109
    v_mfma_f32_16x16x32_bf16 v[204:207], a[204:207], v[18:21], v[204:207]
    v_accvgpr_read_b32 v54, a110
    v_accvgpr_read_b32 v55, a111
    v_mfma_f32_16x16x32_bf16 v[164:167], a[204:207], v[14:17], v[164:167]
WS10:
    s_cbranch_execz WS6
    v_accvgpr_read_b32 v56, a124
    v_accvgpr_read_b32 v57, a125
    v_accvgpr_read_b32 v58, a126
    v_mfma_f32_16x16x32_bf16 v[124:127], a[204:207], v[10:13], v[124:127]
    buffer_store_dwordx4 v[72:75], v1, s[16:19], s97 offen offset:2048
    v_accvgpr_read_b32 v59, a127
    v_mul_f32 v52, v52, v37
    v_mfma_f32_16x16x32_bf16 v[128:131], a[208:211], v[10:13], v[128:131]
    ds_read_b128 a[244:247], v26 offset:20480
    v_mul_f32 v53, v53, v37
    v_mul_f32 v54, v54, v37
    v_mfma_f32_16x16x32_bf16 v[168:171], a[208:211], v[14:17], v[168:171]
    v_mul_f32 v55, v55, v37
    v_mul_f32 v56, v56, v37
    v_mfma_f32_16x16x32_bf16 v[208:211], a[208:211], v[18:21], v[208:211]
    v_mul_f32 v57, v57, v37
    v_mul_f32 v58, v58, v37
    v_mfma_f32_16x16x32_bf16 v[248:251], a[208:211], v[22:25], v[248:251]
    v_mul_f32 v59, v59, v37
    v_cvt_pk_bf16_f32 v76, v52, v53
    v_mfma_f32_16x16x32_bf16 v[252:255], a[212:215], v[22:25], v[252:255]
    buffer_load_dwordx4 a[96:99], v1, s[16:19], s44 offen offset:1024 sc1
    v_cvt_pk_bf16_f32 v77, v54, v55
    v_cvt_pk_bf16_f32 v78, v56, v57
    v_mfma_f32_16x16x32_bf16 v[212:215], a[212:215], v[18:21], v[212:215]
    ds_read_b128 a[248:251], v26 offset:21504
    v_cvt_pk_bf16_f32 v79, v58, v59
    v_mfma_f32_16x16x32_bf16 v[172:175], a[212:215], v[14:17], v[172:175]
    v_accvgpr_read_b32 v44, a128
    v_accvgpr_read_b32 v45, a129
    v_mfma_f32_16x16x32_bf16 v[132:135], a[212:215], v[10:13], v[132:135]
    v_accvgpr_read_b32 v46, a130
    v_and_b32 v62, 3072, v62
    v_mfma_f32_16x16x32_bf16 v[96:99], a[216:219], v[64:67], v[96:99]
    s_and_b32 s58, s2, 0xe7
    buffer_store_dwordx4 v[76:79], v1, s[16:19], s97 offen offset:3072
    v_mfma_f32_16x16x32_bf16 v[136:139], a[216:219], v[68:71], v[136:139]
    s_lshl_b32 s58, s58, 7
    ds_read_b128 a[252:255], v26 offset:22528
    v_accvgpr_read_b32 v47, a131
    v_mfma_f32_16x16x32_bf16 v[176:179], a[216:219], v[72:75], v[176:179]
    s_add_u32 s58, s58, 62390272
    v_accvgpr_read_b32 v48, a144
    s_add_u32 s58, s58, s56
    v_mfma_f32_16x16x32_bf16 v[216:219], a[216:219], v[76:79], v[216:219]
    s_add_u32 s97, s88, 16384
    v_accvgpr_read_b32 v49, a145
    v_accvgpr_read_b32 v50, a146
    v_mfma_f32_16x16x32_bf16 v[220:223], a[220:223], v[76:79], v[220:223]
    v_accvgpr_read_b32 v51, a147
    v_mul_f32 v44, v44, v34
    v_mfma_f32_16x16x32_bf16 v[180:183], a[220:223], v[72:75], v[180:183]
    buffer_load_dword v38, v62, s[16:19], s58 offen offset:64 sc1
    v_mfma_f32_16x16x32_bf16 v[140:143], a[220:223], v[68:71], v[140:143]
    v_mul_f32 v45, v45, v34
    v_mul_f32 v46, v46, v34
    v_mfma_f32_16x16x32_bf16 v[100:103], a[220:223], v[64:67], v[100:103]
    buffer_load_dwordx4 a[100:103], v1, s[16:19], s45 offen offset:1024 sc1
    v_mfma_f32_16x16x32_bf16 v[104:107], a[224:227], v[64:67], v[104:107]
    v_mul_f32 v47, v47, v34
    v_mul_f32 v48, v48, v34
    v_mfma_f32_16x16x32_bf16 v[144:147], a[224:227], v[68:71], v[144:147]
    v_mul_f32 v49, v49, v34
    v_mul_f32 v50, v50, v34
    v_mfma_f32_16x16x32_bf16 v[184:187], a[224:227], v[72:75], v[184:187]
    v_mul_f32 v51, v51, v34
    v_cvt_pk_bf16_f32 v80, v44, v45
    v_mfma_f32_16x16x32_bf16 v[224:227], a[224:227], v[76:79], v[224:227]
    s_waitcnt lgkmcnt(0)
    buffer_load_dwordx4 a[104:107], v1, s[16:19], s46 offen offset:1024 sc1
    v_mfma_f32_16x16x32_bf16 v[228:231], a[228:231], v[76:79], v[228:231]
    v_cvt_pk_bf16_f32 v81, v46, v47
    v_cvt_pk_bf16_f32 v82, v48, v49
    v_mfma_f32_16x16x32_bf16 v[188:191], a[228:231], v[72:75], v[188:191]
    v_cvt_pk_bf16_f32 v83, v50, v51
    v_accvgpr_read_b32 v52, a132
    v_mfma_f32_16x16x32_bf16 v[148:151], a[228:231], v[68:71], v[148:151]
    v_accvgpr_read_b32 v53, a133
    v_accvgpr_read_b32 v54, a134
    v_mfma_f32_16x16x32_bf16 v[108:111], a[228:231], v[64:67], v[108:111]
    buffer_store_dwordx4 v[80:83], v1, s[16:19], s97 offen offset:0
    v_mfma_f32_16x16x32_bf16 v[112:115], a[232:235], v[64:67], v[112:115]
    v_accvgpr_read_b32 v55, a135
    v_accvgpr_read_b32 v56, a148
    v_mfma_f32_16x16x32_bf16 v[152:155], a[232:235], v[68:71], v[152:155]
    v_accvgpr_read_b32 v57, a149
    v_accvgpr_read_b32 v58, a150
    v_mfma_f32_16x16x32_bf16 v[192:195], a[232:235], v[72:75], v[192:195]
    v_accvgpr_read_b32 v59, a151
    v_mul_f32 v52, v52, v35
    v_mfma_f32_16x16x32_bf16 v[232:235], a[232:235], v[76:79], v[232:235]
    v_mul_f32 v53, v53, v35
    v_add_u32 v26, 49152, v29
    v_mfma_f32_16x16x32_bf16 v[236:239], a[236:239], v[76:79], v[236:239]
    buffer_load_dwordx4 a[108:111], v1, s[16:19], s47 offen offset:1024 sc1
    v_mfma_f32_16x16x32_bf16 v[196:199], a[236:239], v[72:75], v[196:199]
    v_mul_f32 v54, v54, v35
    v_mul_f32 v55, v55, v35
    v_mfma_f32_16x16x32_bf16 v[156:159], a[236:239], v[68:71], v[156:159]
    s_waitcnt lgkmcnt(0)
    s_barrier
    v_mfma_f32_16x16x32_bf16 v[116:119], a[236:239], v[64:67], v[116:119]
    ds_read_b128 a[192:195], v26 offset:0
    v_mul_f32 v56, v56, v35
    v_mul_f32 v57, v57, v35
    v_mfma_f32_16x16x32_bf16 v[120:123], a[240:243], v[64:67], v[120:123]
    buffer_load_dwordx4 v1, s[16:19], s6 offen offset:2048 sc1 lds
    v_mul_f32 v58, v58, v35
    v_mfma_f32_16x16x32_bf16 v[160:163], a[240:243], v[68:71], v[160:163]
    ds_read_b128 a[196:199], v26 offset:1024
    v_mul_f32 v59, v59, v35
    v_cvt_pk_bf16_f32 v84, v52, v53
    v_mfma_f32_16x16x32_bf16 v[200:203], a[240:243], v[72:75], v[200:203]
    ds_read_b128 a[200:203], v26 offset:2048
    v_cvt_pk_bf16_f32 v85, v54, v55
    v_mfma_f32_16x16x32_bf16 v[240:243], a[240:243], v[76:79], v[240:243]
    ds_read_b128 a[204:207], v26 offset:3072
    v_cvt_pk_bf16_f32 v86, v56, v57
    v_mfma_f32_16x16x32_bf16 v[244:247], a[244:247], v[76:79], v[244:247]
    buffer_load_dwordx4 v1, s[16:19], s6 offen offset:3072 sc1 lds
    v_cvt_pk_bf16_f32 v87, v58, v59
    v_accvgpr_read_b32 v44, a136
    v_mfma_f32_16x16x32_bf16 v[204:207], a[244:247], v[72:75], v[204:207]
    s_add_u32 m0, m0, 4096
    ds_read_b128 a[208:211], v26 offset:4096
    v_accvgpr_read_b32 v45, a137
    v_accvgpr_read_b32 v46, a138
    v_mfma_f32_16x16x32_bf16 v[164:167], a[244:247], v[68:71], v[164:167]
    v_accvgpr_read_b32 v47, a139
    v_accvgpr_read_b32 v48, a152
    v_mfma_f32_16x16x32_bf16 v[124:127], a[244:247], v[64:67], v[124:127]
    v_accvgpr_read_b32 v49, a153
    v_accvgpr_read_b32 v50, a154
    v_mfma_f32_16x16x32_bf16 v[128:131], a[248:251], v[64:67], v[128:131]
    buffer_store_dwordx4 v[84:87], v1, s[16:19], s97 offen offset:1024
    v_mfma_f32_16x16x32_bf16 v[168:171], a[248:251], v[68:71], v[168:171]
    v_accvgpr_read_b32 v51, a155
    v_mul_f32 v44, v44, v36
    v_mfma_f32_16x16x32_bf16 v[208:211], a[248:251], v[72:75], v[208:211]
    v_mul_f32 v45, v45, v36
    v_mul_f32 v46, v46, v36
    v_mfma_f32_16x16x32_bf16 v[248:251], a[248:251], v[76:79], v[248:251]
    s_waitcnt vmcnt(7)
    v_cmp_ne_u32 vcc, v38, v61
    s_cbranch_vccnz SPIN16
BACK16:
    v_mfma_f32_16x16x32_bf16 v[252:255], a[252:255], v[76:79], v[252:255]
    s_xor_b32 s60, s39, 1
    v_mul_f32 v47, v47, v36
    v_mul_f32 v48, v48, v36
    v_mfma_f32_16x16x32_bf16 v[212:215], a[252:255], v[72:75], v[212:215]
    s_mul_i32 s60, s60, 98304
    buffer_load_dwordx4 v39, s[16:19], s6 offen offset:0 sc1 lds
    v_mul_f32 v49, v49, v36
    v_mfma_f32_16x16x32_bf16 v[172:175], a[252:255], v[68:71], v[172:175]
    s_add_u32 s60, s60, s70
    s_add_u32 s96, s60, 0
    v_mul_f32 v50, v50, v36
    v_mfma_f32_16x16x32_bf16 v[132:135], a[252:255], v[64:67], v[132:135]
    s_waitcnt lgkmcnt(0)
    v_mul_f32 v51, v51, v36
    v_cvt_pk_bf16_f32 v88, v44, v45
    v_mfma_f32_16x16x32_bf16 a[0:3], a[192:195], a[80:83], 0
    s_xor_b32 s6, s40, 24
    v_cvt_pk_bf16_f32 v89, v46, v47
    v_cvt_pk_bf16_f32 v90, v48, v49
    v_mfma_f32_16x16x32_bf16 a[20:23], a[192:195], a[84:87], 0
    s_mul_i32 s6, s6, 245760
    v_cvt_pk_bf16_f32 v91, v50, v51
    v_accvgpr_read_b32 v52, a140
    v_mfma_f32_16x16x32_bf16 a[40:43], a[192:195], a[88:91], 0
    s_add_u32 s6, s6, s75
    buffer_store_dwordx4 v[88:91], v1, s[16:19], s97 offen offset:2048
    v_mfma_f32_16x16x32_bf16 a[60:63], a[192:195], a[92:95], 0
    s_add_u32 m0, s42, 24576
    v_accvgpr_read_b32 v53, a141
    v_accvgpr_read_b32 v54, a142
    v_mfma_f32_16x16x32_bf16 a[64:67], a[196:199], a[92:95], 0
    v_accvgpr_read_b32 v55, a143
    v_accvgpr_read_b32 v56, a156
    v_mfma_f32_16x16x32_bf16 a[44:47], a[196:199], a[88:91], 0
    v_accvgpr_read_b32 v57, a157
    v_accvgpr_read_b32 v58, a158
    v_mfma_f32_16x16x32_bf16 a[24:27], a[196:199], a[84:87], 0
    buffer_load_dwordx4 v1, s[16:19], s6 offen offset:0 sc1 lds
    v_mfma_f32_16x16x32_bf16 a[4:7], a[196:199], a[80:83], 0
    v_add_u32 v26, 73728, v29
    v_accvgpr_read_b32 v59, a159
    v_mfma_f32_16x16x32_bf16 a[8:11], a[200:203], a[80:83], 0
    ds_read_b128 a[212:215], v26 offset:0
    v_mul_f32 v52, v52, v37
    v_mfma_f32_16x16x32_bf16 a[28:31], a[200:203], a[84:87], 0
    ds_read_b128 a[216:219], v26 offset:1024
    v_mul_f32 v53, v53, v37
    v_mfma_f32_16x16x32_bf16 a[48:51], a[200:203], a[88:91], 0
    buffer_load_dwordx4 a[128:131], v1, s[16:19], s96 offen offset:0 sc1
    v_mul_f32 v54, v54, v37
    v_mfma_f32_16x16x32_bf16 a[68:71], a[200:203], a[92:95], 0
    s_cmp_lg_u32 s54, 0
    s_cbranch_scc1 WB1
    buffer_store_dword v61, v9, s[16:19], s55 offen offset:80
WB1B:
    v_mul_f32 v55, v55, v37
    v_mfma_f32_16x16x32_bf16 a[72:75], a[204:207], a[92:95], 0
    ds_read_b128 a[220:223], v26 offset:2048
    v_mul_f32 v56, v56, v37
    v_mul_f32 v57, v57, v37
    v_mfma_f32_16x16x32_bf16 a[52:55], a[204:207], a[88:91], 0
    ds_read_b128 a[224:227], v26 offset:3072
    v_mul_f32 v58, v58, v37
    v_mfma_f32_16x16x32_bf16 a[32:35], a[204:207], a[84:87], 0
    ds_read_b128 a[228:231], v26 offset:4096
    v_mul_f32 v59, v59, v37
    v_cvt_pk_bf16_f32 v92, v52, v53
    v_mfma_f32_16x16x32_bf16 a[12:15], a[204:207], a[80:83], 0
    buffer_load_dwordx4 a[132:135], v1, s[16:19], s96 offen offset:1024 sc1
    v_cvt_pk_bf16_f32 v93, v54, v55
    v_mfma_f32_16x16x32_bf16 a[16:19], a[208:211], a[80:83], 0
    v_cvt_pk_bf16_f32 v94, v56, v57
    v_cvt_pk_bf16_f32 v95, v58, v59
    v_mfma_f32_16x16x32_bf16 a[36:39], a[208:211], a[84:87], 0
    v_accvgpr_read_b32 v44, a160
    v_accvgpr_read_b32 v45, a161
    v_mfma_f32_16x16x32_bf16 a[56:59], a[208:211], a[88:91], 0
    v_accvgpr_read_b32 v46, a162
    v_accvgpr_read_b32 v47, a163
    v_mfma_f32_16x16x32_bf16 a[76:79], a[208:211], a[92:95], 0
    s_waitcnt lgkmcnt(3)
    buffer_store_dwordx4 v[92:95], v1, s[16:19], s97 offen offset:3072
    v_mfma_f32_16x16x32_bf16 a[0:3], a[212:215], a[96:99], a[0:3]
    s_waitcnt vmcnt(13)
    v_accvgpr_read_b32 v48, a176
    v_accvgpr_read_b32 v49, a177
    v_mfma_f32_16x16x32_bf16 a[20:23], a[212:215], a[100:103], a[20:23]
    s_waitcnt vmcnt(12)
    v_accvgpr_read_b32 v50, a178
    v_accvgpr_read_b32 v51, a179
    v_mfma_f32_16x16x32_bf16 a[40:43], a[212:215], a[104:107], a[40:43]
    s_waitcnt vmcnt(10)
    v_mul_f32 v44, v44, v34
    v_mul_f32 v45, v45, v34
    v_mfma_f32_16x16x32_bf16 a[60:63], a[212:215], a[108:111], a[60:63]
    s_add_u32 s97, s88, 20480
    v_mul_f32 v46, v46, v34
    v_mul_f32 v47, v47, v34
    v_mfma_f32_16x16x32_bf16 a[64:67], a[216:219], a[108:111], a[64:67]
    buffer_load_dwordx4 a[136:139], v1, s[16:19], s96 offen offset:2048 sc1
    v_mfma_f32_16x16x32_bf16 a[44:47], a[216:219], a[104:107], a[44:47]
    v_mul_f32 v48, v48, v34
    v_add_u32 v26, 98304, v1
    v_mfma_f32_16x16x32_bf16 a[24:27], a[216:219], a[100:103], a[24:27]
    ds_read_b128 a[232:235], v26 offset:0
    v_mul_f32 v49, v49, v34
    v_mfma_f32_16x16x32_bf16 a[4:7], a[216:219], a[96:99], a[4:7]
    s_waitcnt lgkmcnt(1)
    ds_read_b128 a[236:239], v26 offset:1024
    v_mul_f32 v50, v50, v34
    v_mfma_f32_16x16x32_bf16 a[8:11], a[220:223], a[96:99], a[8:11]
    buffer_load_dwordx4 a[140:143], v1, s[16:19], s96 offen offset:3072 sc1
    v_mfma_f32_16x16x32_bf16 a[28:31], a[220:223], a[100:103], a[28:31]
    s_add_u32 s96, s60, 4096
    ds_read_b128 a[240:243], v26 offset:2048
    v_mul_f32 v51, v51, v34
    v_mfma_f32_16x16x32_bf16 a[48:51], a[220:223], a[104:107], a[48:51]
    ds_read_b128 a[244:247], v26 offset:3072
    v_cvt_pk_bf16_f32 v10, v44, v45
    v_mfma_f32_16x16x32_bf16 a[68:71], a[220:223], a[108:111], a[68:71]
    ds_read_b128 a[248:251], v26 offset:4096
    v_cvt_pk_bf16_f32 v11, v46, v47
    v_mfma_f32_16x16x32_bf16 a[72:75], a[224:227], a[108:111], a[72:75]
    buffer_load_dwordx4 a[144:147], v1, s[16:19], s96 offen offset:0 sc1
    v_mfma_f32_16x16x32_bf16 a[52:55], a[224:227], a[104:107], a[52:55]
    ds_read_b128 a[252:255], v26 offset:6144
    v_cvt_pk_bf16_f32 v12, v48, v49
    v_mfma_f32_16x16x32_bf16 a[32:35], a[224:227], a[100:103], a[32:35]
    ds_read_b128 a[192:195], v26 offset:7168
    v_cvt_pk_bf16_f32 v13, v50, v51
    v_accvgpr_read_b32 v52, a164
    v_mfma_f32_16x16x32_bf16 a[12:15], a[224:227], a[96:99], a[12:15]
    ds_read_b128 a[196:199], v26 offset:8192
    v_accvgpr_read_b32 v53, a165
    v_accvgpr_read_b32 v54, a166
    v_mfma_f32_16x16x32_bf16 a[16:19], a[228:231], a[96:99], a[16:19]
    buffer_store_dwordx4 v[10:13], v1, s[16:19], s97 offen offset:0
    v_accvgpr_read_b32 v55, a167
    v_mfma_f32_16x16x32_bf16 a[36:39], a[228:231], a[100:103], a[36:39]
    ds_read_b128 a[200:203], v26 offset:9216
    v_accvgpr_read_b32 v56, a180
    v_mfma_f32_16x16x32_bf16 a[56:59], a[228:231], a[104:107], a[56:59]
    v_accvgpr_read_b32 v57, a181
    v_accvgpr_read_b32 v58, a182
    v_mfma_f32_16x16x32_bf16 a[76:79], a[228:231], a[108:111], a[76:79]
    s_waitcnt lgkmcnt(5)
    v_accvgpr_read_b32 v59, a183
    v_mul_f32 v52, v52, v35
    v_mfma_f32_16x16x32_bf16 v[96:99], a[232:235], v[80:83], v[96:99]
    ds_read_b128 a[204:207], v26 offset:10240
    v_mul_f32 v53, v53, v35
    v_mfma_f32_16x16x32_bf16 v[136:139], a[232:235], v[84:87], v[136:139]
    buffer_load_dwordx4 a[148:151], v1, s[16:19], s96 offen offset:1024 sc1
    v_mul_f32 v54, v54, v35
    v_mfma_f32_16x16x32_bf16 v[176:179], a[232:235], v[88:91], v[176:179]
    v_mul_f32 v55, v55, v35
    v_mul_f32 v56, v56, v35
    v_mfma_f32_16x16x32_bf16 v[216:219], a[232:235], v[92:95], v[216:219]
    v_mul_f32 v57, v57, v35
    v_mul_f32 v58, v58, v35
    v_mfma_f32_16x16x32_bf16 v[220:223], a[236:239], v[92:95], v[220:223]
    ds_read_b128 a[208:211], v26 offset:12288
    v_mul_f32 v59, v59, v35
    v_mfma_f32_16x16x32_bf16 v[180:183], a[236:239], v[88:91], v[180:183]
    v_cvt_pk_bf16_f32 v14, v52, v53
    v_cvt_pk_bf16_f32 v15, v54, v55
    v_mfma_f32_16x16x32_bf16 v[140:143], a[236:239], v[84:87], v[140:143]
    buffer_load_dwordx4 a[152:155], v1, s[16:19], s96 offen offset:2048 sc1
    v_mfma_f32_16x16x32_bf16 v[100:103], a[236:239], v[80:83], v[100:103]
    v_cvt_pk_bf16_f32 v16, v56, v57
    v_cvt_pk_bf16_f32 v17, v58, v59
    v_mfma_f32_16x16x32_bf16 v[104:107], a[240:243], v[80:83], v[104:107]
    ds_read_b128 a[212:215], v26 offset:13312
    v_accvgpr_read_b32 v44, a168
    v_mfma_f32_16x16x32_bf16 v[144:147], a[240:243], v[84:87], v[144:147]
    v_accvgpr_read_b32 v45, a169
    v_accvgpr_read_b32 v46, a170
    v_mfma_f32_16x16x32_bf16 v[184:187], a[240:243], v[88:91], v[184:187]
    v_accvgpr_read_b32 v47, a171
    v_accvgpr_read_b32 v48, a184
    v_mfma_f32_16x16x32_bf16 v[224:227], a[240:243], v[92:95], v[224:227]
    buffer_store_dwordx4 v[14:17], v1, s[16:19], s97 offen offset:1024
    v_mfma_f32_16x16x32_bf16 v[228:231], a[244:247], v[92:95], v[228:231]
    ds_read_b128 a[216:219], v26 offset:14336
    v_accvgpr_read_b32 v49, a185
    v_accvgpr_read_b32 v50, a186
    v_mfma_f32_16x16x32_bf16 v[188:191], a[244:247], v[88:91], v[188:191]
    v_accvgpr_read_b32 v51, a187
    v_mul_f32 v44, v44, v36
    v_mfma_f32_16x16x32_bf16 v[148:151], a[244:247], v[84:87], v[148:151]
    v_mul_f32 v45, v45, v36
    v_mul_f32 v46, v46, v36
    v_mfma_f32_16x16x32_bf16 v[108:111], a[244:247], v[80:83], v[108:111]
    s_waitcnt lgkmcnt(2)
    v_mul_f32 v47, v47, v36
    v_mul_f32 v48, v48, v36
    v_mfma_f32_16x16x32_bf16 v[112:115], a[248:251], v[80:83], v[112:115]
    buffer_load_dwordx4 a[156:159], v1, s[16:19], s96 offen offset:3072 sc1
    v_mfma_f32_16x16x32_bf16 v[152:155], a[248:251], v[84:87], v[152:155]
    ds_read_b128 a[220:223], v26 offset:15360
    v_mul_f32 v49, v49, v36
    v_mfma_f32_16x16x32_bf16 v[192:195], a[248:251], v[88:91], v[192:195]
    v_mul_f32 v50, v50, v36
    v_mul_f32 v51, v51, v36
    v_mfma_f32_16x16x32_bf16 v[232:235], a[248:251], v[92:95], v[232:235]
    v_cvt_pk_bf16_f32 v18, v44, v45
    v_cvt_pk_bf16_f32 v19, v46, v47
    v_mfma_f32_16x16x32_bf16 v[236:239], a[252:255], v[92:95], v[236:239]
    buffer_load_dwordx4 v1, s[16:19], s6 offen offset:1024 sc1 lds
    v_mfma_f32_16x16x32_bf16 v[196:199], a[252:255], v[88:91], v[196:199]
    ds_read_b128 a[224:227], v26 offset:16384
    v_cvt_pk_bf16_f32 v20, v48, v49
    v_mfma_f32_16x16x32_bf16 v[156:159], a[252:255], v[84:87], v[156:159]
    v_cvt_pk_bf16_f32 v21, v50, v51
    v_accvgpr_read_b32 v52, a172
    v_mfma_f32_16x16x32_bf16 v[116:119], a[252:255], v[80:83], v[116:119]
    v_accvgpr_read_b32 v53, a173
    v_accvgpr_read_b32 v54, a174
    v_mfma_f32_16x16x32_bf16 v[120:123], a[192:195], v[80:83], v[120:123]
    ds_read_b128 a[228:231], v26 offset:18432
    v_accvgpr_read_b32 v55, a175
    v_mfma_f32_16x16x32_bf16 v[160:163], a[192:195], v[84:87], v[160:163]
    buffer_store_dwordx4 v[18:21], v1, s[16:19], s97 offen offset:2048
    v_mfma_f32_16x16x32_bf16 v[200:203], a[192:195], v[88:91], v[200:203]
    v_accvgpr_read_b32 v56, a188
    v_accvgpr_read_b32 v57, a189
    v_mfma_f32_16x16x32_bf16 v[240:243], a[192:195], v[92:95], v[240:243]
    v_accvgpr_read_b32 v58, a190
    v_accvgpr_read_b32 v59, a191
    v_mfma_f32_16x16x32_bf16 v[244:247], a[196:199], v[92:95], v[244:247]
    s_xor_b32 s60, s39, 2
    ds_read_b128 a[232:235], v26 offset:19456
    v_mul_f32 v52, v52, v37
    v_mfma_f32_16x16x32_bf16 v[204:207], a[196:199], v[88:91], v[204:207]
    s_mul_i32 s60, s60, 98304
    v_mul_f32 v53, v53, v37
    v_mul_f32 v54, v54, v37
    v_mfma_f32_16x16x32_bf16 v[164:167], a[196:199], v[84:87], v[164:167]
    s_add_u32 s60, s60, s70
    buffer_load_dwordx4 v1, s[16:19], s6 offen offset:2048 sc1 lds
    v_mfma_f32_16x16x32_bf16 v[124:127], a[196:199], v[80:83], v[124:127]
    s_add_u32 s96, s60, 0
    v_mul_f32 v55, v55, v37
    v_mul_f32 v56, v56, v37
    v_mfma_f32_16x16x32_bf16 v[128:131], a[200:203], v[80:83], v[128:131]
    ds_read_b128 a[236:239], v26 offset:20480
    v_mul_f32 v57, v57, v37
    v_mfma_f32_16x16x32_bf16 v[168:171], a[200:203], v[84:87], v[168:171]
    v_mul_f32 v58, v58, v37
    v_mul_f32 v59, v59, v37
    v_mfma_f32_16x16x32_bf16 v[208:211], a[200:203], v[88:91], v[208:211]
    v_cvt_pk_bf16_f32 v22, v52, v53
    v_cvt_pk_bf16_f32 v23, v54, v55
    v_mfma_f32_16x16x32_bf16 v[248:251], a[200:203], v[92:95], v[248:251]
    buffer_load_dwordx4 a[160:163], v1, s[16:19], s96 offen offset:0 sc1
    v_mfma_f32_16x16x32_bf16 v[252:255], a[204:207], v[92:95], v[252:255]
    ds_read_b128 a[240:243], v26 offset:21504
    v_cvt_pk_bf16_f32 v24, v56, v57
    v_mfma_f32_16x16x32_bf16 v[212:215], a[204:207], v[88:91], v[212:215]
    v_cvt_pk_bf16_f32 v25, v58, v59
    v_mfma_f32_16x16x32_bf16 v[172:175], a[204:207], v[84:87], v[172:175]
    v_mfma_f32_16x16x32_bf16 v[132:135], a[204:207], v[80:83], v[132:135]
    buffer_store_dwordx4 v[22:25], v1, s[16:19], s97 offen offset:3072
    v_mfma_f32_16x16x32_bf16 v[96:99], a[208:211], v[10:13], v[96:99]
    ds_read_b128 a[244:247], v26 offset:22528
    v_mfma_f32_16x16x32_bf16 v[136:139], a[208:211], v[14:17], v[136:139]
    v_mfma_f32_16x16x32_bf16 v[176:179], a[208:211], v[18:21], v[176:179]
    v_mfma_f32_16x16x32_bf16 v[216:219], a[208:211], v[22:25], v[216:219]
    s_waitcnt lgkmcnt(2)
    v_mfma_f32_16x16x32_bf16 v[220:223], a[212:215], v[22:25], v[220:223]
    buffer_load_dwordx4 a[164:167], v1, s[16:19], s96 offen offset:1024 sc1
    v_mfma_f32_16x16x32_bf16 v[180:183], a[212:215], v[18:21], v[180:183]
    v_mfma_f32_16x16x32_bf16 v[140:143], a[212:215], v[14:17], v[140:143]
    v_mfma_f32_16x16x32_bf16 v[100:103], a[212:215], v[10:13], v[100:103]
    v_mfma_f32_16x16x32_bf16 v[104:107], a[216:219], v[10:13], v[104:107]
    v_mfma_f32_16x16x32_bf16 v[144:147], a[216:219], v[14:17], v[144:147]
    buffer_load_dwordx4 a[168:171], v1, s[16:19], s96 offen offset:2048 sc1
    v_mfma_f32_16x16x32_bf16 v[184:187], a[216:219], v[18:21], v[184:187]
    v_mfma_f32_16x16x32_bf16 v[224:227], a[216:219], v[22:25], v[224:227]
    v_mfma_f32_16x16x32_bf16 v[228:231], a[220:223], v[22:25], v[228:231]
    v_mfma_f32_16x16x32_bf16 v[188:191], a[220:223], v[18:21], v[188:191]
    buffer_load_dwordx4 a[172:175], v1, s[16:19], s96 offen offset:3072 sc1
    v_mfma_f32_16x16x32_bf16 v[148:151], a[220:223], v[14:17], v[148:151]
    s_add_u32 s96, s60, 4096
    v_mfma_f32_16x16x32_bf16 v[108:111], a[220:223], v[10:13], v[108:111]
    v_add_u32 v26, 122880, v1
    v_mfma_f32_16x16x32_bf16 v[112:115], a[224:227], v[10:13], v[112:115]
    v_mfma_f32_16x16x32_bf16 v[152:155], a[224:227], v[14:17], v[152:155]
    v_mfma_f32_16x16x32_bf16 v[192:195], a[224:227], v[18:21], v[192:195]
    buffer_load_dwordx4 a[176:179], v1, s[16:19], s96 offen offset:0 sc1
    v_mfma_f32_16x16x32_bf16 v[232:235], a[224:227], v[22:25], v[232:235]
    v_mfma_f32_16x16x32_bf16 v[236:239], a[228:231], v[22:25], v[236:239]
    v_mfma_f32_16x16x32_bf16 v[196:199], a[228:231], v[18:21], v[196:199]
    v_mfma_f32_16x16x32_bf16 v[156:159], a[228:231], v[14:17], v[156:159]
    s_waitcnt lgkmcnt(0)
    s_barrier
    v_mfma_f32_16x16x32_bf16 v[116:119], a[228:231], v[10:13], v[116:119]
    buffer_load_dwordx4 a[180:183], v1, s[16:19], s96 offen offset:1024 sc1
    v_mfma_f32_16x16x32_bf16 v[120:123], a[232:235], v[10:13], v[120:123]
    ds_read_b128 a[248:251], v26 offset:0
    v_mfma_f32_16x16x32_bf16 v[160:163], a[232:235], v[14:17], v[160:163]
    ds_read_b128 a[252:255], v26 offset:12288
    v_mfma_f32_16x16x32_bf16 v[200:203], a[232:235], v[18:21], v[200:203]
    ds_read_b128 a[192:195], v26 offset:1024
    v_mfma_f32_16x16x32_bf16 v[240:243], a[232:235], v[22:25], v[240:243]
    buffer_load_dwordx4 a[184:187], v1, s[16:19], s96 offen offset:2048 sc1
    v_mfma_f32_16x16x32_bf16 v[244:247], a[236:239], v[22:25], v[244:247]
    ds_read_b128 a[196:199], v26 offset:13312
    v_mfma_f32_16x16x32_bf16 v[204:207], a[236:239], v[18:21], v[204:207]
    ds_read_b128 a[200:203], v26 offset:2048
    v_mfma_f32_16x16x32_bf16 v[164:167], a[236:239], v[14:17], v[164:167]
    ds_read_b128 a[204:207], v26 offset:14336
    v_mfma_f32_16x16x32_bf16 v[124:127], a[236:239], v[10:13], v[124:127]
    ds_read_b128 a[208:211], v26 offset:3072
    v_mfma_f32_16x16x32_bf16 v[128:131], a[240:243], v[10:13], v[128:131]
    buffer_load_dwordx4 a[188:191], v1, s[16:19], s96 offen offset:3072 sc1
    v_mfma_f32_16x16x32_bf16 v[168:171], a[240:243], v[14:17], v[168:171]
    ds_read_b128 a[212:215], v26 offset:15360
    v_mfma_f32_16x16x32_bf16 v[208:211], a[240:243], v[18:21], v[208:211]
    v_mfma_f32_16x16x32_bf16 v[248:251], a[240:243], v[22:25], v[248:251]
    v_mfma_f32_16x16x32_bf16 v[252:255], a[244:247], v[22:25], v[252:255]
    buffer_load_dwordx4 v1, s[16:19], s6 offen offset:3072 sc1 lds
    v_mfma_f32_16x16x32_bf16 v[212:215], a[244:247], v[18:21], v[212:215]
    s_add_u32 m0, m0, 4096
    ds_read_b128 a[216:219], v26 offset:4096
    v_mfma_f32_16x16x32_bf16 v[172:175], a[244:247], v[14:17], v[172:175]
    ds_read_b128 a[220:223], v26 offset:16384
    v_mfma_f32_16x16x32_bf16 v[132:135], a[244:247], v[10:13], v[132:135]
    s_waitcnt vmcnt(24) lgkmcnt(4)
    v_mfma_f32_16x16x32_bf16 v[96:99], a[248:251], a[128:131], v[96:99]
    s_waitcnt vmcnt(18)
    v_mfma_f32_16x16x32_bf16 v[96:99], a[252:255], a[144:147], v[96:99]
    s_waitcnt vmcnt(16)
    buffer_load_dword v38, v62, s[16:19], s58 offen offset:80 sc1
    v_mfma_f32_16x16x32_bf16 v[136:139], a[252:255], a[148:151], v[136:139]
    s_xor_b32 s60, s39, 3
    s_mul_i32 s60, s60, 98304
    s_add_u32 s60, s60, s70
    v_mfma_f32_16x16x32_bf16 v[136:139], a[248:251], a[132:135], v[136:139]
    s_add_u32 s96, s60, 0
    buffer_load_dwordx4 v39, s[16:19], s6 offen offset:0 sc1 lds
    v_mfma_f32_16x16x32_bf16 v[176:179], a[248:251], a[136:139], v[176:179]
    s_waitcnt vmcnt(17)
    ds_read_b128 a[224:227], v26 offset:6144
    s_xor_b32 s6, s40, 8
    v_mfma_f32_16x16x32_bf16 v[176:179], a[252:255], a[152:155], v[176:179]
    s_waitcnt vmcnt(15)
    ds_read_b128 a[228:231], v26 offset:18432
    s_mul_i32 s6, s6, 245760
    v_mfma_f32_16x16x32_bf16 v[216:219], a[252:255], a[156:159], v[216:219]
    s_add_u32 s6, s6, s75
    s_add_u32 s6, s6, 81920
    s_add_u32 m0, s42, 49152
    v_mfma_f32_16x16x32_bf16 v[216:219], a[248:251], a[140:143], v[216:219]
    v_mfma_f32_16x16x32_bf16 v[220:223], a[192:195], a[140:143], v[220:223]
    buffer_load_dwordx4 a[96:99], v1, s[16:19], s96 offen offset:0 sc1
    v_mfma_f32_16x16x32_bf16 v[220:223], a[196:199], a[156:159], v[220:223]
    v_mfma_f32_16x16x32_bf16 v[180:183], a[196:199], a[152:155], v[180:183]
    v_mfma_f32_16x16x32_bf16 v[180:183], a[192:195], a[136:139], v[180:183]
    s_waitcnt vmcnt(11)
    s_cmp_lg_u32 s54, 0
    s_cbranch_scc1 WB2
    buffer_store_dword v61, v9, s[16:19], s55 offen offset:96
WB2B:
    v_mfma_f32_16x16x32_bf16 v[140:143], a[192:195], a[132:135], v[140:143]
    ds_read_b128 a[232:235], v26 offset:7168
    v_mfma_f32_16x16x32_bf16 v[140:143], a[196:199], a[148:151], v[140:143]
    ds_read_b128 a[236:239], v26 offset:19456
    v_mfma_f32_16x16x32_bf16 v[100:103], a[196:199], a[144:147], v[100:103]
    buffer_load_dwordx4 a[100:103], v1, s[16:19], s96 offen offset:1024 sc1
    v_mfma_f32_16x16x32_bf16 v[100:103], a[192:195], a[128:131], v[100:103]
    v_mfma_f32_16x16x32_bf16 v[104:107], a[200:203], a[128:131], v[104:107]
    v_mfma_f32_16x16x32_bf16 v[104:107], a[204:207], a[144:147], v[104:107]
    v_mfma_f32_16x16x32_bf16 v[144:147], a[204:207], a[148:151], v[144:147]
    v_mfma_f32_16x16x32_bf16 v[144:147], a[200:203], a[132:135], v[144:147]
    buffer_load_dwordx4 a[104:107], v1, s[16:19], s96 offen offset:2048 sc1
    v_mfma_f32_16x16x32_bf16 v[184:187], a[200:203], a[136:139], v[184:187]
    ds_read_b128 a[240:243], v26 offset:8192
    v_mfma_f32_16x16x32_bf16 v[184:187], a[204:207], a[152:155], v[184:187]
    ds_read_b128 a[244:247], v26 offset:20480
    v_mfma_f32_16x16x32_bf16 v[224:227], a[204:207], a[156:159], v[224:227]
    v_mfma_f32_16x16x32_bf16 v[224:227], a[200:203], a[140:143], v[224:227]
    s_waitcnt lgkmcnt(2)
    buffer_load_dwordx4 a[108:111], v1, s[16:19], s96 offen offset:3072 sc1
    v_mfma_f32_16x16x32_bf16 v[228:231], a[208:211], a[140:143], v[228:231]
    s_add_u32 s96, s60, 4096
    v_mfma_f32_16x16x32_bf16 v[228:231], a[212:215], a[156:159], v[228:231]
    v_mfma_f32_16x16x32_bf16 v[188:191], a[212:215], a[152:155], v[188:191]
    v_mfma_f32_16x16x32_bf16 v[188:191], a[208:211], a[136:139], v[188:191]
    v_mfma_f32_16x16x32_bf16 v[148:151], a[208:211], a[132:135], v[148:151]
    buffer_load_dwordx4 a[112:115], v1, s[16:19], s96 offen offset:0 sc1
    v_mfma_f32_16x16x32_bf16 v[148:151], a[212:215], a[148:151], v[148:151]
    ds_read_b128 a[248:251], v26 offset:9216
    v_mfma_f32_16x16x32_bf16 v[108:111], a[212:215], a[144:147], v[108:111]
    ds_read_b128 a[252:255], v26 offset:21504
    v_mfma_f32_16x16x32_bf16 v[108:111], a[208:211], a[128:131], v[108:111]
    v_mfma_f32_16x16x32_bf16 v[112:115], a[216:219], a[128:131], v[112:115]
    v_mfma_f32_16x16x32_bf16 v[112:115], a[220:223], a[144:147], v[112:115]
    buffer_load_dwordx4 a[116:119], v1, s[16:19], s96 offen offset:1024 sc1
    v_mfma_f32_16x16x32_bf16 v[152:155], a[220:223], a[148:151], v[152:155]
    v_mfma_f32_16x16x32_bf16 v[152:155], a[216:219], a[132:135], v[152:155]
    v_mfma_f32_16x16x32_bf16 v[192:195], a[216:219], a[136:139], v[192:195]
    ds_read_b128 a[192:195], v26 offset:10240
    v_mfma_f32_16x16x32_bf16 v[192:195], a[220:223], a[152:155], v[192:195]
    buffer_load_dwordx4 a[120:123], v1, s[16:19], s96 offen offset:2048 sc1
    v_mfma_f32_16x16x32_bf16 v[232:235], a[220:223], a[156:159], v[232:235]
    ds_read_b128 a[196:199], v26 offset:22528
    v_mfma_f32_16x16x32_bf16 v[232:235], a[216:219], a[140:143], v[232:235]
    v_mfma_f32_16x16x32_bf16 v[236:239], a[224:227], a[140:143], v[236:239]
    v_mfma_f32_16x16x32_bf16 v[236:239], a[228:231], a[156:159], v[236:239]
    v_mfma_f32_16x16x32_bf16 v[196:199], a[228:231], a[152:155], v[196:199]
    buffer_load_dwordx4 a[124:127], v1, s[16:19], s96 offen offset:3072 sc1
    v_mfma_f32_16x16x32_bf16 v[196:199], a[224:227], a[136:139], v[196:199]
    v_mfma_f32_16x16x32_bf16 v[156:159], a[224:227], a[132:135], v[156:159]
    v_mfma_f32_16x16x32_bf16 v[156:159], a[228:231], a[148:151], v[156:159]
    v_mfma_f32_16x16x32_bf16 v[116:119], a[228:231], a[144:147], v[116:119]
    buffer_load_dwordx4 v1, s[16:19], s6 offen offset:0 sc1 lds
    v_mfma_f32_16x16x32_bf16 v[116:119], a[224:227], a[128:131], v[116:119]
    v_mfma_f32_16x16x32_bf16 v[120:123], a[232:235], a[128:131], v[120:123]
    v_mfma_f32_16x16x32_bf16 v[120:123], a[236:239], a[144:147], v[120:123]
    v_mfma_f32_16x16x32_bf16 v[160:163], a[236:239], a[148:151], v[160:163]
    v_mfma_f32_16x16x32_bf16 v[160:163], a[232:235], a[132:135], v[160:163]
    buffer_load_dwordx4 v1, s[16:19], s6 offen offset:1024 sc1 lds
    v_mfma_f32_16x16x32_bf16 v[200:203], a[232:235], a[136:139], v[200:203]
WS11:
    s_cbranch_execz WS7
    v_mfma_f32_16x16x32_bf16 v[200:203], a[236:239], a[152:155], v[200:203]
    v_mfma_f32_16x16x32_bf16 v[240:243], a[236:239], a[156:159], v[240:243]
    v_mfma_f32_16x16x32_bf16 v[240:243], a[232:235], a[140:143], v[240:243]
    s_waitcnt lgkmcnt(0)
    v_add_u32 v26, 0, v1
    v_mfma_f32_16x16x32_bf16 v[244:247], a[240:243], a[140:143], v[244:247]
    buffer_load_dwordx4 v1, s[16:19], s6 offen offset:2048 sc1 lds
    v_mfma_f32_16x16x32_bf16 v[244:247], a[244:247], a[156:159], v[244:247]
    v_mfma_f32_16x16x32_bf16 v[204:207], a[244:247], a[152:155], v[204:207]
    v_mfma_f32_16x16x32_bf16 v[204:207], a[240:243], a[136:139], v[204:207]
    v_mfma_f32_16x16x32_bf16 v[164:167], a[240:243], a[132:135], v[164:167]
    buffer_load_dwordx4 v1, s[16:19], s6 offen offset:3072 sc1 lds
    v_mfma_f32_16x16x32_bf16 v[164:167], a[244:247], a[148:151], v[164:167]
    s_add_u32 m0, m0, 4096
    v_mfma_f32_16x16x32_bf16 v[124:127], a[244:247], a[144:147], v[124:127]
    s_waitcnt lgkmcnt(0)
    s_barrier
    v_mfma_f32_16x16x32_bf16 v[124:127], a[240:243], a[128:131], v[124:127]
    ds_read_b128 a[200:203], v26 offset:0
    v_mfma_f32_16x16x32_bf16 v[128:131], a[248:251], a[128:131], v[128:131]
    ds_read_b128 a[204:207], v26 offset:12288
    v_mfma_f32_16x16x32_bf16 v[128:131], a[252:255], a[144:147], v[128:131]
    buffer_load_dwordx4 v39, s[16:19], s6 offen offset:0 sc1 lds
    v_mfma_f32_16x16x32_bf16 v[168:171], a[252:255], a[148:151], v[168:171]
    s_xor_b32 s6, s40, 16
    ds_read_b128 a[208:211], v26 offset:1024
    s_mul_i32 s6, s6, 245760
    v_mfma_f32_16x16x32_bf16 v[168:171], a[248:251], a[132:135], v[168:171]
    s_add_u32 s6, s6, s75
    ds_read_b128 a[212:215], v26 offset:13312
    s_add_u32 s6, s6, 81920
    v_mfma_f32_16x16x32_bf16 v[208:211], a[248:251], a[136:139], v[208:211]
    s_add_u32 m0, s42, 73728
    ds_read_b128 a[216:219], v26 offset:2048
    v_mfma_f32_16x16x32_bf16 v[208:211], a[252:255], a[152:155], v[208:211]
    buffer_load_dwordx4 v1, s[16:19], s6 offen offset:0 sc1 lds
    v_mfma_f32_16x16x32_bf16 v[248:251], a[252:255], a[156:159], v[248:251]
    ds_read_b128 a[220:223], v26 offset:14336
    v_mfma_f32_16x16x32_bf16 v[248:251], a[248:251], a[140:143], v[248:251]
    ds_read_b128 a[224:227], v26 offset:3072
    v_mfma_f32_16x16x32_bf16 v[252:255], a[192:195], a[140:143], v[252:255]
    ds_read_b128 a[228:231], v26 offset:15360
    v_mfma_f32_16x16x32_bf16 v[252:255], a[196:199], a[156:159], v[252:255]
    v_mfma_f32_16x16x32_bf16 v[212:215], a[196:199], a[152:155], v[212:215]
    buffer_load_dwordx4 v1, s[16:19], s6 offen offset:1024 sc1 lds
    v_mfma_f32_16x16x32_bf16 v[212:215], a[192:195], a[136:139], v[212:215]
    v_mfma_f32_16x16x32_bf16 v[172:175], a[192:195], a[132:135], v[172:175]
    ds_read_b128 a[232:235], v26 offset:4096
    v_mfma_f32_16x16x32_bf16 v[172:175], a[196:199], a[148:151], v[172:175]
    ds_read_b128 a[236:239], v26 offset:16384
    v_mfma_f32_16x16x32_bf16 v[132:135], a[196:199], a[144:147], v[132:135]
    v_mfma_f32_16x16x32_bf16 v[132:135], a[192:195], a[128:131], v[132:135]
    s_waitcnt lgkmcnt(4)
    buffer_load_dwordx4 v1, s[16:19], s6 offen offset:2048 sc1 lds
    v_mfma_f32_16x16x32_bf16 v[96:99], a[200:203], a[160:163], v[96:99]
    s_waitcnt vmcnt(23)
    v_mfma_f32_16x16x32_bf16 v[96:99], a[204:207], a[176:179], v[96:99]
    s_waitcnt vmcnt(18)
    v_cmp_ne_u32 vcc, v38, v61
    s_cbranch_vccnz SPIN20
BACK20:
    v_mfma_f32_16x16x32_bf16 v[136:139], a[204:207], a[180:183], v[136:139]
    s_xor_b32 s60, s39, 1
    s_mul_i32 s60, s60, 98304
    s_add_u32 s60, s60, s70
    v_mfma_f32_16x16x32_bf16 v[136:139], a[200:203], a[164:167], v[136:139]
    s_add_u32 s96, s60, 8192
    buffer_load_dwordx4 a[128:131], v1, s[16:19], s96 offen offset:0 sc1
    v_mfma_f32_16x16x32_bf16 v[176:179], a[200:203], a[168:171], v[176:179]
    ds_read_b128 a[240:243], v26 offset:6144
    v_mfma_f32_16x16x32_bf16 v[176:179], a[204:207], a[184:187], v[176:179]
    ds_read_b128 a[244:247], v26 offset:18432
    v_mfma_f32_16x16x32_bf16 v[216:219], a[204:207], a[188:191], v[216:219]
    v_mfma_f32_16x16x32_bf16 v[216:219], a[200:203], a[172:175], v[216:219]
    v_mfma_f32_16x16x32_bf16 v[220:223], a[208:211], a[172:175], v[220:223]
    buffer_load_dwordx4 a[132:135], v1, s[16:19], s96 offen offset:1024 sc1
    v_mfma_f32_16x16x32_bf16 v[220:223], a[212:215], a[188:191], v[220:223]
    v_mfma_f32_16x16x32_bf16 v[180:183], a[212:215], a[184:187], v[180:183]
    v_mfma_f32_16x16x32_bf16 v[180:183], a[208:211], a[168:171], v[180:183]
    v_mfma_f32_16x16x32_bf16 v[140:143], a[208:211], a[164:167], v[140:143]
    buffer_load_dwordx4 a[136:139], v1, s[16:19], s96 offen offset:2048 sc1
    v_mfma_f32_16x16x32_bf16 v[140:143], a[212:215], a[180:183], v[140:143]
    ds_read_b128 a[248:251], v26 offset:7168
    v_mfma_f32_16x16x32_bf16 v[100:103], a[212:215], a[176:179], v[100:103]
    ds_read_b128 a[252:255], v26 offset:19456
    v_mfma_f32_16x16x32_bf16 v[100:103], a[208:211], a[160:163], v[100:103]
    v_mfma_f32_16x16x32_bf16 v[104:107], a[216:219], a[160:163], v[104:107]
    v_mfma_f32_16x16x32_bf16 v[104:107], a[220:223], a[176:179], v[104:107]
    buffer_load_dwordx4 a[140:143], v1, s[16:19], s96 offen offset:3072 sc1
    v_mfma_f32_16x16x32_bf16 v[144:147], a[220:223], a[180:183], v[144:147]
    s_add_u32 s96, s60, 12288
    v_mfma_f32_16x16x32_bf16 v[144:147], a[216:219], a[164:167], v[144:147]
    v_mfma_f32_16x16x32_bf16 v[184:187], a[216:219], a[168:171], v[184:187]
    s_mov_b32 s24, s82
    ds_read_b128 a[192:195], v26 offset:8192
    v_mfma_f32_16x16x32_bf16 v[184:187], a[220:223], a[184:187], v[184:187]
    ds_read_b128 a[196:199], v26 offset:20480
    v_mfma_f32_16x16x32_bf16 v[224:227], a[220:223], a[188:191], v[224:227]
    s_and_b32 s25, s83, 0xffff
    buffer_load_dwordx4 a[144:147], v1, s[16:19], s96 offen offset:0 sc1
    v_mfma_f32_16x16x32_bf16 v[224:227], a[216:219], a[172:175], v[224:227]
    s_waitcnt lgkmcnt(2)
    v_mfma_f32_16x16x32_bf16 v[228:231], a[224:227], a[172:175], v[228:231]
    s_mov_b32 s26, 2621440
    v_mfma_f32_16x16x32_bf16 v[228:231], a[228:231], a[188:191], v[228:231]
    v_mfma_f32_16x16x32_bf16 v[188:191], a[228:231], a[184:187], v[188:191]
    s_mov_b32 s27, 0x20000
    buffer_load_dwordx4 a[148:151], v1, s[16:19], s96 offen offset:1024 sc1
    v_mfma_f32_16x16x32_bf16 v[188:191], a[224:227], a[168:171], v[188:191]
    v_mfma_f32_16x16x32_bf16 v[148:151], a[224:227], a[164:167], v[148:151]
    ds_read_b128 a[200:203], v26 offset:9216
    v_and_b32 v27, 15, v0
    v_mfma_f32_16x16x32_bf16 v[148:151], a[228:231], a[180:183], v[148:151]
    ds_read_b128 a[204:207], v26 offset:21504
    v_mfma_f32_16x16x32_bf16 v[108:111], a[228:231], a[176:179], v[108:111]
    v_mul_u32_u24 v27, 1280, v27
    v_mfma_f32_16x16x32_bf16 v[108:111], a[224:227], a[160:163], v[108:111]
    buffer_load_dwordx4 a[152:155], v1, s[16:19], s96 offen offset:2048 sc1
    v_mfma_f32_16x16x32_bf16 v[112:115], a[232:235], a[160:163], v[112:115]
    v_lshrrev_b32 v28, 4, v0
    v_mfma_f32_16x16x32_bf16 v[112:115], a[236:239], a[176:179], v[112:115]
    v_mfma_f32_16x16x32_bf16 v[152:155], a[236:239], a[180:183], v[152:155]
    v_lshl_add_u32 v28, v28, 3, v27
    v_mfma_f32_16x16x32_bf16 v[152:155], a[232:235], a[164:167], v[152:155]
    buffer_load_dwordx4 a[156:159], v1, s[16:19], s96 offen offset:3072 sc1
    v_mfma_f32_16x16x32_bf16 v[192:195], a[232:235], a[168:171], v[192:195]
    s_mov_b32 s91, 81920
    ds_read_b128 a[208:211], v26 offset:10240
    v_mfma_f32_16x16x32_bf16 v[192:195], a[236:239], a[184:187], v[192:195]
    ds_read_b128 a[212:215], v26 offset:22528
    v_mfma_f32_16x16x32_bf16 v[232:235], a[236:239], a[188:191], v[232:235]
    v_mfma_f32_16x16x32_bf16 v[232:235], a[232:235], a[172:175], v[232:235]
    v_mfma_f32_16x16x32_bf16 v[236:239], a[240:243], a[172:175], v[236:239]
    buffer_load_dwordx4 v1, s[16:19], s6 offen offset:3072 sc1 lds
    v_mfma_f32_16x16x32_bf16 v[236:239], a[244:247], a[188:191], v[236:239]
    s_add_u32 m0, m0, 4096
    v_mfma_f32_16x16x32_bf16 v[196:199], a[244:247], a[184:187], v[196:199]
    v_mfma_f32_16x16x32_bf16 v[196:199], a[240:243], a[168:171], v[196:199]
    v_mfma_f32_16x16x32_bf16 v[156:159], a[240:243], a[164:167], v[156:159]
    v_mfma_f32_16x16x32_bf16 v[156:159], a[244:247], a[180:183], v[156:159]
    buffer_load_dword v38, v62, s[16:19], s58 offen offset:96 sc1
    v_mfma_f32_16x16x32_bf16 v[116:119], a[244:247], a[176:179], v[116:119]
    v_mfma_f32_16x16x32_bf16 v[116:119], a[240:243], a[160:163], v[116:119]
    buffer_load_dwordx4 v39, s[16:19], s6 offen offset:0 sc1 lds
    v_mfma_f32_16x16x32_bf16 v[120:123], a[248:251], a[160:163], v[120:123]
    s_xor_b32 s6, s40, 24
    s_mul_i32 s6, s6, 245760
    s_add_u32 s6, s6, s75
    v_mfma_f32_16x16x32_bf16 v[120:123], a[252:255], a[176:179], v[120:123]
    s_add_u32 s6, s6, 81920
    s_add_u32 m0, s42, 98304
    v_mfma_f32_16x16x32_bf16 v[160:163], a[252:255], a[180:183], v[160:163]
    v_mfma_f32_16x16x32_bf16 v[160:163], a[248:251], a[164:167], v[160:163]
    buffer_load_dwordx4 v1, s[16:19], s6 offen offset:0 sc1 lds
    v_mfma_f32_16x16x32_bf16 v[200:203], a[248:251], a[168:171], v[200:203]
    v_mfma_f32_16x16x32_bf16 v[200:203], a[252:255], a[184:187], v[200:203]
    v_mfma_f32_16x16x32_bf16 v[240:243], a[252:255], a[188:191], v[240:243]
    v_mfma_f32_16x16x32_bf16 v[240:243], a[248:251], a[172:175], v[240:243]
    s_waitcnt lgkmcnt(0)
    v_add_u32 v26, 24576, v1
    v_mfma_f32_16x16x32_bf16 v[244:247], a[192:195], a[172:175], v[244:247]
    buffer_load_dwordx4 v1, s[16:19], s6 offen offset:1024 sc1 lds
    v_mfma_f32_16x16x32_bf16 v[244:247], a[196:199], a[188:191], v[244:247]
    v_mfma_f32_16x16x32_bf16 v[204:207], a[196:199], a[184:187], v[204:207]
    v_mfma_f32_16x16x32_bf16 v[204:207], a[192:195], a[168:171], v[204:207]
    v_mfma_f32_16x16x32_bf16 v[164:167], a[192:195], a[164:167], v[164:167]
    buffer_load_dwordx4 v1, s[16:19], s6 offen offset:2048 sc1 lds
    v_mfma_f32_16x16x32_bf16 v[164:167], a[196:199], a[180:183], v[164:167]
    v_mfma_f32_16x16x32_bf16 v[124:127], a[196:199], a[176:179], v[124:127]
    s_waitcnt vmcnt(31)
    s_waitcnt lgkmcnt(0)
    s_barrier
    v_mfma_f32_16x16x32_bf16 v[124:127], a[192:195], a[160:163], v[124:127]
    ds_read_b128 a[216:219], v26 offset:0
    v_mfma_f32_16x16x32_bf16 v[128:131], a[200:203], a[160:163], v[128:131]
    ds_read_b128 a[220:223], v26 offset:12288
    v_mfma_f32_16x16x32_bf16 v[128:131], a[204:207], a[176:179], v[128:131]
    buffer_load_dwordx4 v1, s[16:19], s6 offen offset:3072 sc1 lds
    v_mfma_f32_16x16x32_bf16 v[168:171], a[204:207], a[180:183], v[168:171]
    s_add_u32 m0, m0, 4096
    ds_read_b128 a[224:227], v26 offset:1024
    v_mfma_f32_16x16x32_bf16 v[168:171], a[200:203], a[164:167], v[168:171]
    ds_read_b128 a[228:231], v26 offset:13312
    v_mfma_f32_16x16x32_bf16 v[208:211], a[200:203], a[168:171], v[208:211]
    ds_read_b128 a[232:235], v26 offset:2048
    v_mfma_f32_16x16x32_bf16 v[208:211], a[204:207], a[184:187], v[208:211]
    ds_read_b128 a[236:239], v26 offset:14336
    v_mfma_f32_16x16x32_bf16 v[248:251], a[204:207], a[188:191], v[248:251]
    buffer_load_dwordx4 v39, s[16:19], s6 offen offset:0 sc1 lds
    v_mfma_f32_16x16x32_bf16 v[248:251], a[200:203], a[172:175], v[248:251]
    s_add_u32 s6, s77, 81920
    ds_read_b128 a[240:243], v26 offset:3072
    s_add_u32 m0, s42, 122880
    v_mfma_f32_16x16x32_bf16 v[252:255], a[208:211], a[172:175], v[252:255]
    ds_read_b128 a[244:247], v26 offset:15360
    v_mfma_f32_16x16x32_bf16 v[252:255], a[212:215], a[188:191], v[252:255]
    v_mfma_f32_16x16x32_bf16 v[212:215], a[212:215], a[184:187], v[212:215]
    buffer_load_dwordx4 v1, s[16:19], s6 offen offset:0 sc1 lds
    v_mfma_f32_16x16x32_bf16 v[212:215], a[208:211], a[168:171], v[212:215]
    v_mfma_f32_16x16x32_bf16 v[172:175], a[208:211], a[164:167], v[172:175]
    ds_read_b128 a[248:251], v26 offset:4096
    v_mfma_f32_16x16x32_bf16 v[172:175], a[212:215], a[180:183], v[172:175]
    ds_read_b128 a[252:255], v26 offset:16384
    v_mfma_f32_16x16x32_bf16 v[132:135], a[212:215], a[176:179], v[132:135]
    v_mfma_f32_16x16x32_bf16 v[132:135], a[208:211], a[160:163], v[132:135]
    s_waitcnt vmcnt(33) lgkmcnt(4)
    buffer_load_dwordx4 v1, s[16:19], s6 offen offset:1024 sc1 lds
    v_mfma_f32_16x16x32_bf16 v[96:99], a[216:219], a[96:99], v[96:99]
    s_waitcnt vmcnt(29)
    v_mfma_f32_16x16x32_bf16 v[96:99], a[220:223], a[112:115], v[96:99]
    s_waitcnt vmcnt(28)
    s_xor_b32 s60, s39, 2
    s_mul_i32 s60, s60, 98304
    v_mfma_f32_16x16x32_bf16 v[136:139], a[220:223], a[116:119], v[136:139]
    s_add_u32 s60, s60, s70
    s_add_u32 s96, s60, 8192
    v_mfma_f32_16x16x32_bf16 v[136:139], a[216:219], a[100:103], v[136:139]
    buffer_load_dwordx4 a[160:163], v1, s[16:19], s96 offen offset:0 sc1
    v_mfma_f32_16x16x32_bf16 v[176:179], a[216:219], a[104:107], v[176:179]
    s_waitcnt vmcnt(28)
    ds_read_b128 a[192:195], v26 offset:6144
    v_mfma_f32_16x16x32_bf16 v[176:179], a[220:223], a[120:123], v[176:179]
    s_waitcnt vmcnt(27)
    ds_read_b128 a[196:199], v26 offset:18432
    v_mfma_f32_16x16x32_bf16 v[216:219], a[220:223], a[124:127], v[216:219]
    v_mfma_f32_16x16x32_bf16 v[216:219], a[216:219], a[108:111], v[216:219]
    v_mfma_f32_16x16x32_bf16 v[220:223], a[224:227], a[108:111], v[220:223]
    buffer_load_dwordx4 a[164:167], v1, s[16:19], s96 offen offset:1024 sc1
    v_mfma_f32_16x16x32_bf16 v[220:223], a[228:231], a[124:127], v[220:223]
    v_mfma_f32_16x16x32_bf16 v[180:183], a[228:231], a[120:123], v[180:183]
    v_mfma_f32_16x16x32_bf16 v[180:183], a[224:227], a[104:107], v[180:183]
    v_mfma_f32_16x16x32_bf16 v[140:143], a[224:227], a[100:103], v[140:143]
    ds_read_b128 a[200:203], v26 offset:7168
    v_mfma_f32_16x16x32_bf16 v[140:143], a[228:231], a[116:119], v[140:143]
    buffer_load_dwordx4 a[168:171], v1, s[16:19], s96 offen offset:2048 sc1
    v_mfma_f32_16x16x32_bf16 v[100:103], a[228:231], a[112:115], v[100:103]
    ds_read_b128 a[204:207], v26 offset:19456
    v_mfma_f32_16x16x32_bf16 v[100:103], a[224:227], a[96:99], v[100:103]
    v_mfma_f32_16x16x32_bf16 v[104:107], a[232:235], a[96:99], v[104:107]
    v_mfma_f32_16x16x32_bf16 v[104:107], a[236:239], a[112:115], v[104:107]
    buffer_load_dwordx4 a[172:175], v1, s[16:19], s96 offen offset:3072 sc1
    v_mfma_f32_16x16x32_bf16 v[144:147], a[236:239], a[116:119], v[144:147]
    s_add_u32 s96, s60, 12288
    v_mfma_f32_16x16x32_bf16 v[144:147], a[232:235], a[100:103], v[144:147]
    v_mfma_f32_16x16x32_bf16 v[184:187], a[232:235], a[104:107], v[184:187]
    ds_read_b128 a[208:211], v26 offset:8192
    v_mfma_f32_16x16x32_bf16 v[184:187], a[236:239], a[120:123], v[184:187]
    ds_read_b128 a[212:215], v26 offset:20480
    v_mfma_f32_16x16x32_bf16 v[224:227], a[236:239], a[124:127], v[224:227]
    buffer_load_dwordx4 a[176:179], v1, s[16:19], s96 offen offset:0 sc1
    v_mfma_f32_16x16x32_bf16 v[224:227], a[232:235], a[108:111], v[224:227]
    s_waitcnt lgkmcnt(2)
    v_mfma_f32_16x16x32_bf16 v[228:231], a[240:243], a[108:111], v[228:231]
    v_mfma_f32_16x16x32_bf16 v[228:231], a[244:247], a[124:127], v[228:231]
    v_mfma_f32_16x16x32_bf16 v[188:191], a[244:247], a[120:123], v[188:191]
    buffer_load_dwordx4 a[180:183], v1, s[16:19], s96 offen offset:1024 sc1
    v_mfma_f32_16x16x32_bf16 v[188:191], a[240:243], a[104:107], v[188:191]
    v_mfma_f32_16x16x32_bf16 v[148:151], a[240:243], a[100:103], v[148:151]
    ds_read_b128 a[216:219], v26 offset:9216
    v_mfma_f32_16x16x32_bf16 v[148:151], a[244:247], a[116:119], v[148:151]
    ds_read_b128 a[220:223], v26 offset:21504
    v_mfma_f32_16x16x32_bf16 v[108:111], a[244:247], a[112:115], v[108:111]
    v_mfma_f32_16x16x32_bf16 v[108:111], a[240:243], a[96:99], v[108:111]
    buffer_load_dwordx4 a[184:187], v1, s[16:19], s96 offen offset:2048 sc1
    v_mfma_f32_16x16x32_bf16 v[112:115], a[248:251], a[96:99], v[112:115]
    v_mfma_f32_16x16x32_bf16 v[112:115], a[252:255], a[112:115], v[112:115]
    v_mfma_f32_16x16x32_bf16 v[152:155], a[252:255], a[116:119], v[152:155]
    v_mfma_f32_16x16x32_bf16 v[152:155], a[248:251], a[100:103], v[152:155]
    v_mfma_f32_16x16x32_bf16 v[192:195], a[248:251], a[104:107], v[192:195]
    buffer_load_dwordx4 a[188:191], v1, s[16:19], s96 offen offset:3072 sc1
    v_mfma_f32_16x16x32_bf16 v[192:195], a[252:255], a[120:123], v[192:195]
    ds_read_b128 a[224:227], v26 offset:10240
    v_mfma_f32_16x16x32_bf16 v[232:235], a[252:255], a[124:127], v[232:235]
    ds_read_b128 a[228:231], v26 offset:22528
    v_mfma_f32_16x16x32_bf16 v[232:235], a[248:251], a[108:111], v[232:235]
    v_mfma_f32_16x16x32_bf16 v[236:239], a[192:195], a[108:111], v[236:239]
    buffer_load_dwordx4 v1, s[16:19], s6 offen offset:2048 sc1 lds
    v_mfma_f32_16x16x32_bf16 v[236:239], a[196:199], a[124:127], v[236:239]
    v_mfma_f32_16x16x32_bf16 v[196:199], a[196:199], a[120:123], v[196:199]
    v_mfma_f32_16x16x32_bf16 v[196:199], a[192:195], a[104:107], v[196:199]
    v_mfma_f32_16x16x32_bf16 v[156:159], a[192:195], a[100:103], v[156:159]
    v_mfma_f32_16x16x32_bf16 v[156:159], a[196:199], a[116:119], v[156:159]
    buffer_load_dwordx4 v1, s[16:19], s6 offen offset:3072 sc1 lds
    v_mfma_f32_16x16x32_bf16 v[116:119], a[196:199], a[112:115], v[116:119]
    s_add_u32 m0, m0, 4096
    v_mfma_f32_16x16x32_bf16 v[116:119], a[192:195], a[96:99], v[116:119]
    v_mfma_f32_16x16x32_bf16 v[120:123], a[200:203], a[96:99], v[120:123]
    v_mfma_f32_16x16x32_bf16 v[120:123], a[204:207], a[112:115], v[120:123]
    buffer_load_dwordx4 v39, s[16:19], s6 offen offset:0 sc1 lds
    v_mfma_f32_16x16x32_bf16 v[160:163], a[204:207], a[116:119], v[160:163]
    s_add_u32 s6, s77, 122880
    s_add_u32 m0, s42, 0
    v_mfma_f32_16x16x32_bf16 v[160:163], a[200:203], a[100:103], v[160:163]
    v_mfma_f32_16x16x32_bf16 v[200:203], a[200:203], a[104:107], v[200:203]
    v_mfma_f32_16x16x32_bf16 v[200:203], a[204:207], a[120:123], v[200:203]
    v_mfma_f32_16x16x32_bf16 v[240:243], a[204:207], a[124:127], v[240:243]
    buffer_load_dwordx4 v1, s[16:19], s6 offen offset:0 sc1 lds
    v_mfma_f32_16x16x32_bf16 v[240:243], a[200:203], a[108:111], v[240:243]
    s_waitcnt lgkmcnt(0)
    v_add_u32 v26, 49152, v1
    v_mfma_f32_16x16x32_bf16 v[244:247], a[208:211], a[108:111], v[244:247]
    v_mfma_f32_16x16x32_bf16 v[244:247], a[212:215], a[124:127], v[244:247]
    v_mfma_f32_16x16x32_bf16 v[204:207], a[212:215], a[120:123], v[204:207]
    v_mfma_f32_16x16x32_bf16 v[204:207], a[208:211], a[104:107], v[204:207]
    buffer_load_dwordx4 v1, s[16:19], s6 offen offset:1024 sc1 lds
    v_mfma_f32_16x16x32_bf16 v[164:167], a[208:211], a[100:103], v[164:167]
    v_mfma_f32_16x16x32_bf16 v[164:167], a[212:215], a[116:119], v[164:167]
    v_mfma_f32_16x16x32_bf16 v[124:127], a[212:215], a[112:115], v[124:127]
    s_waitcnt vmcnt(34)
    s_waitcnt lgkmcnt(0)
    s_barrier
    v_mfma_f32_16x16x32_bf16 v[124:127], a[208:211], a[96:99], v[124:127]
    buffer_load_dwordx4 v1, s[16:19], s6 offen offset:2048 sc1 lds
    v_mfma_f32_16x16x32_bf16 v[128:131], a[216:219], a[96:99], v[128:131]
    ds_read_b128 a[232:235], v26 offset:0
    v_mfma_f32_16x16x32_bf16 v[128:131], a[220:223], a[112:115], v[128:131]
    ds_read_b128 a[236:239], v26 offset:12288
    v_mfma_f32_16x16x32_bf16 v[168:171], a[220:223], a[116:119], v[168:171]
    ds_read_b128 a[240:243], v26 offset:1024
    v_mfma_f32_16x16x32_bf16 v[168:171], a[216:219], a[100:103], v[168:171]
    ds_read_b128 a[244:247], v26 offset:13312
    v_mfma_f32_16x16x32_bf16 v[208:211], a[216:219], a[104:107], v[208:211]
    buffer_load_dwordx4 v1, s[16:19], s6 offen offset:3072 sc1 lds
    v_mfma_f32_16x16x32_bf16 v[208:211], a[220:223], a[120:123], v[208:211]
    s_add_u32 m0, m0, 4096
    ds_read_b128 a[248:251], v26 offset:2048
    v_mfma_f32_16x16x32_bf16 v[248:251], a[220:223], a[124:127], v[248:251]
    ds_read_b128 a[252:255], v26 offset:14336
    v_mfma_f32_16x16x32_bf16 v[248:251], a[216:219], a[108:111], v[248:251]
    ds_read_b128 a[192:195], v26 offset:3072
    v_mfma_f32_16x16x32_bf16 v[252:255], a[224:227], a[108:111], v[252:255]
    buffer_load_dwordx4 v39, s[16:19], s6 offen offset:0 sc1 lds
    v_mfma_f32_16x16x32_bf16 v[252:255], a[228:231], a[124:127], v[252:255]
    s_add_u32 s6, s77, 163840
    ds_read_b128 a[196:199], v26 offset:15360
    s_add_u32 m0, s42, 24576
    v_mfma_f32_16x16x32_bf16 v[212:215], a[228:231], a[120:123], v[212:215]
    v_mfma_f32_16x16x32_bf16 v[212:215], a[224:227], a[104:107], v[212:215]
    v_mfma_f32_16x16x32_bf16 v[172:175], a[224:227], a[100:103], v[172:175]
    ds_read_b128 a[200:203], v26 offset:4096
    v_mfma_f32_16x16x32_bf16 v[172:175], a[228:231], a[116:119], v[172:175]
    buffer_load_dwordx4 v1, s[16:19], s6 offen offset:0 sc1 lds
    v_mfma_f32_16x16x32_bf16 v[132:135], a[228:231], a[112:115], v[132:135]
    ds_read_b128 a[204:207], v26 offset:16384
    v_mfma_f32_16x16x32_bf16 v[132:135], a[224:227], a[96:99], v[132:135]
    s_waitcnt vmcnt(34) lgkmcnt(4)
    v_mfma_f32_16x16x32_bf16 v[96:99], a[232:235], a[128:131], v[96:99]
    s_waitcnt vmcnt(30)
    v_mfma_f32_16x16x32_bf16 v[96:99], a[236:239], a[144:147], v[96:99]
    s_waitcnt vmcnt(29)
    s_xor_b32 s60, s39, 3
    s_mul_i32 s60, s60, 98304
    v_mfma_f32_16x16x32_bf16 v[136:139], a[236:239], a[148:151], v[136:139]
    s_add_u32 s60, s60, s70
    buffer_load_dwordx4 v1, s[16:19], s6 offen offset:1024 sc1 lds
    v_mfma_f32_16x16x32_bf16 v[136:139], a[232:235], a[132:135], v[136:139]
    s_add_u32 s96, s60, 8192
    v_mfma_f32_16x16x32_bf16 v[176:179], a[232:235], a[136:139], v[176:179]
    s_waitcnt vmcnt(29)
    ds_read_b128 a[208:211], v26 offset:6144
    v_mfma_f32_16x16x32_bf16 v[176:179], a[236:239], a[152:155], v[176:179]
    s_waitcnt vmcnt(28)
    ds_read_b128 a[212:215], v26 offset:18432
    v_mfma_f32_16x16x32_bf16 v[216:219], a[236:239], a[156:159], v[216:219]
    buffer_load_dwordx4 a[96:99], v1, s[16:19], s96 offen offset:0 sc1
    v_mfma_f32_16x16x32_bf16 v[216:219], a[232:235], a[140:143], v[216:219]
    v_mfma_f32_16x16x32_bf16 v[220:223], a[240:243], a[140:143], v[220:223]
    v_mfma_f32_16x16x32_bf16 v[220:223], a[244:247], a[156:159], v[220:223]
    v_mfma_f32_16x16x32_bf16 v[180:183], a[244:247], a[152:155], v[180:183]
    v_mfma_f32_16x16x32_bf16 v[180:183], a[240:243], a[136:139], v[180:183]
    buffer_load_dwordx4 a[100:103], v1, s[16:19], s96 offen offset:1024 sc1
    v_mfma_f32_16x16x32_bf16 v[140:143], a[240:243], a[132:135], v[140:143]
    ds_read_b128 a[216:219], v26 offset:7168
    v_mfma_f32_16x16x32_bf16 v[140:143], a[244:247], a[148:151], v[140:143]
    ds_read_b128 a[220:223], v26 offset:19456
    v_mfma_f32_16x16x32_bf16 v[100:103], a[244:247], a[144:147], v[100:103]
    v_mfma_f32_16x16x32_bf16 v[100:103], a[240:243], a[128:131], v[100:103]
    buffer_load_dwordx4 a[104:107], v1, s[16:19], s96 offen offset:2048 sc1
    v_mfma_f32_16x16x32_bf16 v[104:107], a[248:251], a[128:131], v[104:107]
    v_mfma_f32_16x16x32_bf16 v[104:107], a[252:255], a[144:147], v[104:107]
    v_mfma_f32_16x16x32_bf16 v[144:147], a[252:255], a[148:151], v[144:147]
    v_mfma_f32_16x16x32_bf16 v[144:147], a[248:251], a[132:135], v[144:147]
    v_mfma_f32_16x16x32_bf16 v[184:187], a[248:251], a[136:139], v[184:187]
    buffer_load_dwordx4 a[108:111], v1, s[16:19], s96 offen offset:3072 sc1
    v_mfma_f32_16x16x32_bf16 v[184:187], a[252:255], a[152:155], v[184:187]
    s_add_u32 s96, s60, 12288
    ds_read_b128 a[224:227], v26 offset:8192
    v_mfma_f32_16x16x32_bf16 v[224:227], a[252:255], a[156:159], v[224:227]
    ds_read_b128 a[228:231], v26 offset:20480
    v_mfma_f32_16x16x32_bf16 v[224:227], a[248:251], a[140:143], v[224:227]
    s_waitcnt lgkmcnt(2)
    v_mfma_f32_16x16x32_bf16 v[228:231], a[192:195], a[140:143], v[228:231]
    v_mfma_f32_16x16x32_bf16 v[228:231], a[196:199], a[156:159], v[228:231]
    buffer_load_dwordx4 a[112:115], v1, s[16:19], s96 offen offset:0 sc1
    v_mfma_f32_16x16x32_bf16 v[188:191], a[196:199], a[152:155], v[188:191]
    v_mfma_f32_16x16x32_bf16 v[188:191], a[192:195], a[136:139], v[188:191]
    v_mfma_f32_16x16x32_bf16 v[148:151], a[192:195], a[132:135], v[148:151]
    ds_read_b128 a[232:235], v26 offset:9216
    v_mfma_f32_16x16x32_bf16 v[148:151], a[196:199], a[148:151], v[148:151]
    buffer_load_dwordx4 a[116:119], v1, s[16:19], s96 offen offset:1024 sc1
    v_mfma_f32_16x16x32_bf16 v[108:111], a[196:199], a[144:147], v[108:111]
    ds_read_b128 a[236:239], v26 offset:21504
    v_mfma_f32_16x16x32_bf16 v[108:111], a[192:195], a[128:131], v[108:111]
    v_mfma_f32_16x16x32_bf16 v[112:115], a[200:203], a[128:131], v[112:115]
    v_mfma_f32_16x16x32_bf16 v[112:115], a[204:207], a[144:147], v[112:115]
    v_mfma_f32_16x16x32_bf16 v[152:155], a[204:207], a[148:151], v[152:155]
    buffer_load_dwordx4 a[120:123], v1, s[16:19], s96 offen offset:2048 sc1
    v_mfma_f32_16x16x32_bf16 v[152:155], a[200:203], a[132:135], v[152:155]
    v_mfma_f32_16x16x32_bf16 v[192:195], a[200:203], a[136:139], v[192:195]
    ds_read_b128 a[240:243], v26 offset:10240
    v_mfma_f32_16x16x32_bf16 v[192:195], a[204:207], a[152:155], v[192:195]
    ds_read_b128 a[244:247], v26 offset:22528
    v_mfma_f32_16x16x32_bf16 v[232:235], a[204:207], a[156:159], v[232:235]
    buffer_load_dwordx4 a[124:127], v1, s[16:19], s96 offen offset:3072 sc1
    v_mfma_f32_16x16x32_bf16 v[232:235], a[200:203], a[140:143], v[232:235]
    v_mfma_f32_16x16x32_bf16 v[236:239], a[208:211], a[140:143], v[236:239]
    v_mfma_f32_16x16x32_bf16 v[236:239], a[212:215], a[156:159], v[236:239]
    v_mfma_f32_16x16x32_bf16 v[196:199], a[212:215], a[152:155], v[196:199]
    v_mfma_f32_16x16x32_bf16 v[196:199], a[208:211], a[136:139], v[196:199]
    buffer_load_dwordx4 v1, s[16:19], s6 offen offset:2048 sc1 lds
    v_mfma_f32_16x16x32_bf16 v[156:159], a[208:211], a[132:135], v[156:159]
    v_mfma_f32_16x16x32_bf16 v[156:159], a[212:215], a[148:151], v[156:159]
    v_mfma_f32_16x16x32_bf16 v[116:119], a[212:215], a[144:147], v[116:119]
    v_mfma_f32_16x16x32_bf16 v[116:119], a[208:211], a[128:131], v[116:119]
    v_mfma_f32_16x16x32_bf16 v[120:123], a[216:219], a[128:131], v[120:123]
    buffer_load_dwordx4 a[80:83], v1, s[16:19], s44 offen offset:2048 sc1
    v_mfma_f32_16x16x32_bf16 v[120:123], a[220:223], a[144:147], v[120:123]
    v_mfma_f32_16x16x32_bf16 v[160:163], a[220:223], a[148:151], v[160:163]
    v_mfma_f32_16x16x32_bf16 v[160:163], a[216:219], a[132:135], v[160:163]
    v_mfma_f32_16x16x32_bf16 v[200:203], a[216:219], a[136:139], v[200:203]
    buffer_load_dwordx4 v1, s[16:19], s6 offen offset:3072 sc1 lds
    v_mfma_f32_16x16x32_bf16 v[200:203], a[220:223], a[152:155], v[200:203]
    s_add_u32 m0, m0, 4096
    v_mfma_f32_16x16x32_bf16 v[240:243], a[220:223], a[156:159], v[240:243]
    v_mfma_f32_16x16x32_bf16 v[240:243], a[216:219], a[140:143], v[240:243]
    s_waitcnt lgkmcnt(0)
    v_add_u32 v26, 73728, v1
    v_mfma_f32_16x16x32_bf16 v[244:247], a[224:227], a[140:143], v[244:247]
    v_mfma_f32_16x16x32_bf16 v[244:247], a[228:231], a[156:159], v[244:247]
    buffer_load_dwordx4 a[84:87], v1, s[16:19], s45 offen offset:2048 sc1
    v_mfma_f32_16x16x32_bf16 v[204:207], a[228:231], a[152:155], v[204:207]
    v_mfma_f32_16x16x32_bf16 v[204:207], a[224:227], a[136:139], v[204:207]
    v_mfma_f32_16x16x32_bf16 v[164:167], a[224:227], a[132:135], v[164:167]
    v_mfma_f32_16x16x32_bf16 v[164:167], a[228:231], a[148:151], v[164:167]
    buffer_load_dwordx4 v39, s[16:19], s6 offen offset:0 sc1 lds
    v_mfma_f32_16x16x32_bf16 v[124:127], a[228:231], a[144:147], v[124:127]
    s_waitcnt vmcnt(38)
    s_waitcnt lgkmcnt(0)
    s_barrier
    v_mfma_f32_16x16x32_bf16 v[124:127], a[224:227], a[128:131], v[124:127]
    s_add_u32 s6, s77, 204800
    ds_read_b128 a[248:251], v26 offset:0
    s_add_u32 m0, s42, 49152
    v_mfma_f32_16x16x32_bf16 v[128:131], a[232:235], a[128:131], v[128:131]
    ds_read_b128 a[252:255], v26 offset:12288
    v_mfma_f32_16x16x32_bf16 v[128:131], a[236:239], a[144:147], v[128:131]
    ds_read_b128 a[192:195], v26 offset:1024
    v_mfma_f32_16x16x32_bf16 v[168:171], a[236:239], a[148:151], v[168:171]
    buffer_load_dwordx4 a[88:91], v1, s[16:19], s46 offen offset:2048 sc1
    v_mfma_f32_16x16x32_bf16 v[168:171], a[232:235], a[132:135], v[168:171]
    ds_read_b128 a[196:199], v26 offset:13312
    v_mfma_f32_16x16x32_bf16 v[208:211], a[232:235], a[136:139], v[208:211]
    ds_read_b128 a[200:203], v26 offset:2048
    v_mfma_f32_16x16x32_bf16 v[208:211], a[236:239], a[152:155], v[208:211]
    ds_read_b128 a[204:207], v26 offset:14336
    v_mfma_f32_16x16x32_bf16 v[248:251], a[236:239], a[156:159], v[248:251]
    ds_read_b128 a[208:211], v26 offset:3072
    v_mfma_f32_16x16x32_bf16 v[248:251], a[232:235], a[140:143], v[248:251]
    buffer_load_dwordx4 v1, s[16:19], s6 offen offset:0 sc1 lds
    v_mfma_f32_16x16x32_bf16 v[252:255], a[240:243], a[140:143], v[252:255]
    ds_read_b128 a[212:215], v26 offset:15360
    v_mfma_f32_16x16x32_bf16 v[252:255], a[244:247], a[156:159], v[252:255]
    v_mfma_f32_16x16x32_bf16 v[212:215], a[244:247], a[152:155], v[212:215]
    v_mfma_f32_16x16x32_bf16 v[212:215], a[240:243], a[136:139], v[212:215]
    buffer_load_dwordx4 a[92:95], v1, s[16:19], s47 offen offset:2048 sc1
    v_mfma_f32_16x16x32_bf16 v[172:175], a[240:243], a[132:135], v[172:175]
    ds_read_b128 a[216:219], v26 offset:4096
    v_mfma_f32_16x16x32_bf16 v[172:175], a[244:247], a[148:151], v[172:175]
    ds_read_b128 a[220:223], v26 offset:16384
    v_mfma_f32_16x16x32_bf16 v[132:135], a[244:247], a[144:147], v[132:135]
    v_mfma_f32_16x16x32_bf16 v[132:135], a[240:243], a[128:131], v[132:135]
    s_waitcnt vmcnt(33) lgkmcnt(3)
    v_mfma_f32_16x16x32_bf16 v[96:99], a[248:251], a[160:163], v[96:99]
    s_waitcnt vmcnt(29)
    buffer_load_dwordx4 v1, s[16:19], s6 offen offset:1024 sc1 lds
    v_mfma_f32_16x16x32_bf16 v[96:99], a[252:255], a[176:179], v[96:99]
    s_waitcnt vmcnt(29)
    v_cmp_ne_u32 vcc, v38, v61
    s_cbranch_vccnz SPIN24
BACK24:
    v_mfma_f32_16x16x32_bf16 v[136:139], a[252:255], a[180:183], v[136:139]
    s_xor_b32 s60, s39, 1
    s_mul_i32 s60, s60, 98304
    s_add_u32 s60, s60, s70
    v_mfma_f32_16x16x32_bf16 v[136:139], a[248:251], a[164:167], v[136:139]
    s_add_u32 s96, s60, 16384
    v_mfma_f32_16x16x32_bf16 v[176:179], a[248:251], a[168:171], v[176:179]
    s_waitcnt vmcnt(28)
    buffer_load_dwordx4 a[128:131], v1, s[16:19], s96 offen offset:0 sc1
    v_mfma_f32_16x16x32_bf16 v[176:179], a[252:255], a[184:187], v[176:179]
    s_waitcnt vmcnt(28)
    ds_read_b128 a[224:227], v26 offset:6144
    v_mfma_f32_16x16x32_bf16 v[216:219], a[252:255], a[188:191], v[216:219]
    ds_read_b128 a[228:231], v26 offset:18432
    v_mfma_f32_16x16x32_bf16 v[216:219], a[248:251], a[172:175], v[216:219]
    v_mfma_f32_16x16x32_bf16 v[220:223], a[192:195], a[172:175], v[220:223]
    v_mfma_f32_16x16x32_bf16 v[220:223], a[196:199], a[188:191], v[220:223]
    buffer_load_dwordx4 a[132:135], v1, s[16:19], s96 offen offset:1024 sc1
    v_mfma_f32_16x16x32_bf16 v[180:183], a[196:199], a[184:187], v[180:183]
    v_mfma_f32_16x16x32_bf16 v[180:183], a[192:195], a[168:171], v[180:183]
    v_mfma_f32_16x16x32_bf16 v[140:143], a[192:195], a[164:167], v[140:143]
    ds_read_b128 a[232:235], v26 offset:7168
    v_mfma_f32_16x16x32_bf16 v[140:143], a[196:199], a[180:183], v[140:143]
    ds_read_b128 a[236:239], v26 offset:19456
    v_mfma_f32_16x16x32_bf16 v[100:103], a[196:199], a[176:179], v[100:103]
    buffer_load_dwordx4 a[136:139], v1, s[16:19], s96 offen offset:2048 sc1
    v_mfma_f32_16x16x32_bf16 v[100:103], a[192:195], a[160:163], v[100:103]
    v_mfma_f32_16x16x32_bf16 v[104:107], a[200:203], a[160:163], v[104:107]
    v_mfma_f32_16x16x32_bf16 v[104:107], a[204:207], a[176:179], v[104:107]
    v_mfma_f32_16x16x32_bf16 v[144:147], a[204:207], a[180:183], v[144:147]
    buffer_load_dwordx4 v1, s[16:19], s6 offen offset:2048 sc1 lds
    v_mfma_f32_16x16x32_bf16 v[144:147], a[200:203], a[164:167], v[144:147]
    v_mfma_f32_16x16x32_bf16 v[184:187], a[200:203], a[168:171], v[184:187]
    ds_read_b128 a[240:243], v26 offset:8192
    v_mfma_f32_16x16x32_bf16 v[184:187], a[204:207], a[184:187], v[184:187]
    ds_read_b128 a[244:247], v26 offset:20480
    v_mfma_f32_16x16x32_bf16 v[224:227], a[204:207], a[188:191], v[224:227]
    v_mfma_f32_16x16x32_bf16 v[224:227], a[200:203], a[172:175], v[224:227]
    buffer_load_dwordx4 v[64:67], v1, s[16:19], s44 offen offset:3072 sc1
    v_mfma_f32_16x16x32_bf16 v[228:231], a[208:211], a[172:175], v[228:231]
    s_waitcnt lgkmcnt(2)
    v_mfma_f32_16x16x32_bf16 v[228:231], a[212:215], a[188:191], v[228:231]
    v_mfma_f32_16x16x32_bf16 v[188:191], a[212:215], a[184:187], v[188:191]
    v_mfma_f32_16x16x32_bf16 v[188:191], a[208:211], a[168:171], v[188:191]
    buffer_load_dwordx4 a[140:143], v1, s[16:19], s96 offen offset:3072 sc1
    v_mfma_f32_16x16x32_bf16 v[148:151], a[208:211], a[164:167], v[148:151]
    s_add_u32 s96, s60, 20480
    ds_read_b128 a[248:251], v26 offset:9216
    v_mfma_f32_16x16x32_bf16 v[148:151], a[212:215], a[180:183], v[148:151]
    ds_read_b128 a[252:255], v26 offset:21504
    v_mfma_f32_16x16x32_bf16 v[108:111], a[212:215], a[176:179], v[108:111]
    v_mfma_f32_16x16x32_bf16 v[108:111], a[208:211], a[160:163], v[108:111]
WS12:
    s_cbranch_execz WS8
    v_mfma_f32_16x16x32_bf16 v[112:115], a[216:219], a[160:163], v[112:115]
    buffer_load_dwordx4 v1, s[16:19], s6 offen offset:3072 sc1 lds
    v_mfma_f32_16x16x32_bf16 v[112:115], a[220:223], a[176:179], v[112:115]
    s_add_u32 m0, m0, 4096
    v_mfma_f32_16x16x32_bf16 v[152:155], a[220:223], a[180:183], v[152:155]
    v_mfma_f32_16x16x32_bf16 v[152:155], a[216:219], a[164:167], v[152:155]
    v_mfma_f32_16x16x32_bf16 v[192:195], a[216:219], a[168:171], v[192:195]
    buffer_load_dwordx4 v[68:71], v1, s[16:19], s45 offen offset:3072 sc1
    v_mfma_f32_16x16x32_bf16 v[192:195], a[220:223], a[184:187], v[192:195]
    ds_read_b128 a[192:195], v26 offset:10240
    v_mfma_f32_16x16x32_bf16 v[232:235], a[220:223], a[188:191], v[232:235]
    ds_read_b128 a[196:199], v26 offset:22528
    v_mfma_f32_16x16x32_bf16 v[232:235], a[216:219], a[172:175], v[232:235]
    v_mfma_f32_16x16x32_bf16 v[236:239], a[224:227], a[172:175], v[236:239]
    v_mfma_f32_16x16x32_bf16 v[236:239], a[228:231], a[188:191], v[236:239]
    buffer_load_dwordx4 a[144:147], v1, s[16:19], s96 offen offset:0 sc1
    v_mfma_f32_16x16x32_bf16 v[196:199], a[228:231], a[184:187], v[196:199]
    v_mfma_f32_16x16x32_bf16 v[196:199], a[224:227], a[168:171], v[196:199]
    v_mfma_f32_16x16x32_bf16 v[156:159], a[224:227], a[164:167], v[156:159]
    v_mfma_f32_16x16x32_bf16 v[156:159], a[228:231], a[180:183], v[156:159]
    v_mfma_f32_16x16x32_bf16 v[116:119], a[228:231], a[176:179], v[116:119]
    buffer_load_dwordx4 v39, s[16:19], s6 offen offset:0 sc1 lds
    v_mfma_f32_16x16x32_bf16 v[116:119], a[224:227], a[160:163], v[116:119]
    v_mfma_f32_16x16x32_bf16 v[120:123], a[232:235], a[160:163], v[120:123]
    v_mfma_f32_16x16x32_bf16 v[120:123], a[236:239], a[176:179], v[120:123]
    v_mfma_f32_16x16x32_bf16 v[160:163], a[236:239], a[180:183], v[160:163]
    buffer_load_dwordx4 v[72:75], v1, s[16:19], s46 offen offset:3072 sc1
    v_mfma_f32_16x16x32_bf16 v[160:163], a[232:235], a[164:167], v[160:163]
    v_mfma_f32_16x16x32_bf16 v[200:203], a[232:235], a[168:171], v[200:203]
    v_mfma_f32_16x16x32_bf16 v[200:203], a[236:239], a[184:187], v[200:203]
    v_mfma_f32_16x16x32_bf16 v[240:243], a[236:239], a[188:191], v[240:243]
    v_mfma_f32_16x16x32_bf16 v[240:243], a[232:235], a[172:175], v[240:243]
    s_waitcnt lgkmcnt(0)
    buffer_load_dwordx4 a[148:151], v1, s[16:19], s96 offen offset:1024 sc1
    v_mfma_f32_16x16x32_bf16 v[244:247], a[240:243], a[172:175], v[244:247]
    v_add_u32 v26, 98304, v1
    v_mfma_f32_16x16x32_bf16 v[244:247], a[244:247], a[188:191], v[244:247]
    v_mfma_f32_16x16x32_bf16 v[204:207], a[244:247], a[184:187], v[204:207]
    v_mfma_f32_16x16x32_bf16 v[204:207], a[240:243], a[168:171], v[204:207]
    buffer_load_dwordx4 v[76:79], v1, s[16:19], s47 offen offset:3072 sc1
    v_mfma_f32_16x16x32_bf16 v[164:167], a[240:243], a[164:167], v[164:167]
    s_add_u32 s44, s44, 4096
    v_mfma_f32_16x16x32_bf16 v[164:167], a[244:247], a[180:183], v[164:167]
    v_mfma_f32_16x16x32_bf16 v[124:127], a[244:247], a[176:179], v[124:127]
    s_waitcnt lgkmcnt(0)
    s_barrier
    v_mfma_f32_16x16x32_bf16 v[124:127], a[240:243], a[160:163], v[124:127]
    s_add_u32 m0, s42, 73728
    ds_read_b128 a[200:203], v26 offset:0
    v_mfma_f32_16x16x32_bf16 v[128:131], a[248:251], a[160:163], v[128:131]
    buffer_load_dwordx4 a[152:155], v1, s[16:19], s96 offen offset:2048 sc1
    v_mfma_f32_16x16x32_bf16 v[128:131], a[252:255], a[176:179], v[128:131]
    ds_read_b128 a[204:207], v26 offset:12288
    v_mfma_f32_16x16x32_bf16 v[168:171], a[252:255], a[180:183], v[168:171]
    ds_read_b128 a[208:211], v26 offset:1024
    v_mfma_f32_16x16x32_bf16 v[168:171], a[248:251], a[164:167], v[168:171]
    ds_read_b128 a[212:215], v26 offset:13312
    v_mfma_f32_16x16x32_bf16 v[208:211], a[248:251], a[168:171], v[208:211]
    ds_read_b128 a[216:219], v26 offset:2048
    v_mfma_f32_16x16x32_bf16 v[208:211], a[252:255], a[184:187], v[208:211]
    buffer_load_dwordx4 v[80:83], v1, s[16:19], s44 offen offset:0 sc1
    v_mfma_f32_16x16x32_bf16 v[248:251], a[252:255], a[188:191], v[248:251]
    s_add_u32 s45, s45, 4096
    ds_read_b128 a[220:223], v26 offset:14336
    v_mfma_f32_16x16x32_bf16 v[248:251], a[248:251], a[172:175], v[248:251]
    ds_read_b128 a[224:227], v26 offset:3072
    v_mfma_f32_16x16x32_bf16 v[252:255], a[192:195], a[172:175], v[252:255]
    ds_read_b128 a[228:231], v26 offset:15360
    v_mfma_f32_16x16x32_bf16 v[252:255], a[196:199], a[188:191], v[252:255]
    buffer_load_dwordx4 a[156:159], v1, s[16:19], s96 offen offset:3072 sc1
    v_mfma_f32_16x16x32_bf16 v[212:215], a[196:199], a[184:187], v[212:215]
    v_mfma_f32_16x16x32_bf16 v[212:215], a[192:195], a[168:171], v[212:215]
    v_mfma_f32_16x16x32_bf16 v[172:175], a[192:195], a[164:167], v[172:175]
    ds_read_b128 a[232:235], v26 offset:4096
    v_mfma_f32_16x16x32_bf16 v[172:175], a[196:199], a[180:183], v[172:175]
    ds_read_b128 a[236:239], v26 offset:16384
    v_mfma_f32_16x16x32_bf16 v[132:135], a[196:199], a[176:179], v[132:135]
    buffer_load_dwordx4 v1, s[16:19], s36 offen offset:0 sc1 lds
    v_mfma_f32_16x16x32_bf16 v[132:135], a[192:195], a[160:163], v[132:135]
    s_waitcnt vmcnt(33) lgkmcnt(4)
    v_mfma_f32_16x16x32_bf16 v[96:99], a[200:203], a[96:99], v[96:99]
    s_waitcnt vmcnt(29)
    v_mfma_f32_16x16x32_bf16 v[96:99], a[204:207], a[112:115], v[96:99]
    s_waitcnt vmcnt(28)
    s_xor_b32 s60, s39, 2
    s_mul_i32 s60, s60, 98304
    v_mfma_f32_16x16x32_bf16 v[136:139], a[204:207], a[116:119], v[136:139]
    s_add_u32 s60, s60, s70
    buffer_load_dwordx4 v[84:87], v1, s[16:19], s45 offen offset:0 sc1
    v_mfma_f32_16x16x32_bf16 v[136:139], a[200:203], a[100:103], v[136:139]
    s_add_u32 s96, s60, 16384
    s_add_u32 s46, s46, 4096
    v_mfma_f32_16x16x32_bf16 v[176:179], a[200:203], a[104:107], v[176:179]
    s_waitcnt vmcnt(28)
    ds_read_b128 a[240:243], v26 offset:6144
    v_mfma_f32_16x16x32_bf16 v[176:179], a[204:207], a[120:123], v[176:179]
    s_waitcnt vmcnt(27)
    ds_read_b128 a[244:247], v26 offset:18432
    v_mfma_f32_16x16x32_bf16 v[216:219], a[204:207], a[124:127], v[216:219]
    v_mfma_f32_16x16x32_bf16 v[216:219], a[200:203], a[108:111], v[216:219]
    buffer_load_dwordx4 a[160:163], v1, s[16:19], s96 offen offset:0 sc1
    v_mfma_f32_16x16x32_bf16 v[220:223], a[208:211], a[108:111], v[220:223]
    v_mfma_f32_16x16x32_bf16 v[220:223], a[212:215], a[124:127], v[220:223]
    v_mfma_f32_16x16x32_bf16 v[180:183], a[212:215], a[120:123], v[180:183]
    v_mfma_f32_16x16x32_bf16 v[180:183], a[208:211], a[104:107], v[180:183]
    v_mfma_f32_16x16x32_bf16 v[140:143], a[208:211], a[100:103], v[140:143]
    buffer_load_dwordx4 v1, s[16:19], s36 offen offset:1024 sc1 lds
    v_mfma_f32_16x16x32_bf16 v[140:143], a[212:215], a[116:119], v[140:143]
    ds_read_b128 a[248:251], v26 offset:7168
    v_mfma_f32_16x16x32_bf16 v[100:103], a[212:215], a[112:115], v[100:103]
    ds_read_b128 a[252:255], v26 offset:19456
    v_mfma_f32_16x16x32_bf16 v[100:103], a[208:211], a[96:99], v[100:103]
    v_mfma_f32_16x16x32_bf16 v[104:107], a[216:219], a[96:99], v[104:107]
    buffer_load_dwordx4 v[88:91], v1, s[16:19], s46 offen offset:0 sc1
    v_mfma_f32_16x16x32_bf16 v[104:107], a[220:223], a[112:115], v[104:107]
    s_add_u32 s47, s47, 4096
    v_mfma_f32_16x16x32_bf16 v[144:147], a[220:223], a[116:119], v[144:147]
    v_mfma_f32_16x16x32_bf16 v[144:147], a[216:219], a[100:103], v[144:147]
    v_mfma_f32_16x16x32_bf16 v[184:187], a[216:219], a[104:107], v[184:187]
    ds_read_b128 a[192:195], v26 offset:8192
    v_mfma_f32_16x16x32_bf16 v[184:187], a[220:223], a[120:123], v[184:187]
    buffer_load_dwordx4 a[164:167], v1, s[16:19], s96 offen offset:1024 sc1
    v_mfma_f32_16x16x32_bf16 v[224:227], a[220:223], a[124:127], v[224:227]
    ds_read_b128 a[196:199], v26 offset:20480
    v_mfma_f32_16x16x32_bf16 v[224:227], a[216:219], a[108:111], v[224:227]
    s_waitcnt lgkmcnt(2)
    v_mfma_f32_16x16x32_bf16 v[228:231], a[224:227], a[108:111], v[228:231]
    v_mfma_f32_16x16x32_bf16 v[228:231], a[228:231], a[124:127], v[228:231]
    buffer_load_dwordx4 v1, s[16:19], s36 offen offset:2048 sc1 lds
    v_mfma_f32_16x16x32_bf16 v[188:191], a[228:231], a[120:123], v[188:191]
    v_mfma_f32_16x16x32_bf16 v[188:191], a[224:227], a[104:107], v[188:191]
    v_mfma_f32_16x16x32_bf16 v[148:151], a[224:227], a[100:103], v[148:151]
    ds_read_b128 a[200:203], v26 offset:9216
    v_mfma_f32_16x16x32_bf16 v[148:151], a[228:231], a[116:119], v[148:151]
    ds_read_b128 a[204:207], v26 offset:21504
    v_mfma_f32_16x16x32_bf16 v[108:111], a[228:231], a[112:115], v[108:111]
    buffer_load_dwordx4 v[92:95], v1, s[16:19], s47 offen offset:0 sc1
    v_mfma_f32_16x16x32_bf16 v[108:111], a[224:227], a[96:99], v[108:111]
    v_mfma_f32_16x16x32_bf16 v[112:115], a[232:235], a[96:99], v[112:115]
    v_mfma_f32_16x16x32_bf16 v[112:115], a[236:239], a[112:115], v[112:115]
    v_mfma_f32_16x16x32_bf16 v[152:155], a[236:239], a[116:119], v[152:155]
    v_mfma_f32_16x16x32_bf16 v[152:155], a[232:235], a[100:103], v[152:155]
    buffer_load_dwordx4 a[168:171], v1, s[16:19], s96 offen offset:2048 sc1
    v_mfma_f32_16x16x32_bf16 v[192:195], a[232:235], a[104:107], v[192:195]
    ds_read_b128 a[208:211], v26 offset:10240
    v_mfma_f32_16x16x32_bf16 v[192:195], a[236:239], a[120:123], v[192:195]
    ds_read_b128 a[212:215], v26 offset:22528
    v_mfma_f32_16x16x32_bf16 v[232:235], a[236:239], a[124:127], v[232:235]
    v_mfma_f32_16x16x32_bf16 v[232:235], a[232:235], a[108:111], v[232:235]
    buffer_load_dwordx4 v1, s[16:19], s36 offen offset:3072 sc1 lds
    v_mfma_f32_16x16x32_bf16 v[236:239], a[240:243], a[108:111], v[236:239]
    s_add_u32 m0, m0, 4096
    v_mfma_f32_16x16x32_bf16 v[236:239], a[244:247], a[124:127], v[236:239]
    v_mfma_f32_16x16x32_bf16 v[196:199], a[244:247], a[120:123], v[196:199]
    v_mfma_f32_16x16x32_bf16 v[196:199], a[240:243], a[104:107], v[196:199]
    v_mfma_f32_16x16x32_bf16 v[156:159], a[240:243], a[100:103], v[156:159]
    buffer_load_dwordx4 a[172:175], v1, s[16:19], s96 offen offset:3072 sc1
    v_mfma_f32_16x16x32_bf16 v[156:159], a[244:247], a[116:119], v[156:159]
    s_add_u32 s96, s60, 20480
    v_mfma_f32_16x16x32_bf16 v[116:119], a[244:247], a[112:115], v[116:119]
    v_mfma_f32_16x16x32_bf16 v[116:119], a[240:243], a[96:99], v[116:119]
    v_mfma_f32_16x16x32_bf16 v[120:123], a[248:251], a[96:99], v[120:123]
    buffer_load_dwordx4 v39, s[16:19], s36 offen offset:0 sc1 lds
    v_mfma_f32_16x16x32_bf16 v[120:123], a[252:255], a[112:115], v[120:123]
    v_mfma_f32_16x16x32_bf16 v[160:163], a[252:255], a[116:119], v[160:163]
    v_mfma_f32_16x16x32_bf16 v[160:163], a[248:251], a[100:103], v[160:163]
    v_mfma_f32_16x16x32_bf16 v[200:203], a[248:251], a[104:107], v[200:203]
    v_mfma_f32_16x16x32_bf16 v[200:203], a[252:255], a[120:123], v[200:203]
    buffer_load_dwordx4 v[10:13], v1, s[16:19], s44 offen offset:1024 sc1
    v_mfma_f32_16x16x32_bf16 v[240:243], a[252:255], a[124:127], v[240:243]
    v_mfma_f32_16x16x32_bf16 v[240:243], a[248:251], a[108:111], v[240:243]
    s_waitcnt lgkmcnt(0)
    v_add_u32 v26, 122880, v29
    v_mfma_f32_16x16x32_bf16 v[244:247], a[192:195], a[108:111], v[244:247]
    v_mfma_f32_16x16x32_bf16 v[244:247], a[196:199], a[124:127], v[244:247]
    v_mfma_f32_16x16x32_bf16 v[204:207], a[196:199], a[120:123], v[204:207]
    buffer_load_dwordx4 a[176:179], v1, s[16:19], s96 offen offset:0 sc1
    v_mfma_f32_16x16x32_bf16 v[204:207], a[192:195], a[104:107], v[204:207]
    v_mfma_f32_16x16x32_bf16 v[164:167], a[192:195], a[100:103], v[164:167]
    v_mfma_f32_16x16x32_bf16 v[164:167], a[196:199], a[116:119], v[164:167]
    v_mfma_f32_16x16x32_bf16 v[124:127], a[196:199], a[112:115], v[124:127]
    s_waitcnt lgkmcnt(0)
    s_barrier
    v_mfma_f32_16x16x32_bf16 v[124:127], a[192:195], a[96:99], v[124:127]
    s_add_u32 m0, s42, 98304
    buffer_load_dwordx4 v[14:17], v1, s[16:19], s45 offen offset:1024 sc1
    v_mfma_f32_16x16x32_bf16 v[128:131], a[200:203], a[96:99], v[128:131]
    ds_read_b128 a[216:219], v26 offset:0
    v_mfma_f32_16x16x32_bf16 v[128:131], a[204:207], a[112:115], v[128:131]
    ds_read_b128 a[220:223], v26 offset:1024
    v_mfma_f32_16x16x32_bf16 v[168:171], a[204:207], a[116:119], v[168:171]
    ds_read_b128 a[224:227], v26 offset:2048
    v_mfma_f32_16x16x32_bf16 v[168:171], a[200:203], a[100:103], v[168:171]
    buffer_load_dwordx4 v1, s[16:19], s37 offen offset:0 sc1 lds
    v_mfma_f32_16x16x32_bf16 v[208:211], a[200:203], a[104:107], v[208:211]
    ds_read_b128 a[228:231], v26 offset:3072
    v_mfma_f32_16x16x32_bf16 v[208:211], a[204:207], a[120:123], v[208:211]
    ds_read_b128 a[232:235], v26 offset:4096
    v_mfma_f32_16x16x32_bf16 v[248:251], a[204:207], a[124:127], v[248:251]
    v_mfma_f32_16x16x32_bf16 v[248:251], a[200:203], a[108:111], v[248:251]
    v_mfma_f32_16x16x32_bf16 v[252:255], a[208:211], a[108:111], v[252:255]
    buffer_load_dwordx4 a[180:183], v1, s[16:19], s96 offen offset:1024 sc1
    v_mfma_f32_16x16x32_bf16 v[252:255], a[212:215], a[124:127], v[252:255]
    v_mfma_f32_16x16x32_bf16 v[212:215], a[212:215], a[120:123], v[212:215]
    v_mfma_f32_16x16x32_bf16 v[212:215], a[208:211], a[104:107], v[212:215]
    v_mfma_f32_16x16x32_bf16 v[172:175], a[208:211], a[100:103], v[172:175]
    buffer_load_dwordx4 v[18:21], v1, s[16:19], s46 offen offset:1024 sc1
    v_mfma_f32_16x16x32_bf16 v[172:175], a[212:215], a[116:119], v[172:175]
    v_add_u32 v26, 0, v29
    v_mfma_f32_16x16x32_bf16 v[132:135], a[212:215], a[112:115], v[132:135]
    ds_read_b128 a[236:239], v26 offset:0
    v_mfma_f32_16x16x32_bf16 v[132:135], a[208:211], a[96:99], v[132:135]
    s_waitcnt vmcnt(41) lgkmcnt(1)
    ds_read_b128 a[240:243], v26 offset:1024
    v_mfma_f32_16x16x32_bf16 a[0:3], a[216:219], a[80:83], a[0:3]
    s_waitcnt vmcnt(39)
    ds_read_b128 a[244:247], v26 offset:2048
    v_mfma_f32_16x16x32_bf16 a[20:23], a[216:219], a[84:87], a[20:23]
    s_waitcnt vmcnt(37)
    buffer_load_dwordx4 v1, s[16:19], s37 offen offset:1024 sc1 lds
    v_mfma_f32_16x16x32_bf16 a[40:43], a[216:219], a[88:91], a[40:43]
    s_waitcnt vmcnt(36)
    ds_read_b128 a[248:251], v26 offset:3072
    v_mfma_f32_16x16x32_bf16 a[60:63], a[216:219], a[92:95], a[60:63]
    ds_read_b128 a[252:255], v26 offset:4096
    v_mfma_f32_16x16x32_bf16 a[64:67], a[220:223], a[92:95], a[64:67]
    buffer_load_dwordx4 v[22:25], v1, s[16:19], s47 offen offset:1024 sc1
    v_mfma_f32_16x16x32_bf16 a[44:47], a[220:223], a[88:91], a[44:47]
    v_mfma_f32_16x16x32_bf16 a[24:27], a[220:223], a[84:87], a[24:27]
    v_mfma_f32_16x16x32_bf16 a[4:7], a[220:223], a[80:83], a[4:7]
    v_mfma_f32_16x16x32_bf16 a[8:11], a[224:227], a[80:83], a[8:11]
    v_mfma_f32_16x16x32_bf16 a[28:31], a[224:227], a[84:87], a[28:31]
    v_mfma_f32_16x16x32_bf16 a[48:51], a[224:227], a[88:91], a[48:51]
    buffer_load_dwordx4 a[184:187], v1, s[16:19], s96 offen offset:2048 sc1
    v_mfma_f32_16x16x32_bf16 a[68:71], a[224:227], a[92:95], a[68:71]
    v_mfma_f32_16x16x32_bf16 a[72:75], a[228:231], a[92:95], a[72:75]
    v_mfma_f32_16x16x32_bf16 a[52:55], a[228:231], a[88:91], a[52:55]
    buffer_load_dwordx4 v1, s[16:19], s37 offen offset:2048 sc1 lds
    buffer_load_dwordx4 v1, s[16:19], s37 offen offset:3072 sc1 lds
    s_add_u32 m0, m0, 4096
    s_nop 0
    buffer_load_dwordx4 v39, s[16:19], s37 offen offset:0 sc1 lds
    v_mfma_f32_16x16x32_bf16 a[32:35], a[228:231], a[84:87], a[32:35]
    v_mfma_f32_16x16x32_bf16 a[12:15], a[228:231], a[80:83], a[12:15]
    v_mfma_f32_16x16x32_bf16 a[16:19], a[232:235], a[80:83], a[16:19]
    v_add_u32 v26, 24576, v29
    v_mfma_f32_16x16x32_bf16 a[36:39], a[232:235], a[84:87], a[36:39]
    s_add_u32 s6, s77, 245760
    ds_read_b128 a[192:195], v26 offset:0
    s_add_u32 m0, s42, 122880
    v_mfma_f32_16x16x32_bf16 a[56:59], a[232:235], a[88:91], a[56:59]
    ds_read_b128 a[196:199], v26 offset:1024
    v_mfma_f32_16x16x32_bf16 a[76:79], a[232:235], a[92:95], a[76:79]
    s_waitcnt vmcnt(35) lgkmcnt(2)
    ds_read_b128 a[200:203], v26 offset:2048
    v_mfma_f32_16x16x32_bf16 a[0:3], a[236:239], v[64:67], a[0:3]
    s_waitcnt vmcnt(32)
    buffer_load_dwordx4 a[188:191], v1, s[16:19], s96 offen offset:3072 sc1
    v_mfma_f32_16x16x32_bf16 a[20:23], a[236:239], v[68:71], a[20:23]
    s_waitcnt vmcnt(30)
    s_xor_b32 s60, s39, 3
    s_mul_i32 s60, s60, 98304
    v_mfma_f32_16x16x32_bf16 a[40:43], a[236:239], v[72:75], a[40:43]
    s_waitcnt vmcnt(28)
    s_add_u32 s60, s60, s70
    s_add_u32 s96, s60, 16384
    v_mfma_f32_16x16x32_bf16 a[60:63], a[236:239], v[76:79], a[60:63]
    ds_read_b128 a[204:207], v26 offset:3072
    v_mfma_f32_16x16x32_bf16 a[64:67], a[240:243], v[76:79], a[64:67]
    ds_read_b128 a[208:211], v26 offset:4096
    v_mfma_f32_16x16x32_bf16 a[44:47], a[240:243], v[72:75], a[44:47]
    buffer_load_dwordx4 a[96:99], v1, s[16:19], s96 offen offset:0 sc1
    v_mfma_f32_16x16x32_bf16 a[24:27], a[240:243], v[68:71], a[24:27]
    v_mfma_f32_16x16x32_bf16 a[4:7], a[240:243], v[64:67], a[4:7]
    v_mfma_f32_16x16x32_bf16 a[8:11], a[244:247], v[64:67], a[8:11]
    v_mfma_f32_16x16x32_bf16 a[28:31], a[244:247], v[68:71], a[28:31]
    buffer_load_dwordx4 a[100:103], v1, s[16:19], s96 offen offset:1024 sc1
    v_mfma_f32_16x16x32_bf16 a[48:51], a[244:247], v[72:75], a[48:51]
    v_mfma_f32_16x16x32_bf16 a[68:71], a[244:247], v[76:79], a[68:71]
    v_mfma_f32_16x16x32_bf16 a[72:75], a[248:251], v[76:79], a[72:75]
    v_mfma_f32_16x16x32_bf16 a[52:55], a[248:251], v[72:75], a[52:55]
    v_mfma_f32_16x16x32_bf16 a[32:35], a[248:251], v[68:71], a[32:35]
    buffer_load_dwordx4 a[104:107], v1, s[16:19], s96 offen offset:2048 sc1
    v_mfma_f32_16x16x32_bf16 a[12:15], a[248:251], v[64:67], a[12:15]
    v_mfma_f32_16x16x32_bf16 a[16:19], a[252:255], v[64:67], a[16:19]
    v_add_u32 v26, 49152, v29
    v_mfma_f32_16x16x32_bf16 a[36:39], a[252:255], v[68:71], a[36:39]
    ds_read_b128 a[212:215], v26 offset:0
    v_mfma_f32_16x16x32_bf16 a[56:59], a[252:255], v[72:75], a[56:59]
    buffer_load_dwordx4 a[108:111], v1, s[16:19], s96 offen offset:3072 sc1
    v_mfma_f32_16x16x32_bf16 a[76:79], a[252:255], v[76:79], a[76:79]
    s_waitcnt vmcnt(30) lgkmcnt(1)
    s_add_u32 s96, s60, 20480
    ds_read_b128 a[216:219], v26 offset:1024
    v_mfma_f32_16x16x32_bf16 a[0:3], a[192:195], v[80:83], a[0:3]
    s_waitcnt vmcnt(27)
    buffer_load_dwordx4 a[112:115], v1, s[16:19], s96 offen offset:0 sc1
    buffer_load_dwordx4 a[116:119], v1, s[16:19], s96 offen offset:1024 sc1
    buffer_load_dwordx4 a[120:123], v1, s[16:19], s96 offen offset:2048 sc1
    buffer_load_dwordx4 a[124:127], v1, s[16:19], s96 offen offset:3072 sc1
    v_mfma_f32_16x16x32_bf16 a[20:23], a[192:195], v[84:87], a[20:23]
    s_waitcnt vmcnt(28)
    ds_read_b128 a[220:223], v26 offset:2048
    v_mfma_f32_16x16x32_bf16 a[40:43], a[192:195], v[88:91], a[40:43]
    s_waitcnt vmcnt(25)
    ds_read_b128 a[224:227], v26 offset:3072
    v_mfma_f32_16x16x32_bf16 a[60:63], a[192:195], v[92:95], a[60:63]
    ds_read_b128 a[228:231], v26 offset:4096
    v_mfma_f32_16x16x32_bf16 a[64:67], a[196:199], v[92:95], a[64:67]
    v_mfma_f32_16x16x32_bf16 a[44:47], a[196:199], v[88:91], a[44:47]
    v_mfma_f32_16x16x32_bf16 a[24:27], a[196:199], v[84:87], a[24:27]
    v_mfma_f32_16x16x32_bf16 a[4:7], a[196:199], v[80:83], a[4:7]
    buffer_load_dwordx4 v1, s[16:19], s6 offen offset:0 sc1 lds
    v_mfma_f32_16x16x32_bf16 a[8:11], a[200:203], v[80:83], a[8:11]
    v_mfma_f32_16x16x32_bf16 a[28:31], a[200:203], v[84:87], a[28:31]
    v_mfma_f32_16x16x32_bf16 a[48:51], a[200:203], v[88:91], a[48:51]
    v_mfma_f32_16x16x32_bf16 a[68:71], a[200:203], v[92:95], a[68:71]
    v_mfma_f32_16x16x32_bf16 a[72:75], a[204:207], v[92:95], a[72:75]
    buffer_load_dwordx4 v1, s[16:19], s6 offen offset:1024 sc1 lds
    v_mfma_f32_16x16x32_bf16 a[52:55], a[204:207], v[88:91], a[52:55]
    v_add_u32 v26, 73728, v1
    v_add_u32 v33, 98304, v1
    v_mfma_f32_16x16x32_bf16 a[32:35], a[204:207], v[84:87], a[32:35]
    v_mfma_f32_16x16x32_bf16 a[12:15], a[204:207], v[80:83], a[12:15]
    v_mfma_f32_16x16x32_bf16 a[16:19], a[208:211], v[80:83], a[16:19]
    buffer_load_dwordx4 v1, s[16:19], s6 offen offset:2048 sc1 lds
    v_mfma_f32_16x16x32_bf16 a[36:39], a[208:211], v[84:87], a[36:39]
    v_mfma_f32_16x16x32_bf16 a[56:59], a[208:211], v[88:91], a[56:59]
    v_mfma_f32_16x16x32_bf16 a[76:79], a[208:211], v[92:95], a[76:79]
    s_waitcnt vmcnt(23) lgkmcnt(0)
    v_mfma_f32_16x16x32_bf16 a[0:3], a[212:215], v[10:13], a[0:3]
    s_waitcnt vmcnt(21)
    v_mfma_f32_16x16x32_bf16 a[20:23], a[212:215], v[14:17], a[20:23]
    s_waitcnt vmcnt(18)
    buffer_load_dwordx4 v1, s[16:19], s6 offen offset:3072 sc1 lds
    v_mfma_f32_16x16x32_bf16 a[40:43], a[212:215], v[18:21], a[40:43]
    s_waitcnt vmcnt(17)
    s_add_u32 m0, m0, 4096
    v_mfma_f32_16x16x32_bf16 a[60:63], a[212:215], v[22:25], a[60:63]
    v_mfma_f32_16x16x32_bf16 a[64:67], a[216:219], v[22:25], a[64:67]
    v_mfma_f32_16x16x32_bf16 a[44:47], a[216:219], v[18:21], a[44:47]
    buffer_load_dwordx4 v39, s[16:19], s6 offen offset:0 sc1 lds
    v_mfma_f32_16x16x32_bf16 a[24:27], a[216:219], v[14:17], a[24:27]
    s_add_u32 s6, s77, 286720
    s_waitcnt vmcnt(14)
    s_waitcnt lgkmcnt(0)
    s_barrier
    v_mfma_f32_16x16x32_bf16 a[4:7], a[216:219], v[10:13], a[4:7]
    s_add_u32 m0, s42, 0
    ds_read_b128 a[232:235], v26 offset:0
    v_mfma_f32_16x16x32_bf16 a[8:11], a[220:223], v[10:13], a[8:11]
    ds_read_b128 a[236:239], v26 offset:6144
    v_mfma_f32_16x16x32_bf16 a[28:31], a[220:223], v[14:17], a[28:31]
    ds_read_b128 a[240:243], v26 offset:12288
    v_mfma_f32_16x16x32_bf16 a[48:51], a[220:223], v[18:21], a[48:51]
    buffer_load_dwordx4 v1, s[16:19], s6 offen offset:0 sc1 lds
    v_mfma_f32_16x16x32_bf16 a[68:71], a[220:223], v[22:25], a[68:71]
    ds_read_b128 a[244:247], v26 offset:18432
    v_mfma_f32_16x16x32_bf16 a[72:75], a[224:227], v[22:25], a[72:75]
    ds_read_b128 a[248:251], v33 offset:0
    v_mfma_f32_16x16x32_bf16 a[52:55], a[224:227], v[18:21], a[52:55]
    ds_read_b128 a[252:255], v33 offset:6144
    v_mfma_f32_16x16x32_bf16 a[32:35], a[224:227], v[14:17], a[32:35]
    ds_read_b128 a[192:195], v26 offset:1024
    v_mfma_f32_16x16x32_bf16 a[12:15], a[224:227], v[10:13], a[12:15]
    buffer_load_dwordx4 v1, s[16:19], s6 offen offset:1024 sc1 lds
    v_mfma_f32_16x16x32_bf16 a[16:19], a[228:231], v[10:13], a[16:19]
    ds_read_b128 a[196:199], v26 offset:7168
    v_mfma_f32_16x16x32_bf16 a[36:39], a[228:231], v[14:17], a[36:39]
    ds_read_b128 a[200:203], v26 offset:13312
    v_mfma_f32_16x16x32_bf16 a[56:59], a[228:231], v[18:21], a[56:59]
    ds_read_b128 a[204:207], v26 offset:19456
    v_mfma_f32_16x16x32_bf16 a[76:79], a[228:231], v[22:25], a[76:79]
    s_waitcnt lgkmcnt(7)
    buffer_load_dwordx4 v1, s[16:19], s6 offen offset:2048 sc1 lds
    v_mfma_f32_16x16x32_bf16 v[116:119], a[232:235], a[128:131], v[116:119]
    s_add_u32 s93, s78, 0
    ds_read_b128 a[208:211], v33 offset:1024
    s_add_u32 s94, s78, 163840
    v_mfma_f32_16x16x32_bf16 v[116:119], a[236:239], a[144:147], v[116:119]
    s_add_u32 s95, s78, 327680
    ds_read_b128 a[212:215], v33 offset:7168
    s_add_u32 s36, s78, 491520
    v_mfma_f32_16x16x32_bf16 v[116:119], a[240:243], a[160:163], v[116:119]
    s_waitcnt lgkmcnt(6)
    v_mfma_f32_16x16x32_bf16 v[116:119], a[244:247], a[176:179], v[116:119]
    s_waitcnt vmcnt(15)
    v_mfma_f32_16x16x32_bf16 v[116:119], a[248:251], a[96:99], v[116:119]
    s_waitcnt vmcnt(11)
    buffer_load_dwordx4 v1, s[16:19], s6 offen offset:3072 sc1 lds
    v_mfma_f32_16x16x32_bf16 v[116:119], a[252:255], a[112:115], v[116:119]
    s_add_u32 m0, m0, 4096
    v_and_b32 v32, 896, v42
    v_mfma_f32_16x16x32_bf16 v[156:159], a[232:235], a[132:135], v[156:159]
    v_mfma_f32_16x16x32_bf16 v[156:159], a[236:239], a[148:151], v[156:159]
    v_mfma_f32_16x16x32_bf16 v[156:159], a[240:243], a[164:167], v[156:159]
    buffer_load_dwordx4 v39, s[16:19], s6 offen offset:0 sc1 lds
    v_mfma_f32_16x16x32_bf16 v[156:159], a[244:247], a[180:183], v[156:159]
    s_add_u32 m0, s42, 24576
    v_mfma_f32_16x16x32_bf16 v[156:159], a[248:251], a[100:103], v[156:159]
    s_waitcnt vmcnt(12)
    v_cvt_pk_bf16_f32 v116, v116, v117
    v_cvt_pk_bf16_f32 v117, v118, v119
    v_mfma_f32_16x16x32_bf16 v[156:159], a[252:255], a[116:119], v[156:159]
    v_mfma_f32_16x16x32_bf16 v[196:199], a[232:235], a[136:139], v[196:199]
    ds_read_b128 a[216:219], v26 offset:2048
    v_mfma_f32_16x16x32_bf16 v[196:199], a[236:239], a[152:155], v[196:199]
    buffer_load_dwordx4 v1, s[16:19], s38 offen offset:0 sc1 lds
    v_mfma_f32_16x16x32_bf16 v[196:199], a[240:243], a[168:171], v[196:199]
    ds_read_b128 a[220:223], v26 offset:8192
    v_mfma_f32_16x16x32_bf16 v[196:199], a[244:247], a[184:187], v[196:199]
    ds_read_b128 a[224:227], v26 offset:14336
    v_mfma_f32_16x16x32_bf16 v[196:199], a[248:251], a[104:107], v[196:199]
    s_waitcnt vmcnt(12)
    ds_read_b128 a[228:231], v26 offset:20480
    v_cvt_pk_bf16_f32 v156, v156, v157
    v_mfma_f32_16x16x32_bf16 v[196:199], a[252:255], a[120:123], v[196:199]
    v_cvt_pk_bf16_f32 v157, v158, v159
    v_mfma_f32_16x16x32_bf16 v[236:239], a[232:235], a[140:143], v[236:239]
    buffer_load_dwordx4 v1, s[16:19], s38 offen offset:1024 sc1 lds
    v_mfma_f32_16x16x32_bf16 v[236:239], a[236:239], a[156:159], v[236:239]
    ds_read_b128 a[232:235], v33 offset:2048
    v_mfma_f32_16x16x32_bf16 v[236:239], a[240:243], a[172:175], v[236:239]
    ds_read_b128 a[236:239], v33 offset:8192
    v_lshlrev_b32 v62, 1, v42
    v_mfma_f32_16x16x32_bf16 v[236:239], a[244:247], a[188:191], v[236:239]
    v_and_b32 v62, 768, v62
    s_and_b32 s58, s2, 0xf9
    v_mfma_f32_16x16x32_bf16 v[236:239], a[248:251], a[108:111], v[236:239]
    s_waitcnt vmcnt(12)
    buffer_load_dwordx4 v1, s[16:19], s38 offen offset:2048 sc1 lds
    v_mfma_f32_16x16x32_bf16 v[236:239], a[252:255], a[124:127], v[236:239]
    s_waitcnt lgkmcnt(4)
    v_cvt_pk_bf16_f32 v196, v196, v197
    v_cvt_pk_bf16_f32 v197, v198, v199
    v_mfma_f32_16x16x32_bf16 v[120:123], a[192:195], a[128:131], v[120:123]
    s_xor_b32 s58, s58, 1
    s_lshl_b32 s58, s58, 7
    s_add_u32 s58, s58, 62390272
    v_mfma_f32_16x16x32_bf16 v[120:123], a[196:199], a[144:147], v[120:123]
    s_add_u32 s58, s58, s89
    v_mfma_f32_16x16x32_bf16 v[120:123], a[200:203], a[160:163], v[120:123]
    buffer_load_dwordx4 v1, s[16:19], s38 offen offset:3072 sc1 lds
    s_add_u32 m0, m0, 4096
    s_nop 0
    buffer_load_dwordx4 v39, s[16:19], s38 offen offset:0 sc1 lds
    v_mfma_f32_16x16x32_bf16 v[120:123], a[204:207], a[176:179], v[120:123]
    s_add_u32 s6, s77, 327680
    s_add_u32 m0, s42, 49152
    v_mfma_f32_16x16x32_bf16 v[120:123], a[208:211], a[96:99], v[120:123]
    v_cvt_pk_bf16_f32 v236, v236, v237
    v_cvt_pk_bf16_f32 v237, v238, v239
    v_mfma_f32_16x16x32_bf16 v[120:123], a[212:215], a[112:115], v[120:123]
    v_mfma_f32_16x16x32_bf16 v[160:163], a[192:195], a[132:135], v[160:163]
    v_mfma_f32_16x16x32_bf16 v[160:163], a[196:199], a[148:151], v[160:163]
    v_mfma_f32_16x16x32_bf16 v[160:163], a[200:203], a[164:167], v[160:163]
    v_mfma_f32_16x16x32_bf16 v[160:163], a[204:207], a[180:183], v[160:163]
    buffer_load_dword v32, v32, s[32:35], s59 offen
    v_mfma_f32_16x16x32_bf16 v[160:163], a[208:211], a[100:103], v[160:163]
    s_nop 1
    v_cvt_pk_bf16_f32 v118, v120, v121
    v_cvt_pk_bf16_f32 v119, v122, v123
    v_mfma_f32_16x16x32_bf16 v[160:163], a[212:215], a[116:119], v[160:163]
    buffer_load_dwordx4 v[44:47], v1, s[16:19], s44 offen offset:2048 sc1
    v_mfma_f32_16x16x32_bf16 v[200:203], a[192:195], a[136:139], v[200:203]
    ds_read_b128 a[240:243], v26 offset:3072
    v_mfma_f32_16x16x32_bf16 v[200:203], a[196:199], a[152:155], v[200:203]
    ds_read_b128 a[244:247], v26 offset:9216
    v_mfma_f32_16x16x32_bf16 v[200:203], a[200:203], a[168:171], v[200:203]
    ds_read_b128 a[248:251], v26 offset:15360
    v_mfma_f32_16x16x32_bf16 v[200:203], a[204:207], a[184:187], v[200:203]
    ds_read_b128 a[252:255], v26 offset:21504
    v_mfma_f32_16x16x32_bf16 v[200:203], a[208:211], a[104:107], v[200:203]
    buffer_load_dwordx4 v[48:51], v1, s[16:19], s45 offen offset:2048 sc1
    v_mfma_f32_16x16x32_bf16 v[200:203], a[212:215], a[120:123], v[200:203]
    v_cvt_pk_bf16_f32 v158, v160, v161
    v_cvt_pk_bf16_f32 v159, v162, v163
    v_mfma_f32_16x16x32_bf16 v[240:243], a[192:195], a[140:143], v[240:243]
    ds_read_b128 a[192:195], v33 offset:3072
    v_mfma_f32_16x16x32_bf16 v[240:243], a[196:199], a[156:159], v[240:243]
    ds_read_b128 a[196:199], v33 offset:9216
    v_mfma_f32_16x16x32_bf16 v[240:243], a[200:203], a[172:175], v[240:243]
    buffer_load_dwordx4 v[52:55], v1, s[16:19], s46 offen offset:2048 sc1
    v_mfma_f32_16x16x32_bf16 v[240:243], a[204:207], a[188:191], v[240:243]
    v_mfma_f32_16x16x32_bf16 v[240:243], a[208:211], a[108:111], v[240:243]
    v_cvt_pk_bf16_f32 v198, v200, v201
    v_cvt_pk_bf16_f32 v199, v202, v203
    v_mfma_f32_16x16x32_bf16 v[240:243], a[212:215], a[124:127], v[240:243]
    v_mfma_f32_16x16x32_bf16 v[124:127], a[216:219], a[128:131], v[124:127]
    v_mfma_f32_16x16x32_bf16 v[124:127], a[220:223], a[144:147], v[124:127]
    s_waitcnt lgkmcnt(2)
    buffer_store_dwordx4 v[116:119], v1, s[16:19], s93 offen offset:0 sc1
    v_mfma_f32_16x16x32_bf16 v[124:127], a[224:227], a[160:163], v[124:127]
    v_mfma_f32_16x16x32_bf16 v[124:127], a[228:231], a[176:179], v[124:127]
    v_mfma_f32_16x16x32_bf16 v[124:127], a[232:235], a[96:99], v[124:127]
    s_nop 1
    v_cvt_pk_bf16_f32 v238, v240, v241
    v_cvt_pk_bf16_f32 v239, v242, v243
    v_mfma_f32_16x16x32_bf16 v[124:127], a[236:239], a[112:115], v[124:127]
    v_mfma_f32_16x16x32_bf16 v[164:167], a[216:219], a[132:135], v[164:167]
    v_mfma_f32_16x16x32_bf16 v[164:167], a[220:223], a[148:151], v[164:167]
    buffer_load_dwordx4 v[56:59], v1, s[16:19], s47 offen offset:2048 sc1
    v_mfma_f32_16x16x32_bf16 v[164:167], a[224:227], a[164:167], v[164:167]
    v_mfma_f32_16x16x32_bf16 v[164:167], a[228:231], a[180:183], v[164:167]
    v_mfma_f32_16x16x32_bf16 v[164:167], a[232:235], a[100:103], v[164:167]
    s_nop 1
    v_cvt_pk_bf16_f32 v120, v124, v125
    v_cvt_pk_bf16_f32 v121, v126, v127
    v_mfma_f32_16x16x32_bf16 v[164:167], a[236:239], a[116:119], v[164:167]
    buffer_store_dwordx4 v[156:159], v1, s[16:19], s94 offen offset:0 sc1
    v_mfma_f32_16x16x32_bf16 v[204:207], a[216:219], a[136:139], v[204:207]
    ds_read_b128 a[200:203], v26 offset:4096
    v_mfma_f32_16x16x32_bf16 v[204:207], a[220:223], a[152:155], v[204:207]
    ds_read_b128 a[204:207], v26 offset:10240
    v_mfma_f32_16x16x32_bf16 v[204:207], a[224:227], a[168:171], v[204:207]
    ds_read_b128 a[208:211], v26 offset:16384
    v_mfma_f32_16x16x32_bf16 v[204:207], a[228:231], a[184:187], v[204:207]
    ds_read_b128 a[212:215], v26 offset:22528
    v_mfma_f32_16x16x32_bf16 v[204:207], a[232:235], a[104:107], v[204:207]
    v_cvt_pk_bf16_f32 v160, v164, v165
    v_cvt_pk_bf16_f32 v161, v166, v167
    v_mfma_f32_16x16x32_bf16 v[204:207], a[236:239], a[120:123], v[204:207]
    buffer_load_dwordx4 a[80:83], v1, s[16:19], s44 offen offset:3072 sc1
    v_mfma_f32_16x16x32_bf16 v[244:247], a[216:219], a[140:143], v[244:247]
    ds_read_b128 a[216:219], v33 offset:4096
    v_mfma_f32_16x16x32_bf16 v[244:247], a[220:223], a[156:159], v[244:247]
    ds_read_b128 a[220:223], v33 offset:10240
    v_mfma_f32_16x16x32_bf16 v[244:247], a[224:227], a[172:175], v[244:247]
    v_mfma_f32_16x16x32_bf16 v[244:247], a[228:231], a[188:191], v[244:247]
    v_mfma_f32_16x16x32_bf16 v[244:247], a[232:235], a[108:111], v[244:247]
    buffer_store_dwordx4 v[196:199], v1, s[16:19], s95 offen offset:0 sc1
    v_mfma_f32_16x16x32_bf16 v[244:247], a[236:239], a[124:127], v[244:247]
    v_cvt_pk_bf16_f32 v200, v204, v205
    v_cvt_pk_bf16_f32 v201, v206, v207
    v_mfma_f32_16x16x32_bf16 v[128:131], a[240:243], a[128:131], v[128:131]
    v_mfma_f32_16x16x32_bf16 v[128:131], a[244:247], a[144:147], v[128:131]
    v_mfma_f32_16x16x32_bf16 v[128:131], a[248:251], a[160:163], v[128:131]
    v_mfma_f32_16x16x32_bf16 v[128:131], a[252:255], a[176:179], v[128:131]
    s_waitcnt lgkmcnt(1)
    v_mfma_f32_16x16x32_bf16 v[128:131], a[192:195], a[96:99], v[128:131]
WS13:
    s_cbranch_execz WS9
    buffer_load_dwordx4 a[84:87], v1, s[16:19], s45 offen offset:3072 sc1
    v_mfma_f32_16x16x32_bf16 v[128:131], a[196:199], a[112:115], v[128:131]
    v_cvt_pk_bf16_f32 v240, v244, v245
    v_cvt_pk_bf16_f32 v241, v246, v247
    v_mfma_f32_16x16x32_bf16 v[168:171], a[240:243], a[132:135], v[168:171]
    v_mfma_f32_16x16x32_bf16 v[168:171], a[244:247], a[148:151], v[168:171]
    v_mfma_f32_16x16x32_bf16 v[168:171], a[248:251], a[164:167], v[168:171]
    v_mfma_f32_16x16x32_bf16 v[168:171], a[252:255], a[180:183], v[168:171]
    buffer_load_dwordx4 a[88:91], v1, s[16:19], s46 offen offset:3072 sc1
    v_mfma_f32_16x16x32_bf16 v[168:171], a[192:195], a[100:103], v[168:171]
    buffer_store_dwordx4 v[236:239], v1, s[16:19], s36 offen offset:0 sc1
    v_mfma_f32_16x16x32_bf16 v[168:171], a[196:199], a[116:119], v[168:171]
    v_cvt_pk_bf16_f32 v122, v128, v129
    v_cvt_pk_bf16_f32 v123, v130, v131
    v_mfma_f32_16x16x32_bf16 v[208:211], a[240:243], a[136:139], v[208:211]
    buffer_load_dwordx4 a[92:95], v1, s[16:19], s47 offen offset:3072 sc1
    v_mfma_f32_16x16x32_bf16 v[208:211], a[244:247], a[152:155], v[208:211]
    s_add_u32 s44, s44, 4096
    v_mfma_f32_16x16x32_bf16 v[208:211], a[248:251], a[168:171], v[208:211]
    v_mfma_f32_16x16x32_bf16 v[208:211], a[252:255], a[184:187], v[208:211]
    v_mfma_f32_16x16x32_bf16 v[208:211], a[192:195], a[104:107], v[208:211]
    v_cvt_pk_bf16_f32 v162, v168, v169
    v_cvt_pk_bf16_f32 v163, v170, v171
    v_mfma_f32_16x16x32_bf16 v[208:211], a[196:199], a[120:123], v[208:211]
    v_mfma_f32_16x16x32_bf16 v[248:251], a[240:243], a[140:143], v[248:251]
    v_mfma_f32_16x16x32_bf16 v[248:251], a[244:247], a[156:159], v[248:251]
    buffer_store_dwordx4 v[120:123], v1, s[16:19], s93 offen offset:1024 sc1
    v_mfma_f32_16x16x32_bf16 v[248:251], a[248:251], a[172:175], v[248:251]
    v_mfma_f32_16x16x32_bf16 v[248:251], a[252:255], a[188:191], v[248:251]
    v_mfma_f32_16x16x32_bf16 v[248:251], a[192:195], a[108:111], v[248:251]
    s_nop 1
    v_cvt_pk_bf16_f32 v202, v208, v209
    v_cvt_pk_bf16_f32 v203, v210, v211
    v_mfma_f32_16x16x32_bf16 v[248:251], a[196:199], a[124:127], v[248:251]
    v_add_u32 v26, 122880, v29
    v_mfma_f32_16x16x32_bf16 v[132:135], a[200:203], a[128:131], v[132:135]
    v_mfma_f32_16x16x32_bf16 v[132:135], a[204:207], a[144:147], v[132:135]
    buffer_store_dwordx4 v[160:163], v1, s[16:19], s94 offen offset:1024 sc1
    v_mfma_f32_16x16x32_bf16 v[132:135], a[208:211], a[160:163], v[132:135]
    v_mfma_f32_16x16x32_bf16 v[132:135], a[212:215], a[176:179], v[132:135]
    v_mfma_f32_16x16x32_bf16 v[132:135], a[216:219], a[96:99], v[132:135]
    s_waitcnt lgkmcnt(0)
    s_nop 0
    v_cvt_pk_bf16_f32 v242, v248, v249
    v_cvt_pk_bf16_f32 v243, v250, v251
    v_mfma_f32_16x16x32_bf16 v[132:135], a[220:223], a[112:115], v[132:135]
    v_mfma_f32_16x16x32_bf16 v[172:175], a[200:203], a[132:135], v[172:175]
    s_waitcnt vmcnt(15)
    s_waitcnt lgkmcnt(0)
    s_barrier
    v_mfma_f32_16x16x32_bf16 v[172:175], a[204:207], a[148:151], v[172:175]
    buffer_store_dwordx4 v[200:203], v1, s[16:19], s95 offen offset:1024 sc1
    v_mfma_f32_16x16x32_bf16 v[172:175], a[208:211], a[164:167], v[172:175]
    ds_read_b128 a[224:227], v26 offset:0
    v_mfma_f32_16x16x32_bf16 v[172:175], a[212:215], a[180:183], v[172:175]
    ds_read_b128 a[228:231], v26 offset:1024
    v_mfma_f32_16x16x32_bf16 v[172:175], a[216:219], a[100:103], v[172:175]
    ds_read_b128 a[232:235], v26 offset:2048
    v_cvt_pk_bf16_f32 v124, v132, v133
    v_mfma_f32_16x16x32_bf16 v[172:175], a[220:223], a[116:119], v[172:175]
    ds_read_b128 a[236:239], v26 offset:3072
    v_cvt_pk_bf16_f32 v125, v134, v135
    v_mfma_f32_16x16x32_bf16 v[212:215], a[200:203], a[136:139], v[212:215]
    ds_read_b128 a[240:243], v26 offset:4096
    v_mfma_f32_16x16x32_bf16 v[212:215], a[204:207], a[152:155], v[212:215]
    buffer_store_dwordx4 v[240:243], v1, s[16:19], s36 offen offset:1024 sc1
    v_mfma_f32_16x16x32_bf16 v[212:215], a[208:211], a[168:171], v[212:215]
    v_mfma_f32_16x16x32_bf16 v[212:215], a[212:215], a[184:187], v[212:215]
    v_mfma_f32_16x16x32_bf16 v[212:215], a[216:219], a[104:107], v[212:215]
    v_cvt_pk_bf16_f32 v164, v172, v173
    v_cvt_pk_bf16_f32 v165, v174, v175
    v_mfma_f32_16x16x32_bf16 v[212:215], a[220:223], a[120:123], v[212:215]
    v_mfma_f32_16x16x32_bf16 v[252:255], a[200:203], a[140:143], v[252:255]
    v_mfma_f32_16x16x32_bf16 v[252:255], a[204:207], a[156:159], v[252:255]
    buffer_store_dwordx2 v[124:125], v8, s[16:19], s93 offen offset:2048 sc1
    v_mfma_f32_16x16x32_bf16 v[252:255], a[208:211], a[172:175], v[252:255]
    v_add_u32 v26, 0, v29
    v_mfma_f32_16x16x32_bf16 v[252:255], a[212:215], a[188:191], v[252:255]
    ds_read_b128 a[244:247], v26 offset:0
    v_mfma_f32_16x16x32_bf16 v[252:255], a[216:219], a[108:111], v[252:255]
    ds_read_b128 a[248:251], v26 offset:1024
    v_cvt_pk_bf16_f32 v204, v212, v213
    v_mfma_f32_16x16x32_bf16 v[252:255], a[220:223], a[124:127], v[252:255]
    s_waitcnt vmcnt(16) lgkmcnt(2)
    ds_read_b128 a[252:255], v26 offset:2048
    v_cvt_pk_bf16_f32 v205, v214, v215
    v_mfma_f32_16x16x32_bf16 a[0:3], a[224:227], v[44:47], a[0:3]
    s_waitcnt vmcnt(15)
    ds_read_b128 a[192:195], v26 offset:3072
    v_mfma_f32_16x16x32_bf16 a[20:23], a[224:227], v[48:51], a[20:23]
    s_waitcnt vmcnt(14)
    buffer_store_dwordx2 v[164:165], v8, s[16:19], s94 offen offset:2048 sc1
    v_mfma_f32_16x16x32_bf16 a[40:43], a[224:227], v[52:55], a[40:43]
    s_waitcnt vmcnt(13)
    ds_read_b128 a[196:199], v26 offset:4096
    v_mfma_f32_16x16x32_bf16 a[60:63], a[224:227], v[56:59], a[60:63]
    v_mfma_f32_16x16x32_bf16 a[64:67], a[228:231], v[56:59], a[64:67]
    v_cvt_pk_bf16_f32 v244, v252, v253
    v_cvt_pk_bf16_f32 v245, v254, v255
    v_mfma_f32_16x16x32_bf16 a[44:47], a[228:231], v[52:55], a[44:47]
    v_mfma_f32_16x16x32_bf16 a[24:27], a[228:231], v[48:51], a[24:27]
    v_mfma_f32_16x16x32_bf16 a[4:7], a[228:231], v[44:47], a[4:7]
    buffer_store_dwordx2 v[204:205], v8, s[16:19], s95 offen offset:2048 sc1
    v_mfma_f32_16x16x32_bf16 a[8:11], a[232:235], v[44:47], a[8:11]
    v_mfma_f32_16x16x32_bf16 a[28:31], a[232:235], v[48:51], a[28:31]
    v_mfma_f32_16x16x32_bf16 a[48:51], a[232:235], v[52:55], a[48:51]
    v_mfma_f32_16x16x32_bf16 a[68:71], a[232:235], v[56:59], a[68:71]
    v_mfma_f32_16x16x32_bf16 a[72:75], a[236:239], v[56:59], a[72:75]
    v_add_u32 v26, 24576, v1
    v_mfma_f32_16x16x32_bf16 a[52:55], a[236:239], v[52:55], a[52:55]
    buffer_store_dwordx2 v[244:245], v8, s[16:19], s36 offen offset:2048 sc1
    v_mfma_f32_16x16x32_bf16 a[32:35], a[236:239], v[48:51], a[32:35]
    ds_read_b128 a[200:203], v33 offset:12288
    v_mfma_f32_16x16x32_bf16 a[12:15], a[236:239], v[44:47], a[12:15]
    ds_read_b128 a[204:207], v33 offset:18432
    v_mfma_f32_16x16x32_bf16 a[16:19], a[240:243], v[44:47], a[16:19]
    ds_read_b128 a[208:211], v26 offset:0
    v_mfma_f32_16x16x32_bf16 a[36:39], a[240:243], v[48:51], a[36:39]
    ds_read_b128 a[212:215], v26 offset:6144
    v_mfma_f32_16x16x32_bf16 a[56:59], a[240:243], v[52:55], a[56:59]
    ds_read_b128 a[216:219], v26 offset:12288
    v_mfma_f32_16x16x32_bf16 a[76:79], a[240:243], v[56:59], a[76:79]
    s_waitcnt vmcnt(13) lgkmcnt(5)
    buffer_load_dwordx4 v1, s[16:19], s6 offen offset:0 sc1 lds
    v_mfma_f32_16x16x32_bf16 a[0:3], a[244:247], a[80:83], a[0:3]
    s_waitcnt vmcnt(12)
    ds_read_b128 a[220:223], v26 offset:18432
    v_mfma_f32_16x16x32_bf16 a[20:23], a[244:247], a[84:87], a[20:23]
    s_waitcnt vmcnt(11)
    v_mfma_f32_16x16x32_bf16 a[40:43], a[244:247], a[88:91], a[40:43]
    s_waitcnt vmcnt(9)
    v_mfma_f32_16x16x32_bf16 a[60:63], a[244:247], a[92:95], a[60:63]
    v_mfma_f32_16x16x32_bf16 a[64:67], a[248:251], a[92:95], a[64:67]
    buffer_load_dwordx4 v1, s[16:19], s6 offen offset:1024 sc1 lds
    v_mfma_f32_16x16x32_bf16 a[44:47], a[248:251], a[88:91], a[44:47]
    v_mfma_f32_16x16x32_bf16 a[24:27], a[248:251], a[84:87], a[24:27]
    v_mfma_f32_16x16x32_bf16 a[4:7], a[248:251], a[80:83], a[4:7]
    v_mfma_f32_16x16x32_bf16 a[8:11], a[252:255], a[80:83], a[8:11]
    buffer_load_dwordx4 v1, s[16:19], s6 offen offset:2048 sc1 lds
    v_mfma_f32_16x16x32_bf16 a[28:31], a[252:255], a[84:87], a[28:31]
    ds_read_b128 a[224:227], v33 offset:13312
    v_mfma_f32_16x16x32_bf16 a[48:51], a[252:255], a[88:91], a[48:51]
    ds_read_b128 a[228:231], v33 offset:19456
    v_mfma_f32_16x16x32_bf16 a[68:71], a[252:255], a[92:95], a[68:71]
    ds_read_b128 a[232:235], v26 offset:1024
    v_mfma_f32_16x16x32_bf16 a[72:75], a[192:195], a[92:95], a[72:75]
    ds_read_b128 a[236:239], v26 offset:7168
    v_mfma_f32_16x16x32_bf16 a[52:55], a[192:195], a[88:91], a[52:55]
    buffer_load_dwordx4 v1, s[16:19], s6 offen offset:3072 sc1 lds
    v_mfma_f32_16x16x32_bf16 a[32:35], a[192:195], a[84:87], a[32:35]
    s_add_u32 m0, m0, 4096
    ds_read_b128 a[240:243], v26 offset:13312
    v_mfma_f32_16x16x32_bf16 a[12:15], a[192:195], a[80:83], a[12:15]
    ds_read_b128 a[244:247], v26 offset:19456
    v_mfma_f32_16x16x32_bf16 a[16:19], a[196:199], a[80:83], a[16:19]
    v_mfma_f32_16x16x32_bf16 a[36:39], a[196:199], a[84:87], a[36:39]
    buffer_load_dwordx4 v39, s[16:19], s6 offen offset:0 sc1 lds
    v_mfma_f32_16x16x32_bf16 a[56:59], a[196:199], a[88:91], a[56:59]
    s_add_u32 s6, s77, 368640
    s_add_u32 m0, s42, 73728
    v_mfma_f32_16x16x32_bf16 a[76:79], a[196:199], a[92:95], a[76:79]
    s_waitcnt lgkmcnt(4)
    v_mfma_f32_16x16x32_bf16 v[96:99], a[200:203], a[128:131], v[96:99]
    s_bitcmp1_b32 s2, 0
    s_cselect_b32 s92, s91, 4294885376
    s_add_u32 s78, s78, s92
    v_mfma_f32_16x16x32_bf16 v[96:99], a[204:207], a[144:147], v[96:99]
    s_add_u32 s93, s78, 0
    s_cmp_eq_u32 s5, 0
    s_cselect_b32 s93, 0xffff0000, s93
    v_mfma_f32_16x16x32_bf16 v[96:99], a[208:211], a[160:163], v[96:99]
    buffer_load_dwordx4 v1, s[16:19], s6 offen offset:0 sc1 lds
    v_mfma_f32_16x16x32_bf16 v[96:99], a[212:215], a[176:179], v[96:99]
    s_add_u32 s94, s78, 163840
    s_cmp_eq_u32 s5, 1
    s_cselect_b32 s94, 0xffff0000, s94
    v_mfma_f32_16x16x32_bf16 v[96:99], a[216:219], a[96:99], v[96:99]
    s_add_u32 s95, s78, 327680
    s_cmp_eq_u32 s5, 2
    s_cselect_b32 s95, 0xffff0000, s95
    v_mfma_f32_16x16x32_bf16 v[96:99], a[220:223], a[112:115], v[96:99]
    s_add_u32 s36, s78, 491520
    s_cmp_eq_u32 s5, 3
    s_cselect_b32 s36, 0xffff0000, s36
    v_mfma_f32_16x16x32_bf16 v[136:139], a[200:203], a[132:135], v[136:139]
    v_mfma_f32_16x16x32_bf16 v[136:139], a[204:207], a[148:151], v[136:139]
    buffer_load_dwordx4 v1, s[16:19], s6 offen offset:1024 sc1 lds
    v_mfma_f32_16x16x32_bf16 v[136:139], a[208:211], a[164:167], v[136:139]
    v_mfma_f32_16x16x32_bf16 v[136:139], a[212:215], a[180:183], v[136:139]
    v_mfma_f32_16x16x32_bf16 v[136:139], a[216:219], a[100:103], v[136:139]
    v_cvt_pk_bf16_f32 v126, v96, v97
    v_cvt_pk_bf16_f32 v127, v98, v99
    v_mfma_f32_16x16x32_bf16 v[136:139], a[220:223], a[116:119], v[136:139]
    buffer_load_dwordx4 v1, s[16:19], s6 offen offset:2048 sc1 lds
    v_mfma_f32_16x16x32_bf16 v[176:179], a[200:203], a[136:139], v[176:179]
    ds_read_b128 a[248:251], v33 offset:14336
    v_mfma_f32_16x16x32_bf16 v[176:179], a[204:207], a[152:155], v[176:179]
    ds_read_b128 a[252:255], v33 offset:20480
    v_mfma_f32_16x16x32_bf16 v[176:179], a[208:211], a[168:171], v[176:179]
    ds_read_b128 a[192:195], v26 offset:2048
    v_mfma_f32_16x16x32_bf16 v[176:179], a[212:215], a[184:187], v[176:179]
    ds_read_b128 a[196:199], v26 offset:8192
    v_mfma_f32_16x16x32_bf16 v[176:179], a[216:219], a[104:107], v[176:179]
    buffer_load_dwordx4 v1, s[16:19], s6 offen offset:3072 sc1 lds
    v_mfma_f32_16x16x32_bf16 v[176:179], a[220:223], a[120:123], v[176:179]
    s_add_u32 m0, m0, 4096
    v_cvt_pk_bf16_f32 v166, v136, v137
    v_cvt_pk_bf16_f32 v167, v138, v139
    v_mfma_f32_16x16x32_bf16 v[216:219], a[200:203], a[140:143], v[216:219]
    ds_read_b128 a[200:203], v26 offset:14336
    v_mfma_f32_16x16x32_bf16 v[216:219], a[204:207], a[156:159], v[216:219]
    ds_read_b128 a[204:207], v26 offset:20480
    v_mfma_f32_16x16x32_bf16 v[216:219], a[208:211], a[172:175], v[216:219]
    buffer_load_dwordx4 v39, s[16:19], s6 offen offset:0 sc1 lds
    v_mfma_f32_16x16x32_bf16 v[216:219], a[212:215], a[188:191], v[216:219]
    v_mfma_f32_16x16x32_bf16 v[216:219], a[216:219], a[108:111], v[216:219]
    v_cvt_pk_bf16_f32 v206, v176, v177
    v_cvt_pk_bf16_f32 v207, v178, v179
    v_mfma_f32_16x16x32_bf16 v[216:219], a[220:223], a[124:127], v[216:219]
    v_mfma_f32_16x16x32_bf16 v[100:103], a[224:227], a[128:131], v[100:103]
    v_mfma_f32_16x16x32_bf16 v[100:103], a[228:231], a[144:147], v[100:103]
    s_waitcnt lgkmcnt(2)
    buffer_load_dwordx4 v[64:67], v1, s[16:19], s44 offen offset:0 sc1
    v_mfma_f32_16x16x32_bf16 v[100:103], a[232:235], a[160:163], v[100:103]
    s_add_u32 s45, s45, 4096
    v_mfma_f32_16x16x32_bf16 v[100:103], a[236:239], a[176:179], v[100:103]
    v_mfma_f32_16x16x32_bf16 v[100:103], a[240:243], a[96:99], v[100:103]
    s_nop 0
    v_cvt_pk_bf16_f32 v246, v216, v217
    v_cvt_pk_bf16_f32 v247, v218, v219
    v_mfma_f32_16x16x32_bf16 v[100:103], a[244:247], a[112:115], v[100:103]
    v_mfma_f32_16x16x32_bf16 v[140:143], a[224:227], a[132:135], v[140:143]
    buffer_load_dwordx4 v[68:71], v1, s[16:19], s45 offen offset:0 sc1
    v_mfma_f32_16x16x32_bf16 v[140:143], a[228:231], a[148:151], v[140:143]
    s_add_u32 s46, s46, 4096
    v_mfma_f32_16x16x32_bf16 v[140:143], a[232:235], a[164:167], v[140:143]
    v_mfma_f32_16x16x32_bf16 v[140:143], a[236:239], a[180:183], v[140:143]
    v_mfma_f32_16x16x32_bf16 v[140:143], a[240:243], a[100:103], v[140:143]
    buffer_load_dwordx4 v[72:75], v1, s[16:19], s46 offen offset:0 sc1
    v_mfma_f32_16x16x32_bf16 v[140:143], a[244:247], a[116:119], v[140:143]
    s_add_u32 s47, s47, 4096
    v_cvt_pk_bf16_f32 v128, v100, v101
    v_cvt_pk_bf16_f32 v129, v102, v103
    v_mfma_f32_16x16x32_bf16 v[180:183], a[224:227], a[136:139], v[180:183]
    ds_read_b128 a[208:211], v33 offset:15360
    v_mfma_f32_16x16x32_bf16 v[180:183], a[228:231], a[152:155], v[180:183]
    ds_read_b128 a[212:215], v33 offset:21504
    v_mfma_f32_16x16x32_bf16 v[180:183], a[232:235], a[168:171], v[180:183]
    ds_read_b128 a[216:219], v26 offset:3072
    v_mfma_f32_16x16x32_bf16 v[180:183], a[236:239], a[184:187], v[180:183]
    buffer_load_dwordx4 v[76:79], v1, s[16:19], s47 offen offset:0 sc1
    v_mfma_f32_16x16x32_bf16 v[180:183], a[240:243], a[104:107], v[180:183]
    ds_read_b128 a[220:223], v26 offset:9216
    v_cvt_pk_bf16_f32 v168, v140, v141
    v_mfma_f32_16x16x32_bf16 v[180:183], a[244:247], a[120:123], v[180:183]
    v_cvt_pk_bf16_f32 v169, v142, v143
    v_mfma_f32_16x16x32_bf16 v[220:223], a[224:227], a[140:143], v[220:223]
    ds_read_b128 a[224:227], v26 offset:15360
    v_mfma_f32_16x16x32_bf16 v[220:223], a[228:231], a[156:159], v[220:223]
    buffer_store_dwordx4 v[126:129], v1, s[16:19], s93 offen offset:0 sc1
    v_mfma_f32_16x16x32_bf16 v[220:223], a[232:235], a[172:175], v[220:223]
    ds_read_b128 a[228:231], v26 offset:21504
    v_mfma_f32_16x16x32_bf16 v[220:223], a[236:239], a[188:191], v[220:223]
    v_mfma_f32_16x16x32_bf16 v[220:223], a[240:243], a[108:111], v[220:223]
    v_cvt_pk_bf16_f32 v208, v180, v181
    v_cvt_pk_bf16_f32 v209, v182, v183
    v_mfma_f32_16x16x32_bf16 v[220:223], a[244:247], a[124:127], v[220:223]
    v_mfma_f32_16x16x32_bf16 v[104:107], a[248:251], a[128:131], v[104:107]
    v_mfma_f32_16x16x32_bf16 v[104:107], a[252:255], a[144:147], v[104:107]
    buffer_load_dwordx4 v[80:83], v1, s[16:19], s44 offen offset:1024 sc1
    v_mfma_f32_16x16x32_bf16 v[104:107], a[192:195], a[160:163], v[104:107]
    v_mfma_f32_16x16x32_bf16 v[104:107], a[196:199], a[176:179], v[104:107]
    s_waitcnt lgkmcnt(1)
    v_mfma_f32_16x16x32_bf16 v[104:107], a[200:203], a[96:99], v[104:107]
    s_nop 1
    v_cvt_pk_bf16_f32 v248, v220, v221
    v_cvt_pk_bf16_f32 v249, v222, v223
    v_mfma_f32_16x16x32_bf16 v[104:107], a[204:207], a[112:115], v[104:107]
    v_mfma_f32_16x16x32_bf16 v[144:147], a[248:251], a[132:135], v[144:147]
    buffer_store_dwordx4 v[166:169], v1, s[16:19], s94 offen offset:0 sc1
    v_mfma_f32_16x16x32_bf16 v[144:147], a[252:255], a[148:151], v[144:147]
    v_mfma_f32_16x16x32_bf16 v[144:147], a[192:195], a[164:167], v[144:147]
    v_mfma_f32_16x16x32_bf16 v[144:147], a[196:199], a[180:183], v[144:147]
    v_mfma_f32_16x16x32_bf16 v[144:147], a[200:203], a[100:103], v[144:147]
    s_nop 1
    v_cvt_pk_bf16_f32 v130, v104, v105
    v_cvt_pk_bf16_f32 v131, v106, v107
    v_mfma_f32_16x16x32_bf16 v[144:147], a[204:207], a[116:119], v[144:147]
    v_mfma_f32_16x16x32_bf16 v[184:187], a[248:251], a[136:139], v[184:187]
    buffer_load_dwordx4 v[84:87], v1, s[16:19], s45 offen offset:1024 sc1
    v_mfma_f32_16x16x32_bf16 v[184:187], a[252:255], a[152:155], v[184:187]
    ds_read_b128 a[232:235], v33 offset:16384
    v_mfma_f32_16x16x32_bf16 v[184:187], a[192:195], a[168:171], v[184:187]
    ds_read_b128 a[236:239], v33 offset:22528
    v_mfma_f32_16x16x32_bf16 v[184:187], a[196:199], a[184:187], v[184:187]
    ds_read_b128 a[240:243], v26 offset:4096
    v_mfma_f32_16x16x32_bf16 v[184:187], a[200:203], a[104:107], v[184:187]
    ds_read_b128 a[244:247], v26 offset:10240
    v_cvt_pk_bf16_f32 v170, v144, v145
    v_mfma_f32_16x16x32_bf16 v[184:187], a[204:207], a[120:123], v[184:187]
    buffer_load_dwordx4 v[88:91], v1, s[16:19], s46 offen offset:1024 sc1
    v_mfma_f32_16x16x32_bf16 v[224:227], a[248:251], a[140:143], v[224:227]
    ds_read_b128 a[248:251], v26 offset:16384
    v_cvt_pk_bf16_f32 v171, v146, v147
    v_mfma_f32_16x16x32_bf16 v[224:227], a[252:255], a[156:159], v[224:227]
    ds_read_b128 a[252:255], v26 offset:22528
    v_mfma_f32_16x16x32_bf16 v[224:227], a[192:195], a[172:175], v[224:227]
    v_mfma_f32_16x16x32_bf16 v[224:227], a[196:199], a[188:191], v[224:227]
    buffer_store_dwordx4 v[206:209], v1, s[16:19], s95 offen offset:0 sc1
    v_mfma_f32_16x16x32_bf16 v[224:227], a[200:203], a[108:111], v[224:227]
    v_cvt_pk_bf16_f32 v210, v184, v185
    v_cvt_pk_bf16_f32 v211, v186, v187
    v_mfma_f32_16x16x32_bf16 v[224:227], a[204:207], a[124:127], v[224:227]
    v_mfma_f32_16x16x32_bf16 v[108:111], a[208:211], a[128:131], v[108:111]
    v_mfma_f32_16x16x32_bf16 v[108:111], a[212:215], a[144:147], v[108:111]
    v_mfma_f32_16x16x32_bf16 v[108:111], a[216:219], a[160:163], v[108:111]
    v_mfma_f32_16x16x32_bf16 v[108:111], a[220:223], a[176:179], v[108:111]
    buffer_load_dwordx4 v[92:95], v1, s[16:19], s47 offen offset:1024 sc1
    v_mfma_f32_16x16x32_bf16 v[108:111], a[224:227], a[96:99], v[108:111]
    s_waitcnt lgkmcnt(0)
    s_nop 1
    v_cvt_pk_bf16_f32 v250, v224, v225
    v_cvt_pk_bf16_f32 v251, v226, v227
    v_mfma_f32_16x16x32_bf16 v[108:111], a[228:231], a[112:115], v[108:111]
    v_mfma_f32_16x16x32_bf16 v[148:151], a[208:211], a[132:135], v[148:151]
    v_mfma_f32_16x16x32_bf16 v[148:151], a[212:215], a[148:151], v[148:151]
    v_mfma_f32_16x16x32_bf16 v[148:151], a[216:219], a[164:167], v[148:151]
    buffer_store_dwordx4 v[246:249], v1, s[16:19], s36 offen offset:0 sc1
    v_mfma_f32_16x16x32_bf16 v[148:151], a[220:223], a[180:183], v[148:151]
    v_mfma_f32_16x16x32_bf16 v[148:151], a[224:227], a[100:103], v[148:151]
    s_nop 1
    v_cvt_pk_bf16_f32 v132, v108, v109
    v_cvt_pk_bf16_f32 v133, v110, v111
    v_mfma_f32_16x16x32_bf16 v[148:151], a[228:231], a[116:119], v[148:151]
    v_mfma_f32_16x16x32_bf16 v[188:191], a[208:211], a[136:139], v[188:191]
    s_waitcnt vmcnt(22)
    buffer_store_dword v61, v9, s[16:19], 0 offen offset:32 sc1
    v_mfma_f32_16x16x32_bf16 v[188:191], a[212:215], a[152:155], v[188:191]
    v_mfma_f32_16x16x32_bf16 v[188:191], a[216:219], a[168:171], v[188:191]
    v_mfma_f32_16x16x32_bf16 v[188:191], a[220:223], a[184:187], v[188:191]
    v_mfma_f32_16x16x32_bf16 v[188:191], a[224:227], a[104:107], v[188:191]
    buffer_load_dwordx4 v[10:13], v1, s[16:19], s44 offen offset:2048 sc1
    v_mfma_f32_16x16x32_bf16 v[188:191], a[228:231], a[120:123], v[188:191]
    v_cvt_pk_bf16_f32 v172, v148, v149
    v_cvt_pk_bf16_f32 v173, v150, v151
    v_mfma_f32_16x16x32_bf16 v[228:231], a[208:211], a[140:143], v[228:231]
    v_mfma_f32_16x16x32_bf16 v[228:231], a[212:215], a[156:159], v[228:231]
    v_mfma_f32_16x16x32_bf16 v[228:231], a[216:219], a[172:175], v[228:231]
    buffer_load_dwordx4 v[14:17], v1, s[16:19], s45 offen offset:2048 sc1
    v_mfma_f32_16x16x32_bf16 v[228:231], a[220:223], a[188:191], v[228:231]
    v_mfma_f32_16x16x32_bf16 v[228:231], a[224:227], a[108:111], v[228:231]
    v_cvt_pk_bf16_f32 v212, v188, v189
    v_cvt_pk_bf16_f32 v213, v190, v191
    v_mfma_f32_16x16x32_bf16 v[228:231], a[228:231], a[124:127], v[228:231]
    v_add_u32 v26, 49152, v29
    v_mfma_f32_16x16x32_bf16 v[112:115], a[232:235], a[128:131], v[112:115]
    v_mfma_f32_16x16x32_bf16 v[112:115], a[236:239], a[144:147], v[112:115]
    buffer_load_dwordx4 v[18:21], v1, s[16:19], s46 offen offset:2048 sc1
    v_mfma_f32_16x16x32_bf16 v[112:115], a[240:243], a[160:163], v[112:115]
    v_mfma_f32_16x16x32_bf16 v[112:115], a[244:247], a[176:179], v[112:115]
    v_mfma_f32_16x16x32_bf16 v[112:115], a[248:251], a[96:99], v[112:115]
    s_nop 0
    v_cvt_pk_bf16_f32 v252, v228, v229
    v_cvt_pk_bf16_f32 v253, v230, v231
    v_mfma_f32_16x16x32_bf16 v[112:115], a[252:255], a[112:115], v[112:115]
    v_mfma_f32_16x16x32_bf16 v[152:155], a[232:235], a[132:135], v[152:155]
    s_waitcnt lgkmcnt(0)
    s_barrier
    s_waitcnt vmcnt(21)
    v_mfma_f32_16x16x32_bf16 v[152:155], a[236:239], a[148:151], v[152:155]
    buffer_store_dwordx4 v[130:133], v1, s[16:19], s93 offen offset:1024 sc1
    v_mfma_f32_16x16x32_bf16 v[152:155], a[240:243], a[164:167], v[152:155]
    buffer_load_dwordx4 v[22:25], v1, s[16:19], s47 offen offset:2048 sc1
    v_mfma_f32_16x16x32_bf16 v[152:155], a[244:247], a[180:183], v[152:155]
    ds_read_b128 a[192:195], v26 offset:0
    v_mfma_f32_16x16x32_bf16 v[152:155], a[248:251], a[100:103], v[152:155]
    ds_read_b128 a[196:199], v26 offset:1024
    v_cvt_pk_bf16_f32 v134, v112, v113
    v_mfma_f32_16x16x32_bf16 v[152:155], a[252:255], a[116:119], v[152:155]
    ds_read_b128 a[200:203], v26 offset:2048
    v_cvt_pk_bf16_f32 v135, v114, v115
    v_mfma_f32_16x16x32_bf16 v[192:195], a[232:235], a[136:139], v[192:195]
    ds_read_b128 a[204:207], v26 offset:3072
    v_mfma_f32_16x16x32_bf16 v[192:195], a[236:239], a[152:155], v[192:195]
    ds_read_b128 a[208:211], v26 offset:4096
    v_mfma_f32_16x16x32_bf16 v[192:195], a[240:243], a[168:171], v[192:195]
    buffer_load_dwordx4 v[44:47], v1, s[16:19], s44 offen offset:3072 sc1
    buffer_load_dwordx4 v[48:51], v1, s[16:19], s45 offen offset:3072 sc1
    buffer_load_dwordx4 v[52:55], v1, s[16:19], s46 offen offset:3072 sc1
    buffer_load_dwordx4 v[56:59], v1, s[16:19], s47 offen offset:3072 sc1
    buffer_store_dwordx4 v[170:173], v1, s[16:19], s94 offen offset:1024 sc1
    buffer_store_dwordx4 v[210:213], v1, s[16:19], s95 offen offset:1024 sc1
    buffer_store_dwordx4 v[250:253], v1, s[16:19], s36 offen offset:1024 sc1
    buffer_store_dwordx2 v[134:135], v8, s[16:19], s93 offen offset:2048 sc1
    v_mfma_f32_16x16x32_bf16 v[192:195], a[244:247], a[184:187], v[192:195]
    v_mfma_f32_16x16x32_bf16 v[192:195], a[248:251], a[104:107], v[192:195]
    v_cvt_pk_bf16_f32 v174, v152, v153
    v_cvt_pk_bf16_f32 v175, v154, v155
    v_mfma_f32_16x16x32_bf16 v[192:195], a[252:255], a[120:123], v[192:195]
    v_mfma_f32_16x16x32_bf16 v[232:235], a[232:235], a[140:143], v[232:235]
    v_mfma_f32_16x16x32_bf16 v[232:235], a[236:239], a[156:159], v[232:235]
    v_mfma_f32_16x16x32_bf16 v[232:235], a[240:243], a[172:175], v[232:235]
    buffer_store_dwordx2 v[174:175], v8, s[16:19], s94 offen offset:2048 sc1
    v_mfma_f32_16x16x32_bf16 v[232:235], a[244:247], a[188:191], v[232:235]
    v_add_u32 v26, 73728, v29
    s_waitcnt vmcnt(27)
    v_mfma_f32_16x16x32_bf16 v[232:235], a[248:251], a[108:111], v[232:235]
    ds_read_b128 a[212:215], v26 offset:0
    v_cvt_pk_bf16_f32 v214, v192, v193
    v_mfma_f32_16x16x32_bf16 v[232:235], a[252:255], a[124:127], v[232:235]
    s_waitcnt vmcnt(26) lgkmcnt(1)
    ds_read_b128 a[216:219], v26 offset:1024
    v_cvt_pk_bf16_f32 v215, v194, v195
    v_mfma_f32_16x16x32_bf16 a[0:3], a[192:195], v[64:67], a[0:3]
    s_waitcnt vmcnt(25)
    ds_read_b128 a[220:223], v26 offset:2048
    v_mfma_f32_16x16x32_bf16 a[20:23], a[192:195], v[68:71], a[20:23]
    s_waitcnt vmcnt(24)
    ds_read_b128 a[224:227], v26 offset:3072
    v_mfma_f32_16x16x32_bf16 a[40:43], a[192:195], v[72:75], a[40:43]
    s_waitcnt vmcnt(23)
    buffer_store_dwordx2 v[214:215], v8, s[16:19], s95 offen offset:2048 sc1
    v_mfma_f32_16x16x32_bf16 a[60:63], a[192:195], v[76:79], a[60:63]
    ds_read_b128 a[228:231], v26 offset:4096
    v_mfma_f32_16x16x32_bf16 a[64:67], a[196:199], v[76:79], a[64:67]
    v_cvt_pk_bf16_f32 v254, v232, v233
    v_cvt_pk_bf16_f32 v255, v234, v235
    v_mfma_f32_16x16x32_bf16 a[44:47], a[196:199], v[72:75], a[44:47]
    v_mfma_f32_16x16x32_bf16 a[24:27], a[196:199], v[68:71], a[24:27]
    v_mfma_f32_16x16x32_bf16 a[4:7], a[196:199], v[64:67], a[4:7]
    buffer_store_dwordx2 v[254:255], v8, s[16:19], s36 offen offset:2048 sc1
    v_mfma_f32_16x16x32_bf16 a[8:11], a[200:203], v[64:67], a[8:11]
    v_mfma_f32_16x16x32_bf16 a[28:31], a[200:203], v[68:71], a[28:31]
    v_mfma_f32_16x16x32_bf16 a[48:51], a[200:203], v[72:75], a[48:51]
    buffer_load_dword v38, v62, s[16:19], s58 offen offset:32 sc1
    v_mfma_f32_16x16x32_bf16 a[68:71], a[200:203], v[76:79], a[68:71]
    v_mfma_f32_16x16x32_bf16 a[72:75], a[204:207], v[76:79], a[72:75]
    v_mfma_f32_16x16x32_bf16 a[52:55], a[204:207], v[72:75], a[52:55]
    v_mfma_f32_16x16x32_bf16 a[32:35], a[204:207], v[68:71], a[32:35]
    s_nop 0
    s_cmp_eq_u32 s5, 0
    s_cbranch_scc1 OWN0
    s_cmp_eq_u32 s5, 1
    s_cbranch_scc1 OWN1
    s_cmp_eq_u32 s5, 2
    s_cbranch_scc1 OWN2
    v_mov_b32 v126, v216
    v_mov_b32 v127, v217
    v_mov_b32 v128, v218
    v_mov_b32 v129, v219
    v_mov_b32 v130, v220
    v_mov_b32 v131, v221
    v_mov_b32 v132, v222
    v_mov_b32 v133, v223
    v_mov_b32 v134, v224
    v_mov_b32 v135, v225
    v_mov_b32 v166, v226
    v_mov_b32 v167, v227
    v_mov_b32 v168, v228
    v_mov_b32 v169, v229
    v_mov_b32 v170, v230
    v_mov_b32 v171, v231
    v_mov_b32 v172, v232
    v_mov_b32 v173, v233
    v_mov_b32 v174, v234
    v_mov_b32 v175, v235
    s_branch OWND
OWN2:
    v_mov_b32 v126, v176
    v_mov_b32 v127, v177
    v_mov_b32 v128, v178
    v_mov_b32 v129, v179
    v_mov_b32 v130, v180
    v_mov_b32 v131, v181
    v_mov_b32 v132, v182
    v_mov_b32 v133, v183
    v_mov_b32 v134, v184
    v_mov_b32 v135, v185
    v_mov_b32 v166, v186
    v_mov_b32 v167, v187
    v_mov_b32 v168, v188
    v_mov_b32 v169, v189
    v_mov_b32 v170, v190
    v_mov_b32 v171, v191
    v_mov_b32 v172, v192
    v_mov_b32 v173, v193
    v_mov_b32 v174, v194
    v_mov_b32 v175, v195
    s_branch OWND
OWN1:
    v_mov_b32 v126, v136
    v_mov_b32 v127, v137
    v_mov_b32 v128, v138
    v_mov_b32 v129, v139
    v_mov_b32 v130, v140
    v_mov_b32 v131, v141
    v_mov_b32 v132, v142
    v_mov_b32 v133, v143
    v_mov_b32 v134, v144
    v_mov_b32 v135, v145
    v_mov_b32 v166, v146
    v_mov_b32 v167, v147
    v_mov_b32 v168, v148
    v_mov_b32 v169, v149
    v_mov_b32 v170, v150
    v_mov_b32 v171, v151
    v_mov_b32 v172, v152
    v_mov_b32 v173, v153
    v_mov_b32 v174, v154
    v_mov_b32 v175, v155
    s_branch OWND
OWN0:
    v_mov_b32 v126, v96
    v_mov_b32 v127, v97
    v_mov_b32 v128, v98
    v_mov_b32 v129, v99
    v_mov_b32 v130, v100
    v_mov_b32 v131, v101
    v_mov_b32 v132, v102
    v_mov_b32 v133, v103
    v_mov_b32 v134, v104
    v_mov_b32 v135, v105
    v_mov_b32 v166, v106
    v_mov_b32 v167, v107
    v_mov_b32 v168, v108
    v_mov_b32 v169, v109
    v_mov_b32 v170, v110
    v_mov_b32 v171, v111
    v_mov_b32 v172, v112
    v_mov_b32 v173, v113
    v_mov_b32 v174, v114
    v_mov_b32 v175, v115
OWND:
    v_mfma_f32_16x16x32_bf16 a[12:15], a[204:207], v[64:67], a[12:15]
    v_mfma_f32_16x16x32_bf16 a[16:19], a[208:211], v[64:67], a[16:19]
    v_add_u32 v33, 73728, v29
    v_add_u32 v207, 49152, v29
    v_mfma_f32_16x16x32_bf16 a[36:39], a[208:211], v[68:71], a[36:39]
    s_xor_b32 s61, s3, 1
    ds_read_b128 a[232:235], v29 offset:5120
    v_mfma_f32_16x16x32_bf16 a[56:59], a[208:211], v[72:75], a[56:59]
    s_mul_i32 s61, s61, 6144
    ds_read_b128 a[236:239], v29 offset:29696
    v_mfma_f32_16x16x32_bf16 a[76:79], a[208:211], v[76:79], a[76:79]
    s_waitcnt vmcnt(24) lgkmcnt(2)
    ds_read_b128 a[240:243], v29 offset:54272
    s_add_u32 s61, s61, 49152
    v_mfma_f32_16x16x32_bf16 a[0:3], a[212:215], v[80:83], a[0:3]
    s_waitcnt vmcnt(22)
    ds_read_b128 a[244:247], v33 offset:5120
    v_add_u32 v211, s61, v1
    v_mfma_f32_16x16x32_bf16 a[20:23], a[212:215], v[84:87], a[20:23]
    s_waitcnt vmcnt(21)
    ds_read_b128 a[248:251], v33 offset:29696
    v_add_u32 v208, 73728, v29
    v_mfma_f32_16x16x32_bf16 a[40:43], a[212:215], v[88:91], a[40:43]
    s_waitcnt vmcnt(19)
    s_xor_b32 s61, s3, 2
    v_mfma_f32_16x16x32_bf16 a[60:63], a[212:215], v[92:95], a[60:63]
    s_mul_i32 s61, s61, 6144
    v_mfma_f32_16x16x32_bf16 a[64:67], a[216:219], v[92:95], a[64:67]
    s_add_u32 s61, s61, 73728
    v_mfma_f32_16x16x32_bf16 a[44:47], a[216:219], v[88:91], a[44:47]
    v_add_u32 v212, s61, v1
    v_mfma_f32_16x16x32_bf16 a[24:27], a[216:219], v[84:87], a[24:27]
    v_add_u32 v209, 24576, v29
    v_mfma_f32_16x16x32_bf16 a[4:7], a[216:219], v[80:83], a[4:7]
    s_xor_b32 s61, s3, 3
    v_mfma_f32_16x16x32_bf16 a[8:11], a[220:223], v[80:83], a[8:11]
    s_mul_i32 s61, s61, 6144
    v_mfma_f32_16x16x32_bf16 a[28:31], a[220:223], v[84:87], a[28:31]
    s_add_u32 s61, s61, 24576
    v_mfma_f32_16x16x32_bf16 a[48:51], a[220:223], v[88:91], a[48:51]
    v_add_u32 v213, s61, v1
    v_mfma_f32_16x16x32_bf16 a[68:71], a[220:223], v[92:95], a[68:71]
    v_mfma_f32_16x16x32_bf16 a[72:75], a[224:227], v[92:95], a[72:75]
    v_mfma_f32_16x16x32_bf16 a[52:55], a[224:227], v[88:91], a[52:55]
    v_mfma_f32_16x16x32_bf16 a[32:35], a[224:227], v[84:87], a[32:35]
    v_mfma_f32_16x16x32_bf16 a[12:15], a[224:227], v[80:83], a[12:15]
    v_mfma_f32_16x16x32_bf16 a[16:19], a[228:231], v[80:83], a[16:19]
    v_add_u32 v26, s7, v1
    v_add_u32 v26, 147456, v26
    v_mfma_f32_16x16x32_bf16 a[36:39], a[228:231], v[84:87], a[36:39]
    ds_read_b128 a[252:255], v26 offset:0
    v_mfma_f32_16x16x32_bf16 a[56:59], a[228:231], v[88:91], a[56:59]
    ds_read_b128 a[192:195], v26 offset:1024
    v_mfma_f32_16x16x32_bf16 a[76:79], a[228:231], v[92:95], a[76:79]
WS14:
    s_cbranch_execz WS10
    s_waitcnt vmcnt(16) lgkmcnt(2)
    ds_read_b128 a[196:199], v26 offset:2048
    v_mfma_f32_16x16x32_bf16 a[0:3], a[232:235], v[10:13], a[0:3]
    s_waitcnt vmcnt(15)
    ds_read_b128 a[200:203], v26 offset:3072
    v_mfma_f32_16x16x32_bf16 a[20:23], a[232:235], v[14:17], a[20:23]
    s_waitcnt vmcnt(14)
    ds_read_b128 a[204:207], v33 offset:54272
    v_mfma_f32_16x16x32_bf16 a[40:43], a[232:235], v[18:21], a[40:43]
    s_waitcnt vmcnt(12)
    v_mfma_f32_16x16x32_bf16 a[60:63], a[232:235], v[22:25], a[60:63]
    v_mfma_f32_16x16x32_bf16 a[64:67], a[236:239], v[22:25], a[64:67]
    v_mfma_f32_16x16x32_bf16 a[44:47], a[236:239], v[18:21], a[44:47]
    v_mfma_f32_16x16x32_bf16 a[24:27], a[236:239], v[14:17], a[24:27]
    s_waitcnt vmcnt(1)
    buffer_store_dword v61, v9, s[16:19], 0 offen offset:48 sc1
    v_mfma_f32_16x16x32_bf16 a[4:7], a[236:239], v[10:13], a[4:7]
    s_waitcnt vmcnt(1)
    v_cmp_ne_u32 vcc, v38, v61
    s_cbranch_vccnz SPIN8
BACK8:
    v_mfma_f32_16x16x32_bf16 a[8:11], a[240:243], v[10:13], a[8:11]
    s_xor_b32 s96, s2, 1
    s_and_b32 s96, s96, 7
    s_mul_i32 s96, s96, 10240
    v_mfma_f32_16x16x32_bf16 a[28:31], a[240:243], v[14:17], a[28:31]
    s_add_u32 s96, s96, s79
    buffer_load_dwordx4 v[116:119], v1, s[16:19], s96 offen sc1
    v_mfma_f32_16x16x32_bf16 a[48:51], a[240:243], v[18:21], a[48:51]
    v_mfma_f32_16x16x32_bf16 a[68:71], a[240:243], v[22:25], a[68:71]
    v_mfma_f32_16x16x32_bf16 a[72:75], a[244:247], v[22:25], a[72:75]
    v_mfma_f32_16x16x32_bf16 a[52:55], a[244:247], v[18:21], a[52:55]
    buffer_load_dwordx4 v[120:123], v1, s[16:19], s96 offen offset:1024 sc1
    v_mfma_f32_16x16x32_bf16 a[32:35], a[244:247], v[14:17], a[32:35]
    v_mfma_f32_16x16x32_bf16 a[12:15], a[244:247], v[10:13], a[12:15]
    v_mfma_f32_16x16x32_bf16 a[16:19], a[248:251], v[10:13], a[16:19]
    v_mfma_f32_16x16x32_bf16 a[36:39], a[248:251], v[14:17], a[36:39]
    v_mfma_f32_16x16x32_bf16 a[56:59], a[248:251], v[18:21], a[56:59]
    buffer_load_dwordx2 v[124:125], v8, s[16:19], s96 offen offset:2048 sc1
    v_mfma_f32_16x16x32_bf16 a[76:79], a[248:251], v[22:25], a[76:79]
    s_waitcnt lgkmcnt(0)
    s_xor_b32 s96, s2, 3
    s_and_b32 s96, s96, 7
    v_mfma_f32_16x16x32_bf16 a[0:3], a[252:255], v[44:47], a[0:3]
    s_mul_i32 s96, s96, 10240
    s_add_u32 s96, s96, s79
    v_mfma_f32_16x16x32_bf16 a[20:23], a[252:255], v[48:51], a[20:23]
    v_mfma_f32_16x16x32_bf16 a[40:43], a[252:255], v[52:55], a[40:43]
    buffer_load_dwordx4 v[156:159], v1, s[16:19], s96 offen sc1
    v_mfma_f32_16x16x32_bf16 a[60:63], a[252:255], v[56:59], a[60:63]
    v_mfma_f32_16x16x32_bf16 a[64:67], a[192:195], v[56:59], a[64:67]
    v_mfma_f32_16x16x32_bf16 a[44:47], a[192:195], v[52:55], a[44:47]
    v_mfma_f32_16x16x32_bf16 a[24:27], a[192:195], v[48:51], a[24:27]
    v_mfma_f32_16x16x32_bf16 a[4:7], a[192:195], v[44:47], a[4:7]
    buffer_load_dwordx4 v[160:163], v1, s[16:19], s96 offen offset:1024 sc1
    v_mfma_f32_16x16x32_bf16 a[8:11], a[196:199], v[44:47], a[8:11]
    ds_write_b128 v207, a[20:23] offset:0
    v_mfma_f32_16x16x32_bf16 a[28:31], a[196:199], v[48:51], a[28:31]
    ds_write_b128 v208, a[40:43] offset:0
    v_mfma_f32_16x16x32_bf16 a[48:51], a[196:199], v[52:55], a[48:51]
    ds_write_b128 v209, a[60:63] offset:0
    v_mfma_f32_16x16x32_bf16 a[68:71], a[196:199], v[56:59], a[68:71]
    buffer_load_dwordx2 v[164:165], v8, s[16:19], s96 offen offset:2048 sc1
    v_mfma_f32_16x16x32_bf16 a[72:75], a[200:203], v[56:59], a[72:75]
    s_xor_b32 s96, s2, 5
    s_and_b32 s96, s96, 7
    s_mul_i32 s96, s96, 10240
    v_mfma_f32_16x16x32_bf16 a[52:55], a[200:203], v[52:55], a[52:55]
    s_add_u32 s96, s96, s79
    ds_write_b128 v207, a[24:27] offset:1024
    v_mfma_f32_16x16x32_bf16 a[32:35], a[200:203], v[48:51], a[32:35]
    ds_write_b128 v208, a[44:47] offset:1024
    v_mfma_f32_16x16x32_bf16 a[12:15], a[200:203], v[44:47], a[12:15]
    ds_write_b128 v209, a[64:67] offset:1024
    v_mfma_f32_16x16x32_bf16 a[16:19], a[204:207], v[44:47], a[16:19]
    buffer_load_dwordx4 v[196:199], v1, s[16:19], s96 offen sc1
    v_mfma_f32_16x16x32_bf16 a[36:39], a[204:207], v[48:51], a[36:39]
    ds_write_b128 v207, a[28:31] offset:2048
    v_mfma_f32_16x16x32_bf16 a[56:59], a[204:207], v[52:55], a[56:59]
    ds_write_b128 v208, a[48:51] offset:2048
    v_mfma_f32_16x16x32_bf16 a[76:79], a[204:207], v[56:59], a[76:79]
    buffer_load_dwordx4 v[200:203], v1, s[16:19], s96 offen offset:1024 sc1
    buffer_load_dwordx2 v[204:205], v8, s[16:19], s96 offen offset:2048 sc1
    s_xor_b32 s96, s2, 7
    s_and_b32 s96, s96, 7
    s_mul_i32 s96, s96, 10240
    s_add_u32 s96, s96, s79
    buffer_load_dwordx4 v[236:239], v1, s[16:19], s96 offen sc1
    buffer_load_dwordx4 v[240:243], v1, s[16:19], s96 offen offset:1024 sc1
    buffer_load_dwordx2 v[244:245], v8, s[16:19], s96 offen offset:2048 sc1
    ds_write_b128 v209, a[68:71] offset:2048
    v_lshlrev_b32 v62, 1, v42
    v_and_b32 v62, 768, v62
    s_and_b32 s58, s2, 0xf9
    s_lshl_b32 s58, s58, 7
    s_add_u32 s58, s58, 62390272
    s_add_u32 s58, s58, s89
    ds_write_b128 v207, a[32:35] offset:3072
    ds_write_b128 v208, a[52:55] offset:3072
    ds_write_b128 v209, a[72:75] offset:3072
    ds_write_b128 v207, a[36:39] offset:4096
    ds_write_b128 v208, a[56:59] offset:4096
    ds_write_b128 v209, a[76:79] offset:4096
    v_accvgpr_read_b32 v64, a0
    v_accvgpr_read_b32 v65, a1
    v_accvgpr_read_b32 v66, a2
    v_accvgpr_read_b32 v67, a3
    v_accvgpr_read_b32 v68, a4
    v_accvgpr_read_b32 v69, a5
    v_accvgpr_read_b32 v70, a6
    v_accvgpr_read_b32 v71, a7
    v_accvgpr_read_b32 v72, a8
    v_accvgpr_read_b32 v73, a9
    v_accvgpr_read_b32 v74, a10
    v_accvgpr_read_b32 v75, a11
    v_accvgpr_read_b32 v76, a12
    v_accvgpr_read_b32 v77, a13
    v_accvgpr_read_b32 v78, a14
    v_accvgpr_read_b32 v79, a15
    v_accvgpr_read_b32 v80, a16
    v_accvgpr_read_b32 v81, a17
    v_accvgpr_read_b32 v82, a18
    v_accvgpr_read_b32 v83, a19
    s_waitcnt lgkmcnt(0)
    s_barrier
    ds_read_b128 v[136:139], v211 offset:0
    ds_read_b128 v[140:143], v211 offset:1024
    ds_read_b128 v[144:147], v211 offset:2048
    ds_read_b128 v[148:151], v211 offset:3072
    ds_read_b128 v[152:155], v211 offset:4096
    ds_read_b128 v[176:179], v212 offset:0
    ds_read_b128 v[180:183], v212 offset:1024
    ds_read_b128 v[184:187], v212 offset:2048
    ds_read_b128 v[188:191], v212 offset:3072
    ds_read_b128 v[192:195], v212 offset:4096
    ds_read_b128 v[216:219], v213 offset:0
    ds_read_b128 v[220:223], v213 offset:1024
    ds_read_b128 v[224:227], v213 offset:2048
    ds_read_b128 v[228:231], v213 offset:3072
    ds_read_b128 v[232:235], v213 offset:4096
    s_waitcnt lgkmcnt(14)
    v_pk_add_f32 v[64:65], v[64:65], v[136:137]
    v_pk_add_f32 v[66:67], v[66:67], v[138:139]
    s_waitcnt lgkmcnt(13)
    v_pk_add_f32 v[68:69], v[68:69], v[140:141]
    v_pk_add_f32 v[70:71], v[70:71], v[142:143]
    s_waitcnt lgkmcnt(12)
    v_pk_add_f32 v[72:73], v[72:73], v[144:145]
    v_pk_add_f32 v[74:75], v[74:75], v[146:147]
    s_waitcnt lgkmcnt(11)
    v_pk_add_f32 v[76:77], v[76:77], v[148:149]
    v_pk_add_f32 v[78:79], v[78:79], v[150:151]
    s_waitcnt lgkmcnt(10)
    v_pk_add_f32 v[80:81], v[80:81], v[152:153]
    v_pk_add_f32 v[82:83], v[82:83], v[154:155]
    s_waitcnt lgkmcnt(9)
    v_pk_add_f32 v[64:65], v[64:65], v[176:177]
    v_pk_add_f32 v[66:67], v[66:67], v[178:179]
    s_waitcnt lgkmcnt(8)
    v_pk_add_f32 v[68:69], v[68:69], v[180:181]
    v_pk_add_f32 v[70:71], v[70:71], v[182:183]
    s_waitcnt lgkmcnt(7)
    v_pk_add_f32 v[72:73], v[72:73], v[184:185]
    v_pk_add_f32 v[74:75], v[74:75], v[186:187]
    s_waitcnt lgkmcnt(6)
    v_pk_add_f32 v[76:77], v[76:77], v[188:189]
    v_pk_add_f32 v[78:79], v[78:79], v[190:191]
    s_waitcnt lgkmcnt(5)
    v_pk_add_f32 v[80:81], v[80:81], v[192:193]
    v_pk_add_f32 v[82:83], v[82:83], v[194:195]
    s_waitcnt lgkmcnt(4)
    v_pk_add_f32 v[64:65], v[64:65], v[216:217]
    v_pk_add_f32 v[66:67], v[66:67], v[218:219]
    s_waitcnt lgkmcnt(3)
    v_pk_add_f32 v[68:69], v[68:69], v[220:221]
    v_pk_add_f32 v[70:71], v[70:71], v[222:223]
    s_waitcnt lgkmcnt(2)
    v_pk_add_f32 v[72:73], v[72:73], v[224:225]
    v_pk_add_f32 v[74:75], v[74:75], v[226:227]
    s_waitcnt lgkmcnt(1)
    v_pk_add_f32 v[76:77], v[76:77], v[228:229]
    v_pk_add_f32 v[78:79], v[78:79], v[230:231]
    s_waitcnt lgkmcnt(0)
    v_pk_add_f32 v[80:81], v[80:81], v[232:233]
    v_pk_add_f32 v[82:83], v[82:83], v[234:235]
    s_mov_b32 s60, 0xc3051592
    s_mov_b32 s61, 0xc3051592
    s_mov_b32 s62, 0x42b87e74
    s_mov_b32 s63, 0x42b87e74
    v_pk_mul_f32 v[216:217], v[64:65], s[60:61]
    v_pk_mul_f32 v[218:219], v[66:67], s[60:61]
    v_pk_mul_f32 v[220:221], v[68:69], s[60:61]
    v_pk_mul_f32 v[222:223], v[70:71], s[60:61]
    v_pk_mul_f32 v[224:225], v[72:73], s[60:61]
    v_pk_mul_f32 v[226:227], v[74:75], s[60:61]
    v_pk_mul_f32 v[228:229], v[76:77], s[60:61]
    v_pk_mul_f32 v[230:231], v[78:79], s[60:61]
    v_pk_mul_f32 v[232:233], v[80:81], s[60:61]
    v_pk_mul_f32 v[234:235], v[82:83], s[60:61]
    v_exp_f32 v216, v216
    v_exp_f32 v217, v217
    v_exp_f32 v218, v218
    v_exp_f32 v219, v219
    v_exp_f32 v220, v220
    v_exp_f32 v221, v221
    v_exp_f32 v222, v222
    v_exp_f32 v223, v223
    v_exp_f32 v224, v224
    v_exp_f32 v225, v225
    v_exp_f32 v226, v226
    v_exp_f32 v227, v227
    v_exp_f32 v228, v228
    v_exp_f32 v229, v229
    v_exp_f32 v230, v230
    v_exp_f32 v231, v231
    v_exp_f32 v232, v232
    v_exp_f32 v233, v233
    v_exp_f32 v234, v234
    v_exp_f32 v235, v235
    buffer_load_dword v38, v62, s[16:19], s58 offen offset:48 sc1
    v_pk_mul_f32 v[64:65], v[64:65], s[62:63]
    v_pk_mul_f32 v[66:67], v[66:67], s[62:63]
    v_pk_mul_f32 v[68:69], v[68:69], s[62:63]
    v_pk_mul_f32 v[70:71], v[70:71], s[62:63]
    v_pk_mul_f32 v[72:73], v[72:73], s[62:63]
    v_pk_mul_f32 v[74:75], v[74:75], s[62:63]
    v_pk_mul_f32 v[76:77], v[76:77], s[62:63]
    v_pk_mul_f32 v[78:79], v[78:79], s[62:63]
    v_pk_mul_f32 v[80:81], v[80:81], s[62:63]
    v_pk_mul_f32 v[82:83], v[82:83], s[62:63]
    v_pk_add_f32 v[216:217], v[216:217], 1.0 op_sel_hi:[1,0]
    v_pk_add_f32 v[218:219], v[218:219], 1.0 op_sel_hi:[1,0]
    v_pk_add_f32 v[220:221], v[220:221], 1.0 op_sel_hi:[1,0]
    v_pk_add_f32 v[222:223], v[222:223], 1.0 op_sel_hi:[1,0]
    v_pk_add_f32 v[224:225], v[224:225], 1.0 op_sel_hi:[1,0]
    v_pk_add_f32 v[226:227], v[226:227], 1.0 op_sel_hi:[1,0]
    v_pk_add_f32 v[228:229], v[228:229], 1.0 op_sel_hi:[1,0]
    v_pk_add_f32 v[230:231], v[230:231], 1.0 op_sel_hi:[1,0]
    v_pk_add_f32 v[232:233], v[232:233], 1.0 op_sel_hi:[1,0]
    v_pk_add_f32 v[234:235], v[234:235], 1.0 op_sel_hi:[1,0]
    v_rcp_f32 v216, v216
    v_rcp_f32 v217, v217
    v_rcp_f32 v218, v218
    v_rcp_f32 v219, v219
    v_rcp_f32 v220, v220
    v_rcp_f32 v221, v221
    v_rcp_f32 v222, v222
    v_rcp_f32 v223, v223
    v_rcp_f32 v224, v224
    v_rcp_f32 v225, v225
    v_rcp_f32 v226, v226
    v_rcp_f32 v227, v227
    v_rcp_f32 v228, v228
    v_rcp_f32 v229, v229
    v_rcp_f32 v230, v230
    v_rcp_f32 v231, v231
    v_rcp_f32 v232, v232
    v_rcp_f32 v233, v233
    v_rcp_f32 v234, v234
    v_rcp_f32 v235, v235
    v_lshlrev_b32 v10, 16, v2
    v_and_b32 v11, 0xffff0000, v2
    v_lshlrev_b32 v12, 16, v3
    v_and_b32 v13, 0xffff0000, v3
    v_lshlrev_b32 v14, 16, v4
    v_and_b32 v15, 0xffff0000, v4
    v_lshlrev_b32 v16, 16, v5
    v_and_b32 v17, 0xffff0000, v5
    v_lshlrev_b32 v18, 16, v6
    v_and_b32 v19, 0xffff0000, v6
    v_lshlrev_b32 v20, 16, v7
    v_and_b32 v21, 0xffff0000, v7
    v_lshlrev_b32 v22, 16, v40
    v_and_b32 v23, 0xffff0000, v40
    v_lshlrev_b32 v24, 16, v41
    v_and_b32 v25, 0xffff0000, v41
    v_lshlrev_b32 v84, 16, v30
    v_and_b32 v85, 0xffff0000, v30
    v_lshlrev_b32 v86, 16, v31
    v_and_b32 v87, 0xffff0000, v31
    v_pk_mul_f32 v[216:217], v[64:65], v[216:217]
    v_pk_mul_f32 v[218:219], v[66:67], v[218:219]
    v_pk_mul_f32 v[220:221], v[68:69], v[220:221]
    v_pk_mul_f32 v[222:223], v[70:71], v[222:223]
    v_pk_mul_f32 v[224:225], v[72:73], v[224:225]
    v_pk_mul_f32 v[226:227], v[74:75], v[226:227]
    v_pk_mul_f32 v[228:229], v[76:77], v[228:229]
    v_pk_mul_f32 v[230:231], v[78:79], v[230:231]
    v_pk_mul_f32 v[232:233], v[80:81], v[232:233]
    v_pk_mul_f32 v[234:235], v[82:83], v[234:235]
    s_waitcnt vmcnt(12)
    v_lshlrev_b32 v54, 16, v116
    v_and_b32 v55, 0xffff0000, v116
    v_pk_add_f32 v[126:127], v[126:127], v[54:55]
    v_lshlrev_b32 v56, 16, v117
    v_and_b32 v57, 0xffff0000, v117
    v_pk_add_f32 v[128:129], v[128:129], v[56:57]
    v_lshlrev_b32 v58, 16, v118
    v_and_b32 v59, 0xffff0000, v118
    v_pk_add_f32 v[130:131], v[130:131], v[58:59]
    v_lshlrev_b32 v54, 16, v119
    v_and_b32 v55, 0xffff0000, v119
    v_pk_add_f32 v[132:133], v[132:133], v[54:55]
    s_waitcnt vmcnt(11)
    v_lshlrev_b32 v56, 16, v120
    v_and_b32 v57, 0xffff0000, v120
    v_pk_add_f32 v[134:135], v[134:135], v[56:57]
    v_lshlrev_b32 v58, 16, v121
    v_and_b32 v59, 0xffff0000, v121
    v_pk_add_f32 v[166:167], v[166:167], v[58:59]
    v_lshlrev_b32 v54, 16, v122
    v_and_b32 v55, 0xffff0000, v122
    v_pk_add_f32 v[168:169], v[168:169], v[54:55]
    v_lshlrev_b32 v56, 16, v123
    v_and_b32 v57, 0xffff0000, v123
    v_pk_add_f32 v[170:171], v[170:171], v[56:57]
    s_waitcnt vmcnt(10)
    v_lshlrev_b32 v58, 16, v124
    v_and_b32 v59, 0xffff0000, v124
    v_pk_add_f32 v[172:173], v[172:173], v[58:59]
    v_lshlrev_b32 v54, 16, v125
    v_and_b32 v55, 0xffff0000, v125
    v_pk_add_f32 v[174:175], v[174:175], v[54:55]
    s_waitcnt vmcnt(9)
    v_lshlrev_b32 v54, 16, v156
    v_and_b32 v55, 0xffff0000, v156
    v_pk_add_f32 v[126:127], v[126:127], v[54:55]
    v_lshlrev_b32 v56, 16, v157
    v_and_b32 v57, 0xffff0000, v157
    v_pk_add_f32 v[128:129], v[128:129], v[56:57]
    v_lshlrev_b32 v58, 16, v158
    v_and_b32 v59, 0xffff0000, v158
    v_pk_add_f32 v[130:131], v[130:131], v[58:59]
    v_lshlrev_b32 v54, 16, v159
    v_and_b32 v55, 0xffff0000, v159
    v_pk_add_f32 v[132:133], v[132:133], v[54:55]
    s_waitcnt vmcnt(8)
    v_lshlrev_b32 v56, 16, v160
    v_and_b32 v57, 0xffff0000, v160
    v_pk_add_f32 v[134:135], v[134:135], v[56:57]
    v_lshlrev_b32 v58, 16, v161
    v_and_b32 v59, 0xffff0000, v161
    v_pk_add_f32 v[166:167], v[166:167], v[58:59]
    v_lshlrev_b32 v54, 16, v162
    v_and_b32 v55, 0xffff0000, v162
    v_pk_add_f32 v[168:169], v[168:169], v[54:55]
    v_lshlrev_b32 v56, 16, v163
    v_and_b32 v57, 0xffff0000, v163
    v_pk_add_f32 v[170:171], v[170:171], v[56:57]
    s_waitcnt vmcnt(7)
    v_lshlrev_b32 v58, 16, v164
    v_and_b32 v59, 0xffff0000, v164
    v_pk_add_f32 v[172:173], v[172:173], v[58:59]
    v_lshlrev_b32 v54, 16, v165
    v_and_b32 v55, 0xffff0000, v165
    v_pk_add_f32 v[174:175], v[174:175], v[54:55]
    s_waitcnt vmcnt(6)
    v_lshlrev_b32 v54, 16, v196
    v_and_b32 v55, 0xffff0000, v196
    v_pk_add_f32 v[126:127], v[126:127], v[54:55]
    v_lshlrev_b32 v56, 16, v197
    v_and_b32 v57, 0xffff0000, v197
    v_pk_add_f32 v[128:129], v[128:129], v[56:57]
    v_lshlrev_b32 v58, 16, v198
    v_and_b32 v59, 0xffff0000, v198
    v_pk_add_f32 v[130:131], v[130:131], v[58:59]
    v_lshlrev_b32 v54, 16, v199
    v_and_b32 v55, 0xffff0000, v199
    v_pk_add_f32 v[132:133], v[132:133], v[54:55]
    s_waitcnt vmcnt(5)
    v_lshlrev_b32 v56, 16, v200
    v_and_b32 v57, 0xffff0000, v200
    v_pk_add_f32 v[134:135], v[134:135], v[56:57]
    v_lshlrev_b32 v58, 16, v201
    v_and_b32 v59, 0xffff0000, v201
    v_pk_add_f32 v[166:167], v[166:167], v[58:59]
    v_lshlrev_b32 v54, 16, v202
    v_and_b32 v55, 0xffff0000, v202
    v_pk_add_f32 v[168:169], v[168:169], v[54:55]
    v_lshlrev_b32 v56, 16, v203
    v_and_b32 v57, 0xffff0000, v203
    v_pk_add_f32 v[170:171], v[170:171], v[56:57]
    s_waitcnt vmcnt(4)
    v_lshlrev_b32 v58, 16, v204
    v_and_b32 v59, 0xffff0000, v204
    v_pk_add_f32 v[172:173], v[172:173], v[58:59]
    v_lshlrev_b32 v54, 16, v205
    v_and_b32 v55, 0xffff0000, v205
    v_pk_add_f32 v[174:175], v[174:175], v[54:55]
    s_waitcnt vmcnt(3)
    v_lshlrev_b32 v54, 16, v236
    v_and_b32 v55, 0xffff0000, v236
    v_pk_add_f32 v[126:127], v[126:127], v[54:55]
    v_lshlrev_b32 v56, 16, v237
    v_and_b32 v57, 0xffff0000, v237
    v_pk_add_f32 v[128:129], v[128:129], v[56:57]
    v_lshlrev_b32 v58, 16, v238
    v_and_b32 v59, 0xffff0000, v238
    v_pk_add_f32 v[130:131], v[130:131], v[58:59]
    v_lshlrev_b32 v54, 16, v239
    v_and_b32 v55, 0xffff0000, v239
    v_pk_add_f32 v[132:133], v[132:133], v[54:55]
    s_waitcnt vmcnt(2)
    v_lshlrev_b32 v56, 16, v240
    v_and_b32 v57, 0xffff0000, v240
    v_pk_add_f32 v[134:135], v[134:135], v[56:57]
    v_lshlrev_b32 v58, 16, v241
    v_and_b32 v59, 0xffff0000, v241
    v_pk_add_f32 v[166:167], v[166:167], v[58:59]
    v_lshlrev_b32 v54, 16, v242
    v_and_b32 v55, 0xffff0000, v242
    v_pk_add_f32 v[168:169], v[168:169], v[54:55]
    v_lshlrev_b32 v56, 16, v243
    v_and_b32 v57, 0xffff0000, v243
    v_pk_add_f32 v[170:171], v[170:171], v[56:57]
    s_waitcnt vmcnt(1)
    v_lshlrev_b32 v58, 16, v244
    v_and_b32 v59, 0xffff0000, v244
    v_pk_add_f32 v[172:173], v[172:173], v[58:59]
    v_lshlrev_b32 v54, 16, v245
    v_and_b32 v55, 0xffff0000, v245
    v_pk_add_f32 v[174:175], v[174:175], v[54:55]
    s_mov_b32 s101, 0x80000
ISPP0:
    s_waitcnt vmcnt(0)
    v_cmp_ne_u32 vcc, v38, v61
    s_cbranch_vccz ISDP0
    buffer_load_dword v38, v62, s[16:19], s58 offen offset:48 sc1
    s_sub_u32 s101, s101, 1
    s_cmp_lg_u32 s101, 0
    s_cbranch_scc1 ISPP0
    s_waitcnt vmcnt(0)
ISDP0:
    s_xor_b32 s96, s2, 2
    s_and_b32 s96, s96, 7
    s_mul_i32 s96, s96, 10240
    s_add_u32 s96, s96, s79
    buffer_load_dwordx4 v[96:99], v1, s[16:19], s96 offen sc1
    buffer_load_dwordx4 v[100:103], v1, s[16:19], s96 offen offset:1024 sc1
    buffer_load_dwordx2 v[104:105], v8, s[16:19], s96 offen offset:2048 sc1
    s_xor_b32 s96, s2, 4
    s_and_b32 s96, s96, 7
    s_mul_i32 s96, s96, 10240
    s_add_u32 s96, s96, s79
    buffer_load_dwordx4 v[136:139], v1, s[16:19], s96 offen sc1
    buffer_load_dwordx4 v[140:143], v1, s[16:19], s96 offen offset:1024 sc1
    buffer_load_dwordx2 v[144:145], v8, s[16:19], s96 offen offset:2048 sc1
    s_xor_b32 s96, s2, 6
    s_and_b32 s96, s96, 7
    s_mul_i32 s96, s96, 10240
    s_add_u32 s96, s96, s79
    buffer_load_dwordx4 v[176:179], v1, s[16:19], s96 offen sc1
    buffer_load_dwordx4 v[180:183], v1, s[16:19], s96 offen offset:1024 sc1
    buffer_load_dwordx2 v[184:185], v8, s[16:19], s96 offen offset:2048 sc1
    s_waitcnt vmcnt(8)
    v_lshlrev_b32 v54, 16, v96
    v_and_b32 v55, 0xffff0000, v96
    v_pk_add_f32 v[126:127], v[126:127], v[54:55]
    v_lshlrev_b32 v56, 16, v97
    v_and_b32 v57, 0xffff0000, v97
    v_pk_add_f32 v[128:129], v[128:129], v[56:57]
    v_lshlrev_b32 v58, 16, v98
    v_and_b32 v59, 0xffff0000, v98
    v_pk_add_f32 v[130:131], v[130:131], v[58:59]
    v_lshlrev_b32 v54, 16, v99
    v_and_b32 v55, 0xffff0000, v99
    v_pk_add_f32 v[132:133], v[132:133], v[54:55]
    s_waitcnt vmcnt(7)
    v_lshlrev_b32 v56, 16, v100
    v_and_b32 v57, 0xffff0000, v100
    v_pk_add_f32 v[134:135], v[134:135], v[56:57]
    v_lshlrev_b32 v58, 16, v101
    v_and_b32 v59, 0xffff0000, v101
    v_pk_add_f32 v[166:167], v[166:167], v[58:59]
    v_lshlrev_b32 v54, 16, v102
    v_and_b32 v55, 0xffff0000, v102
    v_pk_add_f32 v[168:169], v[168:169], v[54:55]
    v_lshlrev_b32 v56, 16, v103
    v_and_b32 v57, 0xffff0000, v103
    v_pk_add_f32 v[170:171], v[170:171], v[56:57]
    s_waitcnt vmcnt(6)
    v_lshlrev_b32 v58, 16, v104
    v_and_b32 v59, 0xffff0000, v104
    v_pk_add_f32 v[172:173], v[172:173], v[58:59]
    v_lshlrev_b32 v54, 16, v105
    v_and_b32 v55, 0xffff0000, v105
    v_pk_add_f32 v[174:175], v[174:175], v[54:55]
    s_waitcnt vmcnt(5)
    v_lshlrev_b32 v54, 16, v136
    v_and_b32 v55, 0xffff0000, v136
    v_pk_add_f32 v[126:127], v[126:127], v[54:55]
    v_lshlrev_b32 v56, 16, v137
    v_and_b32 v57, 0xffff0000, v137
    v_pk_add_f32 v[128:129], v[128:129], v[56:57]
    v_lshlrev_b32 v58, 16, v138
    v_and_b32 v59, 0xffff0000, v138
    v_pk_add_f32 v[130:131], v[130:131], v[58:59]
    v_lshlrev_b32 v54, 16, v139
    v_and_b32 v55, 0xffff0000, v139
    v_pk_add_f32 v[132:133], v[132:133], v[54:55]
    s_waitcnt vmcnt(4)
    v_lshlrev_b32 v56, 16, v140
    v_and_b32 v57, 0xffff0000, v140
    v_pk_add_f32 v[134:135], v[134:135], v[56:57]
    v_lshlrev_b32 v58, 16, v141
    v_and_b32 v59, 0xffff0000, v141
    v_pk_add_f32 v[166:167], v[166:167], v[58:59]
    v_lshlrev_b32 v54, 16, v142
    v_and_b32 v55, 0xffff0000, v142
    v_pk_add_f32 v[168:169], v[168:169], v[54:55]
    v_lshlrev_b32 v56, 16, v143
    v_and_b32 v57, 0xffff0000, v143
    v_pk_add_f32 v[170:171], v[170:171], v[56:57]
    s_waitcnt vmcnt(3)
    v_lshlrev_b32 v58, 16, v144
    v_and_b32 v59, 0xffff0000, v144
    v_pk_add_f32 v[172:173], v[172:173], v[58:59]
    v_lshlrev_b32 v54, 16, v145
    v_and_b32 v55, 0xffff0000, v145
    v_pk_add_f32 v[174:175], v[174:175], v[54:55]
    s_waitcnt vmcnt(2)
    v_lshlrev_b32 v54, 16, v176
    v_and_b32 v55, 0xffff0000, v176
    v_pk_add_f32 v[126:127], v[126:127], v[54:55]
    v_lshlrev_b32 v56, 16, v177
    v_and_b32 v57, 0xffff0000, v177
    v_pk_add_f32 v[128:129], v[128:129], v[56:57]
    v_lshlrev_b32 v58, 16, v178
    v_and_b32 v59, 0xffff0000, v178
    v_pk_add_f32 v[130:131], v[130:131], v[58:59]
    v_lshlrev_b32 v54, 16, v179
    v_and_b32 v55, 0xffff0000, v179
    v_pk_add_f32 v[132:133], v[132:133], v[54:55]
    s_waitcnt vmcnt(1)
    v_lshlrev_b32 v56, 16, v180
    v_and_b32 v57, 0xffff0000, v180
    v_pk_add_f32 v[134:135], v[134:135], v[56:57]
    v_lshlrev_b32 v58, 16, v181
    v_and_b32 v59, 0xffff0000, v181
    v_pk_add_f32 v[166:167], v[166:167], v[58:59]
    v_lshlrev_b32 v54, 16, v182
    v_and_b32 v55, 0xffff0000, v182
    v_pk_add_f32 v[168:169], v[168:169], v[54:55]
    v_lshlrev_b32 v56, 16, v183
    v_and_b32 v57, 0xffff0000, v183
    v_pk_add_f32 v[170:171], v[170:171], v[56:57]
    s_waitcnt vmcnt(0)
    v_lshlrev_b32 v58, 16, v184
    v_and_b32 v59, 0xffff0000, v184
    v_pk_add_f32 v[172:173], v[172:173], v[58:59]
    v_lshlrev_b32 v54, 16, v185
    v_and_b32 v55, 0xffff0000, v185
    v_pk_add_f32 v[174:175], v[174:175], v[54:55]
    v_pk_fma_f32 v[10:11], v[126:127], v[216:217], v[10:11]
    v_cvt_pk_bf16_f32 v2, v10, v11
    v_pk_fma_f32 v[12:13], v[128:129], v[218:219], v[12:13]
    v_cvt_pk_bf16_f32 v3, v12, v13
    buffer_store_dwordx2 v[2:3], v28, s[24:27], s4 offen offset:0
    v_pk_fma_f32 v[14:15], v[130:131], v[220:221], v[14:15]
    v_cvt_pk_bf16_f32 v4, v14, v15
    v_pk_fma_f32 v[16:17], v[132:133], v[222:223], v[16:17]
    v_cvt_pk_bf16_f32 v5, v16, v17
    buffer_store_dwordx2 v[4:5], v28, s[24:27], s4 offen offset:32
    v_pk_fma_f32 v[18:19], v[134:135], v[224:225], v[18:19]
    v_cvt_pk_bf16_f32 v6, v18, v19
    v_pk_fma_f32 v[20:21], v[166:167], v[226:227], v[20:21]
    v_cvt_pk_bf16_f32 v7, v20, v21
    buffer_store_dwordx2 v[6:7], v28, s[24:27], s4 offen offset:64
    v_pk_fma_f32 v[22:23], v[168:169], v[228:229], v[22:23]
    v_cvt_pk_bf16_f32 v40, v22, v23
    v_pk_fma_f32 v[24:25], v[170:171], v[230:231], v[24:25]
    v_cvt_pk_bf16_f32 v41, v24, v25
    buffer_store_dwordx2 v[40:41], v28, s[24:27], s4 offen offset:96
    v_pk_fma_f32 v[84:85], v[172:173], v[232:233], v[84:85]
    v_cvt_pk_bf16_f32 v30, v84, v85
    v_pk_fma_f32 v[86:87], v[174:175], v[234:235], v[86:87]
    v_cvt_pk_bf16_f32 v31, v86, v87
    buffer_store_dwordx2 v[30:31], v28, s[24:27], s4 offen offset:128
    buffer_store_dword v61, v43, s[16:19], 0 offen offset:28 sc1
END:
    s_endpgm
WB0:
    buffer_wbl2 sc1
    s_waitcnt vmcnt(0)
    buffer_store_dword v61, v9, s[16:19], s55 offen offset:64 sc1
    s_waitcnt vmcnt(0)
    s_branch WB0B
WB1:
    buffer_wbl2 sc1
    s_waitcnt vmcnt(0)
    buffer_store_dword v61, v9, s[16:19], s55 offen offset:80 sc1
    s_waitcnt vmcnt(0)
    s_branch WB1B
WB2:
    buffer_wbl2 sc1
    s_waitcnt vmcnt(0)
    buffer_store_dword v61, v9, s[16:19], s55 offen offset:96 sc1
    s_waitcnt vmcnt(0)
    s_branch WB2B
SPINWO:
    s_mov_b32 s101, 0x80000
SPINLWO:
    buffer_load_dword v38, v62, s[16:19], s58 offen offset:4 sc1
    s_waitcnt vmcnt(0)
    v_sub_u32 v38, v38, v61
    v_subrev_u32 v38, 4, v38
    v_cmp_lt_u32 vcc, 11, v38
    s_cbranch_vccz BACKWO
    s_sub_u32 s101, s101, 1
    s_cmp_lg_u32 s101, 0
    s_cbranch_scc1 SPINLWO
    s_branch BACKWO
SPINWD:
    s_mov_b32 s101, 0x80000
SPINLWD:
    buffer_load_dword v38, v62, s[16:19], s58 offen offset:4 sc1
    s_waitcnt vmcnt(0)
    v_sub_u32 v38, v38, v61
    v_subrev_u32 v38, 5, v38
    v_cmp_lt_u32 vcc, 10, v38
    s_cbranch_vccz BACKWD
    s_sub_u32 s101, s101, 1
    s_cmp_lg_u32 s101, 0
    s_cbranch_scc1 SPINLWD
    s_branch BACKWD
SPINH:
    s_mov_b32 s101, 0x80000
SPINLH:
    buffer_load_dword v38, v62, s[16:19], s58 offen offset:4 sc1
    s_waitcnt vmcnt(0)
    v_sub_u32 v38, v38, v61
    v_subrev_u32 v38, 1, v38
    v_cmp_lt_u32 vcc, 14, v38
    s_cbranch_vccz BACKH
    s_sub_u32 s101, s101, 1
    s_cmp_lg_u32 s101, 0
    s_cbranch_scc1 SPINLH
    s_branch BACKH
SPIN16:
    s_mov_b32 s101, 0x80000
SPINL16:
    buffer_load_dword v38, v62, s[16:19], s58 offen offset:64 sc1
    s_waitcnt vmcnt(0)
    v_cmp_ne_u32 vcc, v38, v61
    s_cbranch_vccz BACK16
    s_sub_u32 s101, s101, 1
    s_cmp_lg_u32 s101, 0
    s_cbranch_scc1 SPINL16
    s_branch BACK16
SPIN20:
    s_mov_b32 s101, 0x80000
SPINL20:
    buffer_load_dword v38, v62, s[16:19], s58 offen offset:80 sc1
    s_waitcnt vmcnt(0)
    v_cmp_ne_u32 vcc, v38, v61
    s_cbranch_vccz BACK20
    s_sub_u32 s101, s101, 1
    s_cmp_lg_u32 s101, 0
    s_cbranch_scc1 SPINL20
    s_branch BACK20
SPIN24:
    s_mov_b32 s101, 0x80000
SPINL24:
    buffer_load_dword v38, v62, s[16:19], s58 offen offset:96 sc1
    s_waitcnt vmcnt(0)
    v_cmp_ne_u32 vcc, v38, v61
    s_cbranch_vccz BACK24
    s_sub_u32 s101, s101, 1
    s_cmp_lg_u32 s101, 0
    s_cbranch_scc1 SPINL24
    s_branch BACK24
SPIN8:
    s_mov_b32 s101, 0x80000
SPINL8:
    buffer_load_dword v38, v62, s[16:19], s58 offen offset:32 sc1
    s_waitcnt vmcnt(0)
    v_cmp_ne_u32 vcc, v38, v61
    s_cbranch_vccz BACK8
    s_sub_u32 s101, s101, 1
    s_cmp_lg_u32 s101, 0
    s_cbranch_scc1 SPINL8
    s_branch BACK8
CODE_END:
SAFE:
    s_mov_b32 s100, m0
    s_waitcnt vmcnt(0) lgkmcnt(0)
    s_nop 15
    s_mov_b32 s24, s66
    s_and_b32 s25, s67, 0xffff
    s_mov_b32 s26, 196608
    s_mov_b32 s27, 0x20000
    s_mov_b32 s28, s68
    s_and_b32 s29, s69, 0xffff
    s_mov_b32 s30, 196608
    s_mov_b32 s31, 0x20000
    v_and_b32 v56, 15, v0
    v_mul_u32_u24 v56, 384, v56
    v_bfe_u32 v57, v0, 4, 1
    v_lshl_add_u32 v56, v57, 5, v56
    v_lshrrev_b32 v57, 5, v0
    v_lshl_add_u32 v52, v57, 4, v56
    v_lshrrev_b32 v56, 3, v0
    v_mul_u32_u24 v56, 384, v56
    v_and_b32 v57, 7, v0
    v_lshl_add_u32 v53, v57, 4, v56
    v_lshrrev_b32 v56, 2, v0
    v_lshlrev_b32 v56, 7, v56
    v_and_b32 v57, 3, v0
    v_lshl_add_u32 v56, v57, 3, v56
    s_lshl_b32 s62, s3, 12
    s_add_u32 s62, s62, 147456
    v_add_u32 v54, s62, v56
    s_mov_b32 s60, 0
    v_mov_b32 v224, 0xff61b1e6
    v_mov_b32 v34, 0
    v_mov_b32 v225, 0xff61b1e6
    v_mov_b32 v35, 0
    v_mov_b32 v226, 0xff61b1e6
    v_mov_b32 v36, 0
    v_mov_b32 v227, 0xff61b1e6
    v_mov_b32 v37, 0
    v_accvgpr_write_b32 a0, 0
    v_accvgpr_write_b32 a1, 0
    v_accvgpr_write_b32 a2, 0
    v_accvgpr_write_b32 a3, 0
    v_accvgpr_write_b32 a4, 0
    v_accvgpr_write_b32 a5, 0
    v_accvgpr_write_b32 a6, 0
    v_accvgpr_write_b32 a7, 0
    v_accvgpr_write_b32 a8, 0
    v_accvgpr_write_b32 a9, 0
    v_accvgpr_write_b32 a10, 0
    v_accvgpr_write_b32 a11, 0
    v_accvgpr_write_b32 a12, 0
    v_accvgpr_write_b32 a13, 0
    v_accvgpr_write_b32 a14, 0
    v_accvgpr_write_b32 a15, 0
    v_accvgpr_write_b32 a16, 0
    v_accvgpr_write_b32 a17, 0
    v_accvgpr_write_b32 a18, 0
    v_accvgpr_write_b32 a19, 0
    v_accvgpr_write_b32 a20, 0
    v_accvgpr_write_b32 a21, 0
    v_accvgpr_write_b32 a22, 0
    v_accvgpr_write_b32 a23, 0
    v_accvgpr_write_b32 a24, 0
    v_accvgpr_write_b32 a25, 0
    v_accvgpr_write_b32 a26, 0
    v_accvgpr_write_b32 a27, 0
    v_accvgpr_write_b32 a28, 0
    v_accvgpr_write_b32 a29, 0
    v_accvgpr_write_b32 a30, 0
    v_accvgpr_write_b32 a31, 0
    v_accvgpr_write_b32 a32, 0
    v_accvgpr_write_b32 a33, 0
    v_accvgpr_write_b32 a34, 0
    v_accvgpr_write_b32 a35, 0
    v_accvgpr_write_b32 a36, 0
    v_accvgpr_write_b32 a37, 0
    v_accvgpr_write_b32 a38, 0
    v_accvgpr_write_b32 a39, 0
    v_accvgpr_write_b32 a40, 0
    v_accvgpr_write_b32 a41, 0
    v_accvgpr_write_b32 a42, 0
    v_accvgpr_write_b32 a43, 0
    v_accvgpr_write_b32 a44, 0
    v_accvgpr_write_b32 a45, 0
    v_accvgpr_write_b32 a46, 0
    v_accvgpr_write_b32 a47, 0
    v_accvgpr_write_b32 a48, 0
    v_accvgpr_write_b32 a49, 0
    v_accvgpr_write_b32 a50, 0
    v_accvgpr_write_b32 a51, 0
    v_accvgpr_write_b32 a52, 0
    v_accvgpr_write_b32 a53, 0
    v_accvgpr_write_b32 a54, 0
    v_accvgpr_write_b32 a55, 0
    v_accvgpr_write_b32 a56, 0
    v_accvgpr_write_b32 a57, 0
    v_accvgpr_write_b32 a58, 0
    v_accvgpr_write_b32 a59, 0
    v_accvgpr_write_b32 a60, 0
    v_accvgpr_write_b32 a61, 0
    v_accvgpr_write_b32 a62, 0
    v_accvgpr_write_b32 a63, 0
    v_accvgpr_write_b32 a64, 0
    v_accvgpr_write_b32 a65, 0
    v_accvgpr_write_b32 a66, 0
    v_accvgpr_write_b32 a67, 0
    v_accvgpr_write_b32 a68, 0
    v_accvgpr_write_b32 a69, 0
    v_accvgpr_write_b32 a70, 0
    v_accvgpr_write_b32 a71, 0
    v_accvgpr_write_b32 a72, 0
    v_accvgpr_write_b32 a73, 0
    v_accvgpr_write_b32 a74, 0
    v_accvgpr_write_b32 a75, 0
    v_accvgpr_write_b32 a76, 0
    v_accvgpr_write_b32 a77, 0
    v_accvgpr_write_b32 a78, 0
    v_accvgpr_write_b32 a79, 0
    v_accvgpr_write_b32 a80, 0
    v_accvgpr_write_b32 a81, 0
    v_accvgpr_write_b32 a82, 0
    v_accvgpr_write_b32 a83, 0
    v_accvgpr_write_b32 a84, 0
    v_accvgpr_write_b32 a85, 0
    v_accvgpr_write_b32 a86, 0
    v_accvgpr_write_b32 a87, 0
    v_accvgpr_write_b32 a88, 0
    v_accvgpr_write_b32 a89, 0
    v_accvgpr_write_b32 a90, 0
    v_accvgpr_write_b32 a91, 0
    v_accvgpr_write_b32 a92, 0
    v_accvgpr_write_b32 a93, 0
    v_accvgpr_write_b32 a94, 0
    v_accvgpr_write_b32 a95, 0
    v_accvgpr_write_b32 a96, 0
    v_accvgpr_write_b32 a97, 0
    v_accvgpr_write_b32 a98, 0
    v_accvgpr_write_b32 a99, 0
    v_accvgpr_write_b32 a100, 0
    v_accvgpr_write_b32 a101, 0
    v_accvgpr_write_b32 a102, 0
    v_accvgpr_write_b32 a103, 0
    v_accvgpr_write_b32 a104, 0
    v_accvgpr_write_b32 a105, 0
    v_accvgpr_write_b32 a106, 0
    v_accvgpr_write_b32 a107, 0
    v_accvgpr_write_b32 a108, 0
    v_accvgpr_write_b32 a109, 0
    v_accvgpr_write_b32 a110, 0
    v_accvgpr_write_b32 a111, 0
    v_accvgpr_write_b32 a112, 0
    v_accvgpr_write_b32 a113, 0
    v_accvgpr_write_b32 a114, 0
    v_accvgpr_write_b32 a115, 0
    v_accvgpr_write_b32 a116, 0
    v_accvgpr_write_b32 a117, 0
    v_accvgpr_write_b32 a118, 0
    v_accvgpr_write_b32 a119, 0
    v_accvgpr_write_b32 a120, 0
    v_accvgpr_write_b32 a121, 0
    v_accvgpr_write_b32 a122, 0
    v_accvgpr_write_b32 a123, 0
    v_accvgpr_write_b32 a124, 0
    v_accvgpr_write_b32 a125, 0
    v_accvgpr_write_b32 a126, 0
    v_accvgpr_write_b32 a127, 0
    v_accvgpr_write_b32 a128, 0
    v_accvgpr_write_b32 a129, 0
    v_accvgpr_write_b32 a130, 0
    v_accvgpr_write_b32 a131, 0
    v_accvgpr_write_b32 a132, 0
    v_accvgpr_write_b32 a133, 0
    v_accvgpr_write_b32 a134, 0
    v_accvgpr_write_b32 a135, 0
    v_accvgpr_write_b32 a136, 0
    v_accvgpr_write_b32 a137, 0
    v_accvgpr_write_b32 a138, 0
    v_accvgpr_write_b32 a139, 0
    v_accvgpr_write_b32 a140, 0
    v_accvgpr_write_b32 a141, 0
    v_accvgpr_write_b32 a142, 0
    v_accvgpr_write_b32 a143, 0
    v_accvgpr_write_b32 a144, 0
    v_accvgpr_write_b32 a145, 0
    v_accvgpr_write_b32 a146, 0
    v_accvgpr_write_b32 a147, 0
    v_accvgpr_write_b32 a148, 0
    v_accvgpr_write_b32 a149, 0
    v_accvgpr_write_b32 a150, 0
    v_accvgpr_write_b32 a151, 0
    v_accvgpr_write_b32 a152, 0
    v_accvgpr_write_b32 a153, 0
    v_accvgpr_write_b32 a154, 0
    v_accvgpr_write_b32 a155, 0
    v_accvgpr_write_b32 a156, 0
    v_accvgpr_write_b32 a157, 0
    v_accvgpr_write_b32 a158, 0
    v_accvgpr_write_b32 a159, 0
    v_accvgpr_write_b32 a160, 0
    v_accvgpr_write_b32 a161, 0
    v_accvgpr_write_b32 a162, 0
    v_accvgpr_write_b32 a163, 0
    v_accvgpr_write_b32 a164, 0
    v_accvgpr_write_b32 a165, 0
    v_accvgpr_write_b32 a166, 0
    v_accvgpr_write_b32 a167, 0
    v_accvgpr_write_b32 a168, 0
    v_accvgpr_write_b32 a169, 0
    v_accvgpr_write_b32 a170, 0
    v_accvgpr_write_b32 a171, 0
    v_accvgpr_write_b32 a172, 0
    v_accvgpr_write_b32 a173, 0
    v_accvgpr_write_b32 a174, 0
    v_accvgpr_write_b32 a175, 0
    v_accvgpr_write_b32 a176, 0
    v_accvgpr_write_b32 a177, 0
    v_accvgpr_write_b32 a178, 0
    v_accvgpr_write_b32 a179, 0
    v_accvgpr_write_b32 a180, 0
    v_accvgpr_write_b32 a181, 0
    v_accvgpr_write_b32 a182, 0
    v_accvgpr_write_b32 a183, 0
    v_accvgpr_write_b32 a184, 0
    v_accvgpr_write_b32 a185, 0
    v_accvgpr_write_b32 a186, 0
    v_accvgpr_write_b32 a187, 0
    v_accvgpr_write_b32 a188, 0
    v_accvgpr_write_b32 a189, 0
    v_accvgpr_write_b32 a190, 0
    v_accvgpr_write_b32 a191, 0
SAFE_LOOP:
    s_add_u32 s61, s60, 0
    buffer_load_dwordx4 v[232:235], v52, s[24:27], s61 offen offset:0
    buffer_load_dwordx4 v[236:239], v52, s[24:27], s61 offen offset:64
    s_waitcnt vmcnt(0)
    v_mfma_f32_16x16x32_bf16 v[192:195], v[232:235], v[64:67], 0
    v_mfma_f32_16x16x32_bf16 v[196:199], v[232:235], v[68:71], 0
    v_mfma_f32_16x16x32_bf16 v[200:203], v[232:235], v[72:75], 0
    v_mfma_f32_16x16x32_bf16 v[204:207], v[232:235], v[76:79], 0
    v_mfma_f32_16x16x32_bf16 v[192:195], v[236:239], v[80:83], v[192:195]
    v_mfma_f32_16x16x32_bf16 v[196:199], v[236:239], v[84:87], v[196:199]
    v_mfma_f32_16x16x32_bf16 v[200:203], v[236:239], v[88:91], v[200:203]
    v_mfma_f32_16x16x32_bf16 v[204:207], v[236:239], v[92:95], v[204:207]
    s_nop 7
    buffer_load_dwordx4 v[232:235], v52, s[24:27], s61 offen offset:128
    buffer_load_dwordx4 v[236:239], v52, s[24:27], s61 offen offset:192
    s_waitcnt vmcnt(0)
    v_mfma_f32_16x16x32_bf16 v[192:195], v[232:235], v[96:99], v[192:195]
    v_mfma_f32_16x16x32_bf16 v[196:199], v[232:235], v[100:103], v[196:199]
    v_mfma_f32_16x16x32_bf16 v[200:203], v[232:235], v[104:107], v[200:203]
    v_mfma_f32_16x16x32_bf16 v[204:207], v[232:235], v[108:111], v[204:207]
    v_mfma_f32_16x16x32_bf16 v[192:195], v[236:239], v[112:115], v[192:195]
    v_mfma_f32_16x16x32_bf16 v[196:199], v[236:239], v[116:119], v[196:199]
    v_mfma_f32_16x16x32_bf16 v[200:203], v[236:239], v[120:123], v[200:203]
    v_mfma_f32_16x16x32_bf16 v[204:207], v[236:239], v[124:127], v[204:207]
    s_nop 7
    buffer_load_dwordx4 v[232:235], v52, s[24:27], s61 offen offset:256
    buffer_load_dwordx4 v[236:239], v52, s[24:27], s61 offen offset:320
    s_waitcnt vmcnt(0)
    v_mfma_f32_16x16x32_bf16 v[192:195], v[232:235], v[128:131], v[192:195]
    v_mfma_f32_16x16x32_bf16 v[196:199], v[232:235], v[132:135], v[196:199]
    v_mfma_f32_16x16x32_bf16 v[200:203], v[232:235], v[136:139], v[200:203]
    v_mfma_f32_16x16x32_bf16 v[204:207], v[232:235], v[140:143], v[204:207]
    v_mfma_f32_16x16x32_bf16 v[192:195], v[236:239], v[144:147], v[192:195]
    v_mfma_f32_16x16x32_bf16 v[196:199], v[236:239], v[148:151], v[196:199]
    v_mfma_f32_16x16x32_bf16 v[200:203], v[236:239], v[152:155], v[200:203]
    v_mfma_f32_16x16x32_bf16 v[204:207], v[236:239], v[156:159], v[204:207]
    s_nop 7
    s_add_u32 s61, s60, 6144
    buffer_load_dwordx4 v[232:235], v52, s[24:27], s61 offen offset:0
    buffer_load_dwordx4 v[236:239], v52, s[24:27], s61 offen offset:64
    s_waitcnt vmcnt(0)
    v_mfma_f32_16x16x32_bf16 v[208:211], v[232:235], v[64:67], 0
    v_mfma_f32_16x16x32_bf16 v[212:215], v[232:235], v[68:71], 0
    v_mfma_f32_16x16x32_bf16 v[216:219], v[232:235], v[72:75], 0
    v_mfma_f32_16x16x32_bf16 v[220:223], v[232:235], v[76:79], 0
    v_mfma_f32_16x16x32_bf16 v[208:211], v[236:239], v[80:83], v[208:211]
    v_mfma_f32_16x16x32_bf16 v[212:215], v[236:239], v[84:87], v[212:215]
    v_mfma_f32_16x16x32_bf16 v[216:219], v[236:239], v[88:91], v[216:219]
    v_mfma_f32_16x16x32_bf16 v[220:223], v[236:239], v[92:95], v[220:223]
    s_nop 7
    buffer_load_dwordx4 v[232:235], v52, s[24:27], s61 offen offset:128
    buffer_load_dwordx4 v[236:239], v52, s[24:27], s61 offen offset:192
    s_waitcnt vmcnt(0)
    v_mfma_f32_16x16x32_bf16 v[208:211], v[232:235], v[96:99], v[208:211]
    v_mfma_f32_16x16x32_bf16 v[212:215], v[232:235], v[100:103], v[212:215]
    v_mfma_f32_16x16x32_bf16 v[216:219], v[232:235], v[104:107], v[216:219]
    v_mfma_f32_16x16x32_bf16 v[220:223], v[232:235], v[108:111], v[220:223]
    v_mfma_f32_16x16x32_bf16 v[208:211], v[236:239], v[112:115], v[208:211]
    v_mfma_f32_16x16x32_bf16 v[212:215], v[236:239], v[116:119], v[212:215]
    v_mfma_f32_16x16x32_bf16 v[216:219], v[236:239], v[120:123], v[216:219]
    v_mfma_f32_16x16x32_bf16 v[220:223], v[236:239], v[124:127], v[220:223]
    s_nop 7
    buffer_load_dwordx4 v[232:235], v52, s[24:27], s61 offen offset:256
    buffer_load_dwordx4 v[236:239], v52, s[24:27], s61 offen offset:320
    s_waitcnt vmcnt(0)
    v_mfma_f32_16x16x32_bf16 v[208:211], v[232:235], v[128:131], v[208:211]
    v_mfma_f32_16x16x32_bf16 v[212:215], v[232:235], v[132:135], v[212:215]
    v_mfma_f32_16x16x32_bf16 v[216:219], v[232:235], v[136:139], v[216:219]
    v_mfma_f32_16x16x32_bf16 v[220:223], v[232:235], v[140:143], v[220:223]
    v_mfma_f32_16x16x32_bf16 v[208:211], v[236:239], v[144:147], v[208:211]
    v_mfma_f32_16x16x32_bf16 v[212:215], v[236:239], v[148:151], v[212:215]
    v_mfma_f32_16x16x32_bf16 v[216:219], v[236:239], v[152:155], v[216:219]
    v_mfma_f32_16x16x32_bf16 v[220:223], v[236:239], v[156:159], v[220:223]
    s_nop 7
    s_nop 7
    v_max3_f32 v56, v192, v193, v194
    v_max3_f32 v56, v56, v195, v208
    v_max3_f32 v56, v56, v209, v210
    v_max3_f32 v56, v56, v211, v224
    v_mov_b32 v57, v56
    s_nop 0
    s_nop 0
    v_permlane32_swap_b32 v56, v57
    v_max_f32 v56, v56, v57
    v_mov_b32 v57, v56
    s_nop 0
    s_nop 0
    v_permlane16_swap_b32 v56, v57
    v_max_f32 v56, v56, v57
    v_sub_f32 v228, v224, v56
    v_exp_f32 v228, v228
    v_mov_b32 v224, v56
    v_mul_f32 v34, v34, v228
    v_sub_f32 v192, v192, v56
    v_sub_f32 v193, v193, v56
    v_sub_f32 v194, v194, v56
    v_sub_f32 v195, v195, v56
    v_exp_f32 v192, v192
    v_exp_f32 v193, v193
    v_exp_f32 v194, v194
    v_exp_f32 v195, v195
    v_add_f32 v34, v34, v192
    v_add_f32 v34, v34, v193
    v_add_f32 v34, v34, v194
    v_add_f32 v34, v34, v195
    v_sub_f32 v208, v208, v56
    v_sub_f32 v209, v209, v56
    v_sub_f32 v210, v210, v56
    v_sub_f32 v211, v211, v56
    v_exp_f32 v208, v208
    v_exp_f32 v209, v209
    v_exp_f32 v210, v210
    v_exp_f32 v211, v211
    v_add_f32 v34, v34, v208
    v_add_f32 v34, v34, v209
    v_add_f32 v34, v34, v210
    v_add_f32 v34, v34, v211
    v_cvt_pk_bf16_f32 v240, v192, v193
    v_cvt_pk_bf16_f32 v241, v194, v195
    v_cvt_pk_bf16_f32 v242, v208, v209
    v_cvt_pk_bf16_f32 v243, v210, v211
    v_accvgpr_read_b32 v57, a0
    v_mul_f32 v57, v57, v228
    v_accvgpr_write_b32 a0, v57
    v_accvgpr_read_b32 v57, a1
    v_mul_f32 v57, v57, v228
    v_accvgpr_write_b32 a1, v57
    v_accvgpr_read_b32 v57, a2
    v_mul_f32 v57, v57, v228
    v_accvgpr_write_b32 a2, v57
    v_accvgpr_read_b32 v57, a3
    v_mul_f32 v57, v57, v228
    v_accvgpr_write_b32 a3, v57
    v_accvgpr_read_b32 v57, a16
    v_mul_f32 v57, v57, v228
    v_accvgpr_write_b32 a16, v57
    v_accvgpr_read_b32 v57, a17
    v_mul_f32 v57, v57, v228
    v_accvgpr_write_b32 a17, v57
    v_accvgpr_read_b32 v57, a18
    v_mul_f32 v57, v57, v228
    v_accvgpr_write_b32 a18, v57
    v_accvgpr_read_b32 v57, a19
    v_mul_f32 v57, v57, v228
    v_accvgpr_write_b32 a19, v57
    v_accvgpr_read_b32 v57, a32
    v_mul_f32 v57, v57, v228
    v_accvgpr_write_b32 a32, v57
    v_accvgpr_read_b32 v57, a33
    v_mul_f32 v57, v57, v228
    v_accvgpr_write_b32 a33, v57
    v_accvgpr_read_b32 v57, a34
    v_mul_f32 v57, v57, v228
    v_accvgpr_write_b32 a34, v57
    v_accvgpr_read_b32 v57, a35
    v_mul_f32 v57, v57, v228
    v_accvgpr_write_b32 a35, v57
    v_accvgpr_read_b32 v57, a48
    v_mul_f32 v57, v57, v228
    v_accvgpr_write_b32 a48, v57
    v_accvgpr_read_b32 v57, a49
    v_mul_f32 v57, v57, v228
    v_accvgpr_write_b32 a49, v57
    v_accvgpr_read_b32 v57, a50
    v_mul_f32 v57, v57, v228
    v_accvgpr_write_b32 a50, v57
    v_accvgpr_read_b32 v57, a51
    v_mul_f32 v57, v57, v228
    v_accvgpr_write_b32 a51, v57
    v_accvgpr_read_b32 v57, a64
    v_mul_f32 v57, v57, v228
    v_accvgpr_write_b32 a64, v57
    v_accvgpr_read_b32 v57, a65
    v_mul_f32 v57, v57, v228
    v_accvgpr_write_b32 a65, v57
    v_accvgpr_read_b32 v57, a66
    v_mul_f32 v57, v57, v228
    v_accvgpr_write_b32 a66, v57
    v_accvgpr_read_b32 v57, a67
    v_mul_f32 v57, v57, v228
    v_accvgpr_write_b32 a67, v57
    v_accvgpr_read_b32 v57, a80
    v_mul_f32 v57, v57, v228
    v_accvgpr_write_b32 a80, v57
    v_accvgpr_read_b32 v57, a81
    v_mul_f32 v57, v57, v228
    v_accvgpr_write_b32 a81, v57
    v_accvgpr_read_b32 v57, a82
    v_mul_f32 v57, v57, v228
    v_accvgpr_write_b32 a82, v57
    v_accvgpr_read_b32 v57, a83
    v_mul_f32 v57, v57, v228
    v_accvgpr_write_b32 a83, v57
    v_accvgpr_read_b32 v57, a96
    v_mul_f32 v57, v57, v228
    v_accvgpr_write_b32 a96, v57
    v_accvgpr_read_b32 v57, a97
    v_mul_f32 v57, v57, v228
    v_accvgpr_write_b32 a97, v57
    v_accvgpr_read_b32 v57, a98
    v_mul_f32 v57, v57, v228
    v_accvgpr_write_b32 a98, v57
    v_accvgpr_read_b32 v57, a99
    v_mul_f32 v57, v57, v228
    v_accvgpr_write_b32 a99, v57
    v_accvgpr_read_b32 v57, a112
    v_mul_f32 v57, v57, v228
    v_accvgpr_write_b32 a112, v57
    v_accvgpr_read_b32 v57, a113
    v_mul_f32 v57, v57, v228
    v_accvgpr_write_b32 a113, v57
    v_accvgpr_read_b32 v57, a114
    v_mul_f32 v57, v57, v228
    v_accvgpr_write_b32 a114, v57
    v_accvgpr_read_b32 v57, a115
    v_mul_f32 v57, v57, v228
    v_accvgpr_write_b32 a115, v57
    v_accvgpr_read_b32 v57, a128
    v_mul_f32 v57, v57, v228
    v_accvgpr_write_b32 a128, v57
    v_accvgpr_read_b32 v57, a129
    v_mul_f32 v57, v57, v228
    v_accvgpr_write_b32 a129, v57
    v_accvgpr_read_b32 v57, a130
    v_mul_f32 v57, v57, v228
    v_accvgpr_write_b32 a130, v57
    v_accvgpr_read_b32 v57, a131
    v_mul_f32 v57, v57, v228
    v_accvgpr_write_b32 a131, v57
    v_accvgpr_read_b32 v57, a144
    v_mul_f32 v57, v57, v228
    v_accvgpr_write_b32 a144, v57
    v_accvgpr_read_b32 v57, a145
    v_mul_f32 v57, v57, v228
    v_accvgpr_write_b32 a145, v57
    v_accvgpr_read_b32 v57, a146
    v_mul_f32 v57, v57, v228
    v_accvgpr_write_b32 a146, v57
    v_accvgpr_read_b32 v57, a147
    v_mul_f32 v57, v57, v228
    v_accvgpr_write_b32 a147, v57
    v_accvgpr_read_b32 v57, a160
    v_mul_f32 v57, v57, v228
    v_accvgpr_write_b32 a160, v57
    v_accvgpr_read_b32 v57, a161
    v_mul_f32 v57, v57, v228
    v_accvgpr_write_b32 a161, v57
    v_accvgpr_read_b32 v57, a162
    v_mul_f32 v57, v57, v228
    v_accvgpr_write_b32 a162, v57
    v_accvgpr_read_b32 v57, a163
    v_mul_f32 v57, v57, v228
    v_accvgpr_write_b32 a163, v57
    v_accvgpr_read_b32 v57, a176
    v_mul_f32 v57, v57, v228
    v_accvgpr_write_b32 a176, v57
    v_accvgpr_read_b32 v57, a177
    v_mul_f32 v57, v57, v228
    v_accvgpr_write_b32 a177, v57
    v_accvgpr_read_b32 v57, a178
    v_mul_f32 v57, v57, v228
    v_accvgpr_write_b32 a178, v57
    v_accvgpr_read_b32 v57, a179
    v_mul_f32 v57, v57, v228
    v_accvgpr_write_b32 a179, v57
    v_max3_f32 v56, v196, v197, v198
    v_max3_f32 v56, v56, v199, v212
    v_max3_f32 v56, v56, v213, v214
    v_max3_f32 v56, v56, v215, v225
    v_mov_b32 v57, v56
    s_nop 0
    s_nop 0
    v_permlane32_swap_b32 v56, v57
    v_max_f32 v56, v56, v57
    v_mov_b32 v57, v56
    s_nop 0
    s_nop 0
    v_permlane16_swap_b32 v56, v57
    v_max_f32 v56, v56, v57
    v_sub_f32 v229, v225, v56
    v_exp_f32 v229, v229
    v_mov_b32 v225, v56
    v_mul_f32 v35, v35, v229
    v_sub_f32 v196, v196, v56
    v_sub_f32 v197, v197, v56
    v_sub_f32 v198, v198, v56
    v_sub_f32 v199, v199, v56
    v_exp_f32 v196, v196
    v_exp_f32 v197, v197
    v_exp_f32 v198, v198
    v_exp_f32 v199, v199
    v_add_f32 v35, v35, v196
    v_add_f32 v35, v35, v197
    v_add_f32 v35, v35, v198
    v_add_f32 v35, v35, v199
    v_sub_f32 v212, v212, v56
    v_sub_f32 v213, v213, v56
    v_sub_f32 v214, v214, v56
    v_sub_f32 v215, v215, v56
    v_exp_f32 v212, v212
    v_exp_f32 v213, v213
    v_exp_f32 v214, v214
    v_exp_f32 v215, v215
    v_add_f32 v35, v35, v212
    v_add_f32 v35, v35, v213
    v_add_f32 v35, v35, v214
    v_add_f32 v35, v35, v215
    v_cvt_pk_bf16_f32 v244, v196, v197
    v_cvt_pk_bf16_f32 v245, v198, v199
    v_cvt_pk_bf16_f32 v246, v212, v213
    v_cvt_pk_bf16_f32 v247, v214, v215
    v_accvgpr_read_b32 v57, a4
    v_mul_f32 v57, v57, v229
    v_accvgpr_write_b32 a4, v57
    v_accvgpr_read_b32 v57, a5
    v_mul_f32 v57, v57, v229
    v_accvgpr_write_b32 a5, v57
    v_accvgpr_read_b32 v57, a6
    v_mul_f32 v57, v57, v229
    v_accvgpr_write_b32 a6, v57
    v_accvgpr_read_b32 v57, a7
    v_mul_f32 v57, v57, v229
    v_accvgpr_write_b32 a7, v57
    v_accvgpr_read_b32 v57, a20
    v_mul_f32 v57, v57, v229
    v_accvgpr_write_b32 a20, v57
    v_accvgpr_read_b32 v57, a21
    v_mul_f32 v57, v57, v229
    v_accvgpr_write_b32 a21, v57
    v_accvgpr_read_b32 v57, a22
    v_mul_f32 v57, v57, v229
    v_accvgpr_write_b32 a22, v57
    v_accvgpr_read_b32 v57, a23
    v_mul_f32 v57, v57, v229
    v_accvgpr_write_b32 a23, v57
    v_accvgpr_read_b32 v57, a36
    v_mul_f32 v57, v57, v229
    v_accvgpr_write_b32 a36, v57
    v_accvgpr_read_b32 v57, a37
    v_mul_f32 v57, v57, v229
    v_accvgpr_write_b32 a37, v57
    v_accvgpr_read_b32 v57, a38
    v_mul_f32 v57, v57, v229
    v_accvgpr_write_b32 a38, v57
    v_accvgpr_read_b32 v57, a39
    v_mul_f32 v57, v57, v229
    v_accvgpr_write_b32 a39, v57
    v_accvgpr_read_b32 v57, a52
    v_mul_f32 v57, v57, v229
    v_accvgpr_write_b32 a52, v57
    v_accvgpr_read_b32 v57, a53
    v_mul_f32 v57, v57, v229
    v_accvgpr_write_b32 a53, v57
    v_accvgpr_read_b32 v57, a54
    v_mul_f32 v57, v57, v229
    v_accvgpr_write_b32 a54, v57
    v_accvgpr_read_b32 v57, a55
    v_mul_f32 v57, v57, v229
    v_accvgpr_write_b32 a55, v57
    v_accvgpr_read_b32 v57, a68
    v_mul_f32 v57, v57, v229
    v_accvgpr_write_b32 a68, v57
    v_accvgpr_read_b32 v57, a69
    v_mul_f32 v57, v57, v229
    v_accvgpr_write_b32 a69, v57
    v_accvgpr_read_b32 v57, a70
    v_mul_f32 v57, v57, v229
    v_accvgpr_write_b32 a70, v57
    v_accvgpr_read_b32 v57, a71
    v_mul_f32 v57, v57, v229
    v_accvgpr_write_b32 a71, v57
    v_accvgpr_read_b32 v57, a84
    v_mul_f32 v57, v57, v229
    v_accvgpr_write_b32 a84, v57
    v_accvgpr_read_b32 v57, a85
    v_mul_f32 v57, v57, v229
    v_accvgpr_write_b32 a85, v57
    v_accvgpr_read_b32 v57, a86
    v_mul_f32 v57, v57, v229
    v_accvgpr_write_b32 a86, v57
    v_accvgpr_read_b32 v57, a87
    v_mul_f32 v57, v57, v229
    v_accvgpr_write_b32 a87, v57
    v_accvgpr_read_b32 v57, a100
    v_mul_f32 v57, v57, v229
    v_accvgpr_write_b32 a100, v57
    v_accvgpr_read_b32 v57, a101
    v_mul_f32 v57, v57, v229
    v_accvgpr_write_b32 a101, v57
    v_accvgpr_read_b32 v57, a102
    v_mul_f32 v57, v57, v229
    v_accvgpr_write_b32 a102, v57
    v_accvgpr_read_b32 v57, a103
    v_mul_f32 v57, v57, v229
    v_accvgpr_write_b32 a103, v57
    v_accvgpr_read_b32 v57, a116
    v_mul_f32 v57, v57, v229
    v_accvgpr_write_b32 a116, v57
    v_accvgpr_read_b32 v57, a117
    v_mul_f32 v57, v57, v229
    v_accvgpr_write_b32 a117, v57
    v_accvgpr_read_b32 v57, a118
    v_mul_f32 v57, v57, v229
    v_accvgpr_write_b32 a118, v57
    v_accvgpr_read_b32 v57, a119
    v_mul_f32 v57, v57, v229
    v_accvgpr_write_b32 a119, v57
    v_accvgpr_read_b32 v57, a132
    v_mul_f32 v57, v57, v229
    v_accvgpr_write_b32 a132, v57
    v_accvgpr_read_b32 v57, a133
    v_mul_f32 v57, v57, v229
    v_accvgpr_write_b32 a133, v57
    v_accvgpr_read_b32 v57, a134
    v_mul_f32 v57, v57, v229
    v_accvgpr_write_b32 a134, v57
    v_accvgpr_read_b32 v57, a135
    v_mul_f32 v57, v57, v229
    v_accvgpr_write_b32 a135, v57
    v_accvgpr_read_b32 v57, a148
    v_mul_f32 v57, v57, v229
    v_accvgpr_write_b32 a148, v57
    v_accvgpr_read_b32 v57, a149
    v_mul_f32 v57, v57, v229
    v_accvgpr_write_b32 a149, v57
    v_accvgpr_read_b32 v57, a150
    v_mul_f32 v57, v57, v229
    v_accvgpr_write_b32 a150, v57
    v_accvgpr_read_b32 v57, a151
    v_mul_f32 v57, v57, v229
    v_accvgpr_write_b32 a151, v57
    v_accvgpr_read_b32 v57, a164
    v_mul_f32 v57, v57, v229
    v_accvgpr_write_b32 a164, v57
    v_accvgpr_read_b32 v57, a165
    v_mul_f32 v57, v57, v229
    v_accvgpr_write_b32 a165, v57
    v_accvgpr_read_b32 v57, a166
    v_mul_f32 v57, v57, v229
    v_accvgpr_write_b32 a166, v57
    v_accvgpr_read_b32 v57, a167
    v_mul_f32 v57, v57, v229
    v_accvgpr_write_b32 a167, v57
    v_accvgpr_read_b32 v57, a180
    v_mul_f32 v57, v57, v229
    v_accvgpr_write_b32 a180, v57
    v_accvgpr_read_b32 v57, a181
    v_mul_f32 v57, v57, v229
    v_accvgpr_write_b32 a181, v57
    v_accvgpr_read_b32 v57, a182
    v_mul_f32 v57, v57, v229
    v_accvgpr_write_b32 a182, v57
    v_accvgpr_read_b32 v57, a183
    v_mul_f32 v57, v57, v229
    v_accvgpr_write_b32 a183, v57
    v_max3_f32 v56, v200, v201, v202
    v_max3_f32 v56, v56, v203, v216
    v_max3_f32 v56, v56, v217, v218
    v_max3_f32 v56, v56, v219, v226
    v_mov_b32 v57, v56
    s_nop 0
    s_nop 0
    v_permlane32_swap_b32 v56, v57
    v_max_f32 v56, v56, v57
    v_mov_b32 v57, v56
    s_nop 0
    s_nop 0
    v_permlane16_swap_b32 v56, v57
    v_max_f32 v56, v56, v57
    v_sub_f32 v230, v226, v56
    v_exp_f32 v230, v230
    v_mov_b32 v226, v56
    v_mul_f32 v36, v36, v230
    v_sub_f32 v200, v200, v56
    v_sub_f32 v201, v201, v56
    v_sub_f32 v202, v202, v56
    v_sub_f32 v203, v203, v56
    v_exp_f32 v200, v200
    v_exp_f32 v201, v201
    v_exp_f32 v202, v202
    v_exp_f32 v203, v203
    v_add_f32 v36, v36, v200
    v_add_f32 v36, v36, v201
    v_add_f32 v36, v36, v202
    v_add_f32 v36, v36, v203
    v_sub_f32 v216, v216, v56
    v_sub_f32 v217, v217, v56
    v_sub_f32 v218, v218, v56
    v_sub_f32 v219, v219, v56
    v_exp_f32 v216, v216
    v_exp_f32 v217, v217
    v_exp_f32 v218, v218
    v_exp_f32 v219, v219
    v_add_f32 v36, v36, v216
    v_add_f32 v36, v36, v217
    v_add_f32 v36, v36, v218
    v_add_f32 v36, v36, v219
    v_cvt_pk_bf16_f32 v248, v200, v201
    v_cvt_pk_bf16_f32 v249, v202, v203
    v_cvt_pk_bf16_f32 v250, v216, v217
    v_cvt_pk_bf16_f32 v251, v218, v219
    v_accvgpr_read_b32 v57, a8
    v_mul_f32 v57, v57, v230
    v_accvgpr_write_b32 a8, v57
    v_accvgpr_read_b32 v57, a9
    v_mul_f32 v57, v57, v230
    v_accvgpr_write_b32 a9, v57
    v_accvgpr_read_b32 v57, a10
    v_mul_f32 v57, v57, v230
    v_accvgpr_write_b32 a10, v57
    v_accvgpr_read_b32 v57, a11
    v_mul_f32 v57, v57, v230
    v_accvgpr_write_b32 a11, v57
    v_accvgpr_read_b32 v57, a24
    v_mul_f32 v57, v57, v230
    v_accvgpr_write_b32 a24, v57
    v_accvgpr_read_b32 v57, a25
    v_mul_f32 v57, v57, v230
    v_accvgpr_write_b32 a25, v57
    v_accvgpr_read_b32 v57, a26
    v_mul_f32 v57, v57, v230
    v_accvgpr_write_b32 a26, v57
    v_accvgpr_read_b32 v57, a27
    v_mul_f32 v57, v57, v230
    v_accvgpr_write_b32 a27, v57
    v_accvgpr_read_b32 v57, a40
    v_mul_f32 v57, v57, v230
    v_accvgpr_write_b32 a40, v57
    v_accvgpr_read_b32 v57, a41
    v_mul_f32 v57, v57, v230
    v_accvgpr_write_b32 a41, v57
    v_accvgpr_read_b32 v57, a42
    v_mul_f32 v57, v57, v230
    v_accvgpr_write_b32 a42, v57
    v_accvgpr_read_b32 v57, a43
    v_mul_f32 v57, v57, v230
    v_accvgpr_write_b32 a43, v57
    v_accvgpr_read_b32 v57, a56
    v_mul_f32 v57, v57, v230
    v_accvgpr_write_b32 a56, v57
    v_accvgpr_read_b32 v57, a57
    v_mul_f32 v57, v57, v230
    v_accvgpr_write_b32 a57, v57
    v_accvgpr_read_b32 v57, a58
    v_mul_f32 v57, v57, v230
    v_accvgpr_write_b32 a58, v57
    v_accvgpr_read_b32 v57, a59
    v_mul_f32 v57, v57, v230
    v_accvgpr_write_b32 a59, v57
    v_accvgpr_read_b32 v57, a72
    v_mul_f32 v57, v57, v230
    v_accvgpr_write_b32 a72, v57
    v_accvgpr_read_b32 v57, a73
    v_mul_f32 v57, v57, v230
    v_accvgpr_write_b32 a73, v57
    v_accvgpr_read_b32 v57, a74
    v_mul_f32 v57, v57, v230
    v_accvgpr_write_b32 a74, v57
    v_accvgpr_read_b32 v57, a75
    v_mul_f32 v57, v57, v230
    v_accvgpr_write_b32 a75, v57
    v_accvgpr_read_b32 v57, a88
    v_mul_f32 v57, v57, v230
    v_accvgpr_write_b32 a88, v57
    v_accvgpr_read_b32 v57, a89
    v_mul_f32 v57, v57, v230
    v_accvgpr_write_b32 a89, v57
    v_accvgpr_read_b32 v57, a90
    v_mul_f32 v57, v57, v230
    v_accvgpr_write_b32 a90, v57
    v_accvgpr_read_b32 v57, a91
    v_mul_f32 v57, v57, v230
    v_accvgpr_write_b32 a91, v57
    v_accvgpr_read_b32 v57, a104
    v_mul_f32 v57, v57, v230
    v_accvgpr_write_b32 a104, v57
    v_accvgpr_read_b32 v57, a105
    v_mul_f32 v57, v57, v230
    v_accvgpr_write_b32 a105, v57
    v_accvgpr_read_b32 v57, a106
    v_mul_f32 v57, v57, v230
    v_accvgpr_write_b32 a106, v57
    v_accvgpr_read_b32 v57, a107
    v_mul_f32 v57, v57, v230
    v_accvgpr_write_b32 a107, v57
    v_accvgpr_read_b32 v57, a120
    v_mul_f32 v57, v57, v230
    v_accvgpr_write_b32 a120, v57
    v_accvgpr_read_b32 v57, a121
    v_mul_f32 v57, v57, v230
    v_accvgpr_write_b32 a121, v57
    v_accvgpr_read_b32 v57, a122
    v_mul_f32 v57, v57, v230
    v_accvgpr_write_b32 a122, v57
    v_accvgpr_read_b32 v57, a123
    v_mul_f32 v57, v57, v230
    v_accvgpr_write_b32 a123, v57
    v_accvgpr_read_b32 v57, a136
    v_mul_f32 v57, v57, v230
    v_accvgpr_write_b32 a136, v57
    v_accvgpr_read_b32 v57, a137
    v_mul_f32 v57, v57, v230
    v_accvgpr_write_b32 a137, v57
    v_accvgpr_read_b32 v57, a138
    v_mul_f32 v57, v57, v230
    v_accvgpr_write_b32 a138, v57
    v_accvgpr_read_b32 v57, a139
    v_mul_f32 v57, v57, v230
    v_accvgpr_write_b32 a139, v57
    v_accvgpr_read_b32 v57, a152
    v_mul_f32 v57, v57, v230
    v_accvgpr_write_b32 a152, v57
    v_accvgpr_read_b32 v57, a153
    v_mul_f32 v57, v57, v230
    v_accvgpr_write_b32 a153, v57
    v_accvgpr_read_b32 v57, a154
    v_mul_f32 v57, v57, v230
    v_accvgpr_write_b32 a154, v57
    v_accvgpr_read_b32 v57, a155
    v_mul_f32 v57, v57, v230
    v_accvgpr_write_b32 a155, v57
    v_accvgpr_read_b32 v57, a168
    v_mul_f32 v57, v57, v230
    v_accvgpr_write_b32 a168, v57
    v_accvgpr_read_b32 v57, a169
    v_mul_f32 v57, v57, v230
    v_accvgpr_write_b32 a169, v57
    v_accvgpr_read_b32 v57, a170
    v_mul_f32 v57, v57, v230
    v_accvgpr_write_b32 a170, v57
    v_accvgpr_read_b32 v57, a171
    v_mul_f32 v57, v57, v230
    v_accvgpr_write_b32 a171, v57
    v_accvgpr_read_b32 v57, a184
    v_mul_f32 v57, v57, v230
    v_accvgpr_write_b32 a184, v57
    v_accvgpr_read_b32 v57, a185
    v_mul_f32 v57, v57, v230
    v_accvgpr_write_b32 a185, v57
    v_accvgpr_read_b32 v57, a186
    v_mul_f32 v57, v57, v230
    v_accvgpr_write_b32 a186, v57
    v_accvgpr_read_b32 v57, a187
    v_mul_f32 v57, v57, v230
    v_accvgpr_write_b32 a187, v57
    v_max3_f32 v56, v204, v205, v206
    v_max3_f32 v56, v56, v207, v220
    v_max3_f32 v56, v56, v221, v222
    v_max3_f32 v56, v56, v223, v227
    v_mov_b32 v57, v56
    s_nop 0
    s_nop 0
    v_permlane32_swap_b32 v56, v57
    v_max_f32 v56, v56, v57
    v_mov_b32 v57, v56
    s_nop 0
    s_nop 0
    v_permlane16_swap_b32 v56, v57
    v_max_f32 v56, v56, v57
    v_sub_f32 v231, v227, v56
    v_exp_f32 v231, v231
    v_mov_b32 v227, v56
    v_mul_f32 v37, v37, v231
    v_sub_f32 v204, v204, v56
    v_sub_f32 v205, v205, v56
    v_sub_f32 v206, v206, v56
    v_sub_f32 v207, v207, v56
    v_exp_f32 v204, v204
    v_exp_f32 v205, v205
    v_exp_f32 v206, v206
    v_exp_f32 v207, v207
    v_add_f32 v37, v37, v204
    v_add_f32 v37, v37, v205
    v_add_f32 v37, v37, v206
    v_add_f32 v37, v37, v207
    v_sub_f32 v220, v220, v56
    v_sub_f32 v221, v221, v56
    v_sub_f32 v222, v222, v56
    v_sub_f32 v223, v223, v56
    v_exp_f32 v220, v220
    v_exp_f32 v221, v221
    v_exp_f32 v222, v222
    v_exp_f32 v223, v223
    v_add_f32 v37, v37, v220
    v_add_f32 v37, v37, v221
    v_add_f32 v37, v37, v222
    v_add_f32 v37, v37, v223
    v_cvt_pk_bf16_f32 v252, v204, v205
    v_cvt_pk_bf16_f32 v253, v206, v207
    v_cvt_pk_bf16_f32 v254, v220, v221
    v_cvt_pk_bf16_f32 v255, v222, v223
    v_accvgpr_read_b32 v57, a12
    v_mul_f32 v57, v57, v231
    v_accvgpr_write_b32 a12, v57
    v_accvgpr_read_b32 v57, a13
    v_mul_f32 v57, v57, v231
    v_accvgpr_write_b32 a13, v57
    v_accvgpr_read_b32 v57, a14
    v_mul_f32 v57, v57, v231
    v_accvgpr_write_b32 a14, v57
    v_accvgpr_read_b32 v57, a15
    v_mul_f32 v57, v57, v231
    v_accvgpr_write_b32 a15, v57
    v_accvgpr_read_b32 v57, a28
    v_mul_f32 v57, v57, v231
    v_accvgpr_write_b32 a28, v57
    v_accvgpr_read_b32 v57, a29
    v_mul_f32 v57, v57, v231
    v_accvgpr_write_b32 a29, v57
    v_accvgpr_read_b32 v57, a30
    v_mul_f32 v57, v57, v231
    v_accvgpr_write_b32 a30, v57
    v_accvgpr_read_b32 v57, a31
    v_mul_f32 v57, v57, v231
    v_accvgpr_write_b32 a31, v57
    v_accvgpr_read_b32 v57, a44
    v_mul_f32 v57, v57, v231
    v_accvgpr_write_b32 a44, v57
    v_accvgpr_read_b32 v57, a45
    v_mul_f32 v57, v57, v231
    v_accvgpr_write_b32 a45, v57
    v_accvgpr_read_b32 v57, a46
    v_mul_f32 v57, v57, v231
    v_accvgpr_write_b32 a46, v57
    v_accvgpr_read_b32 v57, a47
    v_mul_f32 v57, v57, v231
    v_accvgpr_write_b32 a47, v57
    v_accvgpr_read_b32 v57, a60
    v_mul_f32 v57, v57, v231
    v_accvgpr_write_b32 a60, v57
    v_accvgpr_read_b32 v57, a61
    v_mul_f32 v57, v57, v231
    v_accvgpr_write_b32 a61, v57
    v_accvgpr_read_b32 v57, a62
    v_mul_f32 v57, v57, v231
    v_accvgpr_write_b32 a62, v57
    v_accvgpr_read_b32 v57, a63
    v_mul_f32 v57, v57, v231
    v_accvgpr_write_b32 a63, v57
    v_accvgpr_read_b32 v57, a76
    v_mul_f32 v57, v57, v231
    v_accvgpr_write_b32 a76, v57
    v_accvgpr_read_b32 v57, a77
    v_mul_f32 v57, v57, v231
    v_accvgpr_write_b32 a77, v57
    v_accvgpr_read_b32 v57, a78
    v_mul_f32 v57, v57, v231
    v_accvgpr_write_b32 a78, v57
    v_accvgpr_read_b32 v57, a79
    v_mul_f32 v57, v57, v231
    v_accvgpr_write_b32 a79, v57
    v_accvgpr_read_b32 v57, a92
    v_mul_f32 v57, v57, v231
    v_accvgpr_write_b32 a92, v57
    v_accvgpr_read_b32 v57, a93
    v_mul_f32 v57, v57, v231
    v_accvgpr_write_b32 a93, v57
    v_accvgpr_read_b32 v57, a94
    v_mul_f32 v57, v57, v231
    v_accvgpr_write_b32 a94, v57
    v_accvgpr_read_b32 v57, a95
    v_mul_f32 v57, v57, v231
    v_accvgpr_write_b32 a95, v57
    v_accvgpr_read_b32 v57, a108
    v_mul_f32 v57, v57, v231
    v_accvgpr_write_b32 a108, v57
    v_accvgpr_read_b32 v57, a109
    v_mul_f32 v57, v57, v231
    v_accvgpr_write_b32 a109, v57
    v_accvgpr_read_b32 v57, a110
    v_mul_f32 v57, v57, v231
    v_accvgpr_write_b32 a110, v57
    v_accvgpr_read_b32 v57, a111
    v_mul_f32 v57, v57, v231
    v_accvgpr_write_b32 a111, v57
    v_accvgpr_read_b32 v57, a124
    v_mul_f32 v57, v57, v231
    v_accvgpr_write_b32 a124, v57
    v_accvgpr_read_b32 v57, a125
    v_mul_f32 v57, v57, v231
    v_accvgpr_write_b32 a125, v57
    v_accvgpr_read_b32 v57, a126
    v_mul_f32 v57, v57, v231
    v_accvgpr_write_b32 a126, v57
    v_accvgpr_read_b32 v57, a127
    v_mul_f32 v57, v57, v231
    v_accvgpr_write_b32 a127, v57
    v_accvgpr_read_b32 v57, a140
    v_mul_f32 v57, v57, v231
    v_accvgpr_write_b32 a140, v57
    v_accvgpr_read_b32 v57, a141
    v_mul_f32 v57, v57, v231
    v_accvgpr_write_b32 a141, v57
    v_accvgpr_read_b32 v57, a142
    v_mul_f32 v57, v57, v231
    v_accvgpr_write_b32 a142, v57
    v_accvgpr_read_b32 v57, a143
    v_mul_f32 v57, v57, v231
    v_accvgpr_write_b32 a143, v57
    v_accvgpr_read_b32 v57, a156
    v_mul_f32 v57, v57, v231
    v_accvgpr_write_b32 a156, v57
    v_accvgpr_read_b32 v57, a157
    v_mul_f32 v57, v57, v231
    v_accvgpr_write_b32 a157, v57
    v_accvgpr_read_b32 v57, a158
    v_mul_f32 v57, v57, v231
    v_accvgpr_write_b32 a158, v57
    v_accvgpr_read_b32 v57, a159
    v_mul_f32 v57, v57, v231
    v_accvgpr_write_b32 a159, v57
    v_accvgpr_read_b32 v57, a172
    v_mul_f32 v57, v57, v231
    v_accvgpr_write_b32 a172, v57
    v_accvgpr_read_b32 v57, a173
    v_mul_f32 v57, v57, v231
    v_accvgpr_write_b32 a173, v57
    v_accvgpr_read_b32 v57, a174
    v_mul_f32 v57, v57, v231
    v_accvgpr_write_b32 a174, v57
    v_accvgpr_read_b32 v57, a175
    v_mul_f32 v57, v57, v231
    v_accvgpr_write_b32 a175, v57
    v_accvgpr_read_b32 v57, a188
    v_mul_f32 v57, v57, v231
    v_accvgpr_write_b32 a188, v57
    v_accvgpr_read_b32 v57, a189
    v_mul_f32 v57, v57, v231
    v_accvgpr_write_b32 a189, v57
    v_accvgpr_read_b32 v57, a190
    v_mul_f32 v57, v57, v231
    v_accvgpr_write_b32 a190, v57
    v_accvgpr_read_b32 v57, a191
    v_mul_f32 v57, v57, v231
    v_accvgpr_write_b32 a191, v57
    s_add_u32 m0, s62, 0
    s_add_u32 s61, s60, 0
    buffer_load_dwordx4 v53, s[28:31], s61 offen lds
    s_add_u32 m0, s62, 1024
    s_add_u32 s61, s60, 3072
    buffer_load_dwordx4 v53, s[28:31], s61 offen lds
    s_add_u32 m0, s62, 2048
    s_add_u32 s61, s60, 6144
    buffer_load_dwordx4 v53, s[28:31], s61 offen lds
    s_add_u32 m0, s62, 3072
    s_add_u32 s61, s60, 9216
    buffer_load_dwordx4 v53, s[28:31], s61 offen lds
    s_waitcnt vmcnt(0)
    ds_read_b64_tr_b16 v[232:233], v54 offset:0
    ds_read_b64_tr_b16 v[234:235], v54 offset:2048
    ds_read_b64_tr_b16 v[236:237], v54 offset:32
    ds_read_b64_tr_b16 v[238:239], v54 offset:2080
    s_waitcnt lgkmcnt(0)
    v_mfma_f32_16x16x32_bf16 a[0:3], v[232:235], v[240:243], a[0:3]
    v_mfma_f32_16x16x32_bf16 a[4:7], v[232:235], v[244:247], a[4:7]
    v_mfma_f32_16x16x32_bf16 a[8:11], v[232:235], v[248:251], a[8:11]
    v_mfma_f32_16x16x32_bf16 a[12:15], v[232:235], v[252:255], a[12:15]
    v_mfma_f32_16x16x32_bf16 a[16:19], v[236:239], v[240:243], a[16:19]
    v_mfma_f32_16x16x32_bf16 a[20:23], v[236:239], v[244:247], a[20:23]
    v_mfma_f32_16x16x32_bf16 a[24:27], v[236:239], v[248:251], a[24:27]
    v_mfma_f32_16x16x32_bf16 a[28:31], v[236:239], v[252:255], a[28:31]
    s_nop 7
    ds_read_b64_tr_b16 v[232:233], v54 offset:64
    ds_read_b64_tr_b16 v[234:235], v54 offset:2112
    ds_read_b64_tr_b16 v[236:237], v54 offset:96
    ds_read_b64_tr_b16 v[238:239], v54 offset:2144
    s_waitcnt lgkmcnt(0)
    v_mfma_f32_16x16x32_bf16 a[32:35], v[232:235], v[240:243], a[32:35]
    v_mfma_f32_16x16x32_bf16 a[36:39], v[232:235], v[244:247], a[36:39]
    v_mfma_f32_16x16x32_bf16 a[40:43], v[232:235], v[248:251], a[40:43]
    v_mfma_f32_16x16x32_bf16 a[44:47], v[232:235], v[252:255], a[44:47]
    v_mfma_f32_16x16x32_bf16 a[48:51], v[236:239], v[240:243], a[48:51]
    v_mfma_f32_16x16x32_bf16 a[52:55], v[236:239], v[244:247], a[52:55]
    v_mfma_f32_16x16x32_bf16 a[56:59], v[236:239], v[248:251], a[56:59]
    v_mfma_f32_16x16x32_bf16 a[60:63], v[236:239], v[252:255], a[60:63]
    s_nop 7
    s_add_u32 m0, s62, 0
    s_add_u32 s61, s60, 128
    buffer_load_dwordx4 v53, s[28:31], s61 offen lds
    s_add_u32 m0, s62, 1024
    s_add_u32 s61, s60, 3200
    buffer_load_dwordx4 v53, s[28:31], s61 offen lds
    s_add_u32 m0, s62, 2048
    s_add_u32 s61, s60, 6272
    buffer_load_dwordx4 v53, s[28:31], s61 offen lds
    s_add_u32 m0, s62, 3072
    s_add_u32 s61, s60, 9344
    buffer_load_dwordx4 v53, s[28:31], s61 offen lds
    s_waitcnt vmcnt(0)
    ds_read_b64_tr_b16 v[232:233], v54 offset:0
    ds_read_b64_tr_b16 v[234:235], v54 offset:2048
    ds_read_b64_tr_b16 v[236:237], v54 offset:32
    ds_read_b64_tr_b16 v[238:239], v54 offset:2080
    s_waitcnt lgkmcnt(0)
    v_mfma_f32_16x16x32_bf16 a[64:67], v[232:235], v[240:243], a[64:67]
    v_mfma_f32_16x16x32_bf16 a[68:71], v[232:235], v[244:247], a[68:71]
    v_mfma_f32_16x16x32_bf16 a[72:75], v[232:235], v[248:251], a[72:75]
    v_mfma_f32_16x16x32_bf16 a[76:79], v[232:235], v[252:255], a[76:79]
    v_mfma_f32_16x16x32_bf16 a[80:83], v[236:239], v[240:243], a[80:83]
    v_mfma_f32_16x16x32_bf16 a[84:87], v[236:239], v[244:247], a[84:87]
    v_mfma_f32_16x16x32_bf16 a[88:91], v[236:239], v[248:251], a[88:91]
    v_mfma_f32_16x16x32_bf16 a[92:95], v[236:239], v[252:255], a[92:95]
    s_nop 7
    ds_read_b64_tr_b16 v[232:233], v54 offset:64
    ds_read_b64_tr_b16 v[234:235], v54 offset:2112
    ds_read_b64_tr_b16 v[236:237], v54 offset:96
    ds_read_b64_tr_b16 v[238:239], v54 offset:2144
    s_waitcnt lgkmcnt(0)
    v_mfma_f32_16x16x32_bf16 a[96:99], v[232:235], v[240:243], a[96:99]
    v_mfma_f32_16x16x32_bf16 a[100:103], v[232:235], v[244:247], a[100:103]
    v_mfma_f32_16x16x32_bf16 a[104:107], v[232:235], v[248:251], a[104:107]
    v_mfma_f32_16x16x32_bf16 a[108:111], v[232:235], v[252:255], a[108:111]
    v_mfma_f32_16x16x32_bf16 a[112:115], v[236:239], v[240:243], a[112:115]
    v_mfma_f32_16x16x32_bf16 a[116:119], v[236:239], v[244:247], a[116:119]
    v_mfma_f32_16x16x32_bf16 a[120:123], v[236:239], v[248:251], a[120:123]
    v_mfma_f32_16x16x32_bf16 a[124:127], v[236:239], v[252:255], a[124:127]
    s_nop 7
    s_add_u32 m0, s62, 0
    s_add_u32 s61, s60, 256
    buffer_load_dwordx4 v53, s[28:31], s61 offen lds
    s_add_u32 m0, s62, 1024
    s_add_u32 s61, s60, 3328
    buffer_load_dwordx4 v53, s[28:31], s61 offen lds
    s_add_u32 m0, s62, 2048
    s_add_u32 s61, s60, 6400
    buffer_load_dwordx4 v53, s[28:31], s61 offen lds
    s_add_u32 m0, s62, 3072
    s_add_u32 s61, s60, 9472
    buffer_load_dwordx4 v53, s[28:31], s61 offen lds
    s_waitcnt vmcnt(0)
    ds_read_b64_tr_b16 v[232:233], v54 offset:0
    ds_read_b64_tr_b16 v[234:235], v54 offset:2048
    ds_read_b64_tr_b16 v[236:237], v54 offset:32
    ds_read_b64_tr_b16 v[238:239], v54 offset:2080
    s_waitcnt lgkmcnt(0)
    v_mfma_f32_16x16x32_bf16 a[128:131], v[232:235], v[240:243], a[128:131]
    v_mfma_f32_16x16x32_bf16 a[132:135], v[232:235], v[244:247], a[132:135]
    v_mfma_f32_16x16x32_bf16 a[136:139], v[232:235], v[248:251], a[136:139]
    v_mfma_f32_16x16x32_bf16 a[140:143], v[232:235], v[252:255], a[140:143]
    v_mfma_f32_16x16x32_bf16 a[144:147], v[236:239], v[240:243], a[144:147]
    v_mfma_f32_16x16x32_bf16 a[148:151], v[236:239], v[244:247], a[148:151]
    v_mfma_f32_16x16x32_bf16 a[152:155], v[236:239], v[248:251], a[152:155]
    v_mfma_f32_16x16x32_bf16 a[156:159], v[236:239], v[252:255], a[156:159]
    s_nop 7
    ds_read_b64_tr_b16 v[232:233], v54 offset:64
    ds_read_b64_tr_b16 v[234:235], v54 offset:2112
    ds_read_b64_tr_b16 v[236:237], v54 offset:96
    ds_read_b64_tr_b16 v[238:239], v54 offset:2144
    s_waitcnt lgkmcnt(0)
    v_mfma_f32_16x16x32_bf16 a[160:163], v[232:235], v[240:243], a[160:163]
    v_mfma_f32_16x16x32_bf16 a[164:167], v[232:235], v[244:247], a[164:167]
    v_mfma_f32_16x16x32_bf16 a[168:171], v[232:235], v[248:251], a[168:171]
    v_mfma_f32_16x16x32_bf16 a[172:175], v[232:235], v[252:255], a[172:175]
    v_mfma_f32_16x16x32_bf16 a[176:179], v[236:239], v[240:243], a[176:179]
    v_mfma_f32_16x16x32_bf16 a[180:183], v[236:239], v[244:247], a[180:183]
    v_mfma_f32_16x16x32_bf16 a[184:187], v[236:239], v[248:251], a[184:187]
    v_mfma_f32_16x16x32_bf16 a[188:191], v[236:239], v[252:255], a[188:191]
    s_nop 7
    s_nop 7
    s_add_u32 s60, s60, 12288
    s_cmp_lt_u32 s60, 196608
    s_cbranch_scc1 SAFE_LOOP
    v_mov_b32 v224, 0
    v_mov_b32 v225, 0
    v_mov_b32 v226, 0
    v_mov_b32 v227, 0
    v_mov_b32 v228, 0
    v_mov_b32 v229, 0
    v_mov_b32 v230, 0
    v_mov_b32 v231, 0
    v_mov_b32 v232, 0
    v_mov_b32 v233, 0
    v_mov_b32 v234, 0
    v_mov_b32 v235, 0
    v_mov_b32 v236, 0
    v_mov_b32 v237, 0
    v_mov_b32 v238, 0
    v_mov_b32 v239, 0
    s_add_u32 s60, s77, 450560
    s_add_u32 m0, s7, 147456
    s_nop 0
    buffer_load_dwordx4 v1, s[16:19], s60 offen offset:0 sc1 lds
    buffer_load_dwordx4 v1, s[16:19], s60 offen offset:1024 sc1 lds
    buffer_load_dwordx4 v1, s[16:19], s60 offen offset:2048 sc1 lds
    buffer_load_dwordx4 v1, s[16:19], s60 offen offset:3072 sc1 lds
    s_waitcnt vmcnt(0)
    s_mov_b32 m0, s100
    s_nop 1
    s_branch SAFE_BACK
.section .rodata,"a"
.p2align 6
.amdhsa_kernel recurrent_scan__sliding_block_cached__glu_gated_bilinear__prompt_kernel
  .amdhsa_next_free_vgpr 512
  .amdhsa_next_free_sgpr 102
  .amdhsa_accum_offset 256
  .amdhsa_group_segment_fixed_size 0
  .amdhsa_kernarg_size 96
  .amdhsa_user_sgpr_count 2
  .amdhsa_user_sgpr_kernarg_segment_ptr 1
  .amdhsa_system_sgpr_workgroup_id_x 1
.end_amdhsa_kernel
```
